```python
import torch

def _softmax(x, axis=-1):
    return torch.softmax(x, dim=axis)
def _gelu(x):
    return torch.nn.functional.gelu(x, approximate="tanh")
def _silu(x):
    return torch.nn.functional.silu(x)
def _sigmoid(x):
    return torch.sigmoid(x)
def _layernorm(x, axis=-1, eps=1e-5):
    m = x.mean(dim=axis, keepdim=True)
    v = x.var(dim=axis, keepdim=True, unbiased=False)
    return (x - m) / torch.sqrt(v + eps)
def _scatter_add(tgt, idx, src, axis=0):
    return tgt.clone().index_add_(axis, idx, src)
def _segment_sum(src, seg, n):
    out = torch.zeros((n,) + src.shape[1:], dtype=src.dtype)
    return out.index_add_(0, seg, src)
def _pad(x, pw):
    flat = tuple(v for pair in reversed(pw) for v in pair)
    return torch.nn.functional.pad(x, flat)

kernel_name = 'concat_heads__mha_block_cached__mha_block_cached__near_ridge'

def setup_inputs():

    _w = (lambda a: (lambda t: t.to(torch.bfloat16) if t.is_floating_point() else t)(torch.as_tensor(a)))
    def _A_setup():
        B, Sq, D = 16, 128, 512
        H, Sk, Dh = 32, 512, 128
        return {
            "x": _w((lambda *s: torch.randn(*s, dtype=torch.bfloat16) * 0.8)(B, Sq, D)),
            "k_cache": _w((lambda *s: torch.randn(*s, dtype=torch.bfloat16) * 0.8)(B, H, Sk, Dh)),
            "v_cache": _w((lambda *s: torch.randn(*s, dtype=torch.bfloat16) * 0.05)(B, H, Sk, Dh)),
            "wq": _w((lambda *s: torch.randn(*s, dtype=torch.bfloat16) * 0.8)(D, H * Dh) * (D ** -0.5)),
            "wo": _w((lambda *s: torch.randn(*s, dtype=torch.bfloat16) * 0.05)(H * Dh, D) * ((H * Dh) ** -0.5)),
        }
    _A_in = _A_setup()

    def _B_setup():
        B, Sq, D = 16, 128, 512
        H, Sk, Dh = 32, 512, 128
        return {
            "x": _w((lambda *s: torch.randn(*s, dtype=torch.bfloat16) * 0.8)(B, Sq, D)),
            "k_cache": _w((lambda *s: torch.randn(*s, dtype=torch.bfloat16) * 0.8)(B, H, Sk, Dh)),
            "v_cache": _w((lambda *s: torch.randn(*s, dtype=torch.bfloat16) * 0.05)(B, H, Sk, Dh)),
            "wq": _w((lambda *s: torch.randn(*s, dtype=torch.bfloat16) * 0.8)(D, H * Dh) * (D ** -0.5)),
            "wo": _w((lambda *s: torch.randn(*s, dtype=torch.bfloat16) * 0.05)(H * Dh, D) * ((H * Dh) ** -0.5)),
        }
    _B_in = _B_setup()

    return {
        "A_x": _A_in["x"],
        "A_k_cache": _A_in["k_cache"],
        "A_v_cache": _A_in["v_cache"],
        "A_wq": _A_in["wq"],
        "A_wo": _A_in["wo"],
        "B_x": _B_in["x"],
        "B_k_cache": _B_in["k_cache"],
        "B_v_cache": _B_in["v_cache"],
        "B_wq": _B_in["wq"],
        "B_wo": _B_in["wo"],
    }

def reference(A_x, A_k_cache, A_v_cache, A_wq, A_wo, B_x, B_k_cache, B_v_cache, B_wq, B_wo):
    def _A_ref(x, k_cache, v_cache, wq, wo):
        B, Sq, D = x.shape
        H, Dh = 32, 128
        q = (lambda x, *d: x.permute(*d))((x @ wq).reshape(B, Sq, H, Dh), 0, 2, 1, 3)
        scores = torch.einsum("bhqd,bhkd->bhqk", q, k_cache) * (Dh ** -0.5)
        p = _softmax(scores, axis=-1)
        o = torch.einsum("bhqk,bhkd->bhqd", p, v_cache)
        return (lambda x, *d: x.permute(*d))(o, 0, 2, 1, 3).reshape(B, Sq, H * Dh) @ wo

    def _B_ref(x, k_cache, v_cache, wq, wo):
        B, Sq, D = x.shape
        H, Dh = 32, 128
        q = (lambda x, *d: x.permute(*d))((x @ wq).reshape(B, Sq, H, Dh), 0, 2, 1, 3)
        scores = torch.einsum("bhqd,bhkd->bhqk", q, k_cache) * (Dh ** -0.5)
        p = _softmax(scores, axis=-1)
        o = torch.einsum("bhqk,bhkd->bhqd", p, v_cache)
        return (lambda x, *d: x.permute(*d))(o, 0, 2, 1, 3).reshape(B, Sq, H * Dh) @ wo

    a = _A_ref(A_x, A_k_cache, A_v_cache, A_wq, A_wo)
    b = _B_ref(B_x, B_k_cache, B_v_cache, B_wq, B_wo)
    return torch.concatenate([a, b], axis=-1)
```

```asm
; @launch grid=(256,1,1) block=(256,1,1) lds=163840
.amdgcn_target "amdgcn-amd-amdhsa--gfx950"
.text
.globl concat_heads__mha_block_cached__mha_block_cached__near_ridge_kernel
.p2align 8
.type concat_heads__mha_block_cached__mha_block_cached__near_ridge_kernel,@function
concat_heads__mha_block_cached__mha_block_cached__near_ridge_kernel:
  s_cmp_ge_u32 s2, 256
  s_cbranch_scc1 L_end1
  s_bfe_u32 s5, s2, 0x10002
  s_mul_i32 s6, s5, 40
  s_add_u32 s6, s0, s6
  s_addc_u32 s7, s1, 0
  s_load_dwordx4 s[48:51], s[6:7], 0
  s_load_dwordx4 s[52:55], s[6:7], 16
  v_lshrrev_b32 v1, 6, v0
  v_and_b32 v2, 63, v0
  v_lshl_add_u32 v20, v1, 4, v2
  v_lshlrev_b32 v20, 7, v20
  s_getpc_b64 s[62:63]
  s_mov_b64 exec, 0xffff
  global_load_dword v21, v20, s[62:63] offset:64 nt
  s_mov_b64 exec, -1
  s_load_dwordx2 s[96:97], s[6:7], 32
  s_load_dwordx2 s[64:65], s[0:1], 96
  s_load_dwordx2 s[6:7], s[0:1], 80
  s_load_dwordx2 s[0:1], s[0:1], 88
  v_readfirstlane_b32 s68, v1
  s_lshr_b32 s4, s2, 3
  s_lshr_b32 s60, s4, 1
  s_and_b32 s62, s2, 3
  s_and_b32 s63, s4, 1
  s_lshl_b32 s56, s62, 3
  s_add_u32 s56, s56, s63
  s_lshl_b32 s57, s63, 2
  s_add_u32 s57, s57, s62
  s_add_u32 s58, s57, s60
  v_lshrrev_b32 v8, 5, v2
  v_bfe_u32 v9, v2, 4, 1
  v_lshl_add_u32 v4, v8, 2, v9
  v_and_b32 v5, 7, v2
  v_xor_b32 v5, v5, v4
  v_lshlrev_b32 v5, 4, v5
  v_lshrrev_b32 v4, 3, v2
  v_lshl_add_u32 v4, v1, 5, v4
  v_lshl_add_u32 v5, v4, 10, v5
  s_lshl_b32 s59, s60, 17
  v_add_u32 v238, s59, v5
  v_and_b32 v7, 1, v1
  v_lshrrev_b32 v3, 4, v2
  v_bfe_u32 v4, v2, 2, 2
  v_and_b32 v5, 3, v2
  v_lshlrev_b32 v6, 1, v7
  v_xor_b32 v5, v5, v6
  v_lshlrev_b32 v5, 4, v5
  v_lshl_add_u32 v6, v3, 6, v5
  v_lshl_add_u32 v5, v1, 4, v4
  v_lshl_add_u32 v5, v5, 13, v6
  s_lshl_b32 s59, s56, 8
  v_add_u32 v239, s59, v5
  s_and_b32 s72, s58, 7
  s_lshl_b32 s72, s72, 7
  s_lshl_b32 s80, s72, 12
  s_lshl_b32 s68, s68, 12
  s_mov_b32 s18, 2097152
  s_mov_b32 s19, 0x20000
  s_mov_b32 s34, 4194304
  s_mov_b32 s35, 0x20000
  s_mov_b32 s22, 2089984
  s_mov_b32 s23, 0x20000
  s_mov_b32 s38, 4162560
  s_mov_b32 s39, 0x20000
  s_mov_b32 s26, 2082816
  s_mov_b32 s27, 0x20000
  s_mov_b32 s42, 4130816
  s_mov_b32 s43, 0x20000
  s_mov_b32 s30, 2075648
  s_mov_b32 s31, 0x20000
  s_mov_b32 s46, 4099072
  s_mov_b32 s47, 0x20000
  s_waitcnt lgkmcnt(0)
  s_mov_b32 s32, s54
  s_mov_b32 s33, s55
  s_add_u32 s36, s54, 31744
  s_addc_u32 s37, s55, 0
  s_add_u32 s40, s54, 63488
  s_addc_u32 s41, s55, 0
  s_add_u32 s44, s54, 95232
  s_addc_u32 s45, s55, 0
  s_mov_b32 s16, s48
  s_mov_b32 s17, s49
  s_add_u32 s20, s48, 7168
  s_addc_u32 s21, s49, 0
  s_add_u32 s24, s48, 14336
  s_addc_u32 s25, s49, 0
  s_add_u32 s28, s48, 21504
  s_addc_u32 s29, s49, 0
  s_add_u32 m0, s68, 98304
  s_nop 0
  buffer_load_dwordx4 v239, s[32:35], s80 offen nt lds
  buffer_load_dwordx4 v239, s[36:39], s80 offen offset:1024 nt lds
  buffer_load_dwordx4 v239, s[40:43], s80 offen offset:2048 nt lds
  buffer_load_dwordx4 v239, s[44:47], s80 offen offset:3072 nt lds
  s_add_u32 m0, s68, 32768
  s_nop 0
  buffer_load_dwordx4 v238, s[16:19], s72 offen lds
  buffer_load_dwordx4 v238, s[20:23], s72 offen offset:1024 lds
  buffer_load_dwordx4 v238, s[24:27], s72 offen offset:2048 lds
  buffer_load_dwordx4 v238, s[28:31], s72 offen offset:3072 lds
  s_add_u32 s73, s72, 0x80
  s_and_b32 s73, s73, 0x380
  s_lshl_b32 s81, s73, 12
  s_add_u32 s74, s73, 0x80
  s_and_b32 s74, s74, 0x380
  s_lshl_b32 s82, s74, 12
  s_add_u32 s75, s74, 0x80
  s_and_b32 s75, s75, 0x380
  s_lshl_b32 s83, s75, 12
  v_lshlrev_b32 v17, 6, v4
  v_and_b32 v16, 3, v2
  v_lshl_add_u32 v17, v16, 3, v17
  v_lshl_add_u32 v17, v9, 5, v17
  v_lshl_add_u32 v16, v3, 12, v17
  v_add_u32 v247, 98304, v16
  v_xor_b32 v248, 32, v247
  v_and_b32 v15, 4, v2
  v_bfe_u32 v16, v2, 1, 1
  v_or_b32 v15, v15, v16
  v_lshlrev_b32 v16, 1, v3
  v_xor_b32 v15, v15, v16
  v_lshlrev_b32 v15, 4, v15
  v_and_b32 v16, 15, v2
  v_lshl_add_u32 v15, v16, 7, v15
  v_lshl_add_u32 v15, v1, 12, v15
  v_add_u32 v243, 32768, v15
  v_xor_b32 v244, 16, v243
  s_nop 1
  s_add_u32 m0, s68, 114688
  s_nop 0
  buffer_load_dwordx4 v239, s[32:35], s81 offen nt lds
  buffer_load_dwordx4 v239, s[36:39], s81 offen offset:1024 nt lds
  buffer_load_dwordx4 v239, s[40:43], s81 offen offset:2048 nt lds
  buffer_load_dwordx4 v239, s[44:47], s81 offen offset:3072 nt lds
  s_add_u32 m0, s68, 49152
  s_nop 0
  buffer_load_dwordx4 v238, s[16:19], s73 offen lds
  buffer_load_dwordx4 v238, s[20:23], s73 offen offset:1024 lds
  buffer_load_dwordx4 v238, s[24:27], s73 offen offset:2048 lds
  buffer_load_dwordx4 v238, s[28:31], s73 offen offset:3072 lds
  s_add_u32 m0, s68, 131072
  s_nop 0
  buffer_load_dwordx4 v239, s[32:35], s82 offen nt lds
  buffer_load_dwordx4 v239, s[36:39], s82 offen offset:1024 nt lds
  s_waitcnt vmcnt(10)
  s_barrier
  ds_read_b64_tr_b16 v[200:201], v247 offset:0
  ds_read_b64_tr_b16 v[202:203], v247 offset:1024
  ds_read_b64_tr_b16 v[204:205], v248 offset:0
  ds_read_b64_tr_b16 v[206:207], v248 offset:1024
  ds_read_b64_tr_b16 v[208:209], v247 offset:256
  ds_read_b64_tr_b16 v[210:211], v247 offset:1280
  ds_read_b64_tr_b16 v[212:213], v248 offset:256
  ds_read_b64_tr_b16 v[214:215], v248 offset:1280
  ds_read_b128 a[0:3], v243 offset:0
  ds_read_b128 a[4:7], v243 offset:2048
  s_waitcnt lgkmcnt(0)
  v_mfma_f32_16x16x32_bf16 v[128:131], v[200:203], a[0:3], 0
  ds_read_b64_tr_b16 v[216:217], v247 offset:512
  ds_read_b64_tr_b16 v[218:219], v247 offset:1536
  v_mfma_f32_16x16x32_bf16 v[136:139], v[200:203], a[4:7], 0
  buffer_load_dwordx4 v239, s[40:43], s82 offen offset:2048 nt lds
  s_add_u32 s76, s75, 0x80
  v_mfma_f32_16x16x32_bf16 v[132:135], v[204:207], a[0:3], 0
  ds_read_b64_tr_b16 v[200:201], v248 offset:512
  s_and_b32 s76, s76, 0x380
  v_mfma_f32_16x16x32_bf16 v[140:143], v[204:207], a[4:7], 0
  ds_read_b64_tr_b16 v[202:203], v248 offset:1536
  s_lshl_b32 s84, s76, 12
  s_add_u32 s77, s76, 0x80
  v_mfma_f32_16x16x32_bf16 v[144:147], v[208:211], a[0:3], 0
  ds_read_b64_tr_b16 v[204:205], v247 offset:768
  ds_read_b64_tr_b16 v[206:207], v247 offset:1792
  v_mfma_f32_16x16x32_bf16 v[152:155], v[208:211], a[4:7], 0
  buffer_load_dwordx4 v239, s[44:47], s82 offen offset:3072 nt lds
  s_and_b32 s77, s77, 0x380
  v_mfma_f32_16x16x32_bf16 v[148:151], v[212:215], a[0:3], 0
  ds_read_b64_tr_b16 v[208:209], v248 offset:768
  s_lshl_b32 s85, s77, 12
  v_mfma_f32_16x16x32_bf16 v[156:159], v[212:215], a[4:7], 0
  s_waitcnt lgkmcnt(3)
  ds_read_b64_tr_b16 v[210:211], v248 offset:1792
  s_add_u32 s78, s77, 0x80
  s_and_b32 s78, s78, 0x380
  v_mfma_f32_16x16x32_bf16 v[160:163], v[216:219], a[0:3], 0
  s_add_u32 m0, s68, 81920
  ds_read_b64_tr_b16 v[212:213], v247 offset:2048
  ds_read_b128 a[8:11], v244 offset:0
  v_mfma_f32_16x16x32_bf16 v[168:171], v[216:219], a[4:7], 0
  ds_read_b64_tr_b16 v[214:215], v247 offset:3072
  ds_read_b128 a[12:15], v244 offset:2048
  buffer_load_dwordx4 v238, s[16:19], s74 offen lds
  v_mfma_f32_16x16x32_bf16 v[164:167], v[200:203], a[0:3], 0
  ds_read_b64_tr_b16 v[216:217], v248 offset:2048
  s_lshl_b32 s86, s78, 12
  v_mfma_f32_16x16x32_bf16 v[172:175], v[200:203], a[4:7], 0
  s_waitcnt lgkmcnt(5)
  ds_read_b64_tr_b16 v[218:219], v248 offset:3072
  s_add_u32 s79, s78, 0x80
  s_and_b32 s79, s79, 0x380
  v_mfma_f32_16x16x32_bf16 v[176:179], v[204:207], a[0:3], 0
  ds_read_b64_tr_b16 v[200:201], v247 offset:2304
  ds_read_b64_tr_b16 v[202:203], v247 offset:3328
  v_mfma_f32_16x16x32_bf16 v[184:187], v[204:207], a[4:7], 0
  buffer_load_dwordx4 v238, s[20:23], s74 offen offset:1024 lds
  s_lshl_b32 s87, s79, 12
  v_mfma_f32_16x16x32_bf16 v[180:183], v[208:211], a[0:3], 0
  ds_read_b64_tr_b16 v[204:205], v248 offset:2304
  s_mov_b32 s8, s50
  v_mfma_f32_16x16x32_bf16 v[188:191], v[208:211], a[4:7], 0
  s_waitcnt lgkmcnt(3)
  ds_read_b64_tr_b16 v[206:207], v248 offset:3328
  s_mov_b32 s9, s51
  s_mov_b32 s10, 67108864
  v_mfma_f32_16x16x32_bf16 v[128:131], v[212:215], a[8:11], v[128:131]
  ds_read_b64_tr_b16 v[208:209], v247 offset:2560
  ds_read_b64_tr_b16 v[210:211], v247 offset:3584
  v_mfma_f32_16x16x32_bf16 v[136:139], v[212:215], a[12:15], v[136:139]
  buffer_load_dwordx4 v238, s[24:27], s74 offen offset:2048 lds
  s_mov_b32 s11, 0x20000
  v_mfma_f32_16x16x32_bf16 v[132:135], v[216:219], a[8:11], v[132:135]
  ds_read_b64_tr_b16 v[212:213], v248 offset:2560
  s_mov_b32 s12, s52
  v_mfma_f32_16x16x32_bf16 v[140:143], v[216:219], a[12:15], v[140:143]
  s_waitcnt lgkmcnt(3)
  ds_read_b64_tr_b16 v[214:215], v248 offset:3584
  s_mov_b32 s13, s53
  s_mov_b32 s14, 67108864
  v_mfma_f32_16x16x32_bf16 v[144:147], v[200:203], a[8:11], v[144:147]
  ds_read_b64_tr_b16 v[216:217], v247 offset:2816
  ds_read_b64_tr_b16 v[218:219], v247 offset:3840
  v_mfma_f32_16x16x32_bf16 v[152:155], v[200:203], a[12:15], v[152:155]
  buffer_load_dwordx4 v238, s[28:31], s74 offen offset:3072 lds
  s_mov_b32 s15, 0x20000
  v_mfma_f32_16x16x32_bf16 v[148:151], v[204:207], a[8:11], v[148:151]
  ds_read_b64_tr_b16 v[200:201], v248 offset:2816
  s_lshl_b32 s88, s72, 7
  v_mfma_f32_16x16x32_bf16 v[156:159], v[204:207], a[12:15], v[156:159]
  s_waitcnt lgkmcnt(3)
  ds_read_b64_tr_b16 v[202:203], v248 offset:3840
  s_lshl_b32 s89, s73, 7
  s_lshl_b32 s90, s74, 7
  v_mfma_f32_16x16x32_bf16 v[160:163], v[208:211], a[8:11], v[160:163]
  s_waitcnt vmcnt(8)
  s_barrier
  s_add_u32 m0, s68, 147456
  ds_read_b64_tr_b16 v[204:205], v247 offset:16384
  ds_read_b128 a[16:19], v243 offset:16384
  v_mfma_f32_16x16x32_bf16 v[168:171], v[208:211], a[12:15], v[168:171]
  ds_read_b64_tr_b16 v[206:207], v247 offset:17408
  ds_read_b128 a[20:23], v243 offset:18432
  buffer_load_dwordx4 v239, s[32:35], s83 offen lds
  v_mfma_f32_16x16x32_bf16 v[164:167], v[212:215], a[8:11], v[164:167]
  ds_read_b64_tr_b16 v[208:209], v248 offset:16384
  s_lshl_b32 s91, s75, 7
  v_mfma_f32_16x16x32_bf16 v[172:175], v[212:215], a[12:15], v[172:175]
  s_waitcnt lgkmcnt(5)
  ds_read_b64_tr_b16 v[210:211], v248 offset:17408
  s_lshl_b32 s92, s76, 7
  s_lshl_b32 s93, s77, 7
  v_mfma_f32_16x16x32_bf16 v[176:179], v[216:219], a[8:11], v[176:179]
  ds_read_b64_tr_b16 v[212:213], v247 offset:16640
  ds_read_b64_tr_b16 v[214:215], v247 offset:17664
  v_mfma_f32_16x16x32_bf16 v[184:187], v[216:219], a[12:15], v[184:187]
  buffer_load_dwordx4 v239, s[36:39], s83 offen offset:1024 lds
  s_lshl_b32 s94, s78, 7
  v_mfma_f32_16x16x32_bf16 v[180:183], v[200:203], a[8:11], v[180:183]
  ds_read_b64_tr_b16 v[216:217], v248 offset:16640
  s_lshl_b32 s95, s79, 7
  v_mfma_f32_16x16x32_bf16 v[188:191], v[200:203], a[12:15], v[188:191]
  s_waitcnt lgkmcnt(3)
  ds_read_b64_tr_b16 v[218:219], v248 offset:17664
  s_lshl_b32 s59, s60, 5
  s_add_u32 s59, s59, s56
  s_lshl_b32 s59, s59, 17
  v_lshl_add_u32 v5, v4, 8, v6
  v_lshl_add_u32 v5, v1, 12, v5
  v_add_u32 v237, s59, v5
  v_bfe_u32 v15, v2, 3, 2
  v_lshl_add_u32 v15, v8, 4, v15
  v_lshl_add_u32 v15, v7, 5, v15
  v_lshl_add_u32 v5, v9, 1, v8
  v_lshl_add_u32 v5, v7, 2, v5
  v_and_b32 v6, 7, v2
  v_xor_b32 v5, v5, v6
  v_lshlrev_b32 v5, 4, v5
  v_lshl_add_u32 v5, v15, 8, v5
  v_lshrrev_b32 v15, 1, v1
  v_lshl_add_u32 v5, v15, 7, v5
  v_add_u32 v236, s59, v5
  v_mfma_f32_16x16x32_bf16 v[128:131], v[204:207], a[16:19], v[128:131]
  ds_read_b64_tr_b16 v[200:201], v247 offset:16896
  ds_read_b64_tr_b16 v[202:203], v247 offset:17920
  v_mfma_f32_16x16x32_bf16 v[136:139], v[204:207], a[20:23], v[136:139]
  buffer_load_dwordx4 v239, s[40:43], s83 offen offset:2048 lds
  v_mfma_f32_16x16x32_bf16 v[132:135], v[208:211], a[16:19], v[132:135]
  ds_read_b64_tr_b16 v[204:205], v248 offset:16896
  s_lshr_b32 s69, s68, 12
  v_mfma_f32_16x16x32_bf16 v[140:143], v[208:211], a[20:23], v[140:143]
  s_waitcnt lgkmcnt(3)
  ds_read_b64_tr_b16 v[206:207], v248 offset:17920
  s_lshl_b32 s59, s4, 2
  v_mfma_f32_16x16x32_bf16 v[144:147], v[212:215], a[16:19], v[144:147]
  ds_read_b64_tr_b16 v[208:209], v247 offset:17152
  ds_read_b64_tr_b16 v[210:211], v247 offset:18176
  v_mfma_f32_16x16x32_bf16 v[152:155], v[212:215], a[20:23], v[152:155]
  buffer_load_dwordx4 v239, s[44:47], s83 offen offset:3072 lds
  v_mfma_f32_16x16x32_bf16 v[148:151], v[216:219], a[16:19], v[148:151]
  ds_read_b64_tr_b16 v[212:213], v248 offset:17152
  s_add_u32 s59, s59, s69
  v_mfma_f32_16x16x32_bf16 v[156:159], v[216:219], a[20:23], v[156:159]
  s_waitcnt lgkmcnt(3)
  ds_read_b64_tr_b16 v[214:215], v248 offset:18176
  s_mul_i32 s59, s59, ((L_tailcode-concat_heads__mha_block_cached__mha_block_cached__near_ridge_kernel-0x2000)>>11)+1
  v_mfma_f32_16x16x32_bf16 v[160:163], v[200:203], a[16:19], v[160:163]
  s_add_u32 m0, s68, 32768
  ds_read_b64_tr_b16 v[216:217], v247 offset:18432
  ds_read_b128 a[24:27], v244 offset:16384
  v_mfma_f32_16x16x32_bf16 v[168:171], v[200:203], a[20:23], v[168:171]
  ds_read_b64_tr_b16 v[218:219], v247 offset:19456
  ds_read_b128 a[28:31], v244 offset:18432
  buffer_load_dwordx4 v238, s[16:19], s75 offen lds
  v_mfma_f32_16x16x32_bf16 v[164:167], v[204:207], a[16:19], v[164:167]
  ds_read_b64_tr_b16 v[200:201], v248 offset:18432
  s_lshr_b32 s59, s59, 7
  v_mfma_f32_16x16x32_bf16 v[172:175], v[204:207], a[20:23], v[172:175]
  s_waitcnt lgkmcnt(5)
  ds_read_b64_tr_b16 v[202:203], v248 offset:19456
  s_lshl_b32 s59, s59, 11
  v_mfma_f32_16x16x32_bf16 v[176:179], v[208:211], a[16:19], v[176:179]
  ds_read_b64_tr_b16 v[204:205], v247 offset:18688
  ds_read_b64_tr_b16 v[206:207], v247 offset:19712
  v_mfma_f32_16x16x32_bf16 v[184:187], v[208:211], a[20:23], v[184:187]
  buffer_load_dwordx4 v238, s[20:23], s75 offen offset:1024 lds
  v_mfma_f32_16x16x32_bf16 v[180:183], v[212:215], a[16:19], v[180:183]
  ds_read_b64_tr_b16 v[208:209], v248 offset:18688
  v_and_b32 v13, 15, v2
  v_mfma_f32_16x16x32_bf16 v[188:191], v[212:215], a[20:23], v[188:191]
  s_waitcnt lgkmcnt(3)
  ds_read_b64_tr_b16 v[210:211], v248 offset:19712
  v_lshl_add_u32 v13, v13, 7, s59
  v_mfma_f32_16x16x32_bf16 v[128:131], v[216:219], a[24:27], v[128:131]
  ds_read_b64_tr_b16 v[212:213], v247 offset:18944
  ds_read_b64_tr_b16 v[214:215], v247 offset:19968
  v_mfma_f32_16x16x32_bf16 v[136:139], v[216:219], a[28:31], v[136:139]
  buffer_load_dwordx4 v238, s[24:27], s75 offen offset:2048 lds
  v_mfma_f32_16x16x32_bf16 v[132:135], v[200:203], a[24:27], v[132:135]
  ds_read_b64_tr_b16 v[216:217], v248 offset:18944
  v_mfma_f32_16x16x32_bf16 v[140:143], v[200:203], a[28:31], v[140:143]
  s_waitcnt lgkmcnt(3)
  ds_read_b64_tr_b16 v[218:219], v248 offset:19968
  v_mfma_f32_16x16x32_bf16 v[144:147], v[204:207], a[24:27], v[144:147]
  ds_read_b64_tr_b16 v[200:201], v247 offset:19200
  v_mfma_f32_16x16x32_bf16 v[152:155], v[204:207], a[28:31], v[152:155]
  ds_read_b64_tr_b16 v[202:203], v247 offset:20224
  v_mfma_f32_16x16x32_bf16 v[148:151], v[208:211], a[24:27], v[148:151]
  ds_read_b64_tr_b16 v[204:205], v248 offset:19200
  v_mfma_f32_16x16x32_bf16 v[156:159], v[208:211], a[28:31], v[156:159]
  s_waitcnt lgkmcnt(3)
  ds_read_b64_tr_b16 v[206:207], v248 offset:20224
  v_mfma_f32_16x16x32_bf16 v[160:163], v[212:215], a[24:27], v[160:163]
  s_waitcnt vmcnt(7)
  s_barrier
  ds_read_b64_tr_b16 v[208:209], v247 offset:32768
  ds_read_b128 a[32:35], v243 offset:49152
  v_mfma_f32_16x16x32_bf16 v[168:171], v[212:215], a[28:31], v[168:171]
  ds_read_b64_tr_b16 v[210:211], v247 offset:33792
  ds_read_b128 a[36:39], v243 offset:51200
  buffer_load_dwordx4 v238, s[28:31], s75 offen offset:3072 lds
  v_mfma_f32_16x16x32_bf16 v[164:167], v[216:219], a[24:27], v[164:167]
  ds_read_b64_tr_b16 v[212:213], v248 offset:32768
  v_mfma_f32_16x16x32_bf16 v[172:175], v[216:219], a[28:31], v[172:175]
  s_waitcnt lgkmcnt(5)
  ds_read_b64_tr_b16 v[214:215], v248 offset:33792
  v_mfma_f32_16x16x32_bf16 v[176:179], v[200:203], a[24:27], v[176:179]
  s_add_u32 m0, s68, 98304
  ds_read_b64_tr_b16 v[216:217], v247 offset:33024
  ds_read_b64_tr_b16 v[218:219], v247 offset:34048
  v_mfma_f32_16x16x32_bf16 v[184:187], v[200:203], a[28:31], v[184:187]
  buffer_load_dwordx4 v239, s[32:35], s84 offen lds
  v_mfma_f32_16x16x32_bf16 v[180:183], v[204:207], a[24:27], v[180:183]
  ds_read_b64_tr_b16 v[200:201], v248 offset:33024
  v_mfma_f32_16x16x32_bf16 v[188:191], v[204:207], a[28:31], v[188:191]
  s_waitcnt lgkmcnt(3)
  ds_read_b64_tr_b16 v[202:203], v248 offset:34048
  v_mfma_f32_16x16x32_bf16 v[128:131], v[208:211], a[32:35], v[128:131]
  ds_read_b64_tr_b16 v[204:205], v247 offset:33280
  ds_read_b64_tr_b16 v[206:207], v247 offset:34304
  v_mfma_f32_16x16x32_bf16 v[136:139], v[208:211], a[36:39], v[136:139]
  buffer_load_dwordx4 v239, s[36:39], s84 offen offset:1024 lds
  v_mfma_f32_16x16x32_bf16 v[132:135], v[212:215], a[32:35], v[132:135]
  ds_read_b64_tr_b16 v[208:209], v248 offset:33280
  v_mfma_f32_16x16x32_bf16 v[140:143], v[212:215], a[36:39], v[140:143]
  s_waitcnt lgkmcnt(3)
  ds_read_b64_tr_b16 v[210:211], v248 offset:34304
  v_mfma_f32_16x16x32_bf16 v[144:147], v[216:219], a[32:35], v[144:147]
  ds_read_b64_tr_b16 v[212:213], v247 offset:33536
  ds_read_b64_tr_b16 v[214:215], v247 offset:34560
  v_mfma_f32_16x16x32_bf16 v[152:155], v[216:219], a[36:39], v[152:155]
  buffer_load_dwordx4 v239, s[40:43], s84 offen offset:2048 lds
  v_mfma_f32_16x16x32_bf16 v[148:151], v[200:203], a[32:35], v[148:151]
  ds_read_b64_tr_b16 v[216:217], v248 offset:33536
  v_mfma_f32_16x16x32_bf16 v[156:159], v[200:203], a[36:39], v[156:159]
  s_waitcnt lgkmcnt(3)
  ds_read_b64_tr_b16 v[218:219], v248 offset:34560
  v_mfma_f32_16x16x32_bf16 v[160:163], v[204:207], a[32:35], v[160:163]
  ds_read_b64_tr_b16 v[200:201], v247 offset:34816
  ds_read_b128 a[40:43], v244 offset:49152
  v_mfma_f32_16x16x32_bf16 v[168:171], v[204:207], a[36:39], v[168:171]
  ds_read_b64_tr_b16 v[202:203], v247 offset:35840
  ds_read_b128 a[44:47], v244 offset:51200
  buffer_load_dwordx4 v239, s[44:47], s84 offen offset:3072 lds
  v_mfma_f32_16x16x32_bf16 v[164:167], v[208:211], a[32:35], v[164:167]
  ds_read_b64_tr_b16 v[204:205], v248 offset:34816
  v_mfma_f32_16x16x32_bf16 v[172:175], v[208:211], a[36:39], v[172:175]
  s_waitcnt lgkmcnt(5)
  ds_read_b64_tr_b16 v[206:207], v248 offset:35840
  v_mfma_f32_16x16x32_bf16 v[176:179], v[212:215], a[32:35], v[176:179]
  s_add_u32 m0, s68, 49152
  ds_read_b64_tr_b16 v[208:209], v247 offset:35072
  ds_read_b64_tr_b16 v[210:211], v247 offset:36096
  v_mfma_f32_16x16x32_bf16 v[184:187], v[212:215], a[36:39], v[184:187]
  buffer_load_dwordx4 v238, s[16:19], s76 offen lds
  v_mfma_f32_16x16x32_bf16 v[180:183], v[216:219], a[32:35], v[180:183]
  ds_read_b64_tr_b16 v[212:213], v248 offset:35072
  v_mfma_f32_16x16x32_bf16 v[188:191], v[216:219], a[36:39], v[188:191]
  s_waitcnt lgkmcnt(3)
  ds_read_b64_tr_b16 v[214:215], v248 offset:36096
  v_mfma_f32_16x16x32_bf16 v[128:131], v[200:203], a[40:43], v[128:131]
  ds_read_b64_tr_b16 v[216:217], v247 offset:35328
  ds_read_b64_tr_b16 v[218:219], v247 offset:36352
  v_mfma_f32_16x16x32_bf16 v[136:139], v[200:203], a[44:47], v[136:139]
  buffer_load_dwordx4 v238, s[20:23], s76 offen offset:1024 lds
  v_mfma_f32_16x16x32_bf16 v[132:135], v[204:207], a[40:43], v[132:135]
  ds_read_b64_tr_b16 v[200:201], v248 offset:35328
  v_mfma_f32_16x16x32_bf16 v[140:143], v[204:207], a[44:47], v[140:143]
  s_waitcnt lgkmcnt(3)
  ds_read_b64_tr_b16 v[202:203], v248 offset:36352
  v_mfma_f32_16x16x32_bf16 v[144:147], v[208:211], a[40:43], v[144:147]
  ds_read_b64_tr_b16 v[204:205], v247 offset:35584
  v_mfma_f32_16x16x32_bf16 v[152:155], v[208:211], a[44:47], v[152:155]
  ds_read_b64_tr_b16 v[206:207], v247 offset:36608
  v_mfma_f32_16x16x32_bf16 v[148:151], v[212:215], a[40:43], v[148:151]
  ds_read_b64_tr_b16 v[208:209], v248 offset:35584
  v_mfma_f32_16x16x32_bf16 v[156:159], v[212:215], a[44:47], v[156:159]
  s_waitcnt lgkmcnt(3)
  ds_read_b64_tr_b16 v[210:211], v248 offset:36608
  v_mfma_f32_16x16x32_bf16 v[160:163], v[216:219], a[40:43], v[160:163]
  s_waitcnt vmcnt(6)
  s_barrier
  ds_read_b64_tr_b16 v[212:213], v247 offset:49152
  ds_read_b128 a[48:51], v243 offset:0
  v_mfma_f32_16x16x32_bf16 v[168:171], v[216:219], a[44:47], v[168:171]
  ds_read_b64_tr_b16 v[214:215], v247 offset:50176
  ds_read_b128 a[52:55], v243 offset:2048
  buffer_load_dwordx4 v238, s[24:27], s76 offen offset:2048 lds
  v_mfma_f32_16x16x32_bf16 v[164:167], v[200:203], a[40:43], v[164:167]
  ds_read_b64_tr_b16 v[216:217], v248 offset:49152
  v_mfma_f32_16x16x32_bf16 v[172:175], v[200:203], a[44:47], v[172:175]
  s_waitcnt lgkmcnt(5)
  ds_read_b64_tr_b16 v[218:219], v248 offset:50176
  v_mfma_f32_16x16x32_bf16 v[176:179], v[204:207], a[40:43], v[176:179]
  ds_read_b64_tr_b16 v[200:201], v247 offset:49408
  ds_read_b64_tr_b16 v[202:203], v247 offset:50432
  v_mfma_f32_16x16x32_bf16 v[184:187], v[204:207], a[44:47], v[184:187]
  buffer_load_dwordx4 v238, s[28:31], s76 offen offset:3072 lds
  v_mfma_f32_16x16x32_bf16 v[180:183], v[208:211], a[40:43], v[180:183]
  ds_read_b64_tr_b16 v[204:205], v248 offset:49408
  v_mfma_f32_16x16x32_bf16 v[188:191], v[208:211], a[44:47], v[188:191]
  s_waitcnt lgkmcnt(3)
  ds_read_b64_tr_b16 v[206:207], v248 offset:50432
  v_mfma_f32_16x16x32_bf16 v[128:131], v[212:215], a[48:51], v[128:131]
  s_add_u32 m0, s68, 114688
  ds_read_b64_tr_b16 v[208:209], v247 offset:49664
  ds_read_b64_tr_b16 v[210:211], v247 offset:50688
  v_mfma_f32_16x16x32_bf16 v[136:139], v[212:215], a[52:55], v[136:139]
  buffer_load_dwordx4 v239, s[32:35], s85 offen lds
  v_mfma_f32_16x16x32_bf16 v[132:135], v[216:219], a[48:51], v[132:135]
  ds_read_b64_tr_b16 v[212:213], v248 offset:49664
  v_mfma_f32_16x16x32_bf16 v[140:143], v[216:219], a[52:55], v[140:143]
  s_waitcnt lgkmcnt(3)
  ds_read_b64_tr_b16 v[214:215], v248 offset:50688
  v_mfma_f32_16x16x32_bf16 v[144:147], v[200:203], a[48:51], v[144:147]
  ds_read_b64_tr_b16 v[216:217], v247 offset:49920
  ds_read_b64_tr_b16 v[218:219], v247 offset:50944
  v_mfma_f32_16x16x32_bf16 v[152:155], v[200:203], a[52:55], v[152:155]
  buffer_load_dwordx4 v239, s[36:39], s85 offen offset:1024 lds
  v_mfma_f32_16x16x32_bf16 v[148:151], v[204:207], a[48:51], v[148:151]
  ds_read_b64_tr_b16 v[200:201], v248 offset:49920
  v_mfma_f32_16x16x32_bf16 v[156:159], v[204:207], a[52:55], v[156:159]
  s_waitcnt lgkmcnt(3)
  ds_read_b64_tr_b16 v[202:203], v248 offset:50944
  v_mfma_f32_16x16x32_bf16 v[160:163], v[208:211], a[48:51], v[160:163]
  ds_read_b64_tr_b16 v[204:205], v247 offset:51200
  ds_read_b128 a[56:59], v244 offset:0
  v_mfma_f32_16x16x32_bf16 v[168:171], v[208:211], a[52:55], v[168:171]
  ds_read_b64_tr_b16 v[206:207], v247 offset:52224
  ds_read_b128 a[60:63], v244 offset:2048
  buffer_load_dwordx4 v239, s[40:43], s85 offen offset:2048 lds
  v_mfma_f32_16x16x32_bf16 v[164:167], v[212:215], a[48:51], v[164:167]
  ds_read_b64_tr_b16 v[208:209], v248 offset:51200
  v_mfma_f32_16x16x32_bf16 v[172:175], v[212:215], a[52:55], v[172:175]
  s_waitcnt lgkmcnt(5)
  ds_read_b64_tr_b16 v[210:211], v248 offset:52224
  v_mfma_f32_16x16x32_bf16 v[176:179], v[216:219], a[48:51], v[176:179]
  ds_read_b64_tr_b16 v[212:213], v247 offset:51456
  ds_read_b64_tr_b16 v[214:215], v247 offset:52480
  v_mfma_f32_16x16x32_bf16 v[184:187], v[216:219], a[52:55], v[184:187]
  buffer_load_dwordx4 v239, s[44:47], s85 offen offset:3072 lds
  v_mfma_f32_16x16x32_bf16 v[180:183], v[200:203], a[48:51], v[180:183]
  ds_read_b64_tr_b16 v[216:217], v248 offset:51456
  v_mfma_f32_16x16x32_bf16 v[188:191], v[200:203], a[52:55], v[188:191]
  s_waitcnt lgkmcnt(3)
  ds_read_b64_tr_b16 v[218:219], v248 offset:52480
  v_mfma_f32_16x16x32_bf16 v[128:131], v[204:207], a[56:59], v[128:131]
  s_add_u32 m0, s68, 81920
  ds_read_b64_tr_b16 v[200:201], v247 offset:51712
  ds_read_b64_tr_b16 v[202:203], v247 offset:52736
  v_mfma_f32_16x16x32_bf16 v[136:139], v[204:207], a[60:63], v[136:139]
  buffer_load_dwordx4 v238, s[16:19], s77 offen lds
  v_mfma_f32_16x16x32_bf16 v[132:135], v[208:211], a[56:59], v[132:135]
  ds_read_b64_tr_b16 v[204:205], v248 offset:51712
  v_mfma_f32_16x16x32_bf16 v[140:143], v[208:211], a[60:63], v[140:143]
  s_waitcnt lgkmcnt(3)
  ds_read_b64_tr_b16 v[206:207], v248 offset:52736
  v_mfma_f32_16x16x32_bf16 v[144:147], v[212:215], a[56:59], v[144:147]
  ds_read_b64_tr_b16 v[208:209], v247 offset:51968
  ds_read_b64_tr_b16 v[210:211], v247 offset:52992
  v_mfma_f32_16x16x32_bf16 v[152:155], v[212:215], a[60:63], v[152:155]
  buffer_load_dwordx4 v238, s[20:23], s77 offen offset:1024 lds
  v_mfma_f32_16x16x32_bf16 v[148:151], v[216:219], a[56:59], v[148:151]
  ds_read_b64_tr_b16 v[212:213], v248 offset:51968
  v_mfma_f32_16x16x32_bf16 v[156:159], v[216:219], a[60:63], v[156:159]
  s_waitcnt lgkmcnt(3)
  ds_read_b64_tr_b16 v[214:215], v248 offset:52992
  v_mfma_f32_16x16x32_bf16 v[160:163], v[200:203], a[56:59], v[160:163]
  s_waitcnt vmcnt(6)
  s_barrier
  ds_read_b64_tr_b16 v[216:217], v247 offset:0
  ds_read_b128 a[64:67], v243 offset:16384
  v_mfma_f32_16x16x32_bf16 v[168:171], v[200:203], a[60:63], v[168:171]
  ds_read_b64_tr_b16 v[218:219], v247 offset:1024
  ds_read_b128 a[68:71], v243 offset:18432
  buffer_load_dwordx4 v238, s[24:27], s77 offen offset:2048 lds
  v_mfma_f32_16x16x32_bf16 v[164:167], v[204:207], a[56:59], v[164:167]
  ds_read_b64_tr_b16 v[200:201], v248 offset:0
  v_mfma_f32_16x16x32_bf16 v[172:175], v[204:207], a[60:63], v[172:175]
  s_waitcnt lgkmcnt(5)
  ds_read_b64_tr_b16 v[202:203], v248 offset:1024
  v_mfma_f32_16x16x32_bf16 v[176:179], v[208:211], a[56:59], v[176:179]
  ds_read_b64_tr_b16 v[204:205], v247 offset:256
  ds_read_b64_tr_b16 v[206:207], v247 offset:1280
  v_mfma_f32_16x16x32_bf16 v[184:187], v[208:211], a[60:63], v[184:187]
  buffer_load_dwordx4 v238, s[28:31], s77 offen offset:3072 lds
  v_mfma_f32_16x16x32_bf16 v[180:183], v[212:215], a[56:59], v[180:183]
  ds_read_b64_tr_b16 v[208:209], v248 offset:256
  v_mfma_f32_16x16x32_bf16 v[188:191], v[212:215], a[60:63], v[188:191]
  s_waitcnt lgkmcnt(3)
  ds_read_b64_tr_b16 v[210:211], v248 offset:1280
  v_mfma_f32_16x16x32_bf16 v[128:131], v[216:219], a[64:67], v[128:131]
  s_add_u32 m0, s68, 131072
  ds_read_b64_tr_b16 v[212:213], v247 offset:512
  ds_read_b64_tr_b16 v[214:215], v247 offset:1536
  v_mfma_f32_16x16x32_bf16 v[136:139], v[216:219], a[68:71], v[136:139]
  buffer_load_dwordx4 v239, s[32:35], s86 offen lds
  v_mfma_f32_16x16x32_bf16 v[132:135], v[200:203], a[64:67], v[132:135]
  ds_read_b64_tr_b16 v[216:217], v248 offset:512
  s_getpc_b64 s[62:63]
L_pc1:
  s_add_u32 s62, s62, concat_heads__mha_block_cached__mha_block_cached__near_ridge_kernel+0x2000-L_pc1
  s_addc_u32 s63, s63, 0
  v_mfma_f32_16x16x32_bf16 v[140:143], v[200:203], a[68:71], v[140:143]
  s_waitcnt lgkmcnt(3)
  ds_read_b64_tr_b16 v[218:219], v248 offset:1536
  v_lshl_add_u32 v5, v8, 2, v4
  v_mfma_f32_16x16x32_bf16 v[144:147], v[204:207], a[64:67], v[144:147]
  ds_read_b64_tr_b16 v[200:201], v247 offset:768
  ds_read_b64_tr_b16 v[202:203], v247 offset:1792
  v_mfma_f32_16x16x32_bf16 v[152:155], v[204:207], a[68:71], v[152:155]
  buffer_load_dwordx4 v239, s[36:39], s86 offen offset:1024 lds
  v_lshl_add_u32 v5, v1, 5, v5
  v_mfma_f32_16x16x32_bf16 v[148:151], v[208:211], a[64:67], v[148:151]
  ds_read_b64_tr_b16 v[204:205], v248 offset:768
  v_and_b32 v6, 3, v2
  v_mfma_f32_16x16x32_bf16 v[156:159], v[208:211], a[68:71], v[156:159]
  s_waitcnt lgkmcnt(3)
  ds_read_b64_tr_b16 v[206:207], v248 offset:1792
  v_lshlrev_b32 v15, 1, v8
  v_xor_b32 v6, v6, v15
  v_mfma_f32_16x16x32_bf16 v[160:163], v[212:215], a[64:67], v[160:163]
  ds_read_b64_tr_b16 v[208:209], v247 offset:2048
  ds_read_b128 a[72:75], v244 offset:16384
  v_mfma_f32_16x16x32_bf16 v[168:171], v[212:215], a[68:71], v[168:171]
  ds_read_b64_tr_b16 v[210:211], v247 offset:3072
  ds_read_b128 a[76:79], v244 offset:18432
  buffer_load_dwordx4 v239, s[40:43], s86 offen offset:2048 lds
  v_mfma_f32_16x16x32_bf16 v[164:167], v[216:219], a[64:67], v[164:167]
  ds_read_b64_tr_b16 v[212:213], v248 offset:2048
  v_lshlrev_b32 v6, 4, v6
  v_mfma_f32_16x16x32_bf16 v[172:175], v[216:219], a[68:71], v[172:175]
  s_waitcnt lgkmcnt(5)
  ds_read_b64_tr_b16 v[214:215], v248 offset:3072
  v_lshl_add_u32 v6, v9, 6, v6
  v_lshl_add_u32 v5, v5, 10, v6
  v_mfma_f32_16x16x32_bf16 v[176:179], v[200:203], a[64:67], v[176:179]
  ds_read_b64_tr_b16 v[216:217], v247 offset:2304
  ds_read_b64_tr_b16 v[218:219], v247 offset:3328
  v_mfma_f32_16x16x32_bf16 v[184:187], v[200:203], a[68:71], v[184:187]
  buffer_load_dwordx4 v239, s[44:47], s86 offen offset:3072 lds
  s_lshl_b32 s69, s56, 17
  v_mfma_f32_16x16x32_bf16 v[180:183], v[204:207], a[64:67], v[180:183]
  ds_read_b64_tr_b16 v[200:201], v248 offset:2304
  v_add_u32 v240, s69, v5
  v_mfma_f32_16x16x32_bf16 v[188:191], v[204:207], a[68:71], v[188:191]
  s_waitcnt lgkmcnt(3)
  ds_read_b64_tr_b16 v[202:203], v248 offset:3328
  s_lshl_b32 s3, s5, 4
  s_add_u32 s3, s3, s60
  v_mfma_f32_16x16x32_bf16 v[128:131], v[208:211], a[72:75], v[128:131]
  s_add_u32 m0, s68, 32768
  ds_read_b64_tr_b16 v[204:205], v247 offset:2560
  ds_read_b64_tr_b16 v[206:207], v247 offset:3584
  v_mfma_f32_16x16x32_bf16 v[136:139], v[208:211], a[76:79], v[136:139]
  buffer_load_dwordx4 v238, s[16:19], s78 offen lds
  s_lshl_b32 s59, s60, 18
  v_mfma_f32_16x16x32_bf16 v[132:135], v[212:215], a[72:75], v[132:135]
  ds_read_b64_tr_b16 v[208:209], v248 offset:2560
  s_lshl_b32 s5, s5, 10
  v_mfma_f32_16x16x32_bf16 v[140:143], v[212:215], a[76:79], v[140:143]
  s_waitcnt lgkmcnt(3)
  ds_read_b64_tr_b16 v[210:211], v248 offset:3584
  s_add_u32 s59, s59, s5
  s_lshl_b32 s5, s68, 4
  v_mfma_f32_16x16x32_bf16 v[144:147], v[216:219], a[72:75], v[144:147]
  ds_read_b64_tr_b16 v[212:213], v247 offset:2816
  ds_read_b64_tr_b16 v[214:215], v247 offset:3840
  v_mfma_f32_16x16x32_bf16 v[152:155], v[216:219], a[76:79], v[152:155]
  buffer_load_dwordx4 v238, s[20:23], s78 offen offset:1024 lds
  s_add_u32 s59, s59, s5
  v_mfma_f32_16x16x32_bf16 v[148:151], v[200:203], a[72:75], v[148:151]
  ds_read_b64_tr_b16 v[216:217], v248 offset:2816
  s_add_u32 s6, s6, s59
  s_addc_u32 s7, s7, 0
  v_mfma_f32_16x16x32_bf16 v[156:159], v[200:203], a[76:79], v[156:159]
  s_waitcnt lgkmcnt(3)
  ds_read_b64_tr_b16 v[218:219], v248 offset:3840
  s_lshl_b32 s4, s3, 20
  v_mfma_f32_16x16x32_bf16 v[160:163], v[204:207], a[72:75], v[160:163]
  s_waitcnt vmcnt(6)
  s_barrier
  ds_read_b64_tr_b16 v[200:201], v247 offset:16384
  ds_read_b128 a[80:83], v243 offset:49152
  v_mfma_f32_16x16x32_bf16 v[168:171], v[204:207], a[76:79], v[168:171]
  ds_read_b64_tr_b16 v[202:203], v247 offset:17408
  ds_read_b128 a[84:87], v243 offset:51200
  buffer_load_dwordx4 v238, s[24:27], s78 offen offset:2048 lds
  v_mfma_f32_16x16x32_bf16 v[164:167], v[208:211], a[72:75], v[164:167]
  ds_read_b64_tr_b16 v[204:205], v248 offset:16384
  s_lshl_b32 s59, s57, 14
  v_mfma_f32_16x16x32_bf16 v[172:175], v[208:211], a[76:79], v[172:175]
  s_waitcnt lgkmcnt(5)
  ds_read_b64_tr_b16 v[206:207], v248 offset:17408
  s_add_u32 s4, s4, s59
  s_add_u32 s4, s4, s68
  v_mfma_f32_16x16x32_bf16 v[176:179], v[212:215], a[72:75], v[176:179]
  ds_read_b64_tr_b16 v[208:209], v247 offset:16640
  ds_read_b64_tr_b16 v[210:211], v247 offset:17664
  v_mfma_f32_16x16x32_bf16 v[184:187], v[212:215], a[76:79], v[184:187]
  buffer_load_dwordx4 v238, s[28:31], s78 offen offset:3072 lds
  s_mov_b32 s66, 289406976
  v_mfma_f32_16x16x32_bf16 v[180:183], v[216:219], a[72:75], v[180:183]
  ds_read_b64_tr_b16 v[212:213], v248 offset:16640
  s_mov_b32 s67, 0x20000
  v_mfma_f32_16x16x32_bf16 v[188:191], v[216:219], a[76:79], v[188:191]
  s_waitcnt lgkmcnt(3)
  ds_read_b64_tr_b16 v[214:215], v248 offset:17664
  s_lshl_b32 s59, s3, 10
  s_add_u32 s59, s59, 41943040
  v_mfma_f32_16x16x32_bf16 v[128:131], v[200:203], a[80:83], v[128:131]
  s_add_u32 m0, s68, 147456
  ds_read_b64_tr_b16 v[216:217], v247 offset:16896
  ds_read_b64_tr_b16 v[218:219], v247 offset:17920
  v_mfma_f32_16x16x32_bf16 v[136:139], v[200:203], a[84:87], v[136:139]
  buffer_load_dwordx4 v239, s[32:35], s87 offen lds
  v_lshlrev_b32 v232, 2, v0
  v_mfma_f32_16x16x32_bf16 v[132:135], v[204:207], a[80:83], v[132:135]
  ds_read_b64_tr_b16 v[200:201], v248 offset:16896
  v_add_u32 v232, s59, v232
  v_mfma_f32_16x16x32_bf16 v[140:143], v[204:207], a[84:87], v[140:143]
  s_waitcnt lgkmcnt(3)
  ds_read_b64_tr_b16 v[202:203], v248 offset:17920
  v_mov_b32 v233, 0x7fffff00
  v_cmp_gt_u32 vcc, 32, v0
  v_mfma_f32_16x16x32_bf16 v[144:147], v[208:211], a[80:83], v[144:147]
  ds_read_b64_tr_b16 v[204:205], v247 offset:17152
  ds_read_b64_tr_b16 v[206:207], v247 offset:18176
  v_mfma_f32_16x16x32_bf16 v[152:155], v[208:211], a[84:87], v[152:155]
  buffer_load_dwordx4 v239, s[36:39], s87 offen offset:1024 lds
  v_cndmask_b32 v232, v233, v232, vcc
  v_mfma_f32_16x16x32_bf16 v[148:151], v[212:215], a[80:83], v[148:151]
  ds_read_b64_tr_b16 v[208:209], v248 offset:17152
  v_and_b32 v12, 7, v0
  v_mfma_f32_16x16x32_bf16 v[156:159], v[212:215], a[84:87], v[156:159]
  s_waitcnt lgkmcnt(3)
  ds_read_b64_tr_b16 v[210:211], v248 offset:18176
  v_cmp_eq_u32 vcc, s57, v12
  s_nop 1
  v_cndmask_b32 v233, 0, 1, vcc
  v_mfma_f32_16x16x32_bf16 v[160:163], v[216:219], a[80:83], v[160:163]
  ds_read_b64_tr_b16 v[212:213], v247 offset:18432
  ds_read_b128 a[88:91], v244 offset:49152
  v_mfma_f32_16x16x32_bf16 v[168:171], v[216:219], a[84:87], v[168:171]
  ds_read_b64_tr_b16 v[214:215], v247 offset:19456
  ds_read_b128 a[92:95], v244 offset:51200
  buffer_load_dwordx4 v239, s[40:43], s87 offen offset:2048 lds
  v_mfma_f32_16x16x32_bf16 v[164:167], v[200:203], a[80:83], v[164:167]
  ds_read_b64_tr_b16 v[216:217], v248 offset:18432
  ds_read_b64_tr_b16 v[218:219], v248 offset:19456
  v_mfma_f32_16x16x32_bf16 v[172:175], v[200:203], a[84:87], v[172:175]
  s_waitcnt lgkmcnt(6)
  global_load_dword v14, v13, s[62:63] offset:0
  v_mfma_f32_16x16x32_bf16 v[176:179], v[204:207], a[80:83], v[176:179]
  ds_read_b64_tr_b16 v[200:201], v247 offset:18688
  ds_read_b64_tr_b16 v[202:203], v247 offset:19712
  v_mfma_f32_16x16x32_bf16 v[184:187], v[204:207], a[84:87], v[184:187]
  buffer_load_dwordx4 v239, s[44:47], s87 offen offset:3072 lds
  v_add_u32 v239, 512, v239
  v_mfma_f32_16x16x32_bf16 v[180:183], v[208:211], a[80:83], v[180:183]
  ds_read_b64_tr_b16 v[204:205], v248 offset:18688
  ds_read_b64_tr_b16 v[206:207], v248 offset:19712
  v_mfma_f32_16x16x32_bf16 v[188:191], v[208:211], a[84:87], v[188:191]
  s_waitcnt lgkmcnt(4)
  buffer_store_dword v233, v232, s[64:67], s79 offen sc1
  s_lshl_b32 s5, s57, 2
  v_mfma_f32_16x16x32_bf16 v[128:131], v[212:215], a[88:91], v[128:131]
  ds_read_b64_tr_b16 v[208:209], v247 offset:18944
  s_add_u32 s5, s5, s59
  v_mfma_f32_16x16x32_bf16 v[136:139], v[212:215], a[92:95], v[136:139]
  ds_read_b64_tr_b16 v[210:211], v247 offset:19968
  s_lshr_b32 s59, s68, 7
  s_add_u32 s5, s5, s59
  v_mfma_f32_16x16x32_bf16 v[132:135], v[216:219], a[88:91], v[132:135]
  ds_read_b64_tr_b16 v[212:213], v248 offset:18944
  s_lshl_b32 s3, s3, 2
  v_mfma_f32_16x16x32_bf16 v[140:143], v[216:219], a[92:95], v[140:143]
  s_waitcnt lgkmcnt(3)
  ds_read_b64_tr_b16 v[214:215], v248 offset:19968
  s_add_u32 s0, s0, s3
  s_addc_u32 s1, s1, 0
  v_mfma_f32_16x16x32_bf16 v[144:147], v[200:203], a[88:91], v[144:147]
  ds_read_b64_tr_b16 v[216:217], v247 offset:19200
  s_mov_b32 s2, s57
  v_mfma_f32_16x16x32_bf16 v[152:155], v[200:203], a[92:95], v[152:155]
  ds_read_b64_tr_b16 v[218:219], v247 offset:20224
  s_mov_b32 s48, s96
  s_mov_b32 s49, s97
  v_mfma_f32_16x16x32_bf16 v[148:151], v[204:207], a[88:91], v[148:151]
  s_add_u32 m0, s68, 49152
  ds_read_b64_tr_b16 v[200:201], v248 offset:19200
  ds_read_b64_tr_b16 v[202:203], v248 offset:20224
  v_mfma_f32_16x16x32_bf16 v[156:159], v[204:207], a[92:95], v[156:159]
  s_waitcnt lgkmcnt(4)
  buffer_load_dwordx4 v238, s[16:19], s79 offen lds
  s_mov_b32 s50, 4194304
  v_mfma_f32_16x16x32_bf16 v[160:163], v[208:211], a[88:91], v[160:163]
  s_waitcnt vmcnt(7)
  s_barrier
  ds_read_b64_tr_b16 v[204:205], v247 offset:32768
  ds_read_b128 a[96:99], v243 offset:0
  v_mfma_f32_16x16x32_bf16 v[168:171], v[208:211], a[92:95], v[168:171]
  ds_read_b64_tr_b16 v[206:207], v247 offset:33792
  ds_read_b128 a[100:103], v243 offset:2048
  s_mov_b32 s51, 0x20000
  v_mfma_f32_16x16x32_bf16 v[164:167], v[212:215], a[88:91], v[164:167]
  ds_read_b64_tr_b16 v[208:209], v248 offset:32768
  ds_read_b64_tr_b16 v[210:211], v248 offset:33792
  v_mfma_f32_16x16x32_bf16 v[172:175], v[212:215], a[92:95], v[172:175]
  s_waitcnt lgkmcnt(6)
  buffer_load_dwordx4 v238, s[20:23], s79 offen offset:1024 lds
  v_mfma_f32_16x16x32_bf16 v[176:179], v[216:219], a[88:91], v[176:179]
  ds_read_b64_tr_b16 v[212:213], v247 offset:33024
  s_add_u32 s52, s96, 7168
  s_addc_u32 s53, s97, 0
  v_mfma_f32_16x16x32_bf16 v[184:187], v[216:219], a[92:95], v[184:187]
  ds_read_b64_tr_b16 v[214:215], v247 offset:34048
  s_mov_b32 s54, 4187136
  s_mov_b32 s55, 0x20000
  v_mfma_f32_16x16x32_bf16 v[180:183], v[200:203], a[88:91], v[180:183]
  ds_read_b64_tr_b16 v[216:217], v248 offset:33024
  ds_read_b64_tr_b16 v[218:219], v248 offset:34048
  v_mfma_f32_16x16x32_bf16 v[188:191], v[200:203], a[92:95], v[188:191]
  s_waitcnt lgkmcnt(4)
  buffer_load_dwordx4 v238, s[24:27], s79 offen offset:2048 lds
  v_mfma_f32_16x16x32_bf16 v[128:131], v[204:207], a[96:99], v[128:131]
  ds_read_b64_tr_b16 v[200:201], v247 offset:33280
  s_add_u32 s56, s96, 14336
  s_addc_u32 s57, s97, 0
  v_mfma_f32_16x16x32_bf16 v[136:139], v[204:207], a[100:103], v[136:139]
  ds_read_b64_tr_b16 v[202:203], v247 offset:34304
  s_mov_b32 s58, 4179968
  s_mov_b32 s59, 0x20000
  v_mfma_f32_16x16x32_bf16 v[132:135], v[208:211], a[96:99], v[132:135]
  ds_read_b64_tr_b16 v[204:205], v248 offset:33280
  ds_read_b64_tr_b16 v[206:207], v248 offset:34304
  v_mfma_f32_16x16x32_bf16 v[140:143], v[208:211], a[100:103], v[140:143]
  s_waitcnt lgkmcnt(4)
  buffer_load_dwordx4 v238, s[28:31], s79 offen offset:3072 lds
  v_mfma_f32_16x16x32_bf16 v[144:147], v[212:215], a[96:99], v[144:147]
  ds_read_b64_tr_b16 v[208:209], v247 offset:33536
  s_add_u32 s60, s96, 21504
  s_addc_u32 s61, s97, 0
  v_mfma_f32_16x16x32_bf16 v[152:155], v[212:215], a[100:103], v[152:155]
  ds_read_b64_tr_b16 v[210:211], v247 offset:34560
  s_mov_b32 s62, 4172800
  s_mov_b32 s63, 0x20000
  v_mfma_f32_16x16x32_bf16 v[148:151], v[216:219], a[96:99], v[148:151]
  s_add_u32 m0, s68, 0
  ds_read_b64_tr_b16 v[212:213], v248 offset:33536
  ds_read_b64_tr_b16 v[214:215], v248 offset:34560
  v_mfma_f32_16x16x32_bf16 v[156:159], v[216:219], a[100:103], v[156:159]
  s_waitcnt lgkmcnt(4)
  buffer_load_dwordx4 v236, s[8:11], s88 offen nt lds
  v_and_b32 v15, 7, v2
  v_mfma_f32_16x16x32_bf16 v[160:163], v[200:203], a[96:99], v[160:163]
  ds_read_b64_tr_b16 v[216:217], v247 offset:34816
  ds_read_b128 a[104:107], v244 offset:0
  v_mfma_f32_16x16x32_bf16 v[168:171], v[200:203], a[100:103], v[168:171]
  ds_read_b64_tr_b16 v[218:219], v247 offset:35840
  ds_read_b128 a[108:111], v244 offset:2048
  v_lshlrev_b32 v15, 7, v15
  v_bfe_u32 v4, v2, 3, 1
  v_lshl_add_u32 v15, v4, 12, v15
  v_bfe_u32 v16, v2, 2, 1
  v_lshl_add_u32 v16, v4, 2, v16
  v_and_b32 v5, 2, v2
  v_or_b32 v16, v16, v5
  v_lshl_add_u32 v5, v9, 1, v8
  v_xor_b32 v16, v16, v5
  v_lshl_add_u32 v241, v16, 4, v15
  v_xor_b32 v242, 64, v241
  v_subrev_u32 v245, 32768, v247
  v_xor_b32 v246, 32, v245
  v_lshl_add_u32 v16, v3, 9, v17
  v_add_u32 v249, 98304, v16
  v_xor_b32 v250, 32, v249
  s_mov_b32 s70, 0x3e0293ee
  v_mov_b32 v220, 0x3f803f80
  v_mov_b32 v221, 0x3f803f80
  v_mov_b32 v222, 0x3f803f80
  v_mov_b32 v223, 0x3f803f80
  v_mfma_f32_16x16x32_bf16 v[164:167], v[204:207], a[96:99], v[164:167]
  ds_read_b64_tr_b16 v[200:201], v248 offset:34816
  ds_read_b64_tr_b16 v[202:203], v248 offset:35840
  v_mfma_f32_16x16x32_bf16 v[172:175], v[204:207], a[100:103], v[172:175]
  s_waitcnt lgkmcnt(6)
  buffer_load_dwordx4 v236, s[8:11], s88 offen offset:1024 nt lds
  v_mfma_f32_16x16x32_bf16 v[176:179], v[208:211], a[96:99], v[176:179]
  ds_read_b64_tr_b16 v[204:205], v247 offset:35072
  v_mfma_f32_16x16x32_bf16 v[184:187], v[208:211], a[100:103], v[184:187]
  ds_read_b64_tr_b16 v[206:207], v247 offset:36096
  v_mfma_f32_16x16x32_bf16 v[180:183], v[212:215], a[96:99], v[180:183]
  ds_read_b64_tr_b16 v[208:209], v248 offset:35072
  ds_read_b64_tr_b16 v[210:211], v248 offset:36096
  v_mfma_f32_16x16x32_bf16 v[188:191], v[212:215], a[100:103], v[188:191]
  s_waitcnt lgkmcnt(4)
  buffer_load_dwordx4 v236, s[8:11], s88 offen offset:2048 nt lds
  v_mfma_f32_16x16x32_bf16 v[128:131], v[216:219], a[104:107], v[128:131]
  ds_read_b64_tr_b16 v[212:213], v247 offset:35328
  v_mfma_f32_16x16x32_bf16 v[136:139], v[216:219], a[108:111], v[136:139]
  ds_read_b64_tr_b16 v[214:215], v247 offset:36352
  v_mfma_f32_16x16x32_bf16 v[132:135], v[200:203], a[104:107], v[132:135]
  ds_read_b64_tr_b16 v[216:217], v248 offset:35328
  ds_read_b64_tr_b16 v[218:219], v248 offset:36352
  v_mfma_f32_16x16x32_bf16 v[140:143], v[200:203], a[108:111], v[140:143]
  s_waitcnt lgkmcnt(4)
  buffer_load_dwordx4 v236, s[8:11], s88 offen offset:3072 nt lds
  v_mfma_f32_16x16x32_bf16 v[144:147], v[204:207], a[104:107], v[144:147]
  ds_read_b64_tr_b16 v[200:201], v247 offset:35584
  v_mfma_f32_16x16x32_bf16 v[152:155], v[204:207], a[108:111], v[152:155]
  ds_read_b64_tr_b16 v[202:203], v247 offset:36608
  v_mfma_f32_16x16x32_bf16 v[148:151], v[208:211], a[104:107], v[148:151]
  ds_read_b64_tr_b16 v[204:205], v248 offset:35584
  v_mfma_f32_16x16x32_bf16 v[156:159], v[208:211], a[108:111], v[156:159]
  s_waitcnt lgkmcnt(3)
  ds_read_b64_tr_b16 v[206:207], v248 offset:36608
  v_mfma_f32_16x16x32_bf16 v[160:163], v[212:215], a[104:107], v[160:163]
  s_waitcnt vmcnt(4)
  s_barrier
  s_add_u32 m0, s68, 114688
  ds_read_b64_tr_b16 v[208:209], v247 offset:49152
  ds_read_b128 a[112:115], v243 offset:16384
  v_mfma_f32_16x16x32_bf16 v[168:171], v[212:215], a[108:111], v[168:171]
  ds_read_b64_tr_b16 v[210:211], v247 offset:50176
  ds_read_b128 a[116:119], v243 offset:18432
  buffer_load_dwordx4 v239, s[32:35], s80 offen lds
  v_mfma_f32_16x16x32_bf16 v[164:167], v[216:219], a[104:107], v[164:167]
  ds_read_b64_tr_b16 v[212:213], v248 offset:49152
  v_mfma_f32_16x16x32_bf16 v[172:175], v[216:219], a[108:111], v[172:175]
  s_waitcnt lgkmcnt(5)
  ds_read_b64_tr_b16 v[214:215], v248 offset:50176
  v_mfma_f32_16x16x32_bf16 v[176:179], v[200:203], a[104:107], v[176:179]
  ds_read_b64_tr_b16 v[216:217], v247 offset:49408
  ds_read_b64_tr_b16 v[218:219], v247 offset:50432
  v_mfma_f32_16x16x32_bf16 v[184:187], v[200:203], a[108:111], v[184:187]
  buffer_load_dwordx4 v239, s[36:39], s80 offen offset:1024 lds
  v_mfma_f32_16x16x32_bf16 v[180:183], v[204:207], a[104:107], v[180:183]
  ds_read_b64_tr_b16 v[200:201], v248 offset:49408
  v_mfma_f32_16x16x32_bf16 v[188:191], v[204:207], a[108:111], v[188:191]
  s_waitcnt lgkmcnt(3)
  ds_read_b64_tr_b16 v[202:203], v248 offset:50432
  v_mfma_f32_16x16x32_bf16 v[128:131], v[208:211], a[112:115], v[128:131]
  ds_read_b64_tr_b16 v[204:205], v247 offset:49664
  ds_read_b64_tr_b16 v[206:207], v247 offset:50688
  v_mfma_f32_16x16x32_bf16 v[136:139], v[208:211], a[116:119], v[136:139]
  buffer_load_dwordx4 v239, s[40:43], s80 offen offset:2048 lds
  v_mfma_f32_16x16x32_bf16 v[132:135], v[212:215], a[112:115], v[132:135]
  ds_read_b64_tr_b16 v[208:209], v248 offset:49664
  v_mfma_f32_16x16x32_bf16 v[140:143], v[212:215], a[116:119], v[140:143]
  s_waitcnt lgkmcnt(3)
  ds_read_b64_tr_b16 v[210:211], v248 offset:50688
  v_mfma_f32_16x16x32_bf16 v[144:147], v[216:219], a[112:115], v[144:147]
  ds_read_b64_tr_b16 v[212:213], v247 offset:49920
  ds_read_b64_tr_b16 v[214:215], v247 offset:50944
  v_mfma_f32_16x16x32_bf16 v[152:155], v[216:219], a[116:119], v[152:155]
  buffer_load_dwordx4 v239, s[44:47], s80 offen offset:3072 lds
  v_mfma_f32_16x16x32_bf16 v[148:151], v[200:203], a[112:115], v[148:151]
  ds_read_b64_tr_b16 v[216:217], v248 offset:49920
  v_mfma_f32_16x16x32_bf16 v[156:159], v[200:203], a[116:119], v[156:159]
  s_waitcnt lgkmcnt(3)
  ds_read_b64_tr_b16 v[218:219], v248 offset:50944
  v_mfma_f32_16x16x32_bf16 v[160:163], v[204:207], a[112:115], v[160:163]
  s_add_u32 m0, s68, 16384
  ds_read_b64_tr_b16 v[200:201], v247 offset:51200
  ds_read_b128 a[120:123], v244 offset:16384
  v_mfma_f32_16x16x32_bf16 v[168:171], v[204:207], a[116:119], v[168:171]
  ds_read_b64_tr_b16 v[202:203], v247 offset:52224
  ds_read_b128 a[124:127], v244 offset:18432
  buffer_load_dwordx4 v236, s[8:11], s89 offen nt lds
  v_mfma_f32_16x16x32_bf16 v[164:167], v[208:211], a[112:115], v[164:167]
  ds_read_b64_tr_b16 v[204:205], v248 offset:51200
  v_mfma_f32_16x16x32_bf16 v[172:175], v[208:211], a[116:119], v[172:175]
  s_waitcnt lgkmcnt(5)
  ds_read_b64_tr_b16 v[206:207], v248 offset:52224
  v_mfma_f32_16x16x32_bf16 v[176:179], v[212:215], a[112:115], v[176:179]
  ds_read_b64_tr_b16 v[208:209], v247 offset:51456
  ds_read_b64_tr_b16 v[210:211], v247 offset:52480
  v_mfma_f32_16x16x32_bf16 v[184:187], v[212:215], a[116:119], v[184:187]
  buffer_load_dwordx4 v236, s[8:11], s89 offen offset:1024 nt lds
  v_mfma_f32_16x16x32_bf16 v[180:183], v[216:219], a[112:115], v[180:183]
  ds_read_b64_tr_b16 v[212:213], v248 offset:51456
  v_mfma_f32_16x16x32_bf16 v[188:191], v[216:219], a[116:119], v[188:191]
  s_waitcnt lgkmcnt(3)
  ds_read_b64_tr_b16 v[214:215], v248 offset:52480
  v_mfma_f32_16x16x32_bf16 v[128:131], v[200:203], a[120:123], v[128:131]
  ds_read_b64_tr_b16 v[216:217], v247 offset:51712
  ds_read_b64_tr_b16 v[218:219], v247 offset:52736
  v_mfma_f32_16x16x32_bf16 v[136:139], v[200:203], a[124:127], v[136:139]
  buffer_load_dwordx4 v236, s[8:11], s89 offen offset:2048 nt lds
  v_mfma_f32_16x16x32_bf16 v[132:135], v[204:207], a[120:123], v[132:135]
  ds_read_b64_tr_b16 v[200:201], v248 offset:51712
  v_mfma_f32_16x16x32_bf16 v[140:143], v[204:207], a[124:127], v[140:143]
  s_waitcnt lgkmcnt(3)
  ds_read_b64_tr_b16 v[202:203], v248 offset:52736
  v_mfma_f32_16x16x32_bf16 v[144:147], v[208:211], a[120:123], v[144:147]
  ds_read_b64_tr_b16 v[204:205], v247 offset:51968
  v_mfma_f32_16x16x32_bf16 v[152:155], v[208:211], a[124:127], v[152:155]
  ds_read_b64_tr_b16 v[206:207], v247 offset:52992
  v_mfma_f32_16x16x32_bf16 v[148:151], v[212:215], a[120:123], v[148:151]
  ds_read_b64_tr_b16 v[208:209], v248 offset:51968
  v_mul_f32 v128, s70, v128
  v_mfma_f32_16x16x32_bf16 v[156:159], v[212:215], a[124:127], v[156:159]
  s_waitcnt lgkmcnt(3)
  ds_read_b64_tr_b16 v[210:211], v248 offset:52992
  v_mul_f32 v129, s70, v129
  v_cvt_pk_bf16_f32 v0, v128, v129
  v_mfma_f32_16x16x32_bf16 v[160:163], v[216:219], a[120:123], v[160:163]
  s_waitcnt vmcnt(7)
  s_barrier
  ds_read_b128 v[212:215], v241 offset:0
  v_mfma_f32_16x16x32_bf16 v[168:171], v[216:219], a[124:127], v[168:171]
  buffer_load_dwordx4 v236, s[8:11], s89 offen offset:3072 nt lds
  v_mul_f32 v130, s70, v130
  v_mfma_f32_16x16x32_bf16 v[164:167], v[200:203], a[120:123], v[164:167]
  ds_read_b128 v[216:219], v242 offset:0
  v_mul_f32 v131, s70, v131
  v_mfma_f32_16x16x32_bf16 v[172:175], v[200:203], a[124:127], v[172:175]
  s_waitcnt lgkmcnt(2)
  v_cvt_pk_bf16_f32 v1, v130, v131
  v_mul_f32 v132, s70, v132
  v_mul_f32 v133, s70, v133
  v_mfma_f32_16x16x32_bf16 v[176:179], v[204:207], a[120:123], v[176:179]
  s_add_u32 m0, s68, 65536
  ds_read_b128 v[200:203], v241 offset:8192
  v_cvt_pk_bf16_f32 v2, v132, v133
  v_mfma_f32_16x16x32_bf16 v[184:187], v[204:207], a[124:127], v[184:187]
  buffer_load_dwordx4 v237, s[12:15], s88 offen nt lds
  v_mul_f32 v134, s70, v134
  v_mul_f32 v135, s70, v135
  v_cvt_pk_bf16_f32 v3, v134, v135
  v_permlane16_swap_b32 v0, v2
  s_nop 0
  v_permlane16_swap_b32 v1, v3
  v_mul_f32 v136, s70, v136
  v_mul_f32 v137, s70, v137
  v_cvt_pk_bf16_f32 v4, v136, v137
  v_mul_f32 v138, s70, v138
  v_mul_f32 v139, s70, v139
  v_cvt_pk_bf16_f32 v5, v138, v139
  v_mul_f32 v140, s70, v140
  v_mul_f32 v141, s70, v141
  v_cvt_pk_bf16_f32 v6, v140, v141
  v_mul_f32 v142, s70, v142
  v_mul_f32 v143, s70, v143
  v_cvt_pk_bf16_f32 v7, v142, v143
  v_permlane16_swap_b32 v4, v6
  s_nop 0
  v_permlane16_swap_b32 v5, v7
  v_mfma_f32_16x16x32_bf16 v[180:183], v[208:211], a[120:123], v[180:183]
  ds_read_b128 v[204:207], v242 offset:8192
  v_mul_f32 v144, s70, v144
  v_mfma_f32_16x16x32_bf16 v[188:191], v[208:211], a[124:127], v[188:191]
  s_waitcnt lgkmcnt(2)
  v_mul_f32 v145, s70, v145
  v_cvt_pk_bf16_f32 v8, v144, v145
  v_mul_f32 v146, s70, v146
  v_mul_f32 v147, s70, v147
  v_cvt_pk_bf16_f32 v9, v146, v147
  v_mul_f32 v148, s70, v148
  v_mul_f32 v149, s70, v149
  v_cvt_pk_bf16_f32 v10, v148, v149
  v_mul_f32 v150, s70, v150
  v_mul_f32 v151, s70, v151
  v_cvt_pk_bf16_f32 v11, v150, v151
  v_permlane16_swap_b32 v8, v10
  s_nop 0
  v_permlane16_swap_b32 v9, v11
  v_mul_f32 v152, s70, v152
  v_mul_f32 v153, s70, v153
  v_cvt_pk_bf16_f32 v12, v152, v153
  v_mul_f32 v154, s70, v154
  v_mul_f32 v155, s70, v155
  v_cvt_pk_bf16_f32 v13, v154, v155
  v_mul_f32 v156, s70, v156
  v_mul_f32 v157, s70, v157
  v_cvt_pk_bf16_f32 v14, v156, v157
  v_mul_f32 v158, s70, v158
  v_mul_f32 v159, s70, v159
  v_cvt_pk_bf16_f32 v15, v158, v159
  v_permlane16_swap_b32 v12, v14
  s_nop 0
  v_permlane16_swap_b32 v13, v15
  v_mfma_f32_16x16x32_bf16 v[96:99], v[212:215], v[0:3], 0
  ds_read_b128 v[208:211], v241 offset:1024
  v_mul_f32 v160, s70, v160
  v_mfma_f32_16x16x32_bf16 v[104:107], v[212:215], v[4:7], 0
  buffer_load_dwordx4 v237, s[12:15], s88 offen offset:1024 nt lds
  v_mul_f32 v161, s70, v161
  v_cvt_pk_bf16_f32 v16, v160, v161
  v_mul_f32 v162, s70, v162
  v_mul_f32 v163, s70, v163
  v_cvt_pk_bf16_f32 v17, v162, v163
  v_mul_f32 v164, s70, v164
  v_mul_f32 v165, s70, v165
  v_cvt_pk_bf16_f32 v18, v164, v165
  v_mul_f32 v166, s70, v166
  v_mul_f32 v167, s70, v167
  v_cvt_pk_bf16_f32 v19, v166, v167
  v_permlane16_swap_b32 v16, v18
  s_nop 0
  v_permlane16_swap_b32 v17, v19
  v_mul_f32 v168, s70, v168
  v_mul_f32 v169, s70, v169
  v_cvt_pk_bf16_f32 v20, v168, v169
  v_mul_f32 v170, s70, v170
  v_mul_f32 v171, s70, v171
  v_cvt_pk_bf16_f32 v21, v170, v171
  v_mul_f32 v172, s70, v172
  v_mul_f32 v173, s70, v173
  v_cvt_pk_bf16_f32 v22, v172, v173
  v_mul_f32 v174, s70, v174
  v_mul_f32 v175, s70, v175
  v_cvt_pk_bf16_f32 v23, v174, v175
  v_permlane16_swap_b32 v20, v22
  s_nop 0
  v_permlane16_swap_b32 v21, v23
  v_mfma_f32_16x16x32_bf16 v[96:99], v[216:219], v[8:11], v[96:99]
  ds_read_b128 v[212:215], v242 offset:1024
  v_mul_f32 v176, s70, v176
  v_mfma_f32_16x16x32_bf16 v[104:107], v[216:219], v[12:15], v[104:107]
  s_waitcnt lgkmcnt(2)
  v_mul_f32 v177, s70, v177
  v_cvt_pk_bf16_f32 v24, v176, v177
  v_mul_f32 v178, s70, v178
  v_mul_f32 v179, s70, v179
  v_cvt_pk_bf16_f32 v25, v178, v179
  v_mul_f32 v180, s70, v180
  v_mul_f32 v181, s70, v181
  v_cvt_pk_bf16_f32 v26, v180, v181
  v_mul_f32 v182, s70, v182
  v_mul_f32 v183, s70, v183
  v_cvt_pk_bf16_f32 v27, v182, v183
  v_permlane16_swap_b32 v24, v26
  s_nop 0
  v_permlane16_swap_b32 v25, v27
  v_mul_f32 v184, s70, v184
  v_mul_f32 v185, s70, v185
  v_cvt_pk_bf16_f32 v28, v184, v185
  v_mul_f32 v186, s70, v186
  v_mul_f32 v187, s70, v187
  v_cvt_pk_bf16_f32 v29, v186, v187
  v_mul_f32 v188, s70, v188
  v_mul_f32 v189, s70, v189
  v_cvt_pk_bf16_f32 v30, v188, v189
  v_mul_f32 v190, s70, v190
  v_mul_f32 v191, s70, v191
  v_cvt_pk_bf16_f32 v31, v190, v191
  v_permlane16_swap_b32 v28, v30
  s_nop 0
  v_permlane16_swap_b32 v29, v31
  v_mfma_f32_16x16x32_bf16 v[96:99], v[200:203], v[16:19], v[96:99]
  ds_read_b128 v[216:219], v241 offset:9216
  v_mfma_f32_16x16x32_bf16 v[104:107], v[200:203], v[20:23], v[104:107]
  buffer_load_dwordx4 v237, s[12:15], s88 offen offset:2048 nt lds
  v_mfma_f32_16x16x32_bf16 v[96:99], v[204:207], v[24:27], v[96:99]
  ds_read_b128 v[200:203], v242 offset:9216
  v_mfma_f32_16x16x32_bf16 v[104:107], v[204:207], v[28:31], v[104:107]
  s_waitcnt lgkmcnt(2)
  v_mfma_f32_16x16x32_bf16 v[100:103], v[208:211], v[0:3], 0
  ds_read_b128 v[204:207], v241 offset:2048
  v_mfma_f32_16x16x32_bf16 v[108:111], v[208:211], v[4:7], 0
  buffer_load_dwordx4 v237, s[12:15], s88 offen offset:3072 nt lds
  v_mfma_f32_16x16x32_bf16 v[100:103], v[212:215], v[8:11], v[100:103]
  ds_read_b128 v[208:211], v242 offset:2048
  v_max3_f32 v193, v96, v97, v98
  v_mfma_f32_16x16x32_bf16 v[108:111], v[212:215], v[12:15], v[108:111]
  s_waitcnt lgkmcnt(2)
  v_max3_f32 v197, v104, v105, v106
  v_mfma_f32_16x16x32_bf16 v[100:103], v[216:219], v[16:19], v[100:103]
  s_add_u32 m0, s68, 131072
  ds_read_b128 v[212:215], v241 offset:10240
  v_mfma_f32_16x16x32_bf16 v[108:111], v[216:219], v[20:23], v[108:111]
  buffer_load_dwordx4 v239, s[32:35], s81 offen lds
  v_mfma_f32_16x16x32_bf16 v[100:103], v[200:203], v[24:27], v[100:103]
  ds_read_b128 v[216:219], v242 offset:10240
  v_mfma_f32_16x16x32_bf16 v[108:111], v[200:203], v[28:31], v[108:111]
  s_waitcnt lgkmcnt(2)
  v_mfma_f32_16x16x32_bf16 v[112:115], v[204:207], v[0:3], 0
  ds_read_b128 v[200:203], v241 offset:3072
  v_mfma_f32_16x16x32_bf16 v[120:123], v[204:207], v[4:7], 0
  buffer_load_dwordx4 v239, s[36:39], s81 offen offset:1024 lds
  v_mfma_f32_16x16x32_bf16 v[112:115], v[208:211], v[8:11], v[112:115]
  ds_read_b128 v[204:207], v242 offset:3072
  v_max3_f32 v193, v193, v99, v100
  v_mfma_f32_16x16x32_bf16 v[120:123], v[208:211], v[12:15], v[120:123]
  s_waitcnt lgkmcnt(2)
  v_max3_f32 v193, v193, v101, v102
  v_max3_f32 v197, v197, v107, v108
  v_mfma_f32_16x16x32_bf16 v[112:115], v[212:215], v[16:19], v[112:115]
  ds_read_b128 v[208:211], v241 offset:11264
  v_max3_f32 v197, v197, v109, v110
  v_mfma_f32_16x16x32_bf16 v[120:123], v[212:215], v[20:23], v[120:123]
  v_mfma_f32_16x16x32_bf16 v[112:115], v[216:219], v[24:27], v[112:115]
  ds_read_b128 v[212:215], v242 offset:11264
  v_mfma_f32_16x16x32_bf16 v[120:123], v[216:219], v[28:31], v[120:123]
  s_waitcnt lgkmcnt(2)
  v_mfma_f32_16x16x32_bf16 v[116:119], v[200:203], v[0:3], 0
  s_waitcnt vmcnt(10)
  s_barrier
  ds_read_b64_tr_b16 v[216:217], v247 offset:16384
  v_mfma_f32_16x16x32_bf16 v[124:127], v[200:203], v[4:7], 0
  ds_read_b64_tr_b16 v[218:219], v247 offset:17408
  v_mfma_f32_16x16x32_bf16 v[116:119], v[204:207], v[8:11], v[116:119]
  ds_read_b64_tr_b16 v[200:201], v248 offset:16384
  v_max3_f32 v193, v193, v103, v112
  v_mfma_f32_16x16x32_bf16 v[124:127], v[204:207], v[12:15], v[124:127]
  s_waitcnt lgkmcnt(3)
  ds_read_b64_tr_b16 v[202:203], v248 offset:17408
  v_max3_f32 v193, v193, v113, v114
  v_mfma_f32_16x16x32_bf16 v[116:119], v[208:211], v[16:19], v[116:119]
  ds_read_b64_tr_b16 v[204:205], v247 offset:16640
  v_max3_f32 v197, v197, v111, v120
  v_mfma_f32_16x16x32_bf16 v[124:127], v[208:211], v[20:23], v[124:127]
  ds_read_b64_tr_b16 v[206:207], v247 offset:17664
  v_max3_f32 v197, v197, v121, v122
  v_mfma_f32_16x16x32_bf16 v[116:119], v[212:215], v[24:27], v[116:119]
  ds_read_b64_tr_b16 v[208:209], v248 offset:16640
  v_mfma_f32_16x16x32_bf16 v[124:127], v[212:215], v[28:31], v[124:127]
  s_waitcnt lgkmcnt(3)
  ds_read_b64_tr_b16 v[210:211], v248 offset:17664
  v_mfma_f32_16x16x32_bf16 a[128:131], v[216:219], a[0:3], 0
  ds_read_b64_tr_b16 v[212:213], v247 offset:16896
  v_mfma_f32_16x16x32_bf16 a[136:139], v[216:219], a[4:7], 0
  ds_read_b64_tr_b16 v[214:215], v247 offset:17920
  v_mfma_f32_16x16x32_bf16 a[132:135], v[200:203], a[0:3], 0
  ds_read_b64_tr_b16 v[216:217], v248 offset:16896
  v_max3_f32 v193, v193, v115, v116
  v_mfma_f32_16x16x32_bf16 a[140:143], v[200:203], a[4:7], 0
  s_waitcnt lgkmcnt(3)
  ds_read_b64_tr_b16 v[218:219], v248 offset:17920
  v_max3_f32 v193, v193, v117, v118
  v_max_f32 v193, v193, v119
  v_mfma_f32_16x16x32_bf16 a[144:147], v[204:207], a[0:3], 0
  ds_read_b64_tr_b16 v[200:201], v247 offset:17152
  v_mov_b32 v194, v193
  v_mfma_f32_16x16x32_bf16 a[152:155], v[204:207], a[4:7], 0
  ds_read_b64_tr_b16 v[202:203], v247 offset:18176
  v_max3_f32 v197, v197, v123, v124
  v_max3_f32 v197, v197, v125, v126
  v_mfma_f32_16x16x32_bf16 a[148:151], v[208:211], a[0:3], 0
  ds_read_b64_tr_b16 v[204:205], v248 offset:17152
  v_max_f32 v197, v197, v127
  v_mfma_f32_16x16x32_bf16 a[156:159], v[208:211], a[4:7], 0
  s_waitcnt lgkmcnt(3)
  ds_read_b64_tr_b16 v[206:207], v248 offset:18176
  v_mov_b32 v198, v197
  v_permlane32_swap_b32 v194, v193
  v_mfma_f32_16x16x32_bf16 a[160:163], v[212:215], a[0:3], 0
  ds_read_b64_tr_b16 v[208:209], v247 offset:18432
  ds_read_b64_tr_b16 v[210:211], v247 offset:19456
  v_mfma_f32_16x16x32_bf16 a[168:171], v[212:215], a[4:7], 0
  buffer_load_dwordx4 v239, s[40:43], s81 offen offset:2048 lds
  v_max_f32 v193, v193, v194
  v_mfma_f32_16x16x32_bf16 a[164:167], v[216:219], a[0:3], 0
  ds_read_b64_tr_b16 v[212:213], v248 offset:18432
  v_mov_b32 v194, v193
  v_mfma_f32_16x16x32_bf16 a[172:175], v[216:219], a[4:7], 0
  s_waitcnt lgkmcnt(3)
  ds_read_b64_tr_b16 v[214:215], v248 offset:19456
  v_permlane32_swap_b32 v198, v197
  v_max_f32 v197, v197, v198
  v_mfma_f32_16x16x32_bf16 a[176:179], v[200:203], a[0:3], 0
  ds_read_b64_tr_b16 v[216:217], v247 offset:18688
  ds_read_b64_tr_b16 v[218:219], v247 offset:19712
  v_mfma_f32_16x16x32_bf16 a[184:187], v[200:203], a[4:7], 0
  buffer_load_dwordx4 v239, s[44:47], s81 offen offset:3072 lds
  v_mov_b32 v198, v197
  v_mfma_f32_16x16x32_bf16 a[180:183], v[204:207], a[0:3], 0
  ds_read_b64_tr_b16 v[200:201], v248 offset:18688
  v_permlane16_swap_b32 v194, v193
  v_mfma_f32_16x16x32_bf16 a[188:191], v[204:207], a[4:7], 0
  s_waitcnt lgkmcnt(3)
  ds_read_b64_tr_b16 v[202:203], v248 offset:19712
  v_max_f32 v193, v193, v194
  v_sub_f32 v192, 0, v193
  v_mfma_f32_16x16x32_bf16 a[128:131], v[208:211], a[8:11], a[128:131]
  s_add_u32 m0, s68, 32768
  ds_read_b64_tr_b16 v[204:205], v247 offset:18944
  ds_read_b64_tr_b16 v[206:207], v247 offset:19968
  v_mfma_f32_16x16x32_bf16 a[136:139], v[208:211], a[12:15], a[136:139]
  buffer_load_dwordx4 v236, s[8:11], s90 offen nt lds
  v_mov_b32 v193, v192
  v_mfma_f32_16x16x32_bf16 a[132:135], v[212:215], a[8:11], a[132:135]
  ds_read_b64_tr_b16 v[208:209], v248 offset:18944
  v_mov_b32 v194, v192
  v_mfma_f32_16x16x32_bf16 a[140:143], v[212:215], a[12:15], a[140:143]
  s_waitcnt lgkmcnt(3)
  ds_read_b64_tr_b16 v[210:211], v248 offset:19968
  v_mov_b32 v195, v192
  v_permlane16_swap_b32 v198, v197
  v_mfma_f32_16x16x32_bf16 a[144:147], v[216:219], a[8:11], a[144:147]
  ds_read_b64_tr_b16 v[212:213], v247 offset:19200
  v_max_f32 v197, v197, v198
  v_mfma_f32_16x16x32_bf16 a[152:155], v[216:219], a[12:15], a[152:155]
  ds_read_b64_tr_b16 v[214:215], v247 offset:20224
  v_sub_f32 v196, 0, v197
  v_mov_b32 v197, v196
  v_mfma_f32_16x16x32_bf16 a[148:151], v[200:203], a[8:11], a[148:151]
  ds_read_b64_tr_b16 v[216:217], v248 offset:19200
  v_mov_b32 v198, v196
  v_mfma_f32_16x16x32_bf16 a[156:159], v[200:203], a[12:15], a[156:159]
  s_waitcnt lgkmcnt(3)
  ds_read_b64_tr_b16 v[218:219], v248 offset:20224
  v_mov_b32 v199, v196
  v_add_f32 v96, v96, v192
  v_mfma_f32_16x16x32_bf16 a[160:163], v[204:207], a[8:11], a[160:163]
  s_waitcnt vmcnt(9)
  s_barrier
  ds_read_b128 v[200:203], v241 offset:16384
  v_mfma_f32_16x16x32_bf16 a[168:171], v[204:207], a[12:15], a[168:171]
  buffer_load_dwordx4 v236, s[8:11], s90 offen offset:1024 nt lds
  v_mfma_f32_16x16x32_bf16 a[164:167], v[208:211], a[8:11], a[164:167]
  ds_read_b128 v[204:207], v242 offset:16384
  v_mfma_f32_16x16x32_bf16 a[172:175], v[208:211], a[12:15], a[172:175]
  s_waitcnt lgkmcnt(2)
  v_exp_f32 v96, v96
  v_add_f32 v97, v97, v192
  v_mfma_f32_16x16x32_bf16 a[176:179], v[212:215], a[8:11], a[176:179]
  ds_read_b128 v[208:211], v241 offset:24576
  v_mfma_f32_16x16x32_bf16 a[184:187], v[212:215], a[12:15], a[184:187]
  buffer_load_dwordx4 v236, s[8:11], s90 offen offset:2048 nt lds
  v_mfma_f32_16x16x32_bf16 a[180:183], v[216:219], a[8:11], a[180:183]
  ds_read_b128 v[212:215], v242 offset:24576
  v_mfma_f32_16x16x32_bf16 a[188:191], v[216:219], a[12:15], a[188:191]
  s_waitcnt lgkmcnt(2)
  v_exp_f32 v97, v97
  v_add_f32 v98, v98, v192
  v_mfma_f32_16x16x32_bf16 v[160:163], v[200:203], v[0:3], v[192:195]
  ds_read_b128 v[216:219], v241 offset:17408
  v_cvt_pk_bf16_f32 v96, v96, v97
  v_mfma_f32_16x16x32_bf16 v[168:171], v[200:203], v[4:7], v[196:199]
  v_exp_f32 v98, v98
  v_add_f32 v99, v99, v192
  v_mfma_f32_16x16x32_bf16 v[160:163], v[204:207], v[8:11], v[160:163]
  ds_read_b128 v[200:203], v242 offset:17408
  v_mfma_f32_16x16x32_bf16 v[168:171], v[204:207], v[12:15], v[168:171]
  s_waitcnt lgkmcnt(2)
  buffer_load_dwordx4 v236, s[8:11], s90 offen offset:3072 nt lds
  v_mfma_f32_16x16x32_bf16 v[160:163], v[208:211], v[16:19], v[160:163]
  ds_read_b128 v[204:207], v241 offset:25600
  v_mfma_f32_16x16x32_bf16 v[168:171], v[208:211], v[20:23], v[168:171]
  v_exp_f32 v99, v99
  v_add_f32 v100, v100, v192
  v_mfma_f32_16x16x32_bf16 v[160:163], v[212:215], v[24:27], v[160:163]
  ds_read_b128 v[208:211], v242 offset:25600
  v_cvt_pk_bf16_f32 v97, v98, v99
  v_mfma_f32_16x16x32_bf16 v[168:171], v[212:215], v[28:31], v[168:171]
  s_waitcnt lgkmcnt(2)
  v_exp_f32 v100, v100
  v_add_f32 v101, v101, v192
  v_mfma_f32_16x16x32_bf16 v[164:167], v[216:219], v[0:3], v[192:195]
  ds_read_b128 v[212:215], v241 offset:18432
  v_mfma_f32_16x16x32_bf16 v[172:175], v[216:219], v[4:7], v[196:199]
  v_exp_f32 v101, v101
  v_add_f32 v102, v102, v192
  v_mfma_f32_16x16x32_bf16 v[164:167], v[200:203], v[8:11], v[164:167]
  ds_read_b128 v[216:219], v242 offset:18432
  v_cvt_pk_bf16_f32 v98, v100, v101
  v_mfma_f32_16x16x32_bf16 v[172:175], v[200:203], v[12:15], v[172:175]
  s_waitcnt lgkmcnt(2)
  v_exp_f32 v102, v102
  v_add_f32 v103, v103, v192
  v_mfma_f32_16x16x32_bf16 v[164:167], v[204:207], v[16:19], v[164:167]
  s_add_u32 m0, s68, 98304
  ds_read_b128 v[200:203], v241 offset:26624
  v_max3_f32 v253, v160, v161, v162
  v_mfma_f32_16x16x32_bf16 v[172:175], v[204:207], v[20:23], v[172:175]
  buffer_load_dwordx4 v237, s[12:15], s89 offen nt lds
  v_max3_f32 v253, v253, v163, v168
  v_mfma_f32_16x16x32_bf16 v[164:167], v[208:211], v[24:27], v[164:167]
  ds_read_b128 v[204:207], v242 offset:26624
  v_max3_f32 v253, v253, v169, v170
  v_mfma_f32_16x16x32_bf16 v[172:175], v[208:211], v[28:31], v[172:175]
  s_waitcnt lgkmcnt(2)
  v_exp_f32 v103, v103
  v_add_f32 v104, v104, v196
  v_mfma_f32_16x16x32_bf16 v[176:179], v[212:215], v[0:3], v[192:195]
  ds_read_b128 v[208:211], v241 offset:19456
  v_cvt_pk_bf16_f32 v99, v102, v103
  v_mfma_f32_16x16x32_bf16 v[184:187], v[212:215], v[4:7], v[196:199]
  v_exp_f32 v104, v104
  v_add_f32 v105, v105, v196
  v_mfma_f32_16x16x32_bf16 v[224:227], v[220:223], v[96:99], 0
  v_exp_f32 v105, v105
  v_mfma_f32_16x16x32_bf16 v[176:179], v[216:219], v[8:11], v[176:179]
  ds_read_b128 v[212:215], v242 offset:19456
  v_cvt_pk_bf16_f32 v100, v104, v105
  v_mfma_f32_16x16x32_bf16 v[184:187], v[216:219], v[12:15], v[184:187]
  s_waitcnt lgkmcnt(2)
  v_add_f32 v106, v106, v196
  v_exp_f32 v106, v106
  v_mfma_f32_16x16x32_bf16 v[176:179], v[200:203], v[16:19], v[176:179]
  ds_read_b128 v[216:219], v241 offset:27648
  v_add_f32 v107, v107, v196
  v_mfma_f32_16x16x32_bf16 v[184:187], v[200:203], v[20:23], v[184:187]
  v_exp_f32 v107, v107
  v_add_f32 v108, v108, v196
  v_mfma_f32_16x16x32_bf16 v[176:179], v[204:207], v[24:27], v[176:179]
  ds_read_b128 v[200:203], v242 offset:27648
  v_cvt_pk_bf16_f32 v101, v106, v107
  v_mfma_f32_16x16x32_bf16 v[184:187], v[204:207], v[28:31], v[184:187]
  s_waitcnt lgkmcnt(2)
  v_exp_f32 v108, v108
  v_add_f32 v109, v109, v196
  v_mfma_f32_16x16x32_bf16 v[180:183], v[208:211], v[0:3], v[192:195]
  s_waitcnt vmcnt(9)
  s_barrier
  ds_read_b64_tr_b16 v[204:205], v245 offset:0
  ds_read_b64_tr_b16 v[206:207], v245 offset:1024
  v_mfma_f32_16x16x32_bf16 v[188:191], v[208:211], v[4:7], v[196:199]
  buffer_load_dwordx4 v237, s[12:15], s89 offen offset:1024 nt lds
  v_max3_f32 v253, v253, v171, v164
  v_mfma_f32_16x16x32_bf16 v[180:183], v[212:215], v[8:11], v[180:183]
  ds_read_b64_tr_b16 v[208:209], v246 offset:0
  v_exp_f32 v109, v109
  v_mfma_f32_16x16x32_bf16 v[188:191], v[212:215], v[12:15], v[188:191]
  s_waitcnt lgkmcnt(3)
  ds_read_b64_tr_b16 v[210:211], v246 offset:1024
  v_cvt_pk_bf16_f32 v102, v108, v109
  v_add_f32 v110, v110, v196
  v_mfma_f32_16x16x32_bf16 v[180:183], v[216:219], v[16:19], v[180:183]
  ds_read_b64_tr_b16 v[212:213], v245 offset:256
  ds_read_b64_tr_b16 v[214:215], v245 offset:1280
  v_mfma_f32_16x16x32_bf16 v[188:191], v[216:219], v[20:23], v[188:191]
  buffer_load_dwordx4 v237, s[12:15], s89 offen offset:2048 nt lds
  v_exp_f32 v110, v110
  v_add_f32 v111, v111, v196
  v_exp_f32 v111, v111
  v_add_f32 v112, v112, v192
  v_cvt_pk_bf16_f32 v103, v110, v111
  v_mfma_f32_16x16x32_bf16 v[180:183], v[200:203], v[24:27], v[180:183]
  ds_read_b64_tr_b16 v[216:217], v246 offset:256
  v_exp_f32 v112, v112
  v_mfma_f32_16x16x32_bf16 v[188:191], v[200:203], v[28:31], v[188:191]
  s_waitcnt lgkmcnt(3)
  ds_read_b64_tr_b16 v[218:219], v246 offset:1280
  v_add_f32 v113, v113, v192
  v_max3_f32 v253, v253, v165, v166
  v_mfma_f32_16x16x32_bf16 v[228:231], v[220:223], v[100:103], 0
  v_exp_f32 v113, v113
  v_mfma_f32_16x16x32_bf16 v[32:35], v[204:207], v[96:99], 0
  ds_read_b64_tr_b16 v[200:201], v245 offset:512
  ds_read_b64_tr_b16 v[202:203], v245 offset:1536
  v_mfma_f32_16x16x32_bf16 v[40:43], v[204:207], v[100:103], 0
  buffer_load_dwordx4 v237, s[12:15], s89 offen offset:3072 nt lds
  v_cvt_pk_bf16_f32 v104, v112, v113
  v_mfma_f32_16x16x32_bf16 v[36:39], v[208:211], v[96:99], 0
  ds_read_b64_tr_b16 v[204:205], v246 offset:512
  v_add_f32 v114, v114, v192
  v_mfma_f32_16x16x32_bf16 v[44:47], v[208:211], v[100:103], 0
  s_waitcnt lgkmcnt(3)
  ds_read_b64_tr_b16 v[206:207], v246 offset:1536
  v_exp_f32 v114, v114
  v_mfma_f32_16x16x32_bf16 v[48:51], v[212:215], v[96:99], 0
  s_add_u32 m0, s68, 147456
  ds_read_b64_tr_b16 v[208:209], v245 offset:768
  ds_read_b64_tr_b16 v[210:211], v245 offset:1792
  v_mfma_f32_16x16x32_bf16 v[56:59], v[212:215], v[100:103], 0
  buffer_load_dwordx4 v239, s[32:35], s82 offen lds
  v_add_f32 v115, v115, v192
  v_mfma_f32_16x16x32_bf16 v[52:55], v[216:219], v[96:99], 0
  ds_read_b64_tr_b16 v[212:213], v246 offset:768
  v_exp_f32 v115, v115
  v_mfma_f32_16x16x32_bf16 v[60:63], v[216:219], v[100:103], 0
  s_waitcnt lgkmcnt(3)
  ds_read_b64_tr_b16 v[214:215], v246 offset:1792
  v_cvt_pk_bf16_f32 v105, v114, v115
  v_add_f32 v116, v116, v192
  v_mfma_f32_16x16x32_bf16 v[64:67], v[200:203], v[96:99], 0
  ds_read_b64_tr_b16 v[216:217], v245 offset:2048
  ds_read_b64_tr_b16 v[218:219], v245 offset:3072
  v_mfma_f32_16x16x32_bf16 v[72:75], v[200:203], v[100:103], 0
  buffer_load_dwordx4 v239, s[36:39], s82 offen offset:1024 lds
  v_max3_f32 v253, v253, v167, v172
  v_mfma_f32_16x16x32_bf16 v[68:71], v[204:207], v[96:99], 0
  ds_read_b64_tr_b16 v[200:201], v246 offset:2048
  v_exp_f32 v116, v116
  v_mfma_f32_16x16x32_bf16 v[76:79], v[204:207], v[100:103], 0
  s_waitcnt lgkmcnt(3)
  ds_read_b64_tr_b16 v[202:203], v246 offset:3072
  v_add_f32 v117, v117, v192
  v_max3_f32 v253, v253, v173, v174
  v_mfma_f32_16x16x32_bf16 v[80:83], v[208:211], v[96:99], 0
  ds_read_b64_tr_b16 v[204:205], v245 offset:2304
  v_exp_f32 v117, v117
  v_mfma_f32_16x16x32_bf16 v[88:91], v[208:211], v[100:103], 0
  ds_read_b64_tr_b16 v[206:207], v245 offset:3328
  v_cvt_pk_bf16_f32 v106, v116, v117
  v_add_f32 v118, v118, v192
  v_exp_f32 v118, v118
  v_add_f32 v119, v119, v192
  v_exp_f32 v119, v119
  v_add_f32 v120, v120, v196
  v_cvt_pk_bf16_f32 v107, v118, v119
  v_exp_f32 v120, v120
  v_add_f32 v121, v121, v196
  v_exp_f32 v121, v121
  v_add_f32 v122, v122, v196
  v_cvt_pk_bf16_f32 v108, v120, v121
  v_exp_f32 v122, v122
  v_add_f32 v123, v123, v196
  v_exp_f32 v123, v123
  v_add_f32 v124, v124, v196
  v_cvt_pk_bf16_f32 v109, v122, v123
  v_exp_f32 v124, v124
  v_add_f32 v125, v125, v196
  v_exp_f32 v125, v125
  v_add_f32 v126, v126, v196
  v_cvt_pk_bf16_f32 v110, v124, v125
  v_exp_f32 v126, v126
  v_add_f32 v127, v127, v196
  v_exp_f32 v127, v127
  v_max3_f32 v253, v253, v175, v176
  v_cvt_pk_bf16_f32 v111, v126, v127
  v_mfma_f32_16x16x32_bf16 v[84:87], v[212:215], v[96:99], 0
  ds_read_b64_tr_b16 v[208:209], v246 offset:2304
  ds_read_b64_tr_b16 v[210:211], v246 offset:3328
  v_mfma_f32_16x16x32_bf16 v[92:95], v[212:215], v[100:103], 0
  s_waitcnt lgkmcnt(4)
  buffer_load_dwordx4 v239, s[40:43], s82 offen offset:2048 lds
  v_mfma_f32_16x16x32_bf16 v[224:227], v[220:223], v[104:107], v[224:227]
  v_max3_f32 v253, v253, v177, v178
  v_max3_f32 v253, v253, v179, v184
  v_mfma_f32_16x16x32_bf16 v[32:35], v[216:219], v[104:107], v[32:35]
  ds_read_b64_tr_b16 v[212:213], v245 offset:2560
  v_max3_f32 v253, v253, v185, v186
  v_mfma_f32_16x16x32_bf16 v[40:43], v[216:219], v[108:111], v[40:43]
  ds_read_b64_tr_b16 v[214:215], v245 offset:3584
  v_max3_f32 v253, v253, v187, v180
  v_mfma_f32_16x16x32_bf16 v[228:231], v[220:223], v[108:111], v[228:231]
  v_max3_f32 v253, v253, v181, v182
  v_max3_f32 v253, v253, v183, v188
  v_mfma_f32_16x16x32_bf16 v[36:39], v[200:203], v[104:107], v[36:39]
  ds_read_b64_tr_b16 v[216:217], v246 offset:2560
  v_max3_f32 v253, v253, v189, v190
  v_mfma_f32_16x16x32_bf16 v[44:47], v[200:203], v[108:111], v[44:47]
  s_waitcnt lgkmcnt(3)
  ds_read_b64_tr_b16 v[218:219], v246 offset:3584
  v_max_f32 v253, v253, v191
  v_mfma_f32_16x16x32_bf16 v[48:51], v[204:207], v[104:107], v[48:51]
  ds_read_b64_tr_b16 v[200:201], v245 offset:2816
  ds_read_b64_tr_b16 v[202:203], v245 offset:3840
  v_mfma_f32_16x16x32_bf16 v[56:59], v[204:207], v[108:111], v[56:59]
  buffer_load_dwordx4 v239, s[44:47], s82 offen offset:3072 lds
  v_mfma_f32_16x16x32_bf16 v[52:55], v[208:211], v[104:107], v[52:55]
  ds_read_b64_tr_b16 v[204:205], v246 offset:2816
  v_cmp_lt_f32 vcc, 0x41200000, v253
  v_mfma_f32_16x16x32_bf16 v[60:63], v[208:211], v[108:111], v[60:63]
  s_waitcnt lgkmcnt(3)
  ds_read_b64_tr_b16 v[206:207], v246 offset:3840
  v_mfma_f32_16x16x32_bf16 v[64:67], v[212:215], v[104:107], v[64:67]
  s_waitcnt vmcnt(12)
  s_barrier
  ds_read_b64_tr_b16 v[208:209], v247 offset:32768
  v_mfma_f32_16x16x32_bf16 v[72:75], v[212:215], v[108:111], v[72:75]
  ds_read_b64_tr_b16 v[210:211], v247 offset:33792
  v_mfma_f32_16x16x32_bf16 v[68:71], v[216:219], v[104:107], v[68:71]
  ds_read_b64_tr_b16 v[212:213], v248 offset:32768
  v_mfma_f32_16x16x32_bf16 v[76:79], v[216:219], v[108:111], v[76:79]
  s_waitcnt lgkmcnt(3)
  ds_read_b64_tr_b16 v[214:215], v248 offset:33792
  v_mfma_f32_16x16x32_bf16 v[80:83], v[200:203], v[104:107], v[80:83]
  ds_read_b64_tr_b16 v[216:217], v247 offset:33024
  v_mfma_f32_16x16x32_bf16 v[88:91], v[200:203], v[108:111], v[88:91]
  ds_read_b64_tr_b16 v[218:219], v247 offset:34048
  v_mfma_f32_16x16x32_bf16 v[84:87], v[204:207], v[104:107], v[84:87]
  ds_read_b64_tr_b16 v[200:201], v248 offset:33024
  v_mfma_f32_16x16x32_bf16 v[92:95], v[204:207], v[108:111], v[92:95]
  s_waitcnt lgkmcnt(3)
  s_cbranch_vccnz L_r0_1t
L_r0_1:
  ds_read_b64_tr_b16 v[202:203], v248 offset:34048
  v_mfma_f32_16x16x32_bf16 a[128:131], v[208:211], a[16:19], a[128:131]
  ds_read_b64_tr_b16 v[204:205], v247 offset:33280
  ds_read_b64_tr_b16 v[206:207], v247 offset:34304
  v_mfma_f32_16x16x32_bf16 a[136:139], v[208:211], a[20:23], a[136:139]
  v_exp_f32 v160, v160
  v_mfma_f32_16x16x32_bf16 a[132:135], v[212:215], a[16:19], a[132:135]
  ds_read_b64_tr_b16 v[208:209], v248 offset:33280
  ds_read_b64_tr_b16 v[210:211], v248 offset:34304
  v_mfma_f32_16x16x32_bf16 a[140:143], v[212:215], a[20:23], a[140:143]
  s_waitcnt lgkmcnt(4)
  v_exp_f32 v161, v161
  v_mfma_f32_16x16x32_bf16 a[144:147], v[216:219], a[16:19], a[144:147]
  ds_read_b64_tr_b16 v[212:213], v247 offset:33536
  v_cvt_pk_bf16_f32 v160, v160, v161
  v_mfma_f32_16x16x32_bf16 a[152:155], v[216:219], a[20:23], a[152:155]
  ds_read_b64_tr_b16 v[214:215], v247 offset:34560
  v_mfma_f32_16x16x32_bf16 a[148:151], v[200:203], a[16:19], a[148:151]
  ds_read_b64_tr_b16 v[216:217], v248 offset:33536
  ds_read_b64_tr_b16 v[218:219], v248 offset:34560
  v_mfma_f32_16x16x32_bf16 a[156:159], v[200:203], a[20:23], a[156:159]
  s_waitcnt lgkmcnt(4)
  v_exp_f32 v162, v162
  v_mfma_f32_16x16x32_bf16 a[160:163], v[204:207], a[16:19], a[160:163]
  ds_read_b64_tr_b16 v[200:201], v247 offset:34816
  ds_read_b64_tr_b16 v[202:203], v247 offset:35840
  v_mfma_f32_16x16x32_bf16 a[168:171], v[204:207], a[20:23], a[168:171]
  v_exp_f32 v163, v163
  v_mfma_f32_16x16x32_bf16 a[164:167], v[208:211], a[16:19], a[164:167]
  ds_read_b64_tr_b16 v[204:205], v248 offset:34816
  v_cvt_pk_bf16_f32 v161, v162, v163
  v_mfma_f32_16x16x32_bf16 a[172:175], v[208:211], a[20:23], a[172:175]
  s_waitcnt lgkmcnt(3)
  ds_read_b64_tr_b16 v[206:207], v248 offset:35840
  v_mfma_f32_16x16x32_bf16 a[176:179], v[212:215], a[16:19], a[176:179]
  ds_read_b64_tr_b16 v[208:209], v247 offset:35072
  ds_read_b64_tr_b16 v[210:211], v247 offset:36096
  v_mfma_f32_16x16x32_bf16 a[184:187], v[212:215], a[20:23], a[184:187]
  v_exp_f32 v164, v164
  v_mfma_f32_16x16x32_bf16 a[180:183], v[216:219], a[16:19], a[180:183]
  ds_read_b64_tr_b16 v[212:213], v248 offset:35072
  ds_read_b64_tr_b16 v[214:215], v248 offset:36096
  v_mfma_f32_16x16x32_bf16 a[188:191], v[216:219], a[20:23], a[188:191]
  s_waitcnt lgkmcnt(4)
  v_exp_f32 v165, v165
  v_mfma_f32_16x16x32_bf16 a[128:131], v[200:203], a[24:27], a[128:131]
  ds_read_b64_tr_b16 v[216:217], v247 offset:35328
  v_cvt_pk_bf16_f32 v162, v164, v165
  v_mfma_f32_16x16x32_bf16 a[136:139], v[200:203], a[28:31], a[136:139]
  ds_read_b64_tr_b16 v[218:219], v247 offset:36352
  v_mfma_f32_16x16x32_bf16 a[132:135], v[204:207], a[24:27], a[132:135]
  ds_read_b64_tr_b16 v[200:201], v248 offset:35328
  ds_read_b64_tr_b16 v[202:203], v248 offset:36352
  v_mfma_f32_16x16x32_bf16 a[140:143], v[204:207], a[28:31], a[140:143]
  s_waitcnt lgkmcnt(4)
  v_exp_f32 v166, v166
  v_mfma_f32_16x16x32_bf16 a[144:147], v[208:211], a[24:27], a[144:147]
  ds_read_b64_tr_b16 v[204:205], v247 offset:35584
  ds_read_b64_tr_b16 v[206:207], v247 offset:36608
  v_mfma_f32_16x16x32_bf16 a[152:155], v[208:211], a[28:31], a[152:155]
  v_exp_f32 v167, v167
  v_mfma_f32_16x16x32_bf16 a[148:151], v[212:215], a[24:27], a[148:151]
  s_add_u32 m0, s68, 114688
  ds_read_b64_tr_b16 v[208:209], v248 offset:35584
  ds_read_b64_tr_b16 v[210:211], v248 offset:36608
  v_mfma_f32_16x16x32_bf16 a[156:159], v[212:215], a[28:31], a[156:159]
  s_waitcnt lgkmcnt(4)
  buffer_load_dwordx4 v239, s[32:35], s83 offen lds
  v_mfma_f32_16x16x32_bf16 a[160:163], v[216:219], a[24:27], a[160:163]
  s_waitcnt vmcnt(9)
  s_barrier
  ds_read_b128 v[212:215], v241 offset:32768
  v_mfma_f32_16x16x32_bf16 a[168:171], v[216:219], a[28:31], a[168:171]
  v_cvt_pk_bf16_f32 v163, v166, v167
  v_exp_f32 v168, v168
  v_mfma_f32_16x16x32_bf16 a[164:167], v[200:203], a[24:27], a[164:167]
  ds_read_b128 v[216:219], v242 offset:32768
  v_mfma_f32_16x16x32_bf16 a[172:175], v[200:203], a[28:31], a[172:175]
  s_waitcnt lgkmcnt(2)
  buffer_load_dwordx4 v239, s[36:39], s83 offen offset:1024 lds
  v_mfma_f32_16x16x32_bf16 v[224:227], v[220:223], v[160:163], v[224:227]
  v_exp_f32 v169, v169
  v_mfma_f32_16x16x32_bf16 a[176:179], v[204:207], a[24:27], a[176:179]
  ds_read_b128 v[200:203], v241 offset:40960
  v_cvt_pk_bf16_f32 v164, v168, v169
  v_mfma_f32_16x16x32_bf16 a[184:187], v[204:207], a[28:31], a[184:187]
  v_exp_f32 v170, v170
  v_mfma_f32_16x16x32_bf16 a[180:183], v[208:211], a[24:27], a[180:183]
  ds_read_b128 v[204:207], v242 offset:40960
  v_mfma_f32_16x16x32_bf16 a[188:191], v[208:211], a[28:31], a[188:191]
  s_waitcnt lgkmcnt(2)
  buffer_load_dwordx4 v239, s[40:43], s83 offen offset:2048 lds
  v_mfma_f32_16x16x32_bf16 v[96:99], v[212:215], v[0:3], v[192:195]
  ds_read_b128 v[208:211], v241 offset:33792
  v_mfma_f32_16x16x32_bf16 v[104:107], v[212:215], v[4:7], v[196:199]
  v_exp_f32 v171, v171
  v_mfma_f32_16x16x32_bf16 v[96:99], v[216:219], v[8:11], v[96:99]
  ds_read_b128 v[212:215], v242 offset:33792
  v_cvt_pk_bf16_f32 v165, v170, v171
  v_mfma_f32_16x16x32_bf16 v[104:107], v[216:219], v[12:15], v[104:107]
  s_waitcnt lgkmcnt(2)
  buffer_load_dwordx4 v239, s[44:47], s83 offen offset:3072 lds
  v_mfma_f32_16x16x32_bf16 v[96:99], v[200:203], v[16:19], v[96:99]
  ds_read_b128 v[216:219], v241 offset:41984
  v_mfma_f32_16x16x32_bf16 v[104:107], v[200:203], v[20:23], v[104:107]
  v_exp_f32 v172, v172
  v_mfma_f32_16x16x32_bf16 v[96:99], v[204:207], v[24:27], v[96:99]
  s_add_u32 m0, s68, 49152
  ds_read_b128 v[200:203], v242 offset:41984
  v_mfma_f32_16x16x32_bf16 v[104:107], v[204:207], v[28:31], v[104:107]
  s_waitcnt lgkmcnt(2)
  buffer_load_dwordx4 v236, s[8:11], s91 offen nt lds
  v_mfma_f32_16x16x32_bf16 v[100:103], v[208:211], v[0:3], v[192:195]
  ds_read_b128 v[204:207], v241 offset:34816
  v_mfma_f32_16x16x32_bf16 v[108:111], v[208:211], v[4:7], v[196:199]
  v_exp_f32 v173, v173
  v_mfma_f32_16x16x32_bf16 v[100:103], v[212:215], v[8:11], v[100:103]
  ds_read_b128 v[208:211], v242 offset:34816
  v_cvt_pk_bf16_f32 v166, v172, v173
  v_mfma_f32_16x16x32_bf16 v[108:111], v[212:215], v[12:15], v[108:111]
  s_waitcnt lgkmcnt(2)
  v_exp_f32 v174, v174
  v_max3_f32 v253, v96, v97, v98
  v_mfma_f32_16x16x32_bf16 v[100:103], v[216:219], v[16:19], v[100:103]
  ds_read_b128 v[212:215], v241 offset:43008
  v_max3_f32 v253, v253, v99, v104
  v_mfma_f32_16x16x32_bf16 v[108:111], v[216:219], v[20:23], v[108:111]
  v_exp_f32 v175, v175
  v_max3_f32 v253, v253, v105, v106
  v_mfma_f32_16x16x32_bf16 v[100:103], v[200:203], v[24:27], v[100:103]
  ds_read_b128 v[216:219], v242 offset:43008
  v_cvt_pk_bf16_f32 v167, v174, v175
  v_mfma_f32_16x16x32_bf16 v[108:111], v[200:203], v[28:31], v[108:111]
  s_waitcnt lgkmcnt(2)
  v_exp_f32 v176, v176
  v_mfma_f32_16x16x32_bf16 v[228:231], v[220:223], v[164:167], v[228:231]
  v_exp_f32 v177, v177
  v_mfma_f32_16x16x32_bf16 v[112:115], v[204:207], v[0:3], v[192:195]
  ds_read_b128 v[200:203], v241 offset:35840
  v_cvt_pk_bf16_f32 v168, v176, v177
  v_mfma_f32_16x16x32_bf16 v[120:123], v[204:207], v[4:7], v[196:199]
  v_exp_f32 v178, v178
  v_mfma_f32_16x16x32_bf16 v[112:115], v[208:211], v[8:11], v[112:115]
  ds_read_b128 v[204:207], v242 offset:35840
  v_max3_f32 v253, v253, v107, v100
  v_mfma_f32_16x16x32_bf16 v[120:123], v[208:211], v[12:15], v[120:123]
  s_waitcnt lgkmcnt(2)
  buffer_load_dwordx4 v236, s[8:11], s91 offen offset:1024 nt lds
  v_max3_f32 v253, v253, v101, v102
  v_mfma_f32_16x16x32_bf16 v[112:115], v[212:215], v[16:19], v[112:115]
  ds_read_b128 v[208:211], v241 offset:44032
  v_max3_f32 v253, v253, v103, v108
  v_mfma_f32_16x16x32_bf16 v[120:123], v[212:215], v[20:23], v[120:123]
  v_exp_f32 v179, v179
  v_max3_f32 v253, v253, v109, v110
  v_mfma_f32_16x16x32_bf16 v[112:115], v[216:219], v[24:27], v[112:115]
  ds_read_b128 v[212:215], v242 offset:44032
  v_cvt_pk_bf16_f32 v169, v178, v179
  v_mfma_f32_16x16x32_bf16 v[120:123], v[216:219], v[28:31], v[120:123]
  s_waitcnt lgkmcnt(2)
  buffer_load_dwordx4 v236, s[8:11], s91 offen offset:2048 nt lds
  v_mfma_f32_16x16x32_bf16 v[116:119], v[200:203], v[0:3], v[192:195]
  s_waitcnt vmcnt(11)
  s_barrier
  ds_read_b64_tr_b16 v[216:217], v245 offset:32768
  ds_read_b64_tr_b16 v[218:219], v245 offset:33792
  v_mfma_f32_16x16x32_bf16 v[124:127], v[200:203], v[4:7], v[196:199]
  v_exp_f32 v180, v180
  v_mfma_f32_16x16x32_bf16 v[116:119], v[204:207], v[8:11], v[116:119]
  ds_read_b64_tr_b16 v[200:201], v246 offset:32768
  ds_read_b64_tr_b16 v[202:203], v246 offset:33792
  v_mfma_f32_16x16x32_bf16 v[124:127], v[204:207], v[12:15], v[124:127]
  s_waitcnt lgkmcnt(4)
  buffer_load_dwordx4 v236, s[8:11], s91 offen offset:3072 nt lds
  v_max3_f32 v253, v253, v111, v112
  v_mfma_f32_16x16x32_bf16 v[116:119], v[208:211], v[16:19], v[116:119]
  ds_read_b64_tr_b16 v[204:205], v245 offset:33024
  v_exp_f32 v181, v181
  v_mfma_f32_16x16x32_bf16 v[124:127], v[208:211], v[20:23], v[124:127]
  ds_read_b64_tr_b16 v[206:207], v245 offset:34048
  v_cvt_pk_bf16_f32 v170, v180, v181
  v_mfma_f32_16x16x32_bf16 v[116:119], v[212:215], v[24:27], v[116:119]
  s_add_u32 m0, s68, 131072
  ds_read_b64_tr_b16 v[208:209], v246 offset:33024
  ds_read_b64_tr_b16 v[210:211], v246 offset:34048
  v_mfma_f32_16x16x32_bf16 v[124:127], v[212:215], v[28:31], v[124:127]
  s_waitcnt lgkmcnt(4)
  buffer_load_dwordx4 v239, s[32:35], s84 offen lds
  v_max3_f32 v253, v253, v113, v114
  v_mfma_f32_16x16x32_bf16 v[32:35], v[216:219], v[160:163], v[32:35]
  ds_read_b64_tr_b16 v[212:213], v245 offset:33280
  v_exp_f32 v182, v182
  v_mfma_f32_16x16x32_bf16 v[40:43], v[216:219], v[164:167], v[40:43]
  ds_read_b64_tr_b16 v[214:215], v245 offset:34304
  v_exp_f32 v183, v183
  v_mfma_f32_16x16x32_bf16 v[36:39], v[200:203], v[160:163], v[36:39]
  ds_read_b64_tr_b16 v[216:217], v246 offset:33280
  ds_read_b64_tr_b16 v[218:219], v246 offset:34304
  v_mfma_f32_16x16x32_bf16 v[44:47], v[200:203], v[164:167], v[44:47]
  s_waitcnt lgkmcnt(4)
  buffer_load_dwordx4 v239, s[36:39], s84 offen offset:1024 lds
  v_cvt_pk_bf16_f32 v171, v182, v183
  v_mfma_f32_16x16x32_bf16 v[48:51], v[204:207], v[160:163], v[48:51]
  ds_read_b64_tr_b16 v[200:201], v245 offset:33536
  v_exp_f32 v184, v184
  v_mfma_f32_16x16x32_bf16 v[56:59], v[204:207], v[164:167], v[56:59]
  ds_read_b64_tr_b16 v[202:203], v245 offset:34560
  v_exp_f32 v185, v185
  v_mfma_f32_16x16x32_bf16 v[224:227], v[220:223], v[168:171], v[224:227]
  v_cvt_pk_bf16_f32 v172, v184, v185
  v_max3_f32 v253, v253, v115, v120
  v_mfma_f32_16x16x32_bf16 v[52:55], v[208:211], v[160:163], v[52:55]
  ds_read_b64_tr_b16 v[204:205], v246 offset:33536
  ds_read_b64_tr_b16 v[206:207], v246 offset:34560
  v_mfma_f32_16x16x32_bf16 v[60:63], v[208:211], v[164:167], v[60:63]
  s_waitcnt lgkmcnt(4)
  buffer_load_dwordx4 v239, s[40:43], s84 offen offset:2048 lds
  v_max3_f32 v253, v253, v121, v122
  v_mfma_f32_16x16x32_bf16 v[64:67], v[212:215], v[160:163], v[64:67]
  ds_read_b64_tr_b16 v[208:209], v245 offset:34816
  v_exp_f32 v186, v186
  v_mfma_f32_16x16x32_bf16 v[72:75], v[212:215], v[164:167], v[72:75]
  ds_read_b64_tr_b16 v[210:211], v245 offset:35840
  v_exp_f32 v187, v187
  v_mfma_f32_16x16x32_bf16 v[68:71], v[216:219], v[160:163], v[68:71]
  ds_read_b64_tr_b16 v[212:213], v246 offset:34816
  ds_read_b64_tr_b16 v[214:215], v246 offset:35840
  v_mfma_f32_16x16x32_bf16 v[76:79], v[216:219], v[164:167], v[76:79]
  s_waitcnt lgkmcnt(4)
  buffer_load_dwordx4 v239, s[44:47], s84 offen offset:3072 lds
  v_cvt_pk_bf16_f32 v173, v186, v187
  v_mfma_f32_16x16x32_bf16 v[80:83], v[200:203], v[160:163], v[80:83]
  ds_read_b64_tr_b16 v[216:217], v245 offset:35072
  v_exp_f32 v188, v188
  v_mfma_f32_16x16x32_bf16 v[88:91], v[200:203], v[164:167], v[88:91]
  ds_read_b64_tr_b16 v[218:219], v245 offset:36096
  v_exp_f32 v189, v189
  v_exp_f32 v190, v190
  v_cvt_pk_bf16_f32 v174, v188, v189
  v_exp_f32 v191, v191
  v_max3_f32 v253, v253, v123, v116
  v_cvt_pk_bf16_f32 v175, v190, v191
  v_mfma_f32_16x16x32_bf16 v[84:87], v[204:207], v[160:163], v[84:87]
  s_add_u32 m0, s68, 81920
  ds_read_b64_tr_b16 v[200:201], v246 offset:35072
  ds_read_b64_tr_b16 v[202:203], v246 offset:36096
  v_mfma_f32_16x16x32_bf16 v[92:95], v[204:207], v[164:167], v[92:95]
  s_waitcnt lgkmcnt(4)
  buffer_load_dwordx4 v237, s[12:15], s90 offen nt lds
  v_mfma_f32_16x16x32_bf16 v[228:231], v[220:223], v[172:175], v[228:231]
  v_max3_f32 v253, v253, v117, v118
  v_max3_f32 v253, v253, v119, v124
  v_mfma_f32_16x16x32_bf16 v[32:35], v[208:211], v[168:171], v[32:35]
  ds_read_b64_tr_b16 v[204:205], v245 offset:35328
  v_max3_f32 v253, v253, v125, v126
  v_mfma_f32_16x16x32_bf16 v[40:43], v[208:211], v[172:175], v[40:43]
  ds_read_b64_tr_b16 v[206:207], v245 offset:36352
  v_max_f32 v253, v253, v127
  v_mfma_f32_16x16x32_bf16 v[36:39], v[212:215], v[168:171], v[36:39]
  ds_read_b64_tr_b16 v[208:209], v246 offset:35328
  ds_read_b64_tr_b16 v[210:211], v246 offset:36352
  v_mfma_f32_16x16x32_bf16 v[44:47], v[212:215], v[172:175], v[44:47]
  s_waitcnt lgkmcnt(4)
  buffer_load_dwordx4 v237, s[12:15], s90 offen offset:1024 nt lds
  v_mfma_f32_16x16x32_bf16 v[48:51], v[216:219], v[168:171], v[48:51]
  ds_read_b64_tr_b16 v[212:213], v245 offset:35584
  v_cmp_lt_f32 vcc, 0x41200000, v253
  v_mfma_f32_16x16x32_bf16 v[56:59], v[216:219], v[172:175], v[56:59]
  ds_read_b64_tr_b16 v[214:215], v245 offset:36608
  v_mfma_f32_16x16x32_bf16 v[52:55], v[200:203], v[168:171], v[52:55]
  ds_read_b64_tr_b16 v[216:217], v246 offset:35584
  v_mfma_f32_16x16x32_bf16 v[60:63], v[200:203], v[172:175], v[60:63]
  s_waitcnt lgkmcnt(3)
  ds_read_b64_tr_b16 v[218:219], v246 offset:36608
  v_mfma_f32_16x16x32_bf16 v[64:67], v[204:207], v[168:171], v[64:67]
  s_waitcnt vmcnt(14)
  s_barrier
  ds_read_b64_tr_b16 v[200:201], v247 offset:49152
  v_mfma_f32_16x16x32_bf16 v[72:75], v[204:207], v[172:175], v[72:75]
  ds_read_b64_tr_b16 v[202:203], v247 offset:50176
  v_mfma_f32_16x16x32_bf16 v[68:71], v[208:211], v[168:171], v[68:71]
  ds_read_b64_tr_b16 v[204:205], v248 offset:49152
  v_mfma_f32_16x16x32_bf16 v[76:79], v[208:211], v[172:175], v[76:79]
  s_waitcnt lgkmcnt(3)
  ds_read_b64_tr_b16 v[206:207], v248 offset:50176
  v_mfma_f32_16x16x32_bf16 v[80:83], v[212:215], v[168:171], v[80:83]
  ds_read_b64_tr_b16 v[208:209], v247 offset:49408
  v_mfma_f32_16x16x32_bf16 v[88:91], v[212:215], v[172:175], v[88:91]
  ds_read_b64_tr_b16 v[210:211], v247 offset:50432
  v_mfma_f32_16x16x32_bf16 v[84:87], v[216:219], v[168:171], v[84:87]
  ds_read_b64_tr_b16 v[212:213], v248 offset:49408
  v_mfma_f32_16x16x32_bf16 v[92:95], v[216:219], v[172:175], v[92:95]
  s_waitcnt lgkmcnt(3)
  s_cbranch_vccnz L_r0_2t
L_r0_2:
  ds_read_b64_tr_b16 v[214:215], v248 offset:50432
  v_mfma_f32_16x16x32_bf16 a[128:131], v[200:203], a[32:35], a[128:131]
  ds_read_b64_tr_b16 v[216:217], v247 offset:49664
  ds_read_b64_tr_b16 v[218:219], v247 offset:50688
  v_mfma_f32_16x16x32_bf16 a[136:139], v[200:203], a[36:39], a[136:139]
  v_exp_f32 v96, v96
  v_mfma_f32_16x16x32_bf16 a[132:135], v[204:207], a[32:35], a[132:135]
  ds_read_b64_tr_b16 v[200:201], v248 offset:49664
  ds_read_b64_tr_b16 v[202:203], v248 offset:50688
  v_mfma_f32_16x16x32_bf16 a[140:143], v[204:207], a[36:39], a[140:143]
  s_waitcnt lgkmcnt(4)
  v_exp_f32 v97, v97
  v_mfma_f32_16x16x32_bf16 a[144:147], v[208:211], a[32:35], a[144:147]
  ds_read_b64_tr_b16 v[204:205], v247 offset:49920
  v_cvt_pk_bf16_f32 v96, v96, v97
  v_mfma_f32_16x16x32_bf16 a[152:155], v[208:211], a[36:39], a[152:155]
  ds_read_b64_tr_b16 v[206:207], v247 offset:50944
  v_mfma_f32_16x16x32_bf16 a[148:151], v[212:215], a[32:35], a[148:151]
  ds_read_b64_tr_b16 v[208:209], v248 offset:49920
  ds_read_b64_tr_b16 v[210:211], v248 offset:50944
  v_mfma_f32_16x16x32_bf16 a[156:159], v[212:215], a[36:39], a[156:159]
  s_waitcnt lgkmcnt(4)
  v_exp_f32 v98, v98
  v_mfma_f32_16x16x32_bf16 a[160:163], v[216:219], a[32:35], a[160:163]
  ds_read_b64_tr_b16 v[212:213], v247 offset:51200
  ds_read_b64_tr_b16 v[214:215], v247 offset:52224
  v_mfma_f32_16x16x32_bf16 a[168:171], v[216:219], a[36:39], a[168:171]
  v_exp_f32 v99, v99
  v_mfma_f32_16x16x32_bf16 a[164:167], v[200:203], a[32:35], a[164:167]
  ds_read_b64_tr_b16 v[216:217], v248 offset:51200
  v_cvt_pk_bf16_f32 v97, v98, v99
  v_mfma_f32_16x16x32_bf16 a[172:175], v[200:203], a[36:39], a[172:175]
  s_waitcnt lgkmcnt(3)
  ds_read_b64_tr_b16 v[218:219], v248 offset:52224
  v_mfma_f32_16x16x32_bf16 a[176:179], v[204:207], a[32:35], a[176:179]
  ds_read_b64_tr_b16 v[200:201], v247 offset:51456
  ds_read_b64_tr_b16 v[202:203], v247 offset:52480
  v_mfma_f32_16x16x32_bf16 a[184:187], v[204:207], a[36:39], a[184:187]
  v_exp_f32 v100, v100
  v_mfma_f32_16x16x32_bf16 a[180:183], v[208:211], a[32:35], a[180:183]
  ds_read_b64_tr_b16 v[204:205], v248 offset:51456
  ds_read_b64_tr_b16 v[206:207], v248 offset:52480
  v_mfma_f32_16x16x32_bf16 a[188:191], v[208:211], a[36:39], a[188:191]
  s_waitcnt lgkmcnt(4)
  v_exp_f32 v101, v101
  v_mfma_f32_16x16x32_bf16 a[128:131], v[212:215], a[40:43], a[128:131]
  ds_read_b64_tr_b16 v[208:209], v247 offset:51712
  v_cvt_pk_bf16_f32 v98, v100, v101
  v_mfma_f32_16x16x32_bf16 a[136:139], v[212:215], a[44:47], a[136:139]
  ds_read_b64_tr_b16 v[210:211], v247 offset:52736
  v_mfma_f32_16x16x32_bf16 a[132:135], v[216:219], a[40:43], a[132:135]
  ds_read_b64_tr_b16 v[212:213], v248 offset:51712
  ds_read_b64_tr_b16 v[214:215], v248 offset:52736
  v_mfma_f32_16x16x32_bf16 a[140:143], v[216:219], a[44:47], a[140:143]
  s_waitcnt lgkmcnt(4)
  v_exp_f32 v102, v102
  v_mfma_f32_16x16x32_bf16 a[144:147], v[200:203], a[40:43], a[144:147]
  ds_read_b64_tr_b16 v[216:217], v247 offset:51968
  ds_read_b64_tr_b16 v[218:219], v247 offset:52992
  v_mfma_f32_16x16x32_bf16 a[152:155], v[200:203], a[44:47], a[152:155]
  v_exp_f32 v103, v103
  v_mfma_f32_16x16x32_bf16 a[148:151], v[204:207], a[40:43], a[148:151]
  ds_read_b64_tr_b16 v[200:201], v248 offset:51968
  v_cvt_pk_bf16_f32 v99, v102, v103
  v_mfma_f32_16x16x32_bf16 a[156:159], v[204:207], a[44:47], a[156:159]
  s_waitcnt lgkmcnt(3)
  ds_read_b64_tr_b16 v[202:203], v248 offset:52992
  v_mfma_f32_16x16x32_bf16 v[224:227], v[220:223], v[96:99], v[224:227]
  v_exp_f32 v104, v104
  v_mfma_f32_16x16x32_bf16 a[160:163], v[208:211], a[40:43], a[160:163]
  s_waitcnt vmcnt(10)
  s_barrier
  ds_read_b64_tr_b16 v[204:205], v247 offset:16384
  ds_read_b64_tr_b16 v[206:207], v247 offset:17408
  v_mfma_f32_16x16x32_bf16 a[168:171], v[208:211], a[44:47], a[168:171]
  v_exp_f32 v105, v105
  v_mfma_f32_16x16x32_bf16 a[164:167], v[212:215], a[40:43], a[164:167]
  ds_read_b64_tr_b16 v[208:209], v248 offset:16384
  ds_read_b64_tr_b16 v[210:211], v248 offset:17408
  v_mfma_f32_16x16x32_bf16 a[172:175], v[212:215], a[44:47], a[172:175]
  s_waitcnt lgkmcnt(4)
  buffer_load_dwordx4 v237, s[12:15], s90 offen offset:2048 nt lds
  v_mfma_f32_16x16x32_bf16 a[176:179], v[216:219], a[40:43], a[176:179]
  ds_read_b64_tr_b16 v[212:213], v247 offset:16640
  v_cvt_pk_bf16_f32 v100, v104, v105
  v_mfma_f32_16x16x32_bf16 a[184:187], v[216:219], a[44:47], a[184:187]
  ds_read_b64_tr_b16 v[214:215], v247 offset:17664
  v_mfma_f32_16x16x32_bf16 a[180:183], v[200:203], a[40:43], a[180:183]
  ds_read_b64_tr_b16 v[216:217], v248 offset:16640
  ds_read_b64_tr_b16 v[218:219], v248 offset:17664
  v_mfma_f32_16x16x32_bf16 a[188:191], v[200:203], a[44:47], a[188:191]
  s_waitcnt lgkmcnt(4)
  buffer_load_dwordx4 v237, s[12:15], s90 offen offset:3072 nt lds
  v_mfma_f32_16x16x32_bf16 a[128:131], v[204:207], a[48:51], a[128:131]
  ds_read_b64_tr_b16 v[200:201], v247 offset:16896
  ds_read_b64_tr_b16 v[202:203], v247 offset:17920
  v_mfma_f32_16x16x32_bf16 a[136:139], v[204:207], a[52:55], a[136:139]
  v_exp_f32 v106, v106
  v_mfma_f32_16x16x32_bf16 a[132:135], v[208:211], a[48:51], a[132:135]
  s_add_u32 m0, s68, 0
  ds_read_b64_tr_b16 v[204:205], v248 offset:16896
  ds_read_b64_tr_b16 v[206:207], v248 offset:17920
  v_mfma_f32_16x16x32_bf16 a[140:143], v[208:211], a[52:55], a[140:143]
  s_waitcnt lgkmcnt(4)
  buffer_load_dwordx4 v236, s[8:11], s92 offen nt lds
  v_mfma_f32_16x16x32_bf16 a[144:147], v[212:215], a[48:51], a[144:147]
  ds_read_b64_tr_b16 v[208:209], v247 offset:17152
  ds_read_b64_tr_b16 v[210:211], v247 offset:18176
  v_mfma_f32_16x16x32_bf16 a[152:155], v[212:215], a[52:55], a[152:155]
  v_exp_f32 v107, v107
  v_mfma_f32_16x16x32_bf16 a[148:151], v[216:219], a[48:51], a[148:151]
  ds_read_b64_tr_b16 v[212:213], v248 offset:17152
  ds_read_b64_tr_b16 v[214:215], v248 offset:18176
  v_mfma_f32_16x16x32_bf16 a[156:159], v[216:219], a[52:55], a[156:159]
  s_waitcnt lgkmcnt(4)
  buffer_load_dwordx4 v236, s[8:11], s92 offen offset:1024 nt lds
  v_mfma_f32_16x16x32_bf16 a[160:163], v[200:203], a[48:51], a[160:163]
  ds_read_b64_tr_b16 v[216:217], v247 offset:18432
  v_cvt_pk_bf16_f32 v101, v106, v107
  v_mfma_f32_16x16x32_bf16 a[168:171], v[200:203], a[52:55], a[168:171]
  ds_read_b64_tr_b16 v[218:219], v247 offset:19456
  v_mfma_f32_16x16x32_bf16 a[164:167], v[204:207], a[48:51], a[164:167]
  ds_read_b64_tr_b16 v[200:201], v248 offset:18432
  ds_read_b64_tr_b16 v[202:203], v248 offset:19456
  v_mfma_f32_16x16x32_bf16 a[172:175], v[204:207], a[52:55], a[172:175]
  s_waitcnt lgkmcnt(4)
  buffer_load_dwordx4 v236, s[8:11], s92 offen offset:2048 nt lds
  v_mfma_f32_16x16x32_bf16 a[176:179], v[208:211], a[48:51], a[176:179]
  ds_read_b64_tr_b16 v[204:205], v247 offset:18688
  ds_read_b64_tr_b16 v[206:207], v247 offset:19712
  v_mfma_f32_16x16x32_bf16 a[184:187], v[208:211], a[52:55], a[184:187]
  v_exp_f32 v108, v108
  v_mfma_f32_16x16x32_bf16 a[180:183], v[212:215], a[48:51], a[180:183]
  ds_read_b64_tr_b16 v[208:209], v248 offset:18688
  ds_read_b64_tr_b16 v[210:211], v248 offset:19712
  v_mfma_f32_16x16x32_bf16 a[188:191], v[212:215], a[52:55], a[188:191]
  s_waitcnt lgkmcnt(4)
  buffer_load_dwordx4 v236, s[8:11], s92 offen offset:3072 nt lds
  v_mfma_f32_16x16x32_bf16 a[128:131], v[216:219], a[56:59], a[128:131]
  ds_read_b64_tr_b16 v[212:213], v247 offset:18944
  ds_read_b64_tr_b16 v[214:215], v247 offset:19968
  v_mfma_f32_16x16x32_bf16 a[136:139], v[216:219], a[60:63], a[136:139]
  v_exp_f32 v109, v109
  v_mfma_f32_16x16x32_bf16 a[132:135], v[200:203], a[56:59], a[132:135]
  s_add_u32 m0, s68, 65536
  ds_read_b64_tr_b16 v[216:217], v248 offset:18944
  ds_read_b64_tr_b16 v[218:219], v248 offset:19968
  v_mfma_f32_16x16x32_bf16 a[140:143], v[200:203], a[60:63], a[140:143]
  s_waitcnt lgkmcnt(4)
  buffer_load_dwordx4 v237, s[12:15], s91 offen nt lds
  v_mfma_f32_16x16x32_bf16 a[144:147], v[204:207], a[56:59], a[144:147]
  ds_read_b64_tr_b16 v[200:201], v247 offset:19200
  v_cvt_pk_bf16_f32 v102, v108, v109
  v_mfma_f32_16x16x32_bf16 a[152:155], v[204:207], a[60:63], a[152:155]
  ds_read_b64_tr_b16 v[202:203], v247 offset:20224
  v_mfma_f32_16x16x32_bf16 a[148:151], v[208:211], a[56:59], a[148:151]
  ds_read_b64_tr_b16 v[204:205], v248 offset:19200
  ds_read_b64_tr_b16 v[206:207], v248 offset:20224
  v_mfma_f32_16x16x32_bf16 a[156:159], v[208:211], a[60:63], a[156:159]
  s_waitcnt lgkmcnt(4)
  buffer_load_dwordx4 v237, s[12:15], s91 offen offset:1024 nt lds
  v_mfma_f32_16x16x32_bf16 a[160:163], v[212:215], a[56:59], a[160:163]
  s_waitcnt vmcnt(14)
  s_barrier
  ds_read_b128 v[208:211], v241 offset:49152
  v_mfma_f32_16x16x32_bf16 a[168:171], v[212:215], a[60:63], a[168:171]
  v_exp_f32 v110, v110
  v_mfma_f32_16x16x32_bf16 a[164:167], v[216:219], a[56:59], a[164:167]
  ds_read_b128 v[212:215], v242 offset:49152
  v_mfma_f32_16x16x32_bf16 a[172:175], v[216:219], a[60:63], a[172:175]
  s_waitcnt lgkmcnt(2)
  v_exp_f32 v111, v111
  v_mfma_f32_16x16x32_bf16 a[176:179], v[200:203], a[56:59], a[176:179]
  ds_read_b128 v[216:219], v241 offset:57344
  v_cvt_pk_bf16_f32 v103, v110, v111
  v_mfma_f32_16x16x32_bf16 a[184:187], v[200:203], a[60:63], a[184:187]
  v_exp_f32 v112, v112
  v_mfma_f32_16x16x32_bf16 v[228:231], v[220:223], v[100:103], v[228:231]
  v_exp_f32 v113, v113
  v_mfma_f32_16x16x32_bf16 a[180:183], v[204:207], a[56:59], a[180:183]
  ds_read_b128 v[200:203], v242 offset:57344
  v_cvt_pk_bf16_f32 v104, v112, v113
  v_mfma_f32_16x16x32_bf16 a[188:191], v[204:207], a[60:63], a[188:191]
  s_waitcnt lgkmcnt(2)
  v_exp_f32 v114, v114
  v_mfma_f32_16x16x32_bf16 v[160:163], v[208:211], v[0:3], v[192:195]
  ds_read_b128 v[204:207], v241 offset:50176
  v_mfma_f32_16x16x32_bf16 v[168:171], v[208:211], v[4:7], v[196:199]
  v_exp_f32 v115, v115
  v_mfma_f32_16x16x32_bf16 v[160:163], v[212:215], v[8:11], v[160:163]
  ds_read_b128 v[208:211], v242 offset:50176
  v_cvt_pk_bf16_f32 v105, v114, v115
  v_mfma_f32_16x16x32_bf16 v[168:171], v[212:215], v[12:15], v[168:171]
  s_waitcnt lgkmcnt(2)
  v_exp_f32 v116, v116
  v_mfma_f32_16x16x32_bf16 v[160:163], v[216:219], v[16:19], v[160:163]
  ds_read_b128 v[212:215], v241 offset:58368
  v_mfma_f32_16x16x32_bf16 v[168:171], v[216:219], v[20:23], v[168:171]
  v_exp_f32 v117, v117
  v_mfma_f32_16x16x32_bf16 v[160:163], v[200:203], v[24:27], v[160:163]
  ds_read_b128 v[216:219], v242 offset:58368
  v_cvt_pk_bf16_f32 v106, v116, v117
  v_mfma_f32_16x16x32_bf16 v[168:171], v[200:203], v[28:31], v[168:171]
  s_waitcnt lgkmcnt(2)
  v_exp_f32 v118, v118
  v_mfma_f32_16x16x32_bf16 v[164:167], v[204:207], v[0:3], v[192:195]
  ds_read_b128 v[200:203], v241 offset:51200
  v_mfma_f32_16x16x32_bf16 v[172:175], v[204:207], v[4:7], v[196:199]
  v_exp_f32 v119, v119
  v_mfma_f32_16x16x32_bf16 v[164:167], v[208:211], v[8:11], v[164:167]
  ds_read_b128 v[204:207], v242 offset:51200
  v_cvt_pk_bf16_f32 v107, v118, v119
  v_mfma_f32_16x16x32_bf16 v[172:175], v[208:211], v[12:15], v[172:175]
  s_waitcnt lgkmcnt(2)
  v_exp_f32 v120, v120
  v_mfma_f32_16x16x32_bf16 v[224:227], v[220:223], v[104:107], v[224:227]
  v_exp_f32 v121, v121
  v_mfma_f32_16x16x32_bf16 v[164:167], v[212:215], v[16:19], v[164:167]
  ds_read_b128 v[208:211], v241 offset:59392
  v_cvt_pk_bf16_f32 v108, v120, v121
  v_mfma_f32_16x16x32_bf16 v[172:175], v[212:215], v[20:23], v[172:175]
  v_exp_f32 v122, v122
  v_mfma_f32_16x16x32_bf16 v[164:167], v[216:219], v[24:27], v[164:167]
  ds_read_b128 v[212:215], v242 offset:59392
  v_max3_f32 v253, v160, v161, v162
  v_mfma_f32_16x16x32_bf16 v[172:175], v[216:219], v[28:31], v[172:175]
  s_waitcnt lgkmcnt(2)
  v_exp_f32 v123, v123
  v_mfma_f32_16x16x32_bf16 v[176:179], v[200:203], v[0:3], v[192:195]
  ds_read_b128 v[216:219], v241 offset:52224
  v_cvt_pk_bf16_f32 v109, v122, v123
  v_mfma_f32_16x16x32_bf16 v[184:187], v[200:203], v[4:7], v[196:199]
  v_exp_f32 v124, v124
  v_mfma_f32_16x16x32_bf16 v[176:179], v[204:207], v[8:11], v[176:179]
  ds_read_b128 v[200:203], v242 offset:52224
  v_max3_f32 v253, v253, v163, v168
  v_mfma_f32_16x16x32_bf16 v[184:187], v[204:207], v[12:15], v[184:187]
  s_waitcnt lgkmcnt(2)
  v_exp_f32 v125, v125
  v_mfma_f32_16x16x32_bf16 v[176:179], v[208:211], v[16:19], v[176:179]
  ds_read_b128 v[204:207], v241 offset:60416
  v_cvt_pk_bf16_f32 v110, v124, v125
  v_mfma_f32_16x16x32_bf16 v[184:187], v[208:211], v[20:23], v[184:187]
  v_exp_f32 v126, v126
  v_mfma_f32_16x16x32_bf16 v[176:179], v[212:215], v[24:27], v[176:179]
  ds_read_b128 v[208:211], v242 offset:60416
  v_max3_f32 v253, v253, v169, v170
  v_mfma_f32_16x16x32_bf16 v[184:187], v[212:215], v[28:31], v[184:187]
  s_waitcnt lgkmcnt(2)
  v_exp_f32 v127, v127
  v_mfma_f32_16x16x32_bf16 v[180:183], v[216:219], v[0:3], v[192:195]
  s_waitcnt vmcnt(6)
  s_barrier
  ds_read_b64_tr_b16 v[212:213], v245 offset:16384
  ds_read_b64_tr_b16 v[214:215], v245 offset:17408
  v_mfma_f32_16x16x32_bf16 v[188:191], v[216:219], v[4:7], v[196:199]
  buffer_load_dwordx4 v237, s[12:15], s91 offen offset:2048 nt lds
  v_mfma_f32_16x16x32_bf16 v[180:183], v[200:203], v[8:11], v[180:183]
  ds_read_b64_tr_b16 v[216:217], v246 offset:16384
  v_cvt_pk_bf16_f32 v111, v126, v127
  v_mfma_f32_16x16x32_bf16 v[188:191], v[200:203], v[12:15], v[188:191]
  s_waitcnt lgkmcnt(3)
  ds_read_b64_tr_b16 v[218:219], v246 offset:17408
  v_max3_f32 v253, v253, v171, v164
  v_mfma_f32_16x16x32_bf16 v[228:231], v[220:223], v[108:111], v[228:231]
  v_max3_f32 v253, v253, v165, v166
  v_max3_f32 v253, v253, v167, v172
  v_mfma_f32_16x16x32_bf16 v[180:183], v[204:207], v[16:19], v[180:183]
  ds_read_b64_tr_b16 v[200:201], v245 offset:16640
  ds_read_b64_tr_b16 v[202:203], v245 offset:17664
  v_mfma_f32_16x16x32_bf16 v[188:191], v[204:207], v[20:23], v[188:191]
  buffer_load_dwordx4 v237, s[12:15], s91 offen offset:3072 nt lds
  v_mfma_f32_16x16x32_bf16 v[180:183], v[208:211], v[24:27], v[180:183]
  ds_read_b64_tr_b16 v[204:205], v246 offset:16640
  v_max3_f32 v253, v253, v173, v174
  v_mfma_f32_16x16x32_bf16 v[188:191], v[208:211], v[28:31], v[188:191]
  s_waitcnt lgkmcnt(3)
  ds_read_b64_tr_b16 v[206:207], v246 offset:17664
  v_max3_f32 v253, v253, v175, v176
  v_mfma_f32_16x16x32_bf16 v[32:35], v[212:215], v[96:99], v[32:35]
  s_add_u32 m0, s68, 147456
  ds_read_b64_tr_b16 v[208:209], v245 offset:16896
  ds_read_b64_tr_b16 v[210:211], v245 offset:17920
  v_mfma_f32_16x16x32_bf16 v[40:43], v[212:215], v[100:103], v[40:43]
  buffer_load_dwordx4 v239, s[32:35], s85 offen lds
  v_mfma_f32_16x16x32_bf16 v[36:39], v[216:219], v[96:99], v[36:39]
  ds_read_b64_tr_b16 v[212:213], v246 offset:16896
  v_max3_f32 v253, v253, v177, v178
  v_mfma_f32_16x16x32_bf16 v[44:47], v[216:219], v[100:103], v[44:47]
  s_waitcnt lgkmcnt(3)
  ds_read_b64_tr_b16 v[214:215], v246 offset:17920
  v_max3_f32 v253, v253, v179, v184
  v_mfma_f32_16x16x32_bf16 v[48:51], v[200:203], v[96:99], v[48:51]
  ds_read_b64_tr_b16 v[216:217], v245 offset:17152
  ds_read_b64_tr_b16 v[218:219], v245 offset:18176
  v_mfma_f32_16x16x32_bf16 v[56:59], v[200:203], v[100:103], v[56:59]
  buffer_load_dwordx4 v239, s[36:39], s85 offen offset:1024 lds
  v_mfma_f32_16x16x32_bf16 v[52:55], v[204:207], v[96:99], v[52:55]
  ds_read_b64_tr_b16 v[200:201], v246 offset:17152
  v_max3_f32 v253, v253, v185, v186
  v_mfma_f32_16x16x32_bf16 v[60:63], v[204:207], v[100:103], v[60:63]
  s_waitcnt lgkmcnt(3)
  ds_read_b64_tr_b16 v[202:203], v246 offset:18176
  v_max3_f32 v253, v253, v187, v180
  v_mfma_f32_16x16x32_bf16 v[64:67], v[208:211], v[96:99], v[64:67]
  ds_read_b64_tr_b16 v[204:205], v245 offset:18432
  ds_read_b64_tr_b16 v[206:207], v245 offset:19456
  v_mfma_f32_16x16x32_bf16 v[72:75], v[208:211], v[100:103], v[72:75]
  buffer_load_dwordx4 v239, s[40:43], s85 offen offset:2048 lds
  v_mfma_f32_16x16x32_bf16 v[68:71], v[212:215], v[96:99], v[68:71]
  ds_read_b64_tr_b16 v[208:209], v246 offset:18432
  v_max3_f32 v253, v253, v181, v182
  v_mfma_f32_16x16x32_bf16 v[76:79], v[212:215], v[100:103], v[76:79]
  s_waitcnt lgkmcnt(3)
  ds_read_b64_tr_b16 v[210:211], v246 offset:19456
  v_max3_f32 v253, v253, v183, v188
  v_mfma_f32_16x16x32_bf16 v[80:83], v[216:219], v[96:99], v[80:83]
  ds_read_b64_tr_b16 v[212:213], v245 offset:18688
  ds_read_b64_tr_b16 v[214:215], v245 offset:19712
  v_mfma_f32_16x16x32_bf16 v[88:91], v[216:219], v[100:103], v[88:91]
  buffer_load_dwordx4 v239, s[44:47], s85 offen offset:3072 lds
  v_mfma_f32_16x16x32_bf16 v[84:87], v[200:203], v[96:99], v[84:87]
  ds_read_b64_tr_b16 v[216:217], v246 offset:18688
  v_max3_f32 v253, v253, v189, v190
  v_mfma_f32_16x16x32_bf16 v[92:95], v[200:203], v[100:103], v[92:95]
  s_waitcnt lgkmcnt(3)
  ds_read_b64_tr_b16 v[218:219], v246 offset:19712
  v_max_f32 v253, v253, v191
  v_mfma_f32_16x16x32_bf16 v[32:35], v[204:207], v[104:107], v[32:35]
  s_add_u32 m0, s68, 114688
  ds_read_b64_tr_b16 v[200:201], v245 offset:18944
  ds_read_b64_tr_b16 v[202:203], v245 offset:19968
  v_mfma_f32_16x16x32_bf16 v[40:43], v[204:207], v[108:111], v[40:43]
  buffer_load_dwordx4 v239, s[32:35], s86 offen lds
  v_mfma_f32_16x16x32_bf16 v[36:39], v[208:211], v[104:107], v[36:39]
  ds_read_b64_tr_b16 v[204:205], v246 offset:18944
  v_cmp_lt_f32 vcc, 0x41200000, v253
  v_mfma_f32_16x16x32_bf16 v[44:47], v[208:211], v[108:111], v[44:47]
  s_waitcnt lgkmcnt(3)
  ds_read_b64_tr_b16 v[206:207], v246 offset:19968
  v_mfma_f32_16x16x32_bf16 v[48:51], v[212:215], v[104:107], v[48:51]
  ds_read_b64_tr_b16 v[208:209], v245 offset:19200
  v_mfma_f32_16x16x32_bf16 v[56:59], v[212:215], v[108:111], v[56:59]
  ds_read_b64_tr_b16 v[210:211], v245 offset:20224
  v_mfma_f32_16x16x32_bf16 v[52:55], v[216:219], v[104:107], v[52:55]
  ds_read_b64_tr_b16 v[212:213], v246 offset:19200
  v_mfma_f32_16x16x32_bf16 v[60:63], v[216:219], v[108:111], v[60:63]
  s_waitcnt lgkmcnt(3)
  ds_read_b64_tr_b16 v[214:215], v246 offset:20224
  v_mfma_f32_16x16x32_bf16 v[64:67], v[200:203], v[104:107], v[64:67]
  s_waitcnt vmcnt(17)
  s_barrier
  ds_read_b64_tr_b16 v[216:217], v247 offset:32768
  v_mfma_f32_16x16x32_bf16 v[72:75], v[200:203], v[108:111], v[72:75]
  ds_read_b64_tr_b16 v[218:219], v247 offset:33792
  v_mfma_f32_16x16x32_bf16 v[68:71], v[204:207], v[104:107], v[68:71]
  ds_read_b64_tr_b16 v[200:201], v248 offset:32768
  v_mfma_f32_16x16x32_bf16 v[76:79], v[204:207], v[108:111], v[76:79]
  s_waitcnt lgkmcnt(3)
  ds_read_b64_tr_b16 v[202:203], v248 offset:33792
  v_mfma_f32_16x16x32_bf16 v[80:83], v[208:211], v[104:107], v[80:83]
  ds_read_b64_tr_b16 v[204:205], v247 offset:33024
  v_mfma_f32_16x16x32_bf16 v[88:91], v[208:211], v[108:111], v[88:91]
  ds_read_b64_tr_b16 v[206:207], v247 offset:34048
  v_mfma_f32_16x16x32_bf16 v[84:87], v[212:215], v[104:107], v[84:87]
  ds_read_b64_tr_b16 v[208:209], v248 offset:33024
  v_mfma_f32_16x16x32_bf16 v[92:95], v[212:215], v[108:111], v[92:95]
  s_waitcnt lgkmcnt(3)
  s_cbranch_vccnz L_r0_3t
L_r0_3:
  ds_read_b64_tr_b16 v[210:211], v248 offset:34048
  v_mfma_f32_16x16x32_bf16 a[128:131], v[216:219], a[64:67], a[128:131]
  ds_read_b64_tr_b16 v[212:213], v247 offset:33280
  ds_read_b64_tr_b16 v[214:215], v247 offset:34304
  v_mfma_f32_16x16x32_bf16 a[136:139], v[216:219], a[68:71], a[136:139]
  v_exp_f32 v160, v160
  v_mfma_f32_16x16x32_bf16 a[132:135], v[200:203], a[64:67], a[132:135]
  ds_read_b64_tr_b16 v[216:217], v248 offset:33280
  ds_read_b64_tr_b16 v[218:219], v248 offset:34304
  v_mfma_f32_16x16x32_bf16 a[140:143], v[200:203], a[68:71], a[140:143]
  s_waitcnt lgkmcnt(4)
  v_exp_f32 v161, v161
  v_mfma_f32_16x16x32_bf16 a[144:147], v[204:207], a[64:67], a[144:147]
  ds_read_b64_tr_b16 v[200:201], v247 offset:33536
  v_cvt_pk_bf16_f32 v160, v160, v161
  v_mfma_f32_16x16x32_bf16 a[152:155], v[204:207], a[68:71], a[152:155]
  ds_read_b64_tr_b16 v[202:203], v247 offset:34560
  v_mfma_f32_16x16x32_bf16 a[148:151], v[208:211], a[64:67], a[148:151]
  ds_read_b64_tr_b16 v[204:205], v248 offset:33536
  ds_read_b64_tr_b16 v[206:207], v248 offset:34560
  v_mfma_f32_16x16x32_bf16 a[156:159], v[208:211], a[68:71], a[156:159]
  s_waitcnt lgkmcnt(4)
  v_exp_f32 v162, v162
  v_mfma_f32_16x16x32_bf16 a[160:163], v[212:215], a[64:67], a[160:163]
  ds_read_b64_tr_b16 v[208:209], v247 offset:34816
  ds_read_b64_tr_b16 v[210:211], v247 offset:35840
  v_mfma_f32_16x16x32_bf16 a[168:171], v[212:215], a[68:71], a[168:171]
  v_exp_f32 v163, v163
  v_mfma_f32_16x16x32_bf16 a[164:167], v[216:219], a[64:67], a[164:167]
  ds_read_b64_tr_b16 v[212:213], v248 offset:34816
  v_cvt_pk_bf16_f32 v161, v162, v163
  v_mfma_f32_16x16x32_bf16 a[172:175], v[216:219], a[68:71], a[172:175]
  s_waitcnt lgkmcnt(3)
  ds_read_b64_tr_b16 v[214:215], v248 offset:35840
  v_mfma_f32_16x16x32_bf16 a[176:179], v[200:203], a[64:67], a[176:179]
  ds_read_b64_tr_b16 v[216:217], v247 offset:35072
  ds_read_b64_tr_b16 v[218:219], v247 offset:36096
  v_mfma_f32_16x16x32_bf16 a[184:187], v[200:203], a[68:71], a[184:187]
  v_exp_f32 v164, v164
  v_mfma_f32_16x16x32_bf16 a[180:183], v[204:207], a[64:67], a[180:183]
  ds_read_b64_tr_b16 v[200:201], v248 offset:35072
  ds_read_b64_tr_b16 v[202:203], v248 offset:36096
  v_mfma_f32_16x16x32_bf16 a[188:191], v[204:207], a[68:71], a[188:191]
  s_waitcnt lgkmcnt(4)
  v_exp_f32 v165, v165
  v_mfma_f32_16x16x32_bf16 a[128:131], v[208:211], a[72:75], a[128:131]
  ds_read_b64_tr_b16 v[204:205], v247 offset:35328
  v_cvt_pk_bf16_f32 v162, v164, v165
  v_mfma_f32_16x16x32_bf16 a[136:139], v[208:211], a[76:79], a[136:139]
  ds_read_b64_tr_b16 v[206:207], v247 offset:36352
  v_mfma_f32_16x16x32_bf16 a[132:135], v[212:215], a[72:75], a[132:135]
  ds_read_b64_tr_b16 v[208:209], v248 offset:35328
  ds_read_b64_tr_b16 v[210:211], v248 offset:36352
  v_mfma_f32_16x16x32_bf16 a[140:143], v[212:215], a[76:79], a[140:143]
  s_waitcnt lgkmcnt(4)
  v_exp_f32 v166, v166
  v_mfma_f32_16x16x32_bf16 a[144:147], v[216:219], a[72:75], a[144:147]
  ds_read_b64_tr_b16 v[212:213], v247 offset:35584
  ds_read_b64_tr_b16 v[214:215], v247 offset:36608
  v_mfma_f32_16x16x32_bf16 a[152:155], v[216:219], a[76:79], a[152:155]
  v_exp_f32 v167, v167
  v_mfma_f32_16x16x32_bf16 a[148:151], v[200:203], a[72:75], a[148:151]
  ds_read_b64_tr_b16 v[216:217], v248 offset:35584
  v_cvt_pk_bf16_f32 v163, v166, v167
  v_mfma_f32_16x16x32_bf16 a[156:159], v[200:203], a[76:79], a[156:159]
  s_waitcnt lgkmcnt(3)
  ds_read_b64_tr_b16 v[218:219], v248 offset:36608
  v_mfma_f32_16x16x32_bf16 v[224:227], v[220:223], v[160:163], v[224:227]
  v_exp_f32 v168, v168
  v_mfma_f32_16x16x32_bf16 a[160:163], v[204:207], a[72:75], a[160:163]
  s_waitcnt vmcnt(1)
  s_barrier
  ds_read_b64_tr_b16 v[200:201], v247 offset:49152
  ds_read_b64_tr_b16 v[202:203], v247 offset:50176
  v_mfma_f32_16x16x32_bf16 a[168:171], v[204:207], a[76:79], a[168:171]
  buffer_load_dwordx4 v239, s[36:39], s86 offen offset:1024 lds
  v_mfma_f32_16x16x32_bf16 a[164:167], v[208:211], a[72:75], a[164:167]
  ds_read_b64_tr_b16 v[204:205], v248 offset:49152
  ds_read_b64_tr_b16 v[206:207], v248 offset:50176
  v_mfma_f32_16x16x32_bf16 a[172:175], v[208:211], a[76:79], a[172:175]
  s_waitcnt lgkmcnt(4)
  v_exp_f32 v169, v169
  v_mfma_f32_16x16x32_bf16 a[176:179], v[212:215], a[72:75], a[176:179]
  ds_read_b64_tr_b16 v[208:209], v247 offset:49408
  ds_read_b64_tr_b16 v[210:211], v247 offset:50432
  v_mfma_f32_16x16x32_bf16 a[184:187], v[212:215], a[76:79], a[184:187]
  buffer_load_dwordx4 v239, s[40:43], s86 offen offset:2048 lds
  v_mfma_f32_16x16x32_bf16 a[180:183], v[216:219], a[72:75], a[180:183]
  ds_read_b64_tr_b16 v[212:213], v248 offset:49408
  v_cvt_pk_bf16_f32 v164, v168, v169
  v_mfma_f32_16x16x32_bf16 a[188:191], v[216:219], a[76:79], a[188:191]
  s_waitcnt lgkmcnt(3)
  ds_read_b64_tr_b16 v[214:215], v248 offset:50432
  v_mfma_f32_16x16x32_bf16 a[128:131], v[200:203], a[80:83], a[128:131]
  ds_read_b64_tr_b16 v[216:217], v247 offset:49664
  ds_read_b64_tr_b16 v[218:219], v247 offset:50688
  v_mfma_f32_16x16x32_bf16 a[136:139], v[200:203], a[84:87], a[136:139]
  buffer_load_dwordx4 v239, s[44:47], s86 offen offset:3072 lds
  v_mfma_f32_16x16x32_bf16 a[132:135], v[204:207], a[80:83], a[132:135]
  ds_read_b64_tr_b16 v[200:201], v248 offset:49664
  ds_read_b64_tr_b16 v[202:203], v248 offset:50688
  v_mfma_f32_16x16x32_bf16 a[140:143], v[204:207], a[84:87], a[140:143]
  s_waitcnt lgkmcnt(4)
  v_exp_f32 v170, v170
  v_mfma_f32_16x16x32_bf16 a[144:147], v[208:211], a[80:83], a[144:147]
  s_add_u32 m0, s68, 16384
  ds_read_b64_tr_b16 v[204:205], v247 offset:49920
  ds_read_b64_tr_b16 v[206:207], v247 offset:50944
  v_mfma_f32_16x16x32_bf16 a[152:155], v[208:211], a[84:87], a[152:155]
  buffer_load_dwordx4 v236, s[8:11], s93 offen nt lds
  v_mfma_f32_16x16x32_bf16 a[148:151], v[212:215], a[80:83], a[148:151]
  ds_read_b64_tr_b16 v[208:209], v248 offset:49920
  ds_read_b64_tr_b16 v[210:211], v248 offset:50944
  v_mfma_f32_16x16x32_bf16 a[156:159], v[212:215], a[84:87], a[156:159]
  s_waitcnt lgkmcnt(4)
  v_exp_f32 v171, v171
  v_mfma_f32_16x16x32_bf16 a[160:163], v[216:219], a[80:83], a[160:163]
  ds_read_b64_tr_b16 v[212:213], v247 offset:51200
  ds_read_b64_tr_b16 v[214:215], v247 offset:52224
  v_mfma_f32_16x16x32_bf16 a[168:171], v[216:219], a[84:87], a[168:171]
  buffer_load_dwordx4 v236, s[8:11], s93 offen offset:1024 nt lds
  v_mfma_f32_16x16x32_bf16 a[164:167], v[200:203], a[80:83], a[164:167]
  ds_read_b64_tr_b16 v[216:217], v248 offset:51200
  v_cvt_pk_bf16_f32 v165, v170, v171
  v_mfma_f32_16x16x32_bf16 a[172:175], v[200:203], a[84:87], a[172:175]
  s_waitcnt lgkmcnt(3)
  ds_read_b64_tr_b16 v[218:219], v248 offset:52224
  v_mfma_f32_16x16x32_bf16 a[176:179], v[204:207], a[80:83], a[176:179]
  ds_read_b64_tr_b16 v[200:201], v247 offset:51456
  ds_read_b64_tr_b16 v[202:203], v247 offset:52480
  v_mfma_f32_16x16x32_bf16 a[184:187], v[204:207], a[84:87], a[184:187]
  buffer_load_dwordx4 v236, s[8:11], s93 offen offset:2048 nt lds
  v_mfma_f32_16x16x32_bf16 a[180:183], v[208:211], a[80:83], a[180:183]
  ds_read_b64_tr_b16 v[204:205], v248 offset:51456
  ds_read_b64_tr_b16 v[206:207], v248 offset:52480
  v_mfma_f32_16x16x32_bf16 a[188:191], v[208:211], a[84:87], a[188:191]
  s_waitcnt lgkmcnt(4)
  v_exp_f32 v172, v172
  v_mfma_f32_16x16x32_bf16 a[128:131], v[212:215], a[88:91], a[128:131]
  ds_read_b64_tr_b16 v[208:209], v247 offset:51712
  ds_read_b64_tr_b16 v[210:211], v247 offset:52736
  v_mfma_f32_16x16x32_bf16 a[136:139], v[212:215], a[92:95], a[136:139]
  buffer_load_dwordx4 v236, s[8:11], s93 offen offset:3072 nt lds
  v_mfma_f32_16x16x32_bf16 a[132:135], v[216:219], a[88:91], a[132:135]
  ds_read_b64_tr_b16 v[212:213], v248 offset:51712
  ds_read_b64_tr_b16 v[214:215], v248 offset:52736
  v_mfma_f32_16x16x32_bf16 a[140:143], v[216:219], a[92:95], a[140:143]
  s_waitcnt lgkmcnt(4)
  v_exp_f32 v173, v173
  v_mfma_f32_16x16x32_bf16 a[144:147], v[200:203], a[88:91], a[144:147]
  s_add_u32 m0, s68, 98304
  ds_read_b64_tr_b16 v[216:217], v247 offset:51968
  ds_read_b64_tr_b16 v[218:219], v247 offset:52992
  v_mfma_f32_16x16x32_bf16 a[152:155], v[200:203], a[92:95], a[152:155]
  buffer_load_dwordx4 v237, s[12:15], s92 offen nt lds
  v_mfma_f32_16x16x32_bf16 a[148:151], v[204:207], a[88:91], a[148:151]
  ds_read_b64_tr_b16 v[200:201], v248 offset:51968
  v_cvt_pk_bf16_f32 v166, v172, v173
  v_mfma_f32_16x16x32_bf16 a[156:159], v[204:207], a[92:95], a[156:159]
  s_waitcnt lgkmcnt(3)
  ds_read_b64_tr_b16 v[202:203], v248 offset:52992
  v_mfma_f32_16x16x32_bf16 a[160:163], v[208:211], a[88:91], a[160:163]
  s_waitcnt vmcnt(17)
  s_barrier
  ds_read_b128 v[204:207], v241 offset:0
  v_mfma_f32_16x16x32_bf16 a[168:171], v[208:211], a[92:95], a[168:171]
  buffer_load_dwordx4 v237, s[12:15], s92 offen offset:1024 nt lds
  v_mfma_f32_16x16x32_bf16 a[164:167], v[212:215], a[88:91], a[164:167]
  ds_read_b128 v[208:211], v242 offset:0
  v_mfma_f32_16x16x32_bf16 a[172:175], v[212:215], a[92:95], a[172:175]
  s_waitcnt lgkmcnt(2)
  v_exp_f32 v174, v174
  v_mfma_f32_16x16x32_bf16 a[176:179], v[216:219], a[88:91], a[176:179]
  ds_read_b128 v[212:215], v241 offset:8192
  v_mfma_f32_16x16x32_bf16 a[184:187], v[216:219], a[92:95], a[184:187]
  buffer_load_dwordx4 v237, s[12:15], s92 offen offset:2048 nt lds
  v_mfma_f32_16x16x32_bf16 a[180:183], v[200:203], a[88:91], a[180:183]
  ds_read_b128 v[216:219], v242 offset:8192
  v_mfma_f32_16x16x32_bf16 a[188:191], v[200:203], a[92:95], a[188:191]
  s_waitcnt lgkmcnt(2)
  v_exp_f32 v175, v175
  v_mfma_f32_16x16x32_bf16 v[96:99], v[204:207], v[0:3], v[192:195]
  ds_read_b128 v[200:203], v241 offset:1024
  v_cvt_pk_bf16_f32 v167, v174, v175
  v_mfma_f32_16x16x32_bf16 v[104:107], v[204:207], v[4:7], v[196:199]
  buffer_load_dwordx4 v237, s[12:15], s92 offen offset:3072 nt lds
  v_mfma_f32_16x16x32_bf16 v[228:231], v[220:223], v[164:167], v[228:231]
  v_exp_f32 v176, v176
  v_mfma_f32_16x16x32_bf16 v[96:99], v[208:211], v[8:11], v[96:99]
  ds_read_b128 v[204:207], v242 offset:1024
  v_mfma_f32_16x16x32_bf16 v[104:107], v[208:211], v[12:15], v[104:107]
  s_waitcnt lgkmcnt(2)
  v_exp_f32 v177, v177
  v_mfma_f32_16x16x32_bf16 v[96:99], v[212:215], v[16:19], v[96:99]
  s_add_u32 m0, s68, 131072
  ds_read_b128 v[208:211], v241 offset:9216
  v_cvt_pk_bf16_f32 v168, v176, v177
  v_mfma_f32_16x16x32_bf16 v[104:107], v[212:215], v[20:23], v[104:107]
  buffer_load_dwordx4 v239, s[32:35], s87 offen lds
  v_mfma_f32_16x16x32_bf16 v[96:99], v[216:219], v[24:27], v[96:99]
  ds_read_b128 v[212:215], v242 offset:9216
  v_mfma_f32_16x16x32_bf16 v[104:107], v[216:219], v[28:31], v[104:107]
  s_waitcnt lgkmcnt(2)
  v_exp_f32 v178, v178
  v_mfma_f32_16x16x32_bf16 v[100:103], v[200:203], v[0:3], v[192:195]
  ds_read_b128 v[216:219], v241 offset:2048
  v_mfma_f32_16x16x32_bf16 v[108:111], v[200:203], v[4:7], v[196:199]
  buffer_load_dwordx4 v239, s[36:39], s87 offen offset:1024 lds
  v_mfma_f32_16x16x32_bf16 v[100:103], v[204:207], v[8:11], v[100:103]
  ds_read_b128 v[200:203], v242 offset:2048
  v_max3_f32 v253, v96, v97, v98
  v_mfma_f32_16x16x32_bf16 v[108:111], v[204:207], v[12:15], v[108:111]
  s_waitcnt lgkmcnt(2)
  v_exp_f32 v179, v179
  v_mfma_f32_16x16x32_bf16 v[100:103], v[208:211], v[16:19], v[100:103]
  ds_read_b128 v[204:207], v241 offset:10240
  v_cvt_pk_bf16_f32 v169, v178, v179
  v_mfma_f32_16x16x32_bf16 v[108:111], v[208:211], v[20:23], v[108:111]
  v_exp_f32 v180, v180
  v_mfma_f32_16x16x32_bf16 v[100:103], v[212:215], v[24:27], v[100:103]
  ds_read_b128 v[208:211], v242 offset:10240
  v_max3_f32 v253, v253, v99, v104
  v_mfma_f32_16x16x32_bf16 v[108:111], v[212:215], v[28:31], v[108:111]
  s_waitcnt lgkmcnt(2)
  v_exp_f32 v181, v181
  v_mfma_f32_16x16x32_bf16 v[112:115], v[216:219], v[0:3], v[192:195]
  ds_read_b128 v[212:215], v241 offset:3072
  v_cvt_pk_bf16_f32 v170, v180, v181
  v_mfma_f32_16x16x32_bf16 v[120:123], v[216:219], v[4:7], v[196:199]
  v_exp_f32 v182, v182
  v_mfma_f32_16x16x32_bf16 v[112:115], v[200:203], v[8:11], v[112:115]
  ds_read_b128 v[216:219], v242 offset:3072
  v_max3_f32 v253, v253, v105, v106
  v_mfma_f32_16x16x32_bf16 v[120:123], v[200:203], v[12:15], v[120:123]
  s_waitcnt lgkmcnt(2)
  v_exp_f32 v183, v183
  v_mfma_f32_16x16x32_bf16 v[112:115], v[204:207], v[16:19], v[112:115]
  ds_read_b128 v[200:203], v241 offset:11264
  v_cvt_pk_bf16_f32 v171, v182, v183
  v_mfma_f32_16x16x32_bf16 v[120:123], v[204:207], v[20:23], v[120:123]
  v_exp_f32 v184, v184
  v_mfma_f32_16x16x32_bf16 v[224:227], v[220:223], v[168:171], v[224:227]
  v_exp_f32 v185, v185
  v_mfma_f32_16x16x32_bf16 v[112:115], v[208:211], v[24:27], v[112:115]
  ds_read_b128 v[204:207], v242 offset:11264
  v_cvt_pk_bf16_f32 v172, v184, v185
  v_mfma_f32_16x16x32_bf16 v[120:123], v[208:211], v[28:31], v[120:123]
  s_waitcnt lgkmcnt(2)
  v_exp_f32 v186, v186
  v_mfma_f32_16x16x32_bf16 v[116:119], v[212:215], v[0:3], v[192:195]
  s_waitcnt vmcnt(18)
  s_barrier
  ds_read_b64_tr_b16 v[208:209], v245 offset:0
  ds_read_b64_tr_b16 v[210:211], v245 offset:1024
  v_mfma_f32_16x16x32_bf16 v[124:127], v[212:215], v[4:7], v[196:199]
  v_exp_f32 v187, v187
  v_mfma_f32_16x16x32_bf16 v[116:119], v[216:219], v[8:11], v[116:119]
  ds_read_b64_tr_b16 v[212:213], v246 offset:0
  v_cvt_pk_bf16_f32 v173, v186, v187
  v_mfma_f32_16x16x32_bf16 v[124:127], v[216:219], v[12:15], v[124:127]
  s_waitcnt lgkmcnt(3)
  ds_read_b64_tr_b16 v[214:215], v246 offset:1024
  v_max3_f32 v253, v253, v107, v100
  v_mfma_f32_16x16x32_bf16 v[116:119], v[200:203], v[16:19], v[116:119]
  ds_read_b64_tr_b16 v[216:217], v245 offset:256
  ds_read_b64_tr_b16 v[218:219], v245 offset:1280
  v_mfma_f32_16x16x32_bf16 v[124:127], v[200:203], v[20:23], v[124:127]
  v_exp_f32 v188, v188
  v_mfma_f32_16x16x32_bf16 v[116:119], v[204:207], v[24:27], v[116:119]
  ds_read_b64_tr_b16 v[200:201], v246 offset:256
  ds_read_b64_tr_b16 v[202:203], v246 offset:1280
  v_mfma_f32_16x16x32_bf16 v[124:127], v[204:207], v[28:31], v[124:127]
  s_waitcnt lgkmcnt(4)
  v_exp_f32 v189, v189
  v_mfma_f32_16x16x32_bf16 v[32:35], v[208:211], v[160:163], v[32:35]
  ds_read_b64_tr_b16 v[204:205], v245 offset:512
  v_cvt_pk_bf16_f32 v174, v188, v189
  v_mfma_f32_16x16x32_bf16 v[40:43], v[208:211], v[164:167], v[40:43]
  ds_read_b64_tr_b16 v[206:207], v245 offset:1536
  v_max3_f32 v253, v253, v101, v102
  v_mfma_f32_16x16x32_bf16 v[36:39], v[212:215], v[160:163], v[36:39]
  ds_read_b64_tr_b16 v[208:209], v246 offset:512
  ds_read_b64_tr_b16 v[210:211], v246 offset:1536
  v_mfma_f32_16x16x32_bf16 v[44:47], v[212:215], v[164:167], v[44:47]
  s_waitcnt lgkmcnt(4)
  v_exp_f32 v190, v190
  v_mfma_f32_16x16x32_bf16 v[48:51], v[216:219], v[160:163], v[48:51]
  ds_read_b64_tr_b16 v[212:213], v245 offset:768
  ds_read_b64_tr_b16 v[214:215], v245 offset:1792
  v_mfma_f32_16x16x32_bf16 v[56:59], v[216:219], v[164:167], v[56:59]
  v_exp_f32 v191, v191
  v_mfma_f32_16x16x32_bf16 v[52:55], v[200:203], v[160:163], v[52:55]
  ds_read_b64_tr_b16 v[216:217], v246 offset:768
  v_cvt_pk_bf16_f32 v175, v190, v191
  v_mfma_f32_16x16x32_bf16 v[60:63], v[200:203], v[164:167], v[60:63]
  s_waitcnt lgkmcnt(3)
  ds_read_b64_tr_b16 v[218:219], v246 offset:1792
  v_max3_f32 v253, v253, v103, v108
  v_mfma_f32_16x16x32_bf16 v[228:231], v[220:223], v[172:175], v[228:231]
  v_max3_f32 v253, v253, v109, v110
  v_max3_f32 v253, v253, v111, v112
  v_mfma_f32_16x16x32_bf16 v[64:67], v[204:207], v[160:163], v[64:67]
  ds_read_b64_tr_b16 v[200:201], v245 offset:2048
  v_max3_f32 v253, v253, v113, v114
  v_mfma_f32_16x16x32_bf16 v[72:75], v[204:207], v[164:167], v[72:75]
  ds_read_b64_tr_b16 v[202:203], v245 offset:3072
  v_max3_f32 v253, v253, v115, v120
  v_mfma_f32_16x16x32_bf16 v[68:71], v[208:211], v[160:163], v[68:71]
  ds_read_b64_tr_b16 v[204:205], v246 offset:2048
  v_max3_f32 v253, v253, v121, v122
  v_mfma_f32_16x16x32_bf16 v[76:79], v[208:211], v[164:167], v[76:79]
  s_waitcnt lgkmcnt(3)
  ds_read_b64_tr_b16 v[206:207], v246 offset:3072
  v_max3_f32 v253, v253, v123, v116
  v_mfma_f32_16x16x32_bf16 v[80:83], v[212:215], v[160:163], v[80:83]
  ds_read_b64_tr_b16 v[208:209], v245 offset:2304
  ds_read_b64_tr_b16 v[210:211], v245 offset:3328
  v_mfma_f32_16x16x32_bf16 v[88:91], v[212:215], v[164:167], v[88:91]
  buffer_load_dwordx4 v239, s[40:43], s87 offen offset:2048 lds
  v_mfma_f32_16x16x32_bf16 v[84:87], v[216:219], v[160:163], v[84:87]
  ds_read_b64_tr_b16 v[212:213], v246 offset:2304
  v_max3_f32 v253, v253, v117, v118
  v_mfma_f32_16x16x32_bf16 v[92:95], v[216:219], v[164:167], v[92:95]
  s_waitcnt lgkmcnt(3)
  ds_read_b64_tr_b16 v[214:215], v246 offset:3328
  v_max3_f32 v253, v253, v119, v124
  v_mfma_f32_16x16x32_bf16 v[32:35], v[200:203], v[168:171], v[32:35]
  ds_read_b64_tr_b16 v[216:217], v245 offset:2560
  ds_read_b64_tr_b16 v[218:219], v245 offset:3584
  v_mfma_f32_16x16x32_bf16 v[40:43], v[200:203], v[172:175], v[40:43]
  buffer_load_dwordx4 v239, s[44:47], s87 offen offset:3072 lds
  v_add_u32 v239, 512, v239
  v_mfma_f32_16x16x32_bf16 v[36:39], v[204:207], v[168:171], v[36:39]
  ds_read_b64_tr_b16 v[200:201], v246 offset:2560
  v_max3_f32 v253, v253, v125, v126
  v_mfma_f32_16x16x32_bf16 v[44:47], v[204:207], v[172:175], v[44:47]
  s_waitcnt lgkmcnt(3)
  ds_read_b64_tr_b16 v[202:203], v246 offset:3584
  v_max_f32 v253, v253, v127
  v_mfma_f32_16x16x32_bf16 v[48:51], v[208:211], v[168:171], v[48:51]
  s_add_u32 m0, s68, 147456
  ds_read_b64_tr_b16 v[204:205], v245 offset:2816
  ds_read_b64_tr_b16 v[206:207], v245 offset:3840
  v_mfma_f32_16x16x32_bf16 v[56:59], v[208:211], v[172:175], v[56:59]
  buffer_load_dwordx4 v239, s[32:35], s80 offen lds
  v_mfma_f32_16x16x32_bf16 v[52:55], v[212:215], v[168:171], v[52:55]
  ds_read_b64_tr_b16 v[208:209], v246 offset:2816
  v_cmp_lt_f32 vcc, 0x41200000, v253
  v_mfma_f32_16x16x32_bf16 v[60:63], v[212:215], v[172:175], v[60:63]
  s_waitcnt lgkmcnt(3)
  ds_read_b64_tr_b16 v[210:211], v246 offset:3840
  v_mfma_f32_16x16x32_bf16 v[64:67], v[216:219], v[168:171], v[64:67]
  s_waitcnt vmcnt(13)
  s_barrier
  ds_read_b64_tr_b16 v[212:213], v247 offset:16384
  ds_read_b64_tr_b16 v[214:215], v247 offset:17408
  v_mfma_f32_16x16x32_bf16 v[72:75], v[216:219], v[172:175], v[72:75]
  buffer_load_dwordx4 v239, s[36:39], s80 offen offset:1024 lds
  v_mfma_f32_16x16x32_bf16 v[68:71], v[200:203], v[168:171], v[68:71]
  ds_read_b64_tr_b16 v[216:217], v248 offset:16384
  v_mfma_f32_16x16x32_bf16 v[76:79], v[200:203], v[172:175], v[76:79]
  s_waitcnt lgkmcnt(3)
  ds_read_b64_tr_b16 v[218:219], v248 offset:17408
  v_mfma_f32_16x16x32_bf16 v[80:83], v[204:207], v[168:171], v[80:83]
  ds_read_b64_tr_b16 v[200:201], v247 offset:16640
  ds_read_b64_tr_b16 v[202:203], v247 offset:17664
  v_mfma_f32_16x16x32_bf16 v[88:91], v[204:207], v[172:175], v[88:91]
  buffer_load_dwordx4 v239, s[40:43], s80 offen offset:2048 lds
  v_mfma_f32_16x16x32_bf16 v[84:87], v[208:211], v[168:171], v[84:87]
  ds_read_b64_tr_b16 v[204:205], v248 offset:16640
  v_mfma_f32_16x16x32_bf16 v[92:95], v[208:211], v[172:175], v[92:95]
  s_waitcnt lgkmcnt(3)
  s_cbranch_vccnz L_r0_4t
L_r0_4:
  ds_read_b64_tr_b16 v[206:207], v248 offset:17664
  v_mfma_f32_16x16x32_bf16 a[128:131], v[212:215], a[96:99], a[128:131]
  ds_read_b64_tr_b16 v[208:209], v247 offset:16896
  ds_read_b64_tr_b16 v[210:211], v247 offset:17920
  v_mfma_f32_16x16x32_bf16 a[136:139], v[212:215], a[100:103], a[136:139]
  buffer_load_dwordx4 v239, s[44:47], s80 offen offset:3072 lds
  v_mfma_f32_16x16x32_bf16 a[132:135], v[216:219], a[96:99], a[132:135]
  ds_read_b64_tr_b16 v[212:213], v248 offset:16896
  ds_read_b64_tr_b16 v[214:215], v248 offset:17920
  v_mfma_f32_16x16x32_bf16 a[140:143], v[216:219], a[100:103], a[140:143]
  s_waitcnt lgkmcnt(4)
  v_exp_f32 v96, v96
  v_mfma_f32_16x16x32_bf16 a[144:147], v[200:203], a[96:99], a[144:147]
  s_add_u32 m0, s68, 32768
  ds_read_b64_tr_b16 v[216:217], v247 offset:17152
  ds_read_b64_tr_b16 v[218:219], v247 offset:18176
  v_mfma_f32_16x16x32_bf16 a[152:155], v[200:203], a[100:103], a[152:155]
  buffer_load_dwordx4 v236, s[8:11], s94 offen nt lds
  v_mfma_f32_16x16x32_bf16 a[148:151], v[204:207], a[96:99], a[148:151]
  ds_read_b64_tr_b16 v[200:201], v248 offset:17152
  ds_read_b64_tr_b16 v[202:203], v248 offset:18176
  v_mfma_f32_16x16x32_bf16 a[156:159], v[204:207], a[100:103], a[156:159]
  s_waitcnt lgkmcnt(4)
  v_exp_f32 v97, v97
  v_mfma_f32_16x16x32_bf16 a[160:163], v[208:211], a[96:99], a[160:163]
  ds_read_b64_tr_b16 v[204:205], v247 offset:18432
  v_cvt_pk_bf16_f32 v96, v96, v97
  v_mfma_f32_16x16x32_bf16 a[168:171], v[208:211], a[100:103], a[168:171]
  ds_read_b64_tr_b16 v[206:207], v247 offset:19456
  v_mfma_f32_16x16x32_bf16 a[164:167], v[212:215], a[96:99], a[164:167]
  ds_read_b64_tr_b16 v[208:209], v248 offset:18432
  ds_read_b64_tr_b16 v[210:211], v248 offset:19456
  v_mfma_f32_16x16x32_bf16 a[172:175], v[212:215], a[100:103], a[172:175]
  s_waitcnt lgkmcnt(4)
  v_exp_f32 v98, v98
  v_mfma_f32_16x16x32_bf16 a[176:179], v[216:219], a[96:99], a[176:179]
  ds_read_b64_tr_b16 v[212:213], v247 offset:18688
  ds_read_b64_tr_b16 v[214:215], v247 offset:19712
  v_mfma_f32_16x16x32_bf16 a[184:187], v[216:219], a[100:103], a[184:187]
  v_exp_f32 v99, v99
  v_mfma_f32_16x16x32_bf16 a[180:183], v[200:203], a[96:99], a[180:183]
  ds_read_b64_tr_b16 v[216:217], v248 offset:18688
  v_cvt_pk_bf16_f32 v97, v98, v99
  v_mfma_f32_16x16x32_bf16 a[188:191], v[200:203], a[100:103], a[188:191]
  s_waitcnt lgkmcnt(3)
  ds_read_b64_tr_b16 v[218:219], v248 offset:19712
  v_mfma_f32_16x16x32_bf16 a[128:131], v[204:207], a[104:107], a[128:131]
  ds_read_b64_tr_b16 v[200:201], v247 offset:18944
  ds_read_b64_tr_b16 v[202:203], v247 offset:19968
  v_mfma_f32_16x16x32_bf16 a[136:139], v[204:207], a[108:111], a[136:139]
  v_exp_f32 v100, v100
  v_mfma_f32_16x16x32_bf16 a[132:135], v[208:211], a[104:107], a[132:135]
  ds_read_b64_tr_b16 v[204:205], v248 offset:18944
  ds_read_b64_tr_b16 v[206:207], v248 offset:19968
  v_mfma_f32_16x16x32_bf16 a[140:143], v[208:211], a[108:111], a[140:143]
  s_waitcnt lgkmcnt(4)
  v_exp_f32 v101, v101
  v_mfma_f32_16x16x32_bf16 a[144:147], v[212:215], a[104:107], a[144:147]
  ds_read_b64_tr_b16 v[208:209], v247 offset:19200
  v_cvt_pk_bf16_f32 v98, v100, v101
  v_mfma_f32_16x16x32_bf16 a[152:155], v[212:215], a[108:111], a[152:155]
  ds_read_b64_tr_b16 v[210:211], v247 offset:20224
  v_mfma_f32_16x16x32_bf16 a[148:151], v[216:219], a[104:107], a[148:151]
  ds_read_b64_tr_b16 v[212:213], v248 offset:19200
  ds_read_b64_tr_b16 v[214:215], v248 offset:20224
  v_mfma_f32_16x16x32_bf16 a[156:159], v[216:219], a[108:111], a[156:159]
  s_waitcnt lgkmcnt(4)
  v_exp_f32 v102, v102
  v_mfma_f32_16x16x32_bf16 a[160:163], v[200:203], a[104:107], a[160:163]
  s_waitcnt vmcnt(5)
  s_barrier
  ds_read_b64_tr_b16 v[216:217], v247 offset:32768
  ds_read_b64_tr_b16 v[218:219], v247 offset:33792
  v_mfma_f32_16x16x32_bf16 a[168:171], v[200:203], a[108:111], a[168:171]
  buffer_load_dwordx4 v236, s[8:11], s94 offen offset:1024 nt lds
  v_mfma_f32_16x16x32_bf16 a[164:167], v[204:207], a[104:107], a[164:167]
  ds_read_b64_tr_b16 v[200:201], v248 offset:32768
  ds_read_b64_tr_b16 v[202:203], v248 offset:33792
  v_mfma_f32_16x16x32_bf16 a[172:175], v[204:207], a[108:111], a[172:175]
  s_waitcnt lgkmcnt(4)
  v_exp_f32 v103, v103
  v_mfma_f32_16x16x32_bf16 a[176:179], v[208:211], a[104:107], a[176:179]
  ds_read_b64_tr_b16 v[204:205], v247 offset:33024
  ds_read_b64_tr_b16 v[206:207], v247 offset:34048
  v_mfma_f32_16x16x32_bf16 a[184:187], v[208:211], a[108:111], a[184:187]
  buffer_load_dwordx4 v236, s[8:11], s94 offen offset:2048 nt lds
  v_mfma_f32_16x16x32_bf16 a[180:183], v[212:215], a[104:107], a[180:183]
  ds_read_b64_tr_b16 v[208:209], v248 offset:33024
  v_cvt_pk_bf16_f32 v99, v102, v103
  v_mfma_f32_16x16x32_bf16 a[188:191], v[212:215], a[108:111], a[188:191]
  s_waitcnt lgkmcnt(3)
  ds_read_b64_tr_b16 v[210:211], v248 offset:34048
  v_mfma_f32_16x16x32_bf16 v[224:227], v[220:223], v[96:99], v[224:227]
  v_exp_f32 v104, v104
  v_mfma_f32_16x16x32_bf16 a[128:131], v[216:219], a[112:115], a[128:131]
  ds_read_b64_tr_b16 v[212:213], v247 offset:33280
  ds_read_b64_tr_b16 v[214:215], v247 offset:34304
  v_mfma_f32_16x16x32_bf16 a[136:139], v[216:219], a[116:119], a[136:139]
  buffer_load_dwordx4 v236, s[8:11], s94 offen offset:3072 nt lds
  v_mfma_f32_16x16x32_bf16 a[132:135], v[200:203], a[112:115], a[132:135]
  ds_read_b64_tr_b16 v[216:217], v248 offset:33280
  ds_read_b64_tr_b16 v[218:219], v248 offset:34304
  v_mfma_f32_16x16x32_bf16 a[140:143], v[200:203], a[116:119], a[140:143]
  s_waitcnt lgkmcnt(4)
  v_exp_f32 v105, v105
  v_mfma_f32_16x16x32_bf16 a[144:147], v[204:207], a[112:115], a[144:147]
  s_add_u32 m0, s68, 81920
  ds_read_b64_tr_b16 v[200:201], v247 offset:33536
  ds_read_b64_tr_b16 v[202:203], v247 offset:34560
  v_mfma_f32_16x16x32_bf16 a[152:155], v[204:207], a[116:119], a[152:155]
  buffer_load_dwordx4 v237, s[12:15], s93 offen nt lds
  v_mfma_f32_16x16x32_bf16 a[148:151], v[208:211], a[112:115], a[148:151]
  ds_read_b64_tr_b16 v[204:205], v248 offset:33536
  v_cvt_pk_bf16_f32 v100, v104, v105
  v_mfma_f32_16x16x32_bf16 a[156:159], v[208:211], a[116:119], a[156:159]
  s_waitcnt lgkmcnt(3)
  ds_read_b64_tr_b16 v[206:207], v248 offset:34560
  v_mfma_f32_16x16x32_bf16 a[160:163], v[212:215], a[112:115], a[160:163]
  ds_read_b64_tr_b16 v[208:209], v247 offset:34816
  ds_read_b64_tr_b16 v[210:211], v247 offset:35840
  v_mfma_f32_16x16x32_bf16 a[168:171], v[212:215], a[116:119], a[168:171]
  buffer_load_dwordx4 v237, s[12:15], s93 offen offset:1024 nt lds
  v_mfma_f32_16x16x32_bf16 a[164:167], v[216:219], a[112:115], a[164:167]
  ds_read_b64_tr_b16 v[212:213], v248 offset:34816
  ds_read_b64_tr_b16 v[214:215], v248 offset:35840
  v_mfma_f32_16x16x32_bf16 a[172:175], v[216:219], a[116:119], a[172:175]
  s_waitcnt lgkmcnt(4)
  v_exp_f32 v106, v106
  v_mfma_f32_16x16x32_bf16 a[176:179], v[200:203], a[112:115], a[176:179]
  ds_read_b64_tr_b16 v[216:217], v247 offset:35072
  ds_read_b64_tr_b16 v[218:219], v247 offset:36096
  v_mfma_f32_16x16x32_bf16 a[184:187], v[200:203], a[116:119], a[184:187]
  buffer_load_dwordx4 v237, s[12:15], s93 offen offset:2048 nt lds
  v_mfma_f32_16x16x32_bf16 a[180:183], v[204:207], a[112:115], a[180:183]
  ds_read_b64_tr_b16 v[200:201], v248 offset:35072
  ds_read_b64_tr_b16 v[202:203], v248 offset:36096
  v_mfma_f32_16x16x32_bf16 a[188:191], v[204:207], a[116:119], a[188:191]
  s_waitcnt lgkmcnt(4)
  v_exp_f32 v107, v107
  v_mfma_f32_16x16x32_bf16 a[128:131], v[208:211], a[120:123], a[128:131]
  ds_read_b64_tr_b16 v[204:205], v247 offset:35328
  ds_read_b64_tr_b16 v[206:207], v247 offset:36352
  v_mfma_f32_16x16x32_bf16 a[136:139], v[208:211], a[124:127], a[136:139]
  buffer_load_dwordx4 v237, s[12:15], s93 offen offset:3072 nt lds
  v_mfma_f32_16x16x32_bf16 a[132:135], v[212:215], a[120:123], a[132:135]
  ds_read_b64_tr_b16 v[208:209], v248 offset:35328
  v_cvt_pk_bf16_f32 v101, v106, v107
  v_mfma_f32_16x16x32_bf16 a[140:143], v[212:215], a[124:127], a[140:143]
  s_waitcnt lgkmcnt(3)
  ds_read_b64_tr_b16 v[210:211], v248 offset:36352
  v_mfma_f32_16x16x32_bf16 a[144:147], v[216:219], a[120:123], a[144:147]
  ds_read_b64_tr_b16 v[212:213], v247 offset:35584
  ds_read_b64_tr_b16 v[214:215], v247 offset:36608
  v_mfma_f32_16x16x32_bf16 a[152:155], v[216:219], a[124:127], a[152:155]
  v_exp_f32 v108, v108
  v_mfma_f32_16x16x32_bf16 a[148:151], v[200:203], a[120:123], a[148:151]
  ds_read_b64_tr_b16 v[216:217], v248 offset:35584
  ds_read_b64_tr_b16 v[218:219], v248 offset:36608
  v_mfma_f32_16x16x32_bf16 a[156:159], v[200:203], a[124:127], a[156:159]
  s_waitcnt lgkmcnt(4)
  v_exp_f32 v109, v109
  v_mfma_f32_16x16x32_bf16 a[160:163], v[204:207], a[120:123], a[160:163]
  s_waitcnt vmcnt(20)
  s_barrier
  ds_read_b128 v[200:203], v241 offset:16384
  v_mfma_f32_16x16x32_bf16 a[168:171], v[204:207], a[124:127], a[168:171]
  v_cvt_pk_bf16_f32 v102, v108, v109
  v_accvgpr_read_b32 v128, a128
  v_mfma_f32_16x16x32_bf16 a[164:167], v[208:211], a[120:123], a[164:167]
  ds_read_b128 v[204:207], v242 offset:16384
  v_accvgpr_read_b32 v251, a129
  v_mfma_f32_16x16x32_bf16 a[172:175], v[208:211], a[124:127], a[172:175]
  s_waitcnt lgkmcnt(2)
  v_exp_f32 v110, v110
  v_mfma_f32_16x16x32_bf16 a[176:179], v[212:215], a[120:123], a[176:179]
  ds_read_b128 v[208:211], v241 offset:24576
  v_mul_f32 v128, s70, v128
  v_mfma_f32_16x16x32_bf16 a[184:187], v[212:215], a[124:127], a[184:187]
  v_exp_f32 v111, v111
  v_mfma_f32_16x16x32_bf16 a[180:183], v[216:219], a[120:123], a[180:183]
  ds_read_b128 v[212:215], v242 offset:24576
  v_cvt_pk_bf16_f32 v103, v110, v111
  v_mfma_f32_16x16x32_bf16 a[188:191], v[216:219], a[124:127], a[188:191]
  s_waitcnt lgkmcnt(2)
  v_exp_f32 v112, v112
  v_mfma_f32_16x16x32_bf16 v[228:231], v[220:223], v[100:103], v[228:231]
  v_exp_f32 v113, v113
  v_mfma_f32_16x16x32_bf16 v[160:163], v[200:203], v[0:3], v[192:195]
  ds_read_b128 v[216:219], v241 offset:17408
  v_cvt_pk_bf16_f32 v104, v112, v113
  v_mfma_f32_16x16x32_bf16 v[168:171], v[200:203], v[4:7], v[196:199]
  v_exp_f32 v114, v114
  v_mfma_f32_16x16x32_bf16 v[160:163], v[204:207], v[8:11], v[160:163]
  ds_read_b128 v[200:203], v242 offset:17408
  v_mul_f32 v251, s70, v251
  v_mfma_f32_16x16x32_bf16 v[168:171], v[204:207], v[12:15], v[168:171]
  s_waitcnt lgkmcnt(2)
  v_exp_f32 v115, v115
  v_mfma_f32_16x16x32_bf16 v[160:163], v[208:211], v[16:19], v[160:163]
  ds_read_b128 v[204:207], v241 offset:25600
  v_cvt_pk_bf16_f32 v105, v114, v115
  v_mfma_f32_16x16x32_bf16 v[168:171], v[208:211], v[20:23], v[168:171]
  v_exp_f32 v116, v116
  v_mfma_f32_16x16x32_bf16 v[160:163], v[212:215], v[24:27], v[160:163]
  ds_read_b128 v[208:211], v242 offset:25600
  v_cvt_pk_bf16_f32 v128, v128, v251
  v_mfma_f32_16x16x32_bf16 v[168:171], v[212:215], v[28:31], v[168:171]
  s_waitcnt lgkmcnt(2)
  v_exp_f32 v117, v117
  v_mfma_f32_16x16x32_bf16 v[164:167], v[216:219], v[0:3], v[192:195]
  ds_read_b128 v[212:215], v241 offset:18432
  v_cvt_pk_bf16_f32 v106, v116, v117
  v_mfma_f32_16x16x32_bf16 v[172:175], v[216:219], v[4:7], v[196:199]
  v_exp_f32 v118, v118
  v_mfma_f32_16x16x32_bf16 v[164:167], v[200:203], v[8:11], v[164:167]
  ds_read_b128 v[216:219], v242 offset:18432
  v_max3_f32 v253, v160, v161, v162
  v_mfma_f32_16x16x32_bf16 v[172:175], v[200:203], v[12:15], v[172:175]
  s_waitcnt lgkmcnt(2)
  v_exp_f32 v119, v119
  v_mfma_f32_16x16x32_bf16 v[164:167], v[204:207], v[16:19], v[164:167]
  ds_read_b128 v[200:203], v241 offset:26624
  v_cvt_pk_bf16_f32 v107, v118, v119
  v_mfma_f32_16x16x32_bf16 v[172:175], v[204:207], v[20:23], v[172:175]
  v_exp_f32 v120, v120
  v_mfma_f32_16x16x32_bf16 v[224:227], v[220:223], v[104:107], v[224:227]
  v_exp_f32 v121, v121
  v_mfma_f32_16x16x32_bf16 v[164:167], v[208:211], v[24:27], v[164:167]
  ds_read_b128 v[204:207], v242 offset:26624
  v_cvt_pk_bf16_f32 v108, v120, v121
  v_mfma_f32_16x16x32_bf16 v[172:175], v[208:211], v[28:31], v[172:175]
  s_waitcnt lgkmcnt(2)
  v_exp_f32 v122, v122
  v_mfma_f32_16x16x32_bf16 v[176:179], v[212:215], v[0:3], v[192:195]
  ds_read_b128 v[208:211], v241 offset:19456
  v_max3_f32 v253, v253, v163, v168
  v_mfma_f32_16x16x32_bf16 v[184:187], v[212:215], v[4:7], v[196:199]
  v_exp_f32 v123, v123
  v_mfma_f32_16x16x32_bf16 v[176:179], v[216:219], v[8:11], v[176:179]
  ds_read_b128 v[212:215], v242 offset:19456
  v_cvt_pk_bf16_f32 v109, v122, v123
  v_mfma_f32_16x16x32_bf16 v[184:187], v[216:219], v[12:15], v[184:187]
  s_waitcnt lgkmcnt(2)
  v_exp_f32 v124, v124
  v_mfma_f32_16x16x32_bf16 v[176:179], v[200:203], v[16:19], v[176:179]
  s_add_u32 m0, s68, 114688
  ds_read_b128 v[216:219], v241 offset:27648
  v_max3_f32 v253, v253, v169, v170
  v_mfma_f32_16x16x32_bf16 v[184:187], v[200:203], v[20:23], v[184:187]
  buffer_load_dwordx4 v239, s[32:35], s81 offen lds
  v_mfma_f32_16x16x32_bf16 v[176:179], v[204:207], v[24:27], v[176:179]
  ds_read_b128 v[200:203], v242 offset:27648
  v_max3_f32 v253, v253, v171, v164
  v_mfma_f32_16x16x32_bf16 v[184:187], v[204:207], v[28:31], v[184:187]
  s_waitcnt lgkmcnt(2)
  v_exp_f32 v125, v125
  v_mfma_f32_16x16x32_bf16 v[180:183], v[208:211], v[0:3], v[192:195]
  s_waitcnt vmcnt(17)
  s_barrier
  ds_read_b64_tr_b16 v[204:205], v245 offset:32768
  ds_read_b64_tr_b16 v[206:207], v245 offset:33792
  v_mfma_f32_16x16x32_bf16 v[188:191], v[208:211], v[4:7], v[196:199]
  buffer_load_dwordx4 v239, s[36:39], s81 offen offset:1024 lds
  v_mfma_f32_16x16x32_bf16 v[180:183], v[212:215], v[8:11], v[180:183]
  ds_read_b64_tr_b16 v[208:209], v246 offset:32768
  v_cvt_pk_bf16_f32 v110, v124, v125
  v_mfma_f32_16x16x32_bf16 v[188:191], v[212:215], v[12:15], v[188:191]
  s_waitcnt lgkmcnt(3)
  ds_read_b64_tr_b16 v[210:211], v246 offset:33792
  v_max3_f32 v253, v253, v165, v166
  v_mfma_f32_16x16x32_bf16 v[180:183], v[216:219], v[16:19], v[180:183]
  ds_read_b64_tr_b16 v[212:213], v245 offset:33024
  ds_read_b64_tr_b16 v[214:215], v245 offset:34048
  v_mfma_f32_16x16x32_bf16 v[188:191], v[216:219], v[20:23], v[188:191]
  buffer_load_dwordx4 v239, s[40:43], s81 offen offset:2048 lds
  v_mfma_f32_16x16x32_bf16 v[180:183], v[200:203], v[24:27], v[180:183]
  ds_read_b64_tr_b16 v[216:217], v246 offset:33024
  ds_read_b64_tr_b16 v[218:219], v246 offset:34048
  v_mfma_f32_16x16x32_bf16 v[188:191], v[200:203], v[28:31], v[188:191]
  s_waitcnt lgkmcnt(4)
  v_exp_f32 v126, v126
  v_mfma_f32_16x16x32_bf16 v[32:35], v[204:207], v[96:99], v[32:35]
  ds_read_b64_tr_b16 v[200:201], v245 offset:33280
  ds_read_b64_tr_b16 v[202:203], v245 offset:34304
  v_mfma_f32_16x16x32_bf16 v[40:43], v[204:207], v[100:103], v[40:43]
  buffer_load_dwordx4 v239, s[44:47], s81 offen offset:3072 lds
  v_mfma_f32_16x16x32_bf16 v[36:39], v[208:211], v[96:99], v[36:39]
  ds_read_b64_tr_b16 v[204:205], v246 offset:33280
  ds_read_b64_tr_b16 v[206:207], v246 offset:34304
  v_mfma_f32_16x16x32_bf16 v[44:47], v[208:211], v[100:103], v[44:47]
  s_waitcnt lgkmcnt(4)
  v_exp_f32 v127, v127
  v_mfma_f32_16x16x32_bf16 v[48:51], v[212:215], v[96:99], v[48:51]
  s_add_u32 m0, s68, 131072
  ds_read_b64_tr_b16 v[208:209], v245 offset:33536
  ds_read_b64_tr_b16 v[210:211], v245 offset:34560
  v_mfma_f32_16x16x32_bf16 v[56:59], v[212:215], v[100:103], v[56:59]
  buffer_load_dwordx4 v239, s[32:35], s82 offen lds
  v_mfma_f32_16x16x32_bf16 v[52:55], v[216:219], v[96:99], v[52:55]
  ds_read_b64_tr_b16 v[212:213], v246 offset:33536
  v_cvt_pk_bf16_f32 v111, v126, v127
  v_mfma_f32_16x16x32_bf16 v[60:63], v[216:219], v[100:103], v[60:63]
  s_waitcnt lgkmcnt(3)
  ds_read_b64_tr_b16 v[214:215], v246 offset:34560
  v_max3_f32 v253, v253, v167, v172
  v_mfma_f32_16x16x32_bf16 v[228:231], v[220:223], v[108:111], v[228:231]
  v_max3_f32 v253, v253, v173, v174
  v_max3_f32 v253, v253, v175, v176
  v_mfma_f32_16x16x32_bf16 v[64:67], v[200:203], v[96:99], v[64:67]
  ds_read_b64_tr_b16 v[216:217], v245 offset:34816
  ds_read_b64_tr_b16 v[218:219], v245 offset:35840
  v_mfma_f32_16x16x32_bf16 v[72:75], v[200:203], v[100:103], v[72:75]
  buffer_load_dwordx4 v239, s[36:39], s82 offen offset:1024 lds
  v_mfma_f32_16x16x32_bf16 v[68:71], v[204:207], v[96:99], v[68:71]
  ds_read_b64_tr_b16 v[200:201], v246 offset:34816
  v_max3_f32 v253, v253, v177, v178
  v_mfma_f32_16x16x32_bf16 v[76:79], v[204:207], v[100:103], v[76:79]
  s_waitcnt lgkmcnt(3)
  ds_read_b64_tr_b16 v[202:203], v246 offset:35840
  v_max3_f32 v253, v253, v179, v184
  v_mfma_f32_16x16x32_bf16 v[80:83], v[208:211], v[96:99], v[80:83]
  ds_read_b64_tr_b16 v[204:205], v245 offset:35072
  ds_read_b64_tr_b16 v[206:207], v245 offset:36096
  v_mfma_f32_16x16x32_bf16 v[88:91], v[208:211], v[100:103], v[88:91]
  buffer_load_dwordx4 v239, s[40:43], s82 offen offset:2048 lds
  v_mfma_f32_16x16x32_bf16 v[84:87], v[212:215], v[96:99], v[84:87]
  ds_read_b64_tr_b16 v[208:209], v246 offset:35072
  v_max3_f32 v253, v253, v185, v186
  v_mfma_f32_16x16x32_bf16 v[92:95], v[212:215], v[100:103], v[92:95]
  s_waitcnt lgkmcnt(3)
  ds_read_b64_tr_b16 v[210:211], v246 offset:36096
  v_max3_f32 v253, v253, v187, v180
  v_mfma_f32_16x16x32_bf16 v[32:35], v[216:219], v[104:107], v[32:35]
  ds_read_b64_tr_b16 v[212:213], v245 offset:35328
  v_max3_f32 v253, v253, v181, v182
  v_mfma_f32_16x16x32_bf16 v[40:43], v[216:219], v[108:111], v[40:43]
  ds_read_b64_tr_b16 v[214:215], v245 offset:36352
  v_max3_f32 v253, v253, v183, v188
  v_mfma_f32_16x16x32_bf16 v[36:39], v[200:203], v[104:107], v[36:39]
  ds_read_b64_tr_b16 v[216:217], v246 offset:35328
  v_max3_f32 v253, v253, v189, v190
  v_mfma_f32_16x16x32_bf16 v[44:47], v[200:203], v[108:111], v[44:47]
  s_waitcnt lgkmcnt(3)
  ds_read_b64_tr_b16 v[218:219], v246 offset:36352
  v_max_f32 v253, v253, v191
  v_mfma_f32_16x16x32_bf16 v[48:51], v[204:207], v[104:107], v[48:51]
  ds_read_b64_tr_b16 v[200:201], v245 offset:35584
  v_cmp_lt_f32 vcc, 0x41200000, v253
  v_mfma_f32_16x16x32_bf16 v[56:59], v[204:207], v[108:111], v[56:59]
  ds_read_b64_tr_b16 v[202:203], v245 offset:36608
  v_accvgpr_read_b32 v129, a130
  v_mfma_f32_16x16x32_bf16 v[52:55], v[208:211], v[104:107], v[52:55]
  ds_read_b64_tr_b16 v[204:205], v246 offset:35584
  v_accvgpr_read_b32 v251, a131
  v_mfma_f32_16x16x32_bf16 v[60:63], v[208:211], v[108:111], v[60:63]
  s_waitcnt lgkmcnt(3)
  ds_read_b64_tr_b16 v[206:207], v246 offset:36608
  v_mul_f32 v129, s70, v129
  v_mfma_f32_16x16x32_bf16 v[64:67], v[212:215], v[104:107], v[64:67]
  s_waitcnt vmcnt(15)
  s_barrier
  ds_read_b64_tr_b16 v[208:209], v247 offset:49152
  v_mfma_f32_16x16x32_bf16 v[72:75], v[212:215], v[108:111], v[72:75]
  ds_read_b64_tr_b16 v[210:211], v247 offset:50176
  v_mul_f32 v251, s70, v251
  v_mfma_f32_16x16x32_bf16 v[68:71], v[216:219], v[104:107], v[68:71]
  ds_read_b64_tr_b16 v[212:213], v248 offset:49152
  v_cvt_pk_bf16_f32 v129, v129, v251
  v_mfma_f32_16x16x32_bf16 v[76:79], v[216:219], v[108:111], v[76:79]
  s_waitcnt lgkmcnt(3)
  ds_read_b64_tr_b16 v[214:215], v248 offset:50176
  v_accvgpr_read_b32 v130, a132
  v_mfma_f32_16x16x32_bf16 v[80:83], v[200:203], v[104:107], v[80:83]
  ds_read_b64_tr_b16 v[216:217], v247 offset:49408
  v_accvgpr_read_b32 v251, a133
  v_mfma_f32_16x16x32_bf16 v[88:91], v[200:203], v[108:111], v[88:91]
  ds_read_b64_tr_b16 v[218:219], v247 offset:50432
  v_mul_f32 v130, s70, v130
  v_mfma_f32_16x16x32_bf16 v[84:87], v[204:207], v[104:107], v[84:87]
  ds_read_b64_tr_b16 v[200:201], v248 offset:49408
  v_mul_f32 v251, s70, v251
  v_mfma_f32_16x16x32_bf16 v[92:95], v[204:207], v[108:111], v[92:95]
  s_waitcnt lgkmcnt(3)
  s_cbranch_vccnz L_r0_5t
L_r0_5:
  ds_read_b64_tr_b16 v[202:203], v248 offset:50432
  v_mfma_f32_16x16x32_bf16 a[192:195], v[208:211], a[0:3], 0
  ds_read_b64_tr_b16 v[204:205], v247 offset:49664
  ds_read_b64_tr_b16 v[206:207], v247 offset:50688
  v_mfma_f32_16x16x32_bf16 a[200:203], v[208:211], a[4:7], 0
  v_exp_f32 v160, v160
  v_mfma_f32_16x16x32_bf16 a[196:199], v[212:215], a[0:3], 0
  ds_read_b64_tr_b16 v[208:209], v248 offset:49664
  ds_read_b64_tr_b16 v[210:211], v248 offset:50688
  v_mfma_f32_16x16x32_bf16 a[204:207], v[212:215], a[4:7], 0
  s_waitcnt lgkmcnt(4)
  v_exp_f32 v161, v161
  v_mfma_f32_16x16x32_bf16 a[208:211], v[216:219], a[0:3], 0
  ds_read_b64_tr_b16 v[212:213], v247 offset:49920
  v_cvt_pk_bf16_f32 v160, v160, v161
  v_mfma_f32_16x16x32_bf16 a[216:219], v[216:219], a[4:7], 0
  ds_read_b64_tr_b16 v[214:215], v247 offset:50944
  v_cvt_pk_bf16_f32 v130, v130, v251
  v_mfma_f32_16x16x32_bf16 a[212:215], v[200:203], a[0:3], 0
  ds_read_b64_tr_b16 v[216:217], v248 offset:49920
  ds_read_b64_tr_b16 v[218:219], v248 offset:50944
  v_mfma_f32_16x16x32_bf16 a[220:223], v[200:203], a[4:7], 0
  s_waitcnt lgkmcnt(4)
  v_exp_f32 v162, v162
  v_mfma_f32_16x16x32_bf16 a[224:227], v[204:207], a[0:3], 0
  ds_read_b64_tr_b16 v[200:201], v247 offset:51200
  ds_read_b64_tr_b16 v[202:203], v247 offset:52224
  v_mfma_f32_16x16x32_bf16 a[232:235], v[204:207], a[4:7], 0
  v_exp_f32 v163, v163
  v_mfma_f32_16x16x32_bf16 a[228:231], v[208:211], a[0:3], 0
  ds_read_b64_tr_b16 v[204:205], v248 offset:51200
  v_cvt_pk_bf16_f32 v161, v162, v163
  v_mfma_f32_16x16x32_bf16 a[236:239], v[208:211], a[4:7], 0
  s_waitcnt lgkmcnt(3)
  ds_read_b64_tr_b16 v[206:207], v248 offset:52224
  v_accvgpr_read_b32 v131, a134
  v_mfma_f32_16x16x32_bf16 a[240:243], v[212:215], a[0:3], 0
  ds_read_b64_tr_b16 v[208:209], v247 offset:51456
  ds_read_b64_tr_b16 v[210:211], v247 offset:52480
  v_mfma_f32_16x16x32_bf16 a[248:251], v[212:215], a[4:7], 0
  v_exp_f32 v164, v164
  v_mfma_f32_16x16x32_bf16 a[244:247], v[216:219], a[0:3], 0
  ds_read_b64_tr_b16 v[212:213], v248 offset:51456
  ds_read_b64_tr_b16 v[214:215], v248 offset:52480
  v_mfma_f32_16x16x32_bf16 a[252:255], v[216:219], a[4:7], 0
  s_waitcnt lgkmcnt(4)
  v_exp_f32 v165, v165
  v_mfma_f32_16x16x32_bf16 a[192:195], v[200:203], a[8:11], a[192:195]
  ds_read_b64_tr_b16 v[216:217], v247 offset:51712
  v_cvt_pk_bf16_f32 v162, v164, v165
  v_mfma_f32_16x16x32_bf16 a[200:203], v[200:203], a[12:15], a[200:203]
  ds_read_b64_tr_b16 v[218:219], v247 offset:52736
  v_accvgpr_read_b32 v251, a135
  v_mfma_f32_16x16x32_bf16 a[196:199], v[204:207], a[8:11], a[196:199]
  ds_read_b64_tr_b16 v[200:201], v248 offset:51712
  ds_read_b64_tr_b16 v[202:203], v248 offset:52736
  v_mfma_f32_16x16x32_bf16 a[204:207], v[204:207], a[12:15], a[204:207]
  s_waitcnt lgkmcnt(4)
  v_exp_f32 v166, v166
  v_mfma_f32_16x16x32_bf16 a[208:211], v[208:211], a[8:11], a[208:211]
  ds_read_b64_tr_b16 v[204:205], v247 offset:51968
  ds_read_b64_tr_b16 v[206:207], v247 offset:52992
  v_mfma_f32_16x16x32_bf16 a[216:219], v[208:211], a[12:15], a[216:219]
  v_exp_f32 v167, v167
  v_mfma_f32_16x16x32_bf16 a[212:215], v[212:215], a[8:11], a[212:215]
  ds_read_b64_tr_b16 v[208:209], v248 offset:51968
  v_cvt_pk_bf16_f32 v163, v166, v167
  v_mfma_f32_16x16x32_bf16 a[220:223], v[212:215], a[12:15], a[220:223]
  s_waitcnt lgkmcnt(3)
  ds_read_b64_tr_b16 v[210:211], v248 offset:52992
  v_mul_f32 v131, s70, v131
  v_mfma_f32_16x16x32_bf16 v[224:227], v[220:223], v[160:163], v[224:227]
  v_exp_f32 v168, v168
  v_mfma_f32_16x16x32_bf16 a[224:227], v[216:219], a[8:11], a[224:227]
  s_waitcnt vmcnt(3)
  s_barrier
  ds_read_b64_tr_b16 v[212:213], v247 offset:16384
  ds_read_b64_tr_b16 v[214:215], v247 offset:17408
  v_mfma_f32_16x16x32_bf16 a[232:235], v[216:219], a[12:15], a[232:235]
  buffer_load_dwordx4 v239, s[44:47], s82 offen offset:3072 lds
  v_mfma_f32_16x16x32_bf16 a[228:231], v[200:203], a[8:11], a[228:231]
  ds_read_b64_tr_b16 v[216:217], v248 offset:16384
  ds_read_b64_tr_b16 v[218:219], v248 offset:17408
  v_mfma_f32_16x16x32_bf16 a[236:239], v[200:203], a[12:15], a[236:239]
  s_waitcnt lgkmcnt(4)
  v_exp_f32 v169, v169
  v_mfma_f32_16x16x32_bf16 a[240:243], v[204:207], a[8:11], a[240:243]
  s_add_u32 m0, s68, 65536
  ds_read_b64_tr_b16 v[200:201], v247 offset:16640
  ds_read_b64_tr_b16 v[202:203], v247 offset:17664
  v_mfma_f32_16x16x32_bf16 a[248:251], v[204:207], a[12:15], a[248:251]
  buffer_load_dwordx4 v237, s[12:15], s94 offen nt lds
  v_mfma_f32_16x16x32_bf16 a[244:247], v[208:211], a[8:11], a[244:247]
  ds_read_b64_tr_b16 v[204:205], v248 offset:16640
  v_cvt_pk_bf16_f32 v164, v168, v169
  v_mfma_f32_16x16x32_bf16 a[252:255], v[208:211], a[12:15], a[252:255]
  s_waitcnt lgkmcnt(3)
  ds_read_b64_tr_b16 v[206:207], v248 offset:17664
  v_mul_f32 v251, s70, v251
  v_mfma_f32_16x16x32_bf16 a[192:195], v[212:215], a[16:19], a[192:195]
  ds_read_b64_tr_b16 v[208:209], v247 offset:16896
  ds_read_b64_tr_b16 v[210:211], v247 offset:17920
  v_mfma_f32_16x16x32_bf16 a[200:203], v[212:215], a[20:23], a[200:203]
  buffer_load_dwordx4 v237, s[12:15], s94 offen offset:1024 nt lds
  v_mfma_f32_16x16x32_bf16 a[196:199], v[216:219], a[16:19], a[196:199]
  ds_read_b64_tr_b16 v[212:213], v248 offset:16896
  ds_read_b64_tr_b16 v[214:215], v248 offset:17920
  v_mfma_f32_16x16x32_bf16 a[204:207], v[216:219], a[20:23], a[204:207]
  s_waitcnt lgkmcnt(4)
  v_exp_f32 v170, v170
  v_mfma_f32_16x16x32_bf16 a[208:211], v[200:203], a[16:19], a[208:211]
  ds_read_b64_tr_b16 v[216:217], v247 offset:17152
  ds_read_b64_tr_b16 v[218:219], v247 offset:18176
  v_mfma_f32_16x16x32_bf16 a[216:219], v[200:203], a[20:23], a[216:219]
  buffer_load_dwordx4 v237, s[12:15], s94 offen offset:2048 nt lds
  v_mfma_f32_16x16x32_bf16 a[212:215], v[204:207], a[16:19], a[212:215]
  ds_read_b64_tr_b16 v[200:201], v248 offset:17152
  ds_read_b64_tr_b16 v[202:203], v248 offset:18176
  v_mfma_f32_16x16x32_bf16 a[220:223], v[204:207], a[20:23], a[220:223]
  s_waitcnt lgkmcnt(4)
  v_exp_f32 v171, v171
  v_mfma_f32_16x16x32_bf16 a[224:227], v[208:211], a[16:19], a[224:227]
  ds_read_b64_tr_b16 v[204:205], v247 offset:18432
  ds_read_b64_tr_b16 v[206:207], v247 offset:19456
  v_mfma_f32_16x16x32_bf16 a[232:235], v[208:211], a[20:23], a[232:235]
  buffer_load_dwordx4 v237, s[12:15], s94 offen offset:3072 nt lds
  v_mfma_f32_16x16x32_bf16 a[228:231], v[212:215], a[16:19], a[228:231]
  ds_read_b64_tr_b16 v[208:209], v248 offset:18432
  v_cvt_pk_bf16_f32 v165, v170, v171
  v_mfma_f32_16x16x32_bf16 a[236:239], v[212:215], a[20:23], a[236:239]
  s_waitcnt lgkmcnt(3)
  ds_read_b64_tr_b16 v[210:211], v248 offset:19456
  v_cvt_pk_bf16_f32 v131, v131, v251
  v_mfma_f32_16x16x32_bf16 a[240:243], v[216:219], a[16:19], a[240:243]
  s_add_u32 m0, s68, 49152
  ds_read_b64_tr_b16 v[212:213], v247 offset:18688
  ds_read_b64_tr_b16 v[214:215], v247 offset:19712
  v_mfma_f32_16x16x32_bf16 a[248:251], v[216:219], a[20:23], a[248:251]
  buffer_load_dwordx4 v236, s[8:11], s95 offen nt lds
  v_mfma_f32_16x16x32_bf16 a[244:247], v[200:203], a[16:19], a[244:247]
  ds_read_b64_tr_b16 v[216:217], v248 offset:18688
  ds_read_b64_tr_b16 v[218:219], v248 offset:19712
  v_mfma_f32_16x16x32_bf16 a[252:255], v[200:203], a[20:23], a[252:255]
  s_waitcnt lgkmcnt(4)
  v_exp_f32 v172, v172
  v_mfma_f32_16x16x32_bf16 a[192:195], v[204:207], a[24:27], a[192:195]
  ds_read_b64_tr_b16 v[200:201], v247 offset:18944
  ds_read_b64_tr_b16 v[202:203], v247 offset:19968
  v_mfma_f32_16x16x32_bf16 a[200:203], v[204:207], a[28:31], a[200:203]
  buffer_load_dwordx4 v236, s[8:11], s95 offen offset:1024 nt lds
  v_mfma_f32_16x16x32_bf16 a[196:199], v[208:211], a[24:27], a[196:199]
  ds_read_b64_tr_b16 v[204:205], v248 offset:18944
  ds_read_b64_tr_b16 v[206:207], v248 offset:19968
  v_mfma_f32_16x16x32_bf16 a[204:207], v[208:211], a[28:31], a[204:207]
  s_waitcnt lgkmcnt(4)
  v_exp_f32 v173, v173
  v_mfma_f32_16x16x32_bf16 a[208:211], v[212:215], a[24:27], a[208:211]
  ds_read_b64_tr_b16 v[208:209], v247 offset:19200
  ds_read_b64_tr_b16 v[210:211], v247 offset:20224
  v_mfma_f32_16x16x32_bf16 a[216:219], v[212:215], a[28:31], a[216:219]
  buffer_load_dwordx4 v236, s[8:11], s95 offen offset:2048 nt lds
  v_mfma_f32_16x16x32_bf16 a[212:215], v[216:219], a[24:27], a[212:215]
  ds_read_b64_tr_b16 v[212:213], v248 offset:19200
  v_cvt_pk_bf16_f32 v166, v172, v173
  v_mfma_f32_16x16x32_bf16 a[220:223], v[216:219], a[28:31], a[220:223]
  s_waitcnt lgkmcnt(3)
  ds_read_b64_tr_b16 v[214:215], v248 offset:20224
  v_permlane16_swap_b32 v128, v130
  v_mfma_f32_16x16x32_bf16 a[224:227], v[200:203], a[24:27], a[224:227]
  s_waitcnt vmcnt(19)
  s_barrier
  ds_read_b128 v[216:219], v241 offset:32768
  v_mfma_f32_16x16x32_bf16 a[232:235], v[200:203], a[28:31], a[232:235]
  buffer_load_dwordx4 v236, s[8:11], s95 offen offset:3072 nt lds
  v_add_u32 v236, 262144, v236
  v_mfma_f32_16x16x32_bf16 a[228:231], v[204:207], a[24:27], a[228:231]
  ds_read_b128 v[200:203], v242 offset:32768
  v_permlane16_swap_b32 v129, v131
  v_mfma_f32_16x16x32_bf16 a[236:239], v[204:207], a[28:31], a[236:239]
  s_waitcnt lgkmcnt(2)
  v_exp_f32 v174, v174
  v_mfma_f32_16x16x32_bf16 a[240:243], v[208:211], a[24:27], a[240:243]
  s_add_u32 m0, s68, 147456
  ds_read_b128 v[204:207], v241 offset:40960
  v_accvgpr_read_b32 v132, a136
  v_mfma_f32_16x16x32_bf16 a[248:251], v[208:211], a[28:31], a[248:251]
  buffer_load_dwordx4 v239, s[32:35], s83 offen lds
  v_mfma_f32_16x16x32_bf16 a[244:247], v[212:215], a[24:27], a[244:247]
  ds_read_b128 v[208:211], v242 offset:40960
  v_accvgpr_read_b32 v251, a137
  v_mfma_f32_16x16x32_bf16 a[252:255], v[212:215], a[28:31], a[252:255]
  s_waitcnt lgkmcnt(2)
  v_exp_f32 v175, v175
  v_mfma_f32_16x16x32_bf16 v[96:99], v[216:219], v[0:3], v[192:195]
  ds_read_b128 v[212:215], v241 offset:33792
  v_cvt_pk_bf16_f32 v167, v174, v175
  v_mfma_f32_16x16x32_bf16 v[104:107], v[216:219], v[4:7], v[196:199]
  buffer_load_dwordx4 v239, s[36:39], s83 offen offset:1024 lds
  v_mfma_f32_16x16x32_bf16 v[228:231], v[220:223], v[164:167], v[228:231]
  v_exp_f32 v176, v176
  v_mfma_f32_16x16x32_bf16 v[96:99], v[200:203], v[8:11], v[96:99]
  ds_read_b128 v[216:219], v242 offset:33792
  v_mul_f32 v132, s70, v132
  v_mfma_f32_16x16x32_bf16 v[104:107], v[200:203], v[12:15], v[104:107]
  s_waitcnt lgkmcnt(2)
  v_exp_f32 v177, v177
  v_mfma_f32_16x16x32_bf16 v[96:99], v[204:207], v[16:19], v[96:99]
  ds_read_b128 v[200:203], v241 offset:41984
  v_cvt_pk_bf16_f32 v168, v176, v177
  v_mfma_f32_16x16x32_bf16 v[104:107], v[204:207], v[20:23], v[104:107]
  v_exp_f32 v178, v178
  v_mfma_f32_16x16x32_bf16 v[96:99], v[208:211], v[24:27], v[96:99]
  ds_read_b128 v[204:207], v242 offset:41984
  v_mul_f32 v251, s70, v251
  v_mfma_f32_16x16x32_bf16 v[104:107], v[208:211], v[28:31], v[104:107]
  s_waitcnt lgkmcnt(2)
  v_exp_f32 v179, v179
  v_mfma_f32_16x16x32_bf16 v[100:103], v[212:215], v[0:3], v[192:195]
  ds_read_b128 v[208:211], v241 offset:34816
  v_cvt_pk_bf16_f32 v169, v178, v179
  v_mfma_f32_16x16x32_bf16 v[108:111], v[212:215], v[4:7], v[196:199]
  v_exp_f32 v180, v180
  v_mfma_f32_16x16x32_bf16 v[100:103], v[216:219], v[8:11], v[100:103]
  ds_read_b128 v[212:215], v242 offset:34816
  v_max3_f32 v253, v96, v97, v98
  v_mfma_f32_16x16x32_bf16 v[108:111], v[216:219], v[12:15], v[108:111]
  s_waitcnt lgkmcnt(2)
  v_exp_f32 v181, v181
  v_mfma_f32_16x16x32_bf16 v[100:103], v[200:203], v[16:19], v[100:103]
  ds_read_b128 v[216:219], v241 offset:43008
  v_cvt_pk_bf16_f32 v170, v180, v181
  v_mfma_f32_16x16x32_bf16 v[108:111], v[200:203], v[20:23], v[108:111]
  v_exp_f32 v182, v182
  v_mfma_f32_16x16x32_bf16 v[100:103], v[204:207], v[24:27], v[100:103]
  ds_read_b128 v[200:203], v242 offset:43008
  v_max3_f32 v253, v253, v99, v104
  v_mfma_f32_16x16x32_bf16 v[108:111], v[204:207], v[28:31], v[108:111]
  s_waitcnt lgkmcnt(2)
  v_exp_f32 v183, v183
  v_mfma_f32_16x16x32_bf16 v[112:115], v[208:211], v[0:3], v[192:195]
  ds_read_b128 v[204:207], v241 offset:35840
  v_cvt_pk_bf16_f32 v171, v182, v183
  v_mfma_f32_16x16x32_bf16 v[120:123], v[208:211], v[4:7], v[196:199]
  v_exp_f32 v184, v184
  v_mfma_f32_16x16x32_bf16 v[224:227], v[220:223], v[168:171], v[224:227]
  v_exp_f32 v185, v185
  v_mfma_f32_16x16x32_bf16 v[112:115], v[212:215], v[8:11], v[112:115]
  ds_read_b128 v[208:211], v242 offset:35840
  v_cvt_pk_bf16_f32 v172, v184, v185
  v_mfma_f32_16x16x32_bf16 v[120:123], v[212:215], v[12:15], v[120:123]
  s_waitcnt lgkmcnt(2)
  v_exp_f32 v186, v186
  v_mfma_f32_16x16x32_bf16 v[112:115], v[216:219], v[16:19], v[112:115]
  ds_read_b128 v[212:215], v241 offset:44032
  v_max3_f32 v253, v253, v105, v106
  v_mfma_f32_16x16x32_bf16 v[120:123], v[216:219], v[20:23], v[120:123]
  v_exp_f32 v187, v187
  v_mfma_f32_16x16x32_bf16 v[112:115], v[200:203], v[24:27], v[112:115]
  ds_read_b128 v[216:219], v242 offset:44032
  v_cvt_pk_bf16_f32 v173, v186, v187
  v_mfma_f32_16x16x32_bf16 v[120:123], v[200:203], v[28:31], v[120:123]
  s_waitcnt lgkmcnt(2)
  v_exp_f32 v188, v188
  v_mfma_f32_16x16x32_bf16 v[116:119], v[204:207], v[0:3], v[192:195]
  s_waitcnt vmcnt(18)
  s_barrier
  ds_read_b64_tr_b16 v[200:201], v245 offset:16384
  ds_read_b64_tr_b16 v[202:203], v245 offset:17408
  v_mfma_f32_16x16x32_bf16 v[124:127], v[204:207], v[4:7], v[196:199]
  v_exp_f32 v189, v189
  v_mfma_f32_16x16x32_bf16 v[116:119], v[208:211], v[8:11], v[116:119]
  ds_read_b64_tr_b16 v[204:205], v246 offset:16384
  v_cvt_pk_bf16_f32 v174, v188, v189
  v_mfma_f32_16x16x32_bf16 v[124:127], v[208:211], v[12:15], v[124:127]
  s_waitcnt lgkmcnt(3)
  ds_read_b64_tr_b16 v[206:207], v246 offset:17408
  v_max3_f32 v253, v253, v107, v100
  v_mfma_f32_16x16x32_bf16 v[116:119], v[212:215], v[16:19], v[116:119]
  ds_read_b64_tr_b16 v[208:209], v245 offset:16640
  ds_read_b64_tr_b16 v[210:211], v245 offset:17664
  v_mfma_f32_16x16x32_bf16 v[124:127], v[212:215], v[20:23], v[124:127]
  v_exp_f32 v190, v190
  v_mfma_f32_16x16x32_bf16 v[116:119], v[216:219], v[24:27], v[116:119]
  ds_read_b64_tr_b16 v[212:213], v246 offset:16640
  ds_read_b64_tr_b16 v[214:215], v246 offset:17664
  v_mfma_f32_16x16x32_bf16 v[124:127], v[216:219], v[28:31], v[124:127]
  s_waitcnt lgkmcnt(4)
  v_exp_f32 v191, v191
  v_mfma_f32_16x16x32_bf16 v[32:35], v[200:203], v[160:163], v[32:35]
  ds_read_b64_tr_b16 v[216:217], v245 offset:16896
  v_cvt_pk_bf16_f32 v175, v190, v191
  v_mfma_f32_16x16x32_bf16 v[40:43], v[200:203], v[164:167], v[40:43]
  ds_read_b64_tr_b16 v[218:219], v245 offset:17920
  v_max3_f32 v253, v253, v101, v102
  v_mfma_f32_16x16x32_bf16 v[228:231], v[220:223], v[172:175], v[228:231]
  v_max3_f32 v253, v253, v103, v108
  v_max3_f32 v253, v253, v109, v110
  v_mfma_f32_16x16x32_bf16 v[36:39], v[204:207], v[160:163], v[36:39]
  ds_read_b64_tr_b16 v[200:201], v246 offset:16896
  v_max3_f32 v253, v253, v111, v112
  v_mfma_f32_16x16x32_bf16 v[44:47], v[204:207], v[164:167], v[44:47]
  s_waitcnt lgkmcnt(3)
  ds_read_b64_tr_b16 v[202:203], v246 offset:17920
  v_max3_f32 v253, v253, v113, v114
  v_mfma_f32_16x16x32_bf16 v[48:51], v[208:211], v[160:163], v[48:51]
  ds_read_b64_tr_b16 v[204:205], v245 offset:17152
  ds_read_b64_tr_b16 v[206:207], v245 offset:18176
  v_mfma_f32_16x16x32_bf16 v[56:59], v[208:211], v[164:167], v[56:59]
  buffer_load_dwordx4 v239, s[40:43], s83 offen offset:2048 lds
  v_mfma_f32_16x16x32_bf16 v[52:55], v[212:215], v[160:163], v[52:55]
  ds_read_b64_tr_b16 v[208:209], v246 offset:17152
  v_max3_f32 v253, v253, v115, v120
  v_mfma_f32_16x16x32_bf16 v[60:63], v[212:215], v[164:167], v[60:63]
  s_waitcnt lgkmcnt(3)
  ds_read_b64_tr_b16 v[210:211], v246 offset:18176
  v_max3_f32 v253, v253, v121, v122
  v_mfma_f32_16x16x32_bf16 v[64:67], v[216:219], v[160:163], v[64:67]
  ds_read_b64_tr_b16 v[212:213], v245 offset:18432
  ds_read_b64_tr_b16 v[214:215], v245 offset:19456
  v_mfma_f32_16x16x32_bf16 v[72:75], v[216:219], v[164:167], v[72:75]
  buffer_load_dwordx4 v239, s[44:47], s83 offen offset:3072 lds
  v_mfma_f32_16x16x32_bf16 v[68:71], v[200:203], v[160:163], v[68:71]
  ds_read_b64_tr_b16 v[216:217], v246 offset:18432
  v_max3_f32 v253, v253, v123, v116
  v_mfma_f32_16x16x32_bf16 v[76:79], v[200:203], v[164:167], v[76:79]
  s_waitcnt lgkmcnt(3)
  ds_read_b64_tr_b16 v[218:219], v246 offset:19456
  v_max3_f32 v253, v253, v117, v118
  v_mfma_f32_16x16x32_bf16 v[80:83], v[204:207], v[160:163], v[80:83]
  s_add_u32 m0, s68, 114688
  ds_read_b64_tr_b16 v[200:201], v245 offset:18688
  ds_read_b64_tr_b16 v[202:203], v245 offset:19712
  v_mfma_f32_16x16x32_bf16 v[88:91], v[204:207], v[164:167], v[88:91]
  buffer_load_dwordx4 v239, s[32:35], s84 offen lds
  v_mfma_f32_16x16x32_bf16 v[84:87], v[208:211], v[160:163], v[84:87]
  ds_read_b64_tr_b16 v[204:205], v246 offset:18688
  v_max3_f32 v253, v253, v119, v124
  v_mfma_f32_16x16x32_bf16 v[92:95], v[208:211], v[164:167], v[92:95]
  s_waitcnt lgkmcnt(3)
  ds_read_b64_tr_b16 v[206:207], v246 offset:19712
  v_max3_f32 v253, v253, v125, v126
  v_mfma_f32_16x16x32_bf16 v[32:35], v[212:215], v[168:171], v[32:35]
  ds_read_b64_tr_b16 v[208:209], v245 offset:18944
  ds_read_b64_tr_b16 v[210:211], v245 offset:19968
  v_mfma_f32_16x16x32_bf16 v[40:43], v[212:215], v[172:175], v[40:43]
  buffer_load_dwordx4 v239, s[36:39], s84 offen offset:1024 lds
  v_mfma_f32_16x16x32_bf16 v[36:39], v[216:219], v[168:171], v[36:39]
  ds_read_b64_tr_b16 v[212:213], v246 offset:18944
  v_max_f32 v253, v253, v127
  v_mfma_f32_16x16x32_bf16 v[44:47], v[216:219], v[172:175], v[44:47]
  s_waitcnt lgkmcnt(3)
  ds_read_b64_tr_b16 v[214:215], v246 offset:19968
  v_cmp_lt_f32 vcc, 0x41200000, v253
  v_mfma_f32_16x16x32_bf16 v[48:51], v[200:203], v[168:171], v[48:51]
  ds_read_b64_tr_b16 v[216:217], v245 offset:19200
  ds_read_b64_tr_b16 v[218:219], v245 offset:20224
  v_mfma_f32_16x16x32_bf16 v[56:59], v[200:203], v[172:175], v[56:59]
  buffer_load_dwordx4 v239, s[40:43], s84 offen offset:2048 lds
  v_mfma_f32_16x16x32_bf16 v[52:55], v[204:207], v[168:171], v[52:55]
  ds_read_b64_tr_b16 v[200:201], v246 offset:19200
  v_cvt_pk_bf16_f32 v132, v132, v251
  v_mfma_f32_16x16x32_bf16 v[60:63], v[204:207], v[172:175], v[60:63]
  s_waitcnt lgkmcnt(3)
  ds_read_b64_tr_b16 v[202:203], v246 offset:20224
  v_accvgpr_read_b32 v133, a138
  v_mfma_f32_16x16x32_bf16 v[64:67], v[208:211], v[168:171], v[64:67]
  s_waitcnt vmcnt(15)
  s_barrier
  ds_read_b64_tr_b16 v[204:205], v247 offset:32768
  ds_read_b64_tr_b16 v[206:207], v247 offset:33792
  v_mfma_f32_16x16x32_bf16 v[72:75], v[208:211], v[172:175], v[72:75]
  buffer_load_dwordx4 v239, s[44:47], s84 offen offset:3072 lds
  v_mfma_f32_16x16x32_bf16 v[68:71], v[212:215], v[168:171], v[68:71]
  ds_read_b64_tr_b16 v[208:209], v248 offset:32768
  v_accvgpr_read_b32 v251, a139
  v_mfma_f32_16x16x32_bf16 v[76:79], v[212:215], v[172:175], v[76:79]
  s_waitcnt lgkmcnt(3)
  ds_read_b64_tr_b16 v[210:211], v248 offset:33792
  v_mul_f32 v133, s70, v133
  v_mfma_f32_16x16x32_bf16 v[80:83], v[216:219], v[168:171], v[80:83]
  s_add_u32 m0, s68, 98304
  ds_read_b64_tr_b16 v[212:213], v247 offset:33024
  ds_read_b64_tr_b16 v[214:215], v247 offset:34048
  v_mfma_f32_16x16x32_bf16 v[88:91], v[216:219], v[172:175], v[88:91]
  buffer_load_dwordx4 v237, s[12:15], s95 offen nt lds
  v_mfma_f32_16x16x32_bf16 v[84:87], v[200:203], v[168:171], v[84:87]
  ds_read_b64_tr_b16 v[216:217], v248 offset:33024
  v_mul_f32 v251, s70, v251
  v_mfma_f32_16x16x32_bf16 v[92:95], v[200:203], v[172:175], v[92:95]
  s_waitcnt lgkmcnt(3)
  s_cbranch_vccnz L_r0_6t
L_r0_6:
  ds_read_b64_tr_b16 v[218:219], v248 offset:34048
  v_mfma_f32_16x16x32_bf16 a[192:195], v[204:207], a[32:35], a[192:195]
  ds_read_b64_tr_b16 v[200:201], v247 offset:33280
  ds_read_b64_tr_b16 v[202:203], v247 offset:34304
  v_mfma_f32_16x16x32_bf16 a[200:203], v[204:207], a[36:39], a[200:203]
  v_exp_f32 v96, v96
  v_mfma_f32_16x16x32_bf16 a[196:199], v[208:211], a[32:35], a[196:199]
  ds_read_b64_tr_b16 v[204:205], v248 offset:33280
  ds_read_b64_tr_b16 v[206:207], v248 offset:34304
  v_mfma_f32_16x16x32_bf16 a[204:207], v[208:211], a[36:39], a[204:207]
  s_waitcnt lgkmcnt(4)
  v_exp_f32 v97, v97
  v_mfma_f32_16x16x32_bf16 a[208:211], v[212:215], a[32:35], a[208:211]
  ds_read_b64_tr_b16 v[208:209], v247 offset:33536
  v_cvt_pk_bf16_f32 v96, v96, v97
  v_mfma_f32_16x16x32_bf16 a[216:219], v[212:215], a[36:39], a[216:219]
  ds_read_b64_tr_b16 v[210:211], v247 offset:34560
  v_cvt_pk_bf16_f32 v133, v133, v251
  v_mfma_f32_16x16x32_bf16 a[212:215], v[216:219], a[32:35], a[212:215]
  ds_read_b64_tr_b16 v[212:213], v248 offset:33536
  ds_read_b64_tr_b16 v[214:215], v248 offset:34560
  v_mfma_f32_16x16x32_bf16 a[220:223], v[216:219], a[36:39], a[220:223]
  s_waitcnt lgkmcnt(4)
  v_exp_f32 v98, v98
  v_mfma_f32_16x16x32_bf16 a[224:227], v[200:203], a[32:35], a[224:227]
  ds_read_b64_tr_b16 v[216:217], v247 offset:34816
  ds_read_b64_tr_b16 v[218:219], v247 offset:35840
  v_mfma_f32_16x16x32_bf16 a[232:235], v[200:203], a[36:39], a[232:235]
  v_exp_f32 v99, v99
  v_mfma_f32_16x16x32_bf16 a[228:231], v[204:207], a[32:35], a[228:231]
  ds_read_b64_tr_b16 v[200:201], v248 offset:34816
  v_cvt_pk_bf16_f32 v97, v98, v99
  v_mfma_f32_16x16x32_bf16 a[236:239], v[204:207], a[36:39], a[236:239]
  s_waitcnt lgkmcnt(3)
  ds_read_b64_tr_b16 v[202:203], v248 offset:35840
  v_accvgpr_read_b32 v134, a140
  v_mfma_f32_16x16x32_bf16 a[240:243], v[208:211], a[32:35], a[240:243]
  ds_read_b64_tr_b16 v[204:205], v247 offset:35072
  ds_read_b64_tr_b16 v[206:207], v247 offset:36096
  v_mfma_f32_16x16x32_bf16 a[248:251], v[208:211], a[36:39], a[248:251]
  v_exp_f32 v100, v100
  v_mfma_f32_16x16x32_bf16 a[244:247], v[212:215], a[32:35], a[244:247]
  ds_read_b64_tr_b16 v[208:209], v248 offset:35072
  ds_read_b64_tr_b16 v[210:211], v248 offset:36096
  v_mfma_f32_16x16x32_bf16 a[252:255], v[212:215], a[36:39], a[252:255]
  s_waitcnt lgkmcnt(4)
  v_exp_f32 v101, v101
  v_mfma_f32_16x16x32_bf16 a[192:195], v[216:219], a[40:43], a[192:195]
  ds_read_b64_tr_b16 v[212:213], v247 offset:35328
  v_cvt_pk_bf16_f32 v98, v100, v101
  v_mfma_f32_16x16x32_bf16 a[200:203], v[216:219], a[44:47], a[200:203]
  ds_read_b64_tr_b16 v[214:215], v247 offset:36352
  v_accvgpr_read_b32 v251, a141
  v_mfma_f32_16x16x32_bf16 a[196:199], v[200:203], a[40:43], a[196:199]
  ds_read_b64_tr_b16 v[216:217], v248 offset:35328
  ds_read_b64_tr_b16 v[218:219], v248 offset:36352
  v_mfma_f32_16x16x32_bf16 a[204:207], v[200:203], a[44:47], a[204:207]
  s_waitcnt lgkmcnt(4)
  v_exp_f32 v102, v102
  v_mfma_f32_16x16x32_bf16 a[208:211], v[204:207], a[40:43], a[208:211]
  ds_read_b64_tr_b16 v[200:201], v247 offset:35584
  ds_read_b64_tr_b16 v[202:203], v247 offset:36608
  v_mfma_f32_16x16x32_bf16 a[216:219], v[204:207], a[44:47], a[216:219]
  v_exp_f32 v103, v103
  v_mfma_f32_16x16x32_bf16 a[212:215], v[208:211], a[40:43], a[212:215]
  ds_read_b64_tr_b16 v[204:205], v248 offset:35584
  v_cvt_pk_bf16_f32 v99, v102, v103
  v_mfma_f32_16x16x32_bf16 a[220:223], v[208:211], a[44:47], a[220:223]
  s_waitcnt lgkmcnt(3)
  ds_read_b64_tr_b16 v[206:207], v248 offset:36608
  v_mul_f32 v134, s70, v134
  v_mfma_f32_16x16x32_bf16 v[224:227], v[220:223], v[96:99], v[224:227]
  v_exp_f32 v104, v104
  v_mfma_f32_16x16x32_bf16 a[224:227], v[212:215], a[40:43], a[224:227]
  s_waitcnt vmcnt(5)
  s_barrier
  ds_read_b64_tr_b16 v[208:209], v247 offset:49152
  ds_read_b64_tr_b16 v[210:211], v247 offset:50176
  v_mfma_f32_16x16x32_bf16 a[232:235], v[212:215], a[44:47], a[232:235]
  buffer_load_dwordx4 v237, s[12:15], s95 offen offset:1024 nt lds
  v_mfma_f32_16x16x32_bf16 a[228:231], v[216:219], a[40:43], a[228:231]
  ds_read_b64_tr_b16 v[212:213], v248 offset:49152
  ds_read_b64_tr_b16 v[214:215], v248 offset:50176
  v_mfma_f32_16x16x32_bf16 a[236:239], v[216:219], a[44:47], a[236:239]
  s_waitcnt lgkmcnt(4)
  v_exp_f32 v105, v105
  v_mfma_f32_16x16x32_bf16 a[240:243], v[200:203], a[40:43], a[240:243]
  ds_read_b64_tr_b16 v[216:217], v247 offset:49408
  ds_read_b64_tr_b16 v[218:219], v247 offset:50432
  v_mfma_f32_16x16x32_bf16 a[248:251], v[200:203], a[44:47], a[248:251]
  buffer_load_dwordx4 v237, s[12:15], s95 offen offset:2048 nt lds
  v_mfma_f32_16x16x32_bf16 a[244:247], v[204:207], a[40:43], a[244:247]
  ds_read_b64_tr_b16 v[200:201], v248 offset:49408
  v_cvt_pk_bf16_f32 v100, v104, v105
  v_mfma_f32_16x16x32_bf16 a[252:255], v[204:207], a[44:47], a[252:255]
  s_waitcnt lgkmcnt(3)
  ds_read_b64_tr_b16 v[202:203], v248 offset:50432
  v_exp_f32 v106, v106
  v_mfma_f32_16x16x32_bf16 a[192:195], v[208:211], a[48:51], a[192:195]
  ds_read_b64_tr_b16 v[204:205], v247 offset:49664
  ds_read_b64_tr_b16 v[206:207], v247 offset:50688
  v_mfma_f32_16x16x32_bf16 a[200:203], v[208:211], a[52:55], a[200:203]
  buffer_load_dwordx4 v237, s[12:15], s95 offen offset:3072 nt lds
  v_add_u32 v237, 262144, v237
  v_mfma_f32_16x16x32_bf16 a[196:199], v[212:215], a[48:51], a[196:199]
  ds_read_b64_tr_b16 v[208:209], v248 offset:49664
  v_exp_f32 v107, v107
  v_mfma_f32_16x16x32_bf16 a[204:207], v[212:215], a[52:55], a[204:207]
  s_waitcnt lgkmcnt(3)
  ds_read_b64_tr_b16 v[210:211], v248 offset:50688
  v_cvt_pk_bf16_f32 v101, v106, v107
  v_mfma_f32_16x16x32_bf16 a[208:211], v[216:219], a[48:51], a[208:211]
  s_add_u32 m0, s68, 0
  ds_read_b64_tr_b16 v[212:213], v247 offset:49920
  ds_read_b64_tr_b16 v[214:215], v247 offset:50944
  v_mfma_f32_16x16x32_bf16 a[216:219], v[216:219], a[52:55], a[216:219]
  buffer_load_dwordx4 v236, s[8:11], s88 offen nt lds
  v_mul_f32 v251, s70, v251
  v_mfma_f32_16x16x32_bf16 a[212:215], v[200:203], a[48:51], a[212:215]
  ds_read_b64_tr_b16 v[216:217], v248 offset:49920
  v_exp_f32 v108, v108
  v_mfma_f32_16x16x32_bf16 a[220:223], v[200:203], a[52:55], a[220:223]
  s_waitcnt lgkmcnt(3)
  ds_read_b64_tr_b16 v[218:219], v248 offset:50944
  v_cvt_pk_bf16_f32 v134, v134, v251
  v_mfma_f32_16x16x32_bf16 a[224:227], v[204:207], a[48:51], a[224:227]
  ds_read_b64_tr_b16 v[200:201], v247 offset:51200
  ds_read_b64_tr_b16 v[202:203], v247 offset:52224
  v_mfma_f32_16x16x32_bf16 a[232:235], v[204:207], a[52:55], a[232:235]
  buffer_load_dwordx4 v236, s[8:11], s88 offen offset:1024 nt lds
  v_accvgpr_read_b32 v135, a142
  v_mfma_f32_16x16x32_bf16 a[228:231], v[208:211], a[48:51], a[228:231]
  ds_read_b64_tr_b16 v[204:205], v248 offset:51200
  v_exp_f32 v109, v109
  v_mfma_f32_16x16x32_bf16 a[236:239], v[208:211], a[52:55], a[236:239]
  s_waitcnt lgkmcnt(3)
  ds_read_b64_tr_b16 v[206:207], v248 offset:52224
  v_cvt_pk_bf16_f32 v102, v108, v109
  v_mfma_f32_16x16x32_bf16 a[240:243], v[212:215], a[48:51], a[240:243]
  ds_read_b64_tr_b16 v[208:209], v247 offset:51456
  ds_read_b64_tr_b16 v[210:211], v247 offset:52480
  v_mfma_f32_16x16x32_bf16 a[248:251], v[212:215], a[52:55], a[248:251]
  buffer_load_dwordx4 v236, s[8:11], s88 offen offset:2048 nt lds
  v_accvgpr_read_b32 v251, a143
  v_mfma_f32_16x16x32_bf16 a[244:247], v[216:219], a[48:51], a[244:247]
  ds_read_b64_tr_b16 v[212:213], v248 offset:51456
  v_exp_f32 v110, v110
  v_mfma_f32_16x16x32_bf16 a[252:255], v[216:219], a[52:55], a[252:255]
  s_waitcnt lgkmcnt(3)
  ds_read_b64_tr_b16 v[214:215], v248 offset:52480
  v_mul_f32 v135, s70, v135
  v_mfma_f32_16x16x32_bf16 a[192:195], v[200:203], a[56:59], a[192:195]
  ds_read_b64_tr_b16 v[216:217], v247 offset:51712
  ds_read_b64_tr_b16 v[218:219], v247 offset:52736
  v_mfma_f32_16x16x32_bf16 a[200:203], v[200:203], a[60:63], a[200:203]
  buffer_load_dwordx4 v236, s[8:11], s88 offen offset:3072 nt lds
  v_mul_f32 v251, s70, v251
  v_mfma_f32_16x16x32_bf16 a[196:199], v[204:207], a[56:59], a[196:199]
  ds_read_b64_tr_b16 v[200:201], v248 offset:51712
  v_exp_f32 v111, v111
  v_mfma_f32_16x16x32_bf16 a[204:207], v[204:207], a[60:63], a[204:207]
  s_waitcnt lgkmcnt(3)
  ds_read_b64_tr_b16 v[202:203], v248 offset:52736
  v_cvt_pk_bf16_f32 v103, v110, v111
  v_mfma_f32_16x16x32_bf16 a[208:211], v[208:211], a[56:59], a[208:211]
  s_add_u32 m0, s68, 81920
  ds_read_b64_tr_b16 v[204:205], v247 offset:51968
  ds_read_b64_tr_b16 v[206:207], v247 offset:52992
  v_mfma_f32_16x16x32_bf16 a[216:219], v[208:211], a[60:63], a[216:219]
  buffer_load_dwordx4 v237, s[12:15], s88 offen nt lds
  v_cvt_pk_bf16_f32 v135, v135, v251
  v_mfma_f32_16x16x32_bf16 v[228:231], v[220:223], v[100:103], v[228:231]
  v_exp_f32 v112, v112
  v_mfma_f32_16x16x32_bf16 a[212:215], v[212:215], a[56:59], a[212:215]
  ds_read_b64_tr_b16 v[208:209], v248 offset:51968
  v_exp_f32 v113, v113
  v_mfma_f32_16x16x32_bf16 a[220:223], v[212:215], a[60:63], a[220:223]
  s_waitcnt lgkmcnt(3)
  ds_read_b64_tr_b16 v[210:211], v248 offset:52992
  v_cvt_pk_bf16_f32 v104, v112, v113
  v_mfma_f32_16x16x32_bf16 a[224:227], v[216:219], a[56:59], a[224:227]
  s_waitcnt vmcnt(21)
  s_barrier
  ds_read_b64_tr_b16 v[212:213], v245 offset:0
  ds_read_b64_tr_b16 v[214:215], v245 offset:1024
  v_mfma_f32_16x16x32_bf16 a[232:235], v[216:219], a[60:63], a[232:235]
  buffer_load_dwordx4 v237, s[12:15], s88 offen offset:1024 nt lds
  v_permlane16_swap_b32 v132, v134
  v_mfma_f32_16x16x32_bf16 a[228:231], v[200:203], a[56:59], a[228:231]
  ds_read_b64_tr_b16 v[216:217], v246 offset:0
  v_exp_f32 v114, v114
  v_mfma_f32_16x16x32_bf16 a[236:239], v[200:203], a[60:63], a[236:239]
  s_waitcnt lgkmcnt(3)
  ds_read_b64_tr_b16 v[218:219], v246 offset:1024
  v_exp_f32 v115, v115
  v_mfma_f32_16x16x32_bf16 a[240:243], v[204:207], a[56:59], a[240:243]
  ds_read_b64_tr_b16 v[200:201], v245 offset:256
  v_cvt_pk_bf16_f32 v105, v114, v115
  v_mfma_f32_16x16x32_bf16 a[248:251], v[204:207], a[60:63], a[248:251]
  ds_read_b64_tr_b16 v[202:203], v245 offset:1280
  v_exp_f32 v116, v116
  v_mfma_f32_16x16x32_bf16 a[244:247], v[208:211], a[56:59], a[244:247]
  ds_read_b64_tr_b16 v[204:205], v246 offset:256
  v_exp_f32 v117, v117
  v_mfma_f32_16x16x32_bf16 a[252:255], v[208:211], a[60:63], a[252:255]
  s_waitcnt lgkmcnt(3)
  ds_read_b64_tr_b16 v[206:207], v246 offset:1280
  v_cvt_pk_bf16_f32 v106, v116, v117
  v_permlane16_swap_b32 v133, v135
  v_mfma_f32_16x16x32_bf16 v[32:35], v[212:215], v[96:99], v[32:35]
  ds_read_b64_tr_b16 v[208:209], v245 offset:512
  v_exp_f32 v118, v118
  v_mfma_f32_16x16x32_bf16 v[40:43], v[212:215], v[100:103], v[40:43]
  ds_read_b64_tr_b16 v[210:211], v245 offset:1536
  v_exp_f32 v119, v119
  v_mfma_f32_16x16x32_bf16 v[36:39], v[216:219], v[96:99], v[36:39]
  ds_read_b64_tr_b16 v[212:213], v246 offset:512
  v_cvt_pk_bf16_f32 v107, v118, v119
  v_mfma_f32_16x16x32_bf16 v[44:47], v[216:219], v[100:103], v[44:47]
  s_waitcnt lgkmcnt(3)
  ds_read_b64_tr_b16 v[214:215], v246 offset:1536
  v_exp_f32 v120, v120
  v_mfma_f32_16x16x32_bf16 v[224:227], v[220:223], v[104:107], v[224:227]
  v_exp_f32 v121, v121
  v_mfma_f32_16x16x32_bf16 v[48:51], v[200:203], v[96:99], v[48:51]
  ds_read_b64_tr_b16 v[216:217], v245 offset:768
  v_cvt_pk_bf16_f32 v108, v120, v121
  v_mfma_f32_16x16x32_bf16 v[56:59], v[200:203], v[100:103], v[56:59]
  ds_read_b64_tr_b16 v[218:219], v245 offset:1792
  v_exp_f32 v122, v122
  v_mfma_f32_16x16x32_bf16 v[52:55], v[204:207], v[96:99], v[52:55]
  ds_read_b64_tr_b16 v[200:201], v246 offset:768
  v_exp_f32 v123, v123
  v_mfma_f32_16x16x32_bf16 v[60:63], v[204:207], v[100:103], v[60:63]
  s_waitcnt lgkmcnt(3)
  ds_read_b64_tr_b16 v[202:203], v246 offset:1792
  v_cvt_pk_bf16_f32 v109, v122, v123
  v_mfma_f32_16x16x32_bf16 v[64:67], v[208:211], v[96:99], v[64:67]
  ds_read_b64_tr_b16 v[204:205], v245 offset:2048
  v_exp_f32 v124, v124
  v_mfma_f32_16x16x32_bf16 v[72:75], v[208:211], v[100:103], v[72:75]
  ds_read_b64_tr_b16 v[206:207], v245 offset:3072
  v_exp_f32 v125, v125
  v_mfma_f32_16x16x32_bf16 v[68:71], v[212:215], v[96:99], v[68:71]
  ds_read_b64_tr_b16 v[208:209], v246 offset:2048
  v_cvt_pk_bf16_f32 v110, v124, v125
  v_mfma_f32_16x16x32_bf16 v[76:79], v[212:215], v[100:103], v[76:79]
  s_waitcnt lgkmcnt(3)
  ds_read_b64_tr_b16 v[210:211], v246 offset:3072
  v_exp_f32 v126, v126
  v_mfma_f32_16x16x32_bf16 v[80:83], v[216:219], v[96:99], v[80:83]
  ds_read_b64_tr_b16 v[212:213], v245 offset:2304
  v_exp_f32 v127, v127
  v_mfma_f32_16x16x32_bf16 v[88:91], v[216:219], v[100:103], v[88:91]
  ds_read_b64_tr_b16 v[214:215], v245 offset:3328
  v_cvt_pk_bf16_f32 v111, v126, v127
  v_mfma_f32_16x16x32_bf16 v[84:87], v[200:203], v[96:99], v[84:87]
  ds_read_b64_tr_b16 v[216:217], v246 offset:2304
  v_accvgpr_read_b32 v136, a144
  v_mfma_f32_16x16x32_bf16 v[92:95], v[200:203], v[100:103], v[92:95]
  s_waitcnt lgkmcnt(3)
  ds_read_b64_tr_b16 v[218:219], v246 offset:3328
  v_accvgpr_read_b32 v251, a145
  v_mfma_f32_16x16x32_bf16 v[228:231], v[220:223], v[108:111], v[228:231]
  v_mul_f32 v136, s70, v136
  v_mul_f32 v251, s70, v251
  v_mfma_f32_16x16x32_bf16 v[32:35], v[204:207], v[104:107], v[32:35]
  ds_read_b64_tr_b16 v[200:201], v245 offset:2560
  v_cvt_pk_bf16_f32 v136, v136, v251
  v_mfma_f32_16x16x32_bf16 v[40:43], v[204:207], v[108:111], v[40:43]
  ds_read_b64_tr_b16 v[202:203], v245 offset:3584
  v_accvgpr_read_b32 v137, a146
  v_mfma_f32_16x16x32_bf16 v[36:39], v[208:211], v[104:107], v[36:39]
  ds_read_b64_tr_b16 v[204:205], v246 offset:2560
  v_accvgpr_read_b32 v251, a147
  v_mfma_f32_16x16x32_bf16 v[44:47], v[208:211], v[108:111], v[44:47]
  s_waitcnt lgkmcnt(3)
  ds_read_b64_tr_b16 v[206:207], v246 offset:3584
  v_mul_f32 v137, s70, v137
  v_mfma_f32_16x16x32_bf16 v[48:51], v[212:215], v[104:107], v[48:51]
  ds_read_b64_tr_b16 v[208:209], v245 offset:2816
  ds_read_b64_tr_b16 v[210:211], v245 offset:3840
  v_mfma_f32_16x16x32_bf16 v[56:59], v[212:215], v[108:111], v[56:59]
  buffer_load_dwordx4 v237, s[12:15], s88 offen offset:2048 nt lds
  v_mfma_f32_16x16x32_bf16 v[52:55], v[216:219], v[104:107], v[52:55]
  ds_read_b64_tr_b16 v[212:213], v246 offset:2816
  v_mul_f32 v251, s70, v251
  v_mfma_f32_16x16x32_bf16 v[60:63], v[216:219], v[108:111], v[60:63]
  s_waitcnt lgkmcnt(3)
  ds_read_b64_tr_b16 v[214:215], v246 offset:3840
  v_cvt_pk_bf16_f32 v137, v137, v251
  v_mfma_f32_16x16x32_bf16 v[64:67], v[200:203], v[104:107], v[64:67]
  s_waitcnt vmcnt(19)
  s_barrier
  ds_read_b128 v[216:219], v241 offset:49152
  v_mfma_f32_16x16x32_bf16 v[72:75], v[200:203], v[108:111], v[72:75]
  v_accvgpr_read_b32 v138, a148
  v_accvgpr_read_b32 v251, a149
  v_mfma_f32_16x16x32_bf16 v[68:71], v[204:207], v[104:107], v[68:71]
  ds_read_b128 v[200:203], v242 offset:49152
  v_mul_f32 v138, s70, v138
  v_mfma_f32_16x16x32_bf16 v[76:79], v[204:207], v[108:111], v[76:79]
  s_waitcnt lgkmcnt(2)
  buffer_load_dwordx4 v237, s[12:15], s88 offen offset:3072 nt lds
  v_mfma_f32_16x16x32_bf16 v[80:83], v[208:211], v[104:107], v[80:83]
  ds_read_b128 v[204:207], v241 offset:57344
  v_mul_f32 v251, s70, v251
  v_mfma_f32_16x16x32_bf16 v[88:91], v[208:211], v[108:111], v[88:91]
  v_cvt_pk_bf16_f32 v138, v138, v251
  v_accvgpr_read_b32 v139, a150
  v_mfma_f32_16x16x32_bf16 v[84:87], v[212:215], v[104:107], v[84:87]
  ds_read_b128 v[208:211], v242 offset:57344
  v_accvgpr_read_b32 v251, a151
  v_mfma_f32_16x16x32_bf16 v[92:95], v[212:215], v[108:111], v[92:95]
  s_waitcnt lgkmcnt(2)
  v_mul_f32 v139, s70, v139
  v_mul_f32 v251, s70, v251
  v_mfma_f32_16x16x32_bf16 v[96:99], v[216:219], v[0:3], v[192:195]
  s_add_u32 m0, s68, 131072
  ds_read_b128 v[212:215], v241 offset:50176
  v_cvt_pk_bf16_f32 v139, v139, v251
  v_mfma_f32_16x16x32_bf16 v[104:107], v[216:219], v[4:7], v[196:199]
  buffer_load_dwordx4 v239, s[32:35], s85 offen lds
  v_mfma_f32_16x16x32_bf16 v[96:99], v[200:203], v[8:11], v[96:99]
  ds_read_b128 v[216:219], v242 offset:50176
  v_permlane16_swap_b32 v136, v138
  v_mfma_f32_16x16x32_bf16 v[104:107], v[200:203], v[12:15], v[104:107]
  s_waitcnt lgkmcnt(2)
  v_permlane16_swap_b32 v137, v139
  v_accvgpr_read_b32 v140, a152
  v_mfma_f32_16x16x32_bf16 v[96:99], v[204:207], v[16:19], v[96:99]
  ds_read_b128 v[200:203], v241 offset:58368
  v_accvgpr_read_b32 v251, a153
  v_mfma_f32_16x16x32_bf16 v[104:107], v[204:207], v[20:23], v[104:107]
  buffer_load_dwordx4 v239, s[36:39], s85 offen offset:1024 lds
  v_mfma_f32_16x16x32_bf16 v[96:99], v[208:211], v[24:27], v[96:99]
  ds_read_b128 v[204:207], v242 offset:58368
  v_mul_f32 v140, s70, v140
  v_mfma_f32_16x16x32_bf16 v[104:107], v[208:211], v[28:31], v[104:107]
  s_waitcnt lgkmcnt(2)
  v_mul_f32 v251, s70, v251
  v_cvt_pk_bf16_f32 v140, v140, v251
  v_mfma_f32_16x16x32_bf16 v[100:103], v[212:215], v[0:3], v[192:195]
  ds_read_b128 v[208:211], v241 offset:51200
  v_accvgpr_read_b32 v141, a154
  v_mfma_f32_16x16x32_bf16 v[108:111], v[212:215], v[4:7], v[196:199]
  buffer_load_dwordx4 v239, s[40:43], s85 offen offset:2048 lds
  v_mfma_f32_16x16x32_bf16 v[100:103], v[216:219], v[8:11], v[100:103]
  ds_read_b128 v[212:215], v242 offset:51200
  v_max3_f32 v253, v96, v97, v98
  v_mfma_f32_16x16x32_bf16 v[108:111], v[216:219], v[12:15], v[108:111]
  s_waitcnt lgkmcnt(2)
  v_max3_f32 v253, v253, v99, v104
  v_max3_f32 v253, v253, v105, v106
  v_mfma_f32_16x16x32_bf16 v[100:103], v[200:203], v[16:19], v[100:103]
  ds_read_b128 v[216:219], v241 offset:59392
  v_accvgpr_read_b32 v251, a155
  v_mfma_f32_16x16x32_bf16 v[108:111], v[200:203], v[20:23], v[108:111]
  buffer_load_dwordx4 v239, s[44:47], s85 offen offset:3072 lds
  v_mfma_f32_16x16x32_bf16 v[100:103], v[204:207], v[24:27], v[100:103]
  ds_read_b128 v[200:203], v242 offset:59392
  v_mul_f32 v141, s70, v141
  v_mfma_f32_16x16x32_bf16 v[108:111], v[204:207], v[28:31], v[108:111]
  s_waitcnt lgkmcnt(2)
  v_mul_f32 v251, s70, v251
  v_cvt_pk_bf16_f32 v141, v141, v251
  v_mfma_f32_16x16x32_bf16 v[112:115], v[208:211], v[0:3], v[192:195]
  s_add_u32 m0, s68, 147456
  ds_read_b128 v[204:207], v241 offset:52224
  v_accvgpr_read_b32 v142, a156
  v_mfma_f32_16x16x32_bf16 v[120:123], v[208:211], v[4:7], v[196:199]
  buffer_load_dwordx4 v239, s[32:35], s86 offen lds
  v_mfma_f32_16x16x32_bf16 v[112:115], v[212:215], v[8:11], v[112:115]
  ds_read_b128 v[208:211], v242 offset:52224
  v_max3_f32 v253, v253, v107, v100
  v_mfma_f32_16x16x32_bf16 v[120:123], v[212:215], v[12:15], v[120:123]
  s_waitcnt lgkmcnt(2)
  v_max3_f32 v253, v253, v101, v102
  v_max3_f32 v253, v253, v103, v108
  v_mfma_f32_16x16x32_bf16 v[112:115], v[216:219], v[16:19], v[112:115]
  ds_read_b128 v[212:215], v241 offset:60416
  v_max3_f32 v253, v253, v109, v110
  v_mfma_f32_16x16x32_bf16 v[120:123], v[216:219], v[20:23], v[120:123]
  v_accvgpr_read_b32 v251, a157
  v_mul_f32 v142, s70, v142
  v_mfma_f32_16x16x32_bf16 v[112:115], v[200:203], v[24:27], v[112:115]
  ds_read_b128 v[216:219], v242 offset:60416
  v_mul_f32 v251, s70, v251
  v_mfma_f32_16x16x32_bf16 v[120:123], v[200:203], v[28:31], v[120:123]
  s_waitcnt lgkmcnt(2)
  v_cvt_pk_bf16_f32 v142, v142, v251
  v_accvgpr_read_b32 v143, a158
  v_mfma_f32_16x16x32_bf16 v[116:119], v[204:207], v[0:3], v[192:195]
  s_waitcnt vmcnt(17)
  s_barrier
  ds_read_b64_tr_b16 v[200:201], v247 offset:16384
  v_mfma_f32_16x16x32_bf16 v[124:127], v[204:207], v[4:7], v[196:199]
  ds_read_b64_tr_b16 v[202:203], v247 offset:17408
  v_accvgpr_read_b32 v251, a159
  v_mfma_f32_16x16x32_bf16 v[116:119], v[208:211], v[8:11], v[116:119]
  ds_read_b64_tr_b16 v[204:205], v248 offset:16384
  v_max3_f32 v253, v253, v111, v112
  v_mfma_f32_16x16x32_bf16 v[124:127], v[208:211], v[12:15], v[124:127]
  s_waitcnt lgkmcnt(3)
  ds_read_b64_tr_b16 v[206:207], v248 offset:17408
  v_max3_f32 v253, v253, v113, v114
  v_mfma_f32_16x16x32_bf16 v[116:119], v[212:215], v[16:19], v[116:119]
  ds_read_b64_tr_b16 v[208:209], v247 offset:16640
  v_max3_f32 v253, v253, v115, v120
  v_mfma_f32_16x16x32_bf16 v[124:127], v[212:215], v[20:23], v[124:127]
  ds_read_b64_tr_b16 v[210:211], v247 offset:17664
  v_max3_f32 v253, v253, v121, v122
  v_mfma_f32_16x16x32_bf16 v[116:119], v[216:219], v[24:27], v[116:119]
  ds_read_b64_tr_b16 v[212:213], v248 offset:16640
  v_mul_f32 v143, s70, v143
  v_mfma_f32_16x16x32_bf16 v[124:127], v[216:219], v[28:31], v[124:127]
  s_waitcnt lgkmcnt(3)
  ds_read_b64_tr_b16 v[214:215], v248 offset:17664
  v_mul_f32 v251, s70, v251
  v_mfma_f32_16x16x32_bf16 a[192:195], v[200:203], a[64:67], a[192:195]
  ds_read_b64_tr_b16 v[216:217], v247 offset:16896
  v_cvt_pk_bf16_f32 v143, v143, v251
  v_mfma_f32_16x16x32_bf16 a[200:203], v[200:203], a[68:71], a[200:203]
  ds_read_b64_tr_b16 v[218:219], v247 offset:17920
  v_permlane16_swap_b32 v140, v142
  v_mfma_f32_16x16x32_bf16 a[196:199], v[204:207], a[64:67], a[196:199]
  ds_read_b64_tr_b16 v[200:201], v248 offset:16896
  v_max3_f32 v253, v253, v123, v116
  v_mfma_f32_16x16x32_bf16 a[204:207], v[204:207], a[68:71], a[204:207]
  s_waitcnt lgkmcnt(3)
  ds_read_b64_tr_b16 v[202:203], v248 offset:17920
  v_max3_f32 v253, v253, v117, v118
  v_max3_f32 v253, v253, v119, v124
  v_mfma_f32_16x16x32_bf16 a[208:211], v[208:211], a[64:67], a[208:211]
  ds_read_b64_tr_b16 v[204:205], v247 offset:17152
  v_max3_f32 v253, v253, v125, v126
  v_mfma_f32_16x16x32_bf16 a[216:219], v[208:211], a[68:71], a[216:219]
  ds_read_b64_tr_b16 v[206:207], v247 offset:18176
  v_max_f32 v253, v253, v127
  v_cmp_lt_f32 vcc, 0x41200000, v253
  v_mfma_f32_16x16x32_bf16 a[212:215], v[212:215], a[64:67], a[212:215]
  s_cbranch_vccnz L_r0_7t
L_r0_7:
  ds_read_b64_tr_b16 v[208:209], v248 offset:17152
  v_exp_f32 v96, v96
  v_mfma_f32_16x16x32_bf16 a[220:223], v[212:215], a[68:71], a[220:223]
  s_waitcnt lgkmcnt(3)
  ds_read_b64_tr_b16 v[210:211], v248 offset:18176
  v_exp_f32 v97, v97
  v_mfma_f32_16x16x32_bf16 a[224:227], v[216:219], a[64:67], a[224:227]
  ds_read_b64_tr_b16 v[212:213], v247 offset:18432
  v_cvt_pk_bf16_f32 v96, v96, v97
  v_mfma_f32_16x16x32_bf16 a[232:235], v[216:219], a[68:71], a[232:235]
  ds_read_b64_tr_b16 v[214:215], v247 offset:19456
  v_exp_f32 v98, v98
  v_mfma_f32_16x16x32_bf16 a[228:231], v[200:203], a[64:67], a[228:231]
  ds_read_b64_tr_b16 v[216:217], v248 offset:18432
  v_exp_f32 v99, v99
  v_mfma_f32_16x16x32_bf16 a[236:239], v[200:203], a[68:71], a[236:239]
  s_waitcnt lgkmcnt(3)
  ds_read_b64_tr_b16 v[218:219], v248 offset:19456
  v_cvt_pk_bf16_f32 v97, v98, v99
  v_permlane16_swap_b32 v141, v143
  v_mfma_f32_16x16x32_bf16 a[240:243], v[204:207], a[64:67], a[240:243]
  ds_read_b64_tr_b16 v[200:201], v247 offset:18688
  v_exp_f32 v100, v100
  v_mfma_f32_16x16x32_bf16 a[248:251], v[204:207], a[68:71], a[248:251]
  ds_read_b64_tr_b16 v[202:203], v247 offset:19712
  v_exp_f32 v101, v101
  v_mfma_f32_16x16x32_bf16 a[244:247], v[208:211], a[64:67], a[244:247]
  ds_read_b64_tr_b16 v[204:205], v248 offset:18688
  v_cvt_pk_bf16_f32 v98, v100, v101
  v_mfma_f32_16x16x32_bf16 a[252:255], v[208:211], a[68:71], a[252:255]
  s_waitcnt lgkmcnt(3)
  ds_read_b64_tr_b16 v[206:207], v248 offset:19712
  v_exp_f32 v102, v102
  v_mfma_f32_16x16x32_bf16 a[192:195], v[212:215], a[72:75], a[192:195]
  ds_read_b64_tr_b16 v[208:209], v247 offset:18944
  v_exp_f32 v103, v103
  v_mfma_f32_16x16x32_bf16 a[200:203], v[212:215], a[76:79], a[200:203]
  ds_read_b64_tr_b16 v[210:211], v247 offset:19968
  v_cvt_pk_bf16_f32 v99, v102, v103
  v_accvgpr_read_b32 v144, a160
  v_mfma_f32_16x16x32_bf16 a[196:199], v[216:219], a[72:75], a[196:199]
  ds_read_b64_tr_b16 v[212:213], v248 offset:18944
  v_exp_f32 v104, v104
  v_mfma_f32_16x16x32_bf16 a[204:207], v[216:219], a[76:79], a[204:207]
  s_waitcnt lgkmcnt(3)
  ds_read_b64_tr_b16 v[214:215], v248 offset:19968
  v_exp_f32 v105, v105
  v_mfma_f32_16x16x32_bf16 v[224:227], v[220:223], v[96:99], v[224:227]
  v_cvt_pk_bf16_f32 v100, v104, v105
  v_accvgpr_read_b32 v251, a161
  v_mfma_f32_16x16x32_bf16 a[208:211], v[200:203], a[72:75], a[208:211]
  ds_read_b64_tr_b16 v[216:217], v247 offset:19200
  v_exp_f32 v106, v106
  v_mfma_f32_16x16x32_bf16 a[216:219], v[200:203], a[76:79], a[216:219]
  ds_read_b64_tr_b16 v[218:219], v247 offset:20224
  v_exp_f32 v107, v107
  v_mfma_f32_16x16x32_bf16 a[212:215], v[204:207], a[72:75], a[212:215]
  ds_read_b64_tr_b16 v[200:201], v248 offset:19200
  v_cvt_pk_bf16_f32 v101, v106, v107
  v_mfma_f32_16x16x32_bf16 a[220:223], v[204:207], a[76:79], a[220:223]
  s_waitcnt lgkmcnt(3)
  ds_read_b64_tr_b16 v[202:203], v248 offset:20224
  v_exp_f32 v108, v108
  v_mfma_f32_16x16x32_bf16 a[224:227], v[208:211], a[72:75], a[224:227]
  s_waitcnt vmcnt(1)
  s_barrier
  ds_read_b64_tr_b16 v[204:205], v247 offset:32768
  ds_read_b64_tr_b16 v[206:207], v247 offset:33792
  v_mfma_f32_16x16x32_bf16 a[232:235], v[208:211], a[76:79], a[232:235]
  buffer_load_dwordx4 v239, s[36:39], s86 offen offset:1024 lds
  v_mul_f32 v144, s70, v144
  v_mfma_f32_16x16x32_bf16 a[228:231], v[212:215], a[72:75], a[228:231]
  ds_read_b64_tr_b16 v[208:209], v248 offset:32768
  v_exp_f32 v109, v109
  v_mfma_f32_16x16x32_bf16 a[236:239], v[212:215], a[76:79], a[236:239]
  s_waitcnt lgkmcnt(3)
  ds_read_b64_tr_b16 v[210:211], v248 offset:33792
  v_cvt_pk_bf16_f32 v102, v108, v109
  v_mul_f32 v251, s70, v251
  v_mfma_f32_16x16x32_bf16 a[240:243], v[216:219], a[72:75], a[240:243]
  ds_read_b64_tr_b16 v[212:213], v247 offset:33024
  ds_read_b64_tr_b16 v[214:215], v247 offset:34048
  v_mfma_f32_16x16x32_bf16 a[248:251], v[216:219], a[76:79], a[248:251]
  buffer_load_dwordx4 v239, s[40:43], s86 offen offset:2048 lds
  v_cvt_pk_bf16_f32 v144, v144, v251
  v_mfma_f32_16x16x32_bf16 a[244:247], v[200:203], a[72:75], a[244:247]
  ds_read_b64_tr_b16 v[216:217], v248 offset:33024
  v_exp_f32 v110, v110
  v_mfma_f32_16x16x32_bf16 a[252:255], v[200:203], a[76:79], a[252:255]
  s_waitcnt lgkmcnt(3)
  ds_read_b64_tr_b16 v[218:219], v248 offset:34048
  v_exp_f32 v111, v111
  v_mfma_f32_16x16x32_bf16 a[192:195], v[204:207], a[80:83], a[192:195]
  ds_read_b64_tr_b16 v[200:201], v247 offset:33280
  ds_read_b64_tr_b16 v[202:203], v247 offset:34304
  v_mfma_f32_16x16x32_bf16 a[200:203], v[204:207], a[84:87], a[200:203]
  buffer_load_dwordx4 v239, s[44:47], s86 offen offset:3072 lds
  v_cvt_pk_bf16_f32 v103, v110, v111
  v_mfma_f32_16x16x32_bf16 a[196:199], v[208:211], a[80:83], a[196:199]
  ds_read_b64_tr_b16 v[204:205], v248 offset:33280
  v_exp_f32 v112, v112
  v_mfma_f32_16x16x32_bf16 a[204:207], v[208:211], a[84:87], a[204:207]
  s_waitcnt lgkmcnt(3)
  ds_read_b64_tr_b16 v[206:207], v248 offset:34304
  v_exp_f32 v113, v113
  v_mfma_f32_16x16x32_bf16 v[228:231], v[220:223], v[100:103], v[228:231]
  v_cvt_pk_bf16_f32 v104, v112, v113
  v_accvgpr_read_b32 v145, a162
  v_mfma_f32_16x16x32_bf16 a[208:211], v[212:215], a[80:83], a[208:211]
  s_add_u32 m0, s68, 16384
  ds_read_b64_tr_b16 v[208:209], v247 offset:33536
  ds_read_b64_tr_b16 v[210:211], v247 offset:34560
  v_mfma_f32_16x16x32_bf16 a[216:219], v[212:215], a[84:87], a[216:219]
  buffer_load_dwordx4 v236, s[8:11], s89 offen nt lds
  v_accvgpr_read_b32 v251, a163
  v_mfma_f32_16x16x32_bf16 a[212:215], v[216:219], a[80:83], a[212:215]
  ds_read_b64_tr_b16 v[212:213], v248 offset:33536
  v_exp_f32 v114, v114
  v_mfma_f32_16x16x32_bf16 a[220:223], v[216:219], a[84:87], a[220:223]
  s_waitcnt lgkmcnt(3)
  ds_read_b64_tr_b16 v[214:215], v248 offset:34560
  v_exp_f32 v115, v115
  v_mfma_f32_16x16x32_bf16 a[224:227], v[200:203], a[80:83], a[224:227]
  ds_read_b64_tr_b16 v[216:217], v247 offset:34816
  ds_read_b64_tr_b16 v[218:219], v247 offset:35840
  v_mfma_f32_16x16x32_bf16 a[232:235], v[200:203], a[84:87], a[232:235]
  buffer_load_dwordx4 v236, s[8:11], s89 offen offset:1024 nt lds
  v_cvt_pk_bf16_f32 v105, v114, v115
  v_mfma_f32_16x16x32_bf16 a[228:231], v[204:207], a[80:83], a[228:231]
  ds_read_b64_tr_b16 v[200:201], v248 offset:34816
  v_exp_f32 v116, v116
  v_mfma_f32_16x16x32_bf16 a[236:239], v[204:207], a[84:87], a[236:239]
  s_waitcnt lgkmcnt(3)
  ds_read_b64_tr_b16 v[202:203], v248 offset:35840
  v_exp_f32 v117, v117
  v_mfma_f32_16x16x32_bf16 a[240:243], v[208:211], a[80:83], a[240:243]
  ds_read_b64_tr_b16 v[204:205], v247 offset:35072
  ds_read_b64_tr_b16 v[206:207], v247 offset:36096
  v_mfma_f32_16x16x32_bf16 a[248:251], v[208:211], a[84:87], a[248:251]
  buffer_load_dwordx4 v236, s[8:11], s89 offen offset:2048 nt lds
  v_cvt_pk_bf16_f32 v106, v116, v117
  v_mfma_f32_16x16x32_bf16 a[244:247], v[212:215], a[80:83], a[244:247]
  ds_read_b64_tr_b16 v[208:209], v248 offset:35072
  v_exp_f32 v118, v118
  v_mfma_f32_16x16x32_bf16 a[252:255], v[212:215], a[84:87], a[252:255]
  s_waitcnt lgkmcnt(3)
  ds_read_b64_tr_b16 v[210:211], v248 offset:36096
  v_exp_f32 v119, v119
  v_mfma_f32_16x16x32_bf16 a[192:195], v[216:219], a[88:91], a[192:195]
  ds_read_b64_tr_b16 v[212:213], v247 offset:35328
  ds_read_b64_tr_b16 v[214:215], v247 offset:36352
  v_mfma_f32_16x16x32_bf16 a[200:203], v[216:219], a[92:95], a[200:203]
  buffer_load_dwordx4 v236, s[8:11], s89 offen offset:3072 nt lds
  v_cvt_pk_bf16_f32 v107, v118, v119
  v_mfma_f32_16x16x32_bf16 a[196:199], v[200:203], a[88:91], a[196:199]
  ds_read_b64_tr_b16 v[216:217], v248 offset:35328
  v_exp_f32 v120, v120
  v_mfma_f32_16x16x32_bf16 a[204:207], v[200:203], a[92:95], a[204:207]
  s_waitcnt lgkmcnt(3)
  ds_read_b64_tr_b16 v[218:219], v248 offset:36352
  v_exp_f32 v121, v121
  v_mfma_f32_16x16x32_bf16 v[224:227], v[220:223], v[104:107], v[224:227]
  v_cvt_pk_bf16_f32 v108, v120, v121
  v_mul_f32 v145, s70, v145
  v_mfma_f32_16x16x32_bf16 a[208:211], v[204:207], a[88:91], a[208:211]
  s_add_u32 m0, s68, 65536
  ds_read_b64_tr_b16 v[200:201], v247 offset:35584
  ds_read_b64_tr_b16 v[202:203], v247 offset:36608
  v_mfma_f32_16x16x32_bf16 a[216:219], v[204:207], a[92:95], a[216:219]
  buffer_load_dwordx4 v237, s[12:15], s89 offen nt lds
  v_mul_f32 v251, s70, v251
  v_mfma_f32_16x16x32_bf16 a[212:215], v[208:211], a[88:91], a[212:215]
  ds_read_b64_tr_b16 v[204:205], v248 offset:35584
  v_exp_f32 v122, v122
  v_mfma_f32_16x16x32_bf16 a[220:223], v[208:211], a[92:95], a[220:223]
  s_waitcnt lgkmcnt(3)
  ds_read_b64_tr_b16 v[206:207], v248 offset:36608
  v_exp_f32 v123, v123
  v_mfma_f32_16x16x32_bf16 a[224:227], v[212:215], a[88:91], a[224:227]
  s_waitcnt vmcnt(21)
  s_barrier
  ds_read_b64_tr_b16 v[208:209], v245 offset:32768
  ds_read_b64_tr_b16 v[210:211], v245 offset:33792
  v_mfma_f32_16x16x32_bf16 a[232:235], v[212:215], a[92:95], a[232:235]
  buffer_load_dwordx4 v237, s[12:15], s89 offen offset:1024 nt lds
  v_cvt_pk_bf16_f32 v109, v122, v123
  v_mfma_f32_16x16x32_bf16 a[228:231], v[216:219], a[88:91], a[228:231]
  ds_read_b64_tr_b16 v[212:213], v246 offset:32768
  v_exp_f32 v124, v124
  v_mfma_f32_16x16x32_bf16 a[236:239], v[216:219], a[92:95], a[236:239]
  s_waitcnt lgkmcnt(3)
  ds_read_b64_tr_b16 v[214:215], v246 offset:33792
  v_exp_f32 v125, v125
  v_mfma_f32_16x16x32_bf16 a[240:243], v[200:203], a[88:91], a[240:243]
  ds_read_b64_tr_b16 v[216:217], v245 offset:33024
  ds_read_b64_tr_b16 v[218:219], v245 offset:34048
  v_mfma_f32_16x16x32_bf16 a[248:251], v[200:203], a[92:95], a[248:251]
  buffer_load_dwordx4 v237, s[12:15], s89 offen offset:2048 nt lds
  v_cvt_pk_bf16_f32 v110, v124, v125
  v_mfma_f32_16x16x32_bf16 a[244:247], v[204:207], a[88:91], a[244:247]
  ds_read_b64_tr_b16 v[200:201], v246 offset:33024
  v_exp_f32 v126, v126
  v_mfma_f32_16x16x32_bf16 a[252:255], v[204:207], a[92:95], a[252:255]
  s_waitcnt lgkmcnt(3)
  ds_read_b64_tr_b16 v[202:203], v246 offset:34048
  v_exp_f32 v127, v127
  v_mfma_f32_16x16x32_bf16 v[32:35], v[208:211], v[96:99], v[32:35]
  ds_read_b64_tr_b16 v[204:205], v245 offset:33280
  ds_read_b64_tr_b16 v[206:207], v245 offset:34304
  v_mfma_f32_16x16x32_bf16 v[40:43], v[208:211], v[100:103], v[40:43]
  buffer_load_dwordx4 v237, s[12:15], s89 offen offset:3072 nt lds
  v_cvt_pk_bf16_f32 v111, v126, v127
  v_mfma_f32_16x16x32_bf16 v[36:39], v[212:215], v[96:99], v[36:39]
  ds_read_b64_tr_b16 v[208:209], v246 offset:33280
  v_cvt_pk_bf16_f32 v145, v145, v251
  v_mfma_f32_16x16x32_bf16 v[44:47], v[212:215], v[100:103], v[44:47]
  s_waitcnt lgkmcnt(3)
  ds_read_b64_tr_b16 v[210:211], v246 offset:34304
  v_accvgpr_read_b32 v146, a164
  v_accvgpr_read_b32 v251, a165
  v_mfma_f32_16x16x32_bf16 v[228:231], v[220:223], v[108:111], v[228:231]
  v_mul_f32 v146, s70, v146
  v_mul_f32 v251, s70, v251
  v_mfma_f32_16x16x32_bf16 v[48:51], v[216:219], v[96:99], v[48:51]
  s_add_u32 m0, s68, 114688
  ds_read_b64_tr_b16 v[212:213], v245 offset:33536
  ds_read_b64_tr_b16 v[214:215], v245 offset:34560
  v_mfma_f32_16x16x32_bf16 v[56:59], v[216:219], v[100:103], v[56:59]
  buffer_load_dwordx4 v239, s[32:35], s87 offen lds
  v_cvt_pk_bf16_f32 v146, v146, v251
  v_mfma_f32_16x16x32_bf16 v[52:55], v[200:203], v[96:99], v[52:55]
  ds_read_b64_tr_b16 v[216:217], v246 offset:33536
  v_accvgpr_read_b32 v147, a166
  v_mfma_f32_16x16x32_bf16 v[60:63], v[200:203], v[100:103], v[60:63]
  s_waitcnt lgkmcnt(3)
  ds_read_b64_tr_b16 v[218:219], v246 offset:34560
  v_accvgpr_read_b32 v251, a167
  v_mul_f32 v147, s70, v147
  v_mfma_f32_16x16x32_bf16 v[64:67], v[204:207], v[96:99], v[64:67]
  ds_read_b64_tr_b16 v[200:201], v245 offset:34816
  ds_read_b64_tr_b16 v[202:203], v245 offset:35840
  v_mfma_f32_16x16x32_bf16 v[72:75], v[204:207], v[100:103], v[72:75]
  buffer_load_dwordx4 v239, s[36:39], s87 offen offset:1024 lds
  v_mul_f32 v251, s70, v251
  v_mfma_f32_16x16x32_bf16 v[68:71], v[208:211], v[96:99], v[68:71]
  ds_read_b64_tr_b16 v[204:205], v246 offset:34816
  v_cvt_pk_bf16_f32 v147, v147, v251
  v_mfma_f32_16x16x32_bf16 v[76:79], v[208:211], v[100:103], v[76:79]
  s_waitcnt lgkmcnt(3)
  ds_read_b64_tr_b16 v[206:207], v246 offset:35840
  v_permlane16_swap_b32 v144, v146
  v_permlane16_swap_b32 v145, v147
  v_mfma_f32_16x16x32_bf16 v[80:83], v[212:215], v[96:99], v[80:83]
  ds_read_b64_tr_b16 v[208:209], v245 offset:35072
  v_accvgpr_read_b32 v148, a168
  v_mfma_f32_16x16x32_bf16 v[88:91], v[212:215], v[100:103], v[88:91]
  ds_read_b64_tr_b16 v[210:211], v245 offset:36096
  v_accvgpr_read_b32 v251, a169
  v_mul_f32 v148, s70, v148
  v_mfma_f32_16x16x32_bf16 v[84:87], v[216:219], v[96:99], v[84:87]
  ds_read_b64_tr_b16 v[212:213], v246 offset:35072
  v_mul_f32 v251, s70, v251
  v_mfma_f32_16x16x32_bf16 v[92:95], v[216:219], v[100:103], v[92:95]
  s_waitcnt lgkmcnt(3)
  ds_read_b64_tr_b16 v[214:215], v246 offset:36096
  v_cvt_pk_bf16_f32 v148, v148, v251
  v_accvgpr_read_b32 v149, a170
  v_mfma_f32_16x16x32_bf16 v[32:35], v[200:203], v[104:107], v[32:35]
  ds_read_b64_tr_b16 v[216:217], v245 offset:35328
  v_accvgpr_read_b32 v251, a171
  v_mfma_f32_16x16x32_bf16 v[40:43], v[200:203], v[108:111], v[40:43]
  ds_read_b64_tr_b16 v[218:219], v245 offset:36352
  v_mul_f32 v149, s70, v149
  v_mul_f32 v251, s70, v251
  v_mfma_f32_16x16x32_bf16 v[36:39], v[204:207], v[104:107], v[36:39]
  ds_read_b64_tr_b16 v[200:201], v246 offset:35328
  v_cvt_pk_bf16_f32 v149, v149, v251
  v_mfma_f32_16x16x32_bf16 v[44:47], v[204:207], v[108:111], v[44:47]
  s_waitcnt lgkmcnt(3)
  ds_read_b64_tr_b16 v[202:203], v246 offset:36352
  v_accvgpr_read_b32 v150, a172
  v_accvgpr_read_b32 v251, a173
  v_mfma_f32_16x16x32_bf16 v[48:51], v[208:211], v[104:107], v[48:51]
  ds_read_b64_tr_b16 v[204:205], v245 offset:35584
  v_mul_f32 v150, s70, v150
  v_mfma_f32_16x16x32_bf16 v[56:59], v[208:211], v[108:111], v[56:59]
  ds_read_b64_tr_b16 v[206:207], v245 offset:36608
  v_mul_f32 v251, s70, v251
  v_cvt_pk_bf16_f32 v150, v150, v251
  v_mfma_f32_16x16x32_bf16 v[52:55], v[212:215], v[104:107], v[52:55]
  ds_read_b64_tr_b16 v[208:209], v246 offset:35584
  v_accvgpr_read_b32 v151, a174
  v_mfma_f32_16x16x32_bf16 v[60:63], v[212:215], v[108:111], v[60:63]
  s_waitcnt lgkmcnt(3)
  ds_read_b64_tr_b16 v[210:211], v246 offset:36608
  v_accvgpr_read_b32 v251, a175
  v_mul_f32 v151, s70, v151
  v_mfma_f32_16x16x32_bf16 v[64:67], v[216:219], v[104:107], v[64:67]
  s_waitcnt vmcnt(22)
  s_barrier
  ds_read_b128 v[212:215], v241 offset:0
  v_mfma_f32_16x16x32_bf16 v[72:75], v[216:219], v[108:111], v[72:75]
  v_mul_f32 v251, s70, v251
  v_cvt_pk_bf16_f32 v151, v151, v251
  v_permlane16_swap_b32 v148, v150
  v_mfma_f32_16x16x32_bf16 v[68:71], v[200:203], v[104:107], v[68:71]
  ds_read_b128 v[216:219], v242 offset:0
  v_permlane16_swap_b32 v149, v151
  v_mfma_f32_16x16x32_bf16 v[76:79], v[200:203], v[108:111], v[76:79]
  s_waitcnt lgkmcnt(2)
  v_accvgpr_read_b32 v152, a176
  v_accvgpr_read_b32 v251, a177
  v_mul_f32 v152, s70, v152
  v_mfma_f32_16x16x32_bf16 v[80:83], v[204:207], v[104:107], v[80:83]
  ds_read_b128 v[200:203], v241 offset:8192
  v_mul_f32 v251, s70, v251
  v_mfma_f32_16x16x32_bf16 v[88:91], v[204:207], v[108:111], v[88:91]
  v_cvt_pk_bf16_f32 v152, v152, v251
  v_accvgpr_read_b32 v153, a178
  v_accvgpr_read_b32 v251, a179
  v_mul_f32 v153, s70, v153
  v_mul_f32 v251, s70, v251
  v_cvt_pk_bf16_f32 v153, v153, v251
  v_accvgpr_read_b32 v154, a180
  v_accvgpr_read_b32 v251, a181
  v_mul_f32 v154, s70, v154
  v_mul_f32 v251, s70, v251
  v_cvt_pk_bf16_f32 v154, v154, v251
  v_accvgpr_read_b32 v155, a182
  v_accvgpr_read_b32 v251, a183
  v_mul_f32 v155, s70, v155
  v_mul_f32 v251, s70, v251
  v_cvt_pk_bf16_f32 v155, v155, v251
  v_permlane16_swap_b32 v152, v154
  s_nop 0
  v_permlane16_swap_b32 v153, v155
  v_accvgpr_read_b32 v156, a184
  v_accvgpr_read_b32 v251, a185
  v_mul_f32 v156, s70, v156
  v_mul_f32 v251, s70, v251
  v_cvt_pk_bf16_f32 v156, v156, v251
  v_accvgpr_read_b32 v157, a186
  v_accvgpr_read_b32 v251, a187
  v_mul_f32 v157, s70, v157
  v_mul_f32 v251, s70, v251
  v_cvt_pk_bf16_f32 v157, v157, v251
  v_accvgpr_read_b32 v158, a188
  v_accvgpr_read_b32 v251, a189
  v_mul_f32 v158, s70, v158
  v_mul_f32 v251, s70, v251
  v_cvt_pk_bf16_f32 v158, v158, v251
  v_accvgpr_read_b32 v159, a190
  v_accvgpr_read_b32 v251, a191
  v_mul_f32 v159, s70, v159
  v_mul_f32 v251, s70, v251
  v_cvt_pk_bf16_f32 v159, v159, v251
  v_permlane16_swap_b32 v156, v158
  s_nop 0
  v_permlane16_swap_b32 v157, v159
  v_mfma_f32_16x16x32_bf16 v[84:87], v[208:211], v[104:107], v[84:87]
  ds_read_b128 v[204:207], v242 offset:8192
  v_mfma_f32_16x16x32_bf16 v[92:95], v[208:211], v[108:111], v[92:95]
  s_waitcnt lgkmcnt(2)
  v_rcp_f32 v238, v224
  v_mfma_f32_16x16x32_bf16 v[96:99], v[212:215], v[128:131], 0
  ds_read_b128 v[208:211], v241 offset:1024
  v_mfma_f32_16x16x32_bf16 v[104:107], v[212:215], v[132:135], 0
  v_rcp_f32 v244, v228
  v_mfma_f32_16x16x32_bf16 v[96:99], v[216:219], v[136:139], v[96:99]
  ds_read_b128 v[212:215], v242 offset:1024
  v_mul_f32 v32, v238, v32
  v_mfma_f32_16x16x32_bf16 v[104:107], v[216:219], v[140:143], v[104:107]
  s_waitcnt lgkmcnt(2)
  buffer_load_dwordx4 v239, s[40:43], s87 offen offset:2048 lds
  v_mfma_f32_16x16x32_bf16 v[96:99], v[200:203], v[144:147], v[96:99]
  ds_read_b128 v[216:219], v241 offset:9216
  v_mul_f32 v33, v238, v33
  v_mfma_f32_16x16x32_bf16 v[104:107], v[200:203], v[148:151], v[104:107]
  v_cvt_pk_bf16_f32 v0, v32, v33
  v_mul_f32 v34, v238, v34
  v_mfma_f32_16x16x32_bf16 v[96:99], v[204:207], v[152:155], v[96:99]
  ds_read_b128 v[200:203], v242 offset:9216
  v_mul_f32 v35, v238, v35
  v_mfma_f32_16x16x32_bf16 v[104:107], v[204:207], v[156:159], v[104:107]
  s_waitcnt lgkmcnt(2)
  v_cvt_pk_bf16_f32 v1, v34, v35
  v_mul_f32 v36, v238, v36
  v_mfma_f32_16x16x32_bf16 v[100:103], v[208:211], v[128:131], 0
  ds_read_b128 v[204:207], v241 offset:2048
  v_mul_f32 v37, v238, v37
  v_mfma_f32_16x16x32_bf16 v[108:111], v[208:211], v[132:135], 0
  buffer_load_dwordx4 v239, s[44:47], s87 offen offset:3072 lds
  v_add_u32 v239, 512, v239
  v_mfma_f32_16x16x32_bf16 v[100:103], v[212:215], v[136:139], v[100:103]
  ds_read_b128 v[208:211], v242 offset:2048
  v_max3_f32 v193, v96, v97, v98
  v_mfma_f32_16x16x32_bf16 v[108:111], v[212:215], v[140:143], v[108:111]
  s_waitcnt lgkmcnt(2)
  v_max3_f32 v197, v104, v105, v106
  v_cvt_pk_bf16_f32 v2, v36, v37
  v_mfma_f32_16x16x32_bf16 v[100:103], v[216:219], v[144:147], v[100:103]
  s_add_u32 m0, s68, 131072
  ds_read_b128 v[212:215], v241 offset:10240
  v_mul_f32 v38, v238, v38
  v_mfma_f32_16x16x32_bf16 v[108:111], v[216:219], v[148:151], v[108:111]
  buffer_load_dwordx4 v239, s[32:35], s80 offen lds
  v_mfma_f32_16x16x32_bf16 v[100:103], v[200:203], v[152:155], v[100:103]
  ds_read_b128 v[216:219], v242 offset:10240
  v_mul_f32 v39, v238, v39
  v_mfma_f32_16x16x32_bf16 v[108:111], v[200:203], v[156:159], v[108:111]
  s_waitcnt lgkmcnt(2)
  v_cvt_pk_bf16_f32 v3, v38, v39
  v_mul_f32 v40, v244, v40
  v_mfma_f32_16x16x32_bf16 v[112:115], v[204:207], v[128:131], 0
  ds_read_b128 v[200:203], v241 offset:3072
  v_mul_f32 v41, v244, v41
  v_mfma_f32_16x16x32_bf16 v[120:123], v[204:207], v[132:135], 0
  buffer_load_dwordx4 v239, s[36:39], s80 offen offset:1024 lds
  v_mfma_f32_16x16x32_bf16 v[112:115], v[208:211], v[136:139], v[112:115]
  ds_read_b128 v[204:207], v242 offset:3072
  v_max3_f32 v193, v193, v99, v100
  v_mfma_f32_16x16x32_bf16 v[120:123], v[208:211], v[140:143], v[120:123]
  s_waitcnt lgkmcnt(2)
  v_max3_f32 v193, v193, v101, v102
  v_max3_f32 v197, v197, v107, v108
  v_mfma_f32_16x16x32_bf16 v[112:115], v[212:215], v[144:147], v[112:115]
  ds_read_b128 v[208:211], v241 offset:11264
  v_max3_f32 v197, v197, v109, v110
  v_mfma_f32_16x16x32_bf16 v[120:123], v[212:215], v[148:151], v[120:123]
  v_cvt_pk_bf16_f32 v4, v40, v41
  v_mul_f32 v42, v244, v42
  v_mfma_f32_16x16x32_bf16 v[112:115], v[216:219], v[152:155], v[112:115]
  ds_read_b128 v[212:215], v242 offset:11264
  v_mul_f32 v43, v244, v43
  v_mfma_f32_16x16x32_bf16 v[120:123], v[216:219], v[156:159], v[120:123]
  s_waitcnt lgkmcnt(2)
  buffer_load_dwordx4 v239, s[40:43], s80 offen offset:2048 lds
  v_mfma_f32_16x16x32_bf16 v[116:119], v[200:203], v[128:131], 0
  s_waitcnt vmcnt(15)
  s_barrier
  ds_read_b64_tr_b16 v[216:217], v247 offset:49152
  v_mfma_f32_16x16x32_bf16 v[124:127], v[200:203], v[132:135], 0
  ds_read_b64_tr_b16 v[218:219], v247 offset:50176
  v_cvt_pk_bf16_f32 v5, v42, v43
  v_mfma_f32_16x16x32_bf16 v[116:119], v[204:207], v[136:139], v[116:119]
  ds_read_b64_tr_b16 v[200:201], v248 offset:49152
  ds_read_b64_tr_b16 v[202:203], v248 offset:50176
  v_mfma_f32_16x16x32_bf16 v[124:127], v[204:207], v[140:143], v[124:127]
  s_waitcnt lgkmcnt(4)
  buffer_load_dwordx4 v239, s[44:47], s80 offen offset:3072 lds
  v_mfma_f32_16x16x32_bf16 v[116:119], v[208:211], v[144:147], v[116:119]
  ds_read_b64_tr_b16 v[204:205], v247 offset:49408
  v_max3_f32 v193, v193, v103, v112
  v_mfma_f32_16x16x32_bf16 v[124:127], v[208:211], v[148:151], v[124:127]
  ds_read_b64_tr_b16 v[206:207], v247 offset:50432
  v_max3_f32 v193, v193, v113, v114
  v_mfma_f32_16x16x32_bf16 v[116:119], v[212:215], v[152:155], v[116:119]
  s_add_u32 m0, s68, 32768
  ds_read_b64_tr_b16 v[208:209], v248 offset:49408
  ds_read_b64_tr_b16 v[210:211], v248 offset:50432
  v_mfma_f32_16x16x32_bf16 v[124:127], v[212:215], v[156:159], v[124:127]
  s_waitcnt lgkmcnt(4)
  buffer_load_dwordx4 v236, s[8:11], s90 offen nt lds
  v_mfma_f32_16x16x32_bf16 a[192:195], v[216:219], a[96:99], a[192:195]
  ds_read_b64_tr_b16 v[212:213], v247 offset:49664
  v_max3_f32 v197, v197, v111, v120
  v_mfma_f32_16x16x32_bf16 a[200:203], v[216:219], a[100:103], a[200:203]
  ds_read_b64_tr_b16 v[214:215], v247 offset:50688
  v_max3_f32 v197, v197, v121, v122
  v_mfma_f32_16x16x32_bf16 a[196:199], v[200:203], a[96:99], a[196:199]
  ds_read_b64_tr_b16 v[216:217], v248 offset:49664
  v_max3_f32 v193, v193, v115, v116
  v_mfma_f32_16x16x32_bf16 a[204:207], v[200:203], a[100:103], a[204:207]
  s_waitcnt lgkmcnt(3)
  ds_read_b64_tr_b16 v[218:219], v248 offset:50688
  v_max3_f32 v193, v193, v117, v118
  v_max_f32 v193, v193, v119
  v_mfma_f32_16x16x32_bf16 a[208:211], v[204:207], a[96:99], a[208:211]
  ds_read_b64_tr_b16 v[200:201], v247 offset:49920
  v_mov_b32 v194, v193
  v_mfma_f32_16x16x32_bf16 a[216:219], v[204:207], a[100:103], a[216:219]
  ds_read_b64_tr_b16 v[202:203], v247 offset:50944
  v_max3_f32 v197, v197, v123, v124
  v_max3_f32 v197, v197, v125, v126
  v_mfma_f32_16x16x32_bf16 a[212:215], v[208:211], a[96:99], a[212:215]
  ds_read_b64_tr_b16 v[204:205], v248 offset:49920
  v_max_f32 v197, v197, v127
  v_mfma_f32_16x16x32_bf16 a[220:223], v[208:211], a[100:103], a[220:223]
  s_waitcnt lgkmcnt(3)
  ds_read_b64_tr_b16 v[206:207], v248 offset:50944
  v_mov_b32 v198, v197
  v_permlane32_swap_b32 v194, v193
  v_mfma_f32_16x16x32_bf16 a[224:227], v[212:215], a[96:99], a[224:227]
  ds_read_b64_tr_b16 v[208:209], v247 offset:51200
  v_max_f32 v193, v193, v194
  v_mfma_f32_16x16x32_bf16 a[232:235], v[212:215], a[100:103], a[232:235]
  ds_read_b64_tr_b16 v[210:211], v247 offset:52224
  v_mov_b32 v194, v193
  v_permlane32_swap_b32 v198, v197
  v_mfma_f32_16x16x32_bf16 a[228:231], v[216:219], a[96:99], a[228:231]
  ds_read_b64_tr_b16 v[212:213], v248 offset:51200
  v_max_f32 v197, v197, v198
  v_mfma_f32_16x16x32_bf16 a[236:239], v[216:219], a[100:103], a[236:239]
  s_waitcnt lgkmcnt(3)
  ds_read_b64_tr_b16 v[214:215], v248 offset:52224
  v_mov_b32 v198, v197
  v_mul_f32 v44, v244, v44
  v_mfma_f32_16x16x32_bf16 a[240:243], v[200:203], a[96:99], a[240:243]
  ds_read_b64_tr_b16 v[216:217], v247 offset:51456
  v_mul_f32 v45, v244, v45
  v_mfma_f32_16x16x32_bf16 a[248:251], v[200:203], a[100:103], a[248:251]
  ds_read_b64_tr_b16 v[218:219], v247 offset:52480
  v_cvt_pk_bf16_f32 v6, v44, v45
  v_mul_f32 v46, v244, v46
  v_mfma_f32_16x16x32_bf16 a[244:247], v[204:207], a[96:99], a[244:247]
  ds_read_b64_tr_b16 v[200:201], v248 offset:51456
  v_mul_f32 v47, v244, v47
  v_mfma_f32_16x16x32_bf16 a[252:255], v[204:207], a[100:103], a[252:255]
  s_waitcnt lgkmcnt(3)
  ds_read_b64_tr_b16 v[202:203], v248 offset:52480
  v_cvt_pk_bf16_f32 v7, v46, v47
  v_permlane16_swap_b32 v194, v193
  v_mfma_f32_16x16x32_bf16 a[192:195], v[208:211], a[104:107], a[192:195]
  ds_read_b64_tr_b16 v[204:205], v247 offset:51712
  v_max_f32 v193, v193, v194
  v_mfma_f32_16x16x32_bf16 a[200:203], v[208:211], a[108:111], a[200:203]
  ds_read_b64_tr_b16 v[206:207], v247 offset:52736
  v_sub_f32 v192, 0, v193
  v_permlane16_swap_b32 v198, v197
  v_mfma_f32_16x16x32_bf16 a[196:199], v[212:215], a[104:107], a[196:199]
  ds_read_b64_tr_b16 v[208:209], v248 offset:51712
  v_max_f32 v197, v197, v198
  v_mfma_f32_16x16x32_bf16 a[204:207], v[212:215], a[108:111], a[204:207]
  s_waitcnt lgkmcnt(3)
  ds_read_b64_tr_b16 v[210:211], v248 offset:52736
  v_sub_f32 v196, 0, v197
  v_add_f32 v96, v96, v192
  v_mfma_f32_16x16x32_bf16 a[208:211], v[216:219], a[104:107], a[208:211]
  ds_read_b64_tr_b16 v[212:213], v247 offset:51968
  v_exp_f32 v96, v96
  v_mfma_f32_16x16x32_bf16 a[216:219], v[216:219], a[108:111], a[216:219]
  ds_read_b64_tr_b16 v[214:215], v247 offset:52992
  v_add_f32 v97, v97, v192
  v_mul_f32 v48, v238, v48
  v_mfma_f32_16x16x32_bf16 a[212:215], v[200:203], a[104:107], a[212:215]
  ds_read_b64_tr_b16 v[216:217], v248 offset:51968
  v_exp_f32 v97, v97
  v_mfma_f32_16x16x32_bf16 a[220:223], v[200:203], a[108:111], a[220:223]
  s_waitcnt lgkmcnt(3)
  ds_read_b64_tr_b16 v[218:219], v248 offset:52992
  v_cvt_pk_bf16_f32 v96, v96, v97
  v_add_f32 v98, v98, v192
  v_mfma_f32_16x16x32_bf16 a[224:227], v[204:207], a[104:107], a[224:227]
  s_waitcnt vmcnt(5)
  s_barrier
  ds_read_b64_tr_b16 v[200:201], v247 offset:16384
  ds_read_b64_tr_b16 v[202:203], v247 offset:17408
  v_mfma_f32_16x16x32_bf16 a[232:235], v[204:207], a[108:111], a[232:235]
  buffer_load_dwordx4 v236, s[8:11], s90 offen offset:1024 nt lds
  v_mul_f32 v49, v238, v49
  v_mfma_f32_16x16x32_bf16 a[228:231], v[208:211], a[104:107], a[228:231]
  ds_read_b64_tr_b16 v[204:205], v248 offset:16384
  v_exp_f32 v98, v98
  v_mfma_f32_16x16x32_bf16 a[236:239], v[208:211], a[108:111], a[236:239]
  s_waitcnt lgkmcnt(3)
  ds_read_b64_tr_b16 v[206:207], v248 offset:17408
  v_add_f32 v99, v99, v192
  v_cvt_pk_bf16_f32 v8, v48, v49
  v_mfma_f32_16x16x32_bf16 a[240:243], v[212:215], a[104:107], a[240:243]
  ds_read_b64_tr_b16 v[208:209], v247 offset:16640
  ds_read_b64_tr_b16 v[210:211], v247 offset:17664
  v_mfma_f32_16x16x32_bf16 a[248:251], v[212:215], a[108:111], a[248:251]
  buffer_load_dwordx4 v236, s[8:11], s90 offen offset:2048 nt lds
  v_mul_f32 v50, v238, v50
  v_mfma_f32_16x16x32_bf16 a[244:247], v[216:219], a[104:107], a[244:247]
  ds_read_b64_tr_b16 v[212:213], v248 offset:16640
  v_exp_f32 v99, v99
  v_mfma_f32_16x16x32_bf16 a[252:255], v[216:219], a[108:111], a[252:255]
  s_waitcnt lgkmcnt(3)
  ds_read_b64_tr_b16 v[214:215], v248 offset:17664
  v_cvt_pk_bf16_f32 v97, v98, v99
  v_add_f32 v100, v100, v192
  v_mfma_f32_16x16x32_bf16 a[192:195], v[200:203], a[112:115], a[192:195]
  ds_read_b64_tr_b16 v[216:217], v247 offset:16896
  ds_read_b64_tr_b16 v[218:219], v247 offset:17920
  v_mfma_f32_16x16x32_bf16 a[200:203], v[200:203], a[116:119], a[200:203]
  buffer_load_dwordx4 v236, s[8:11], s90 offen offset:3072 nt lds
  v_mul_f32 v51, v238, v51
  v_mfma_f32_16x16x32_bf16 a[196:199], v[204:207], a[112:115], a[196:199]
  ds_read_b64_tr_b16 v[200:201], v248 offset:16896
  v_exp_f32 v100, v100
  v_mfma_f32_16x16x32_bf16 a[204:207], v[204:207], a[116:119], a[204:207]
  s_waitcnt lgkmcnt(3)
  ds_read_b64_tr_b16 v[202:203], v248 offset:17920
  v_add_f32 v101, v101, v192
  v_cvt_pk_bf16_f32 v9, v50, v51
  v_mfma_f32_16x16x32_bf16 a[208:211], v[208:211], a[112:115], a[208:211]
  s_add_u32 m0, s68, 98304
  ds_read_b64_tr_b16 v[204:205], v247 offset:17152
  ds_read_b64_tr_b16 v[206:207], v247 offset:18176
  v_mfma_f32_16x16x32_bf16 a[216:219], v[208:211], a[116:119], a[216:219]
  buffer_load_dwordx4 v237, s[12:15], s90 offen nt lds
  v_mul_f32 v52, v238, v52
  v_mfma_f32_16x16x32_bf16 a[212:215], v[212:215], a[112:115], a[212:215]
  ds_read_b64_tr_b16 v[208:209], v248 offset:17152
  v_exp_f32 v101, v101
  v_mfma_f32_16x16x32_bf16 a[220:223], v[212:215], a[116:119], a[220:223]
  s_waitcnt lgkmcnt(3)
  ds_read_b64_tr_b16 v[210:211], v248 offset:18176
  v_cvt_pk_bf16_f32 v98, v100, v101
  v_add_f32 v102, v102, v192
  v_mfma_f32_16x16x32_bf16 a[224:227], v[216:219], a[112:115], a[224:227]
  ds_read_b64_tr_b16 v[212:213], v247 offset:18432
  ds_read_b64_tr_b16 v[214:215], v247 offset:19456
  v_mfma_f32_16x16x32_bf16 a[232:235], v[216:219], a[116:119], a[232:235]
  buffer_load_dwordx4 v237, s[12:15], s90 offen offset:1024 nt lds
  v_mul_f32 v53, v238, v53
  v_mfma_f32_16x16x32_bf16 a[228:231], v[200:203], a[112:115], a[228:231]
  ds_read_b64_tr_b16 v[216:217], v248 offset:18432
  v_exp_f32 v102, v102
  v_mfma_f32_16x16x32_bf16 a[236:239], v[200:203], a[116:119], a[236:239]
  s_waitcnt lgkmcnt(3)
  ds_read_b64_tr_b16 v[218:219], v248 offset:19456
  v_add_f32 v103, v103, v192
  v_cvt_pk_bf16_f32 v10, v52, v53
  v_mfma_f32_16x16x32_bf16 a[240:243], v[204:207], a[112:115], a[240:243]
  ds_read_b64_tr_b16 v[200:201], v247 offset:18688
  ds_read_b64_tr_b16 v[202:203], v247 offset:19712
  v_mfma_f32_16x16x32_bf16 a[248:251], v[204:207], a[116:119], a[248:251]
  buffer_load_dwordx4 v237, s[12:15], s90 offen offset:2048 nt lds
  v_mul_f32 v54, v238, v54
  v_mfma_f32_16x16x32_bf16 a[244:247], v[208:211], a[112:115], a[244:247]
  ds_read_b64_tr_b16 v[204:205], v248 offset:18688
  v_exp_f32 v103, v103
  v_mfma_f32_16x16x32_bf16 a[252:255], v[208:211], a[116:119], a[252:255]
  s_waitcnt lgkmcnt(3)
  ds_read_b64_tr_b16 v[206:207], v248 offset:19712
  v_cvt_pk_bf16_f32 v99, v102, v103
  v_add_f32 v104, v104, v196
  v_mfma_f32_16x16x32_bf16 a[192:195], v[212:215], a[120:123], a[192:195]
  ds_read_b64_tr_b16 v[208:209], v247 offset:18944
  ds_read_b64_tr_b16 v[210:211], v247 offset:19968
  v_mfma_f32_16x16x32_bf16 a[200:203], v[212:215], a[124:127], a[200:203]
  buffer_load_dwordx4 v237, s[12:15], s90 offen offset:3072 nt lds
  v_mul_f32 v55, v238, v55
  v_mfma_f32_16x16x32_bf16 v[224:227], v[220:223], v[96:99], 0
  v_exp_f32 v104, v104
  v_mfma_f32_16x16x32_bf16 a[196:199], v[216:219], a[120:123], a[196:199]
  ds_read_b64_tr_b16 v[212:213], v248 offset:18944
  v_add_f32 v105, v105, v196
  v_mfma_f32_16x16x32_bf16 a[204:207], v[216:219], a[124:127], a[204:207]
  s_waitcnt lgkmcnt(3)
  ds_read_b64_tr_b16 v[214:215], v248 offset:19968
  v_exp_f32 v105, v105
  v_mfma_f32_16x16x32_bf16 a[208:211], v[200:203], a[120:123], a[208:211]
  ds_read_b64_tr_b16 v[216:217], v247 offset:19200
  v_cvt_pk_bf16_f32 v100, v104, v105
  v_mfma_f32_16x16x32_bf16 a[216:219], v[200:203], a[124:127], a[216:219]
  ds_read_b64_tr_b16 v[218:219], v247 offset:20224
  v_add_f32 v106, v106, v196
  v_cvt_pk_bf16_f32 v11, v54, v55
  v_mfma_f32_16x16x32_bf16 a[212:215], v[204:207], a[120:123], a[212:215]
  ds_read_b64_tr_b16 v[200:201], v248 offset:19200
  v_exp_f32 v106, v106
  v_mfma_f32_16x16x32_bf16 a[220:223], v[204:207], a[124:127], a[220:223]
  s_waitcnt lgkmcnt(3)
  ds_read_b64_tr_b16 v[202:203], v248 offset:20224
  v_add_f32 v107, v107, v196
  v_mul_f32 v56, v244, v56
  v_mfma_f32_16x16x32_bf16 a[224:227], v[208:211], a[120:123], a[224:227]
  s_waitcnt vmcnt(32)
  s_barrier
  ds_read_b64_tr_b16 v[204:205], v245 offset:16384
  v_mfma_f32_16x16x32_bf16 a[232:235], v[208:211], a[124:127], a[232:235]
  ds_read_b64_tr_b16 v[206:207], v245 offset:17408
  v_exp_f32 v107, v107
  v_mfma_f32_16x16x32_bf16 a[228:231], v[212:215], a[120:123], a[228:231]
  ds_read_b64_tr_b16 v[208:209], v246 offset:16384
  v_cvt_pk_bf16_f32 v101, v106, v107
  v_mfma_f32_16x16x32_bf16 a[236:239], v[212:215], a[124:127], a[236:239]
  s_waitcnt lgkmcnt(3)
  ds_read_b64_tr_b16 v[210:211], v246 offset:17408
  v_add_f32 v108, v108, v196
  v_mul_f32 v57, v244, v57
  v_mfma_f32_16x16x32_bf16 a[240:243], v[216:219], a[120:123], a[240:243]
  ds_read_b64_tr_b16 v[212:213], v245 offset:16640
  v_exp_f32 v108, v108
  v_mfma_f32_16x16x32_bf16 a[248:251], v[216:219], a[124:127], a[248:251]
  ds_read_b64_tr_b16 v[214:215], v245 offset:17664
  v_add_f32 v109, v109, v196
  v_exp_f32 v109, v109
  v_add_f32 v110, v110, v196
  v_cvt_pk_bf16_f32 v102, v108, v109
  v_exp_f32 v110, v110
  v_add_f32 v111, v111, v196
  v_exp_f32 v111, v111
  v_cvt_pk_bf16_f32 v12, v56, v57
  v_cvt_pk_bf16_f32 v103, v110, v111
  v_mfma_f32_16x16x32_bf16 a[244:247], v[200:203], a[120:123], a[244:247]
  ds_read_b64_tr_b16 v[216:217], v246 offset:16640
  v_mul_f32 v58, v244, v58
  v_mfma_f32_16x16x32_bf16 a[252:255], v[200:203], a[124:127], a[252:255]
  s_waitcnt lgkmcnt(3)
  ds_read_b64_tr_b16 v[218:219], v246 offset:17664
  v_mul_f32 v59, v244, v59
  v_cvt_pk_bf16_f32 v13, v58, v59
  v_mfma_f32_16x16x32_bf16 v[228:231], v[220:223], v[100:103], 0
  v_mul_f32 v60, v244, v60
  v_mul_f32 v61, v244, v61
  v_mfma_f32_16x16x32_bf16 v[32:35], v[204:207], v[96:99], 0
  ds_read_b64_tr_b16 v[200:201], v245 offset:16896
  v_cvt_pk_bf16_f32 v14, v60, v61
  v_mfma_f32_16x16x32_bf16 v[40:43], v[204:207], v[100:103], 0
  ds_read_b64_tr_b16 v[202:203], v245 offset:17920
  v_mul_f32 v62, v244, v62
  v_mul_f32 v63, v244, v63
  v_cvt_pk_bf16_f32 v15, v62, v63
  v_mfma_f32_16x16x32_bf16 v[36:39], v[208:211], v[96:99], 0
  ds_read_b64_tr_b16 v[204:205], v246 offset:16896
  v_mul_f32 v64, v238, v64
  v_mfma_f32_16x16x32_bf16 v[44:47], v[208:211], v[100:103], 0
  s_waitcnt lgkmcnt(3)
  ds_read_b64_tr_b16 v[206:207], v246 offset:17920
  v_mul_f32 v65, v238, v65
  v_cvt_pk_bf16_f32 v16, v64, v65
  v_mfma_f32_16x16x32_bf16 v[48:51], v[212:215], v[96:99], 0
  ds_read_b64_tr_b16 v[208:209], v245 offset:17152
  v_mul_f32 v66, v238, v66
  v_mfma_f32_16x16x32_bf16 v[56:59], v[212:215], v[100:103], 0
  ds_read_b64_tr_b16 v[210:211], v245 offset:18176
  v_mul_f32 v67, v238, v67
  v_cvt_pk_bf16_f32 v17, v66, v67
  v_mul_f32 v68, v238, v68
  v_mul_f32 v69, v238, v69
  v_cvt_pk_bf16_f32 v18, v68, v69
  v_mul_f32 v70, v238, v70
  v_mul_f32 v71, v238, v71
  v_cvt_pk_bf16_f32 v19, v70, v71
  v_mul_f32 v72, v244, v72
  v_mul_f32 v73, v244, v73
  v_cvt_pk_bf16_f32 v20, v72, v73
  v_mul_f32 v74, v244, v74
  v_mul_f32 v75, v244, v75
  v_cvt_pk_bf16_f32 v21, v74, v75
  v_mul_f32 v76, v244, v76
  v_mul_f32 v77, v244, v77
  v_cvt_pk_bf16_f32 v22, v76, v77
  v_mul_f32 v78, v244, v78
  v_mul_f32 v79, v244, v79
  v_cvt_pk_bf16_f32 v23, v78, v79
  v_mfma_f32_16x16x32_bf16 v[52:55], v[216:219], v[96:99], 0
  ds_read_b64_tr_b16 v[212:213], v246 offset:17152
  v_mul_f32 v80, v238, v80
  v_mfma_f32_16x16x32_bf16 v[60:63], v[216:219], v[100:103], 0
  s_waitcnt lgkmcnt(3)
  ds_read_b64_tr_b16 v[214:215], v246 offset:18176
  v_mul_f32 v81, v238, v81
  v_cvt_pk_bf16_f32 v24, v80, v81
  v_mfma_f32_16x16x32_bf16 v[64:67], v[200:203], v[96:99], 0
  s_add_u32 m0, s68, 147456
  ds_read_b64_tr_b16 v[216:217], v245 offset:18432
  ds_read_b64_tr_b16 v[218:219], v245 offset:19456
  v_mfma_f32_16x16x32_bf16 v[72:75], v[200:203], v[100:103], 0
  buffer_load_dwordx4 v239, s[32:35], s81 offen lds
  v_mul_f32 v82, v238, v82
  v_mul_f32 v83, v238, v83
  v_cvt_pk_bf16_f32 v25, v82, v83
  v_mul_f32 v84, v238, v84
  v_mul_f32 v85, v238, v85
  v_cvt_pk_bf16_f32 v26, v84, v85
  v_mul_f32 v86, v238, v86
  v_mul_f32 v87, v238, v87
  v_cvt_pk_bf16_f32 v27, v86, v87
  v_mul_f32 v88, v244, v88
  v_mul_f32 v89, v244, v89
  v_cvt_pk_bf16_f32 v28, v88, v89
  v_mul_f32 v90, v244, v90
  v_mul_f32 v91, v244, v91
  v_cvt_pk_bf16_f32 v29, v90, v91
  v_mul_f32 v92, v244, v92
  v_mul_f32 v93, v244, v93
  v_cvt_pk_bf16_f32 v30, v92, v93
  v_mul_f32 v94, v244, v94
  v_mul_f32 v95, v244, v95
  v_cvt_pk_bf16_f32 v31, v94, v95
  v_mfma_f32_16x16x32_bf16 v[68:71], v[204:207], v[96:99], 0
  ds_read_b64_tr_b16 v[200:201], v246 offset:18432
  v_add_f32 v112, v112, v192
  v_mfma_f32_16x16x32_bf16 v[76:79], v[204:207], v[100:103], 0
  s_waitcnt lgkmcnt(3)
  ds_read_b64_tr_b16 v[202:203], v246 offset:19456
  v_exp_f32 v112, v112
  v_mfma_f32_16x16x32_bf16 v[80:83], v[208:211], v[96:99], 0
  ds_read_b64_tr_b16 v[204:205], v245 offset:18688
  ds_read_b64_tr_b16 v[206:207], v245 offset:19712
  v_mfma_f32_16x16x32_bf16 v[88:91], v[208:211], v[100:103], 0
  buffer_load_dwordx4 v239, s[36:39], s81 offen offset:1024 lds
  v_add_f32 v113, v113, v192
  v_exp_f32 v113, v113
  v_add_f32 v114, v114, v192
  v_cvt_pk_bf16_f32 v104, v112, v113
  v_exp_f32 v114, v114
  v_add_f32 v115, v115, v192
  v_exp_f32 v115, v115
  v_add_f32 v116, v116, v192
  v_cvt_pk_bf16_f32 v105, v114, v115
  v_exp_f32 v116, v116
  v_add_f32 v117, v117, v192
  v_exp_f32 v117, v117
  v_add_f32 v118, v118, v192
  v_cvt_pk_bf16_f32 v106, v116, v117
  v_exp_f32 v118, v118
  v_add_f32 v119, v119, v192
  v_exp_f32 v119, v119
  v_add_f32 v120, v120, v196
  v_cvt_pk_bf16_f32 v107, v118, v119
  v_exp_f32 v120, v120
  v_add_f32 v121, v121, v196
  v_exp_f32 v121, v121
  v_add_f32 v122, v122, v196
  v_cvt_pk_bf16_f32 v108, v120, v121
  v_exp_f32 v122, v122
  v_add_f32 v123, v123, v196
  v_exp_f32 v123, v123
  v_add_f32 v124, v124, v196
  v_cvt_pk_bf16_f32 v109, v122, v123
  v_exp_f32 v124, v124
  v_add_f32 v125, v125, v196
  v_exp_f32 v125, v125
  v_add_f32 v126, v126, v196
  v_cvt_pk_bf16_f32 v110, v124, v125
  v_exp_f32 v126, v126
  v_add_f32 v127, v127, v196
  v_exp_f32 v127, v127
  v_mov_b32 v193, v192
  v_cvt_pk_bf16_f32 v111, v126, v127
  v_mfma_f32_16x16x32_bf16 v[84:87], v[212:215], v[96:99], 0
  ds_read_b64_tr_b16 v[208:209], v246 offset:18688
  v_mov_b32 v194, v192
  v_mfma_f32_16x16x32_bf16 v[92:95], v[212:215], v[100:103], 0
  s_waitcnt lgkmcnt(3)
  ds_read_b64_tr_b16 v[210:211], v246 offset:19712
  v_mov_b32 v195, v192
  v_mfma_f32_16x16x32_bf16 v[224:227], v[220:223], v[104:107], v[224:227]
  v_mov_b32 v197, v196
  v_mov_b32 v198, v196
  v_mfma_f32_16x16x32_bf16 v[32:35], v[216:219], v[104:107], v[32:35]
  ds_read_b64_tr_b16 v[212:213], v245 offset:18944
  ds_read_b64_tr_b16 v[214:215], v245 offset:19968
  v_mfma_f32_16x16x32_bf16 v[40:43], v[216:219], v[108:111], v[40:43]
  buffer_load_dwordx4 v239, s[40:43], s81 offen offset:2048 lds
  v_mfma_f32_16x16x32_bf16 v[228:231], v[220:223], v[108:111], v[228:231]
  v_mov_b32 v199, v196
  v_accvgpr_read_b32 v160, a192
  v_mfma_f32_16x16x32_bf16 v[36:39], v[200:203], v[104:107], v[36:39]
  ds_read_b64_tr_b16 v[216:217], v246 offset:18944
  v_accvgpr_read_b32 v251, a193
  v_mfma_f32_16x16x32_bf16 v[44:47], v[200:203], v[108:111], v[44:47]
  s_waitcnt lgkmcnt(3)
  ds_read_b64_tr_b16 v[218:219], v246 offset:19968
  v_mul_f32 v160, s70, v160
  v_mfma_f32_16x16x32_bf16 v[48:51], v[204:207], v[104:107], v[48:51]
  ds_read_b64_tr_b16 v[200:201], v245 offset:19200
  ds_read_b64_tr_b16 v[202:203], v245 offset:20224
  v_mfma_f32_16x16x32_bf16 v[56:59], v[204:207], v[108:111], v[56:59]
  buffer_load_dwordx4 v239, s[44:47], s81 offen offset:3072 lds
  v_mfma_f32_16x16x32_bf16 v[52:55], v[208:211], v[104:107], v[52:55]
  ds_read_b64_tr_b16 v[204:205], v246 offset:19200
  v_mul_f32 v251, s70, v251
  v_mfma_f32_16x16x32_bf16 v[60:63], v[208:211], v[108:111], v[60:63]
  s_waitcnt lgkmcnt(3)
  ds_read_b64_tr_b16 v[206:207], v246 offset:20224
  v_cvt_pk_bf16_f32 v160, v160, v251
  v_mfma_f32_16x16x32_bf16 v[64:67], v[212:215], v[104:107], v[64:67]
  s_waitcnt vmcnt(24)
  s_barrier
  s_add_u32 m0, s68, 114688
  ds_read_b128 v[208:211], v241 offset:16384
  v_mfma_f32_16x16x32_bf16 v[72:75], v[212:215], v[108:111], v[72:75]
  buffer_load_dwordx4 v239, s[32:35], s82 offen lds
  v_mfma_f32_16x16x32_bf16 v[68:71], v[216:219], v[104:107], v[68:71]
  ds_read_b128 v[212:215], v242 offset:16384
  v_accvgpr_read_b32 v161, a194
  v_mfma_f32_16x16x32_bf16 v[76:79], v[216:219], v[108:111], v[76:79]
  s_waitcnt lgkmcnt(2)
  v_accvgpr_read_b32 v251, a195
  v_mul_f32 v161, s70, v161
  v_mfma_f32_16x16x32_bf16 v[80:83], v[200:203], v[104:107], v[80:83]
  ds_read_b128 v[216:219], v241 offset:24576
  v_mul_f32 v251, s70, v251
  v_mfma_f32_16x16x32_bf16 v[88:91], v[200:203], v[108:111], v[88:91]
  buffer_load_dwordx4 v239, s[36:39], s82 offen offset:1024 lds
  v_mfma_f32_16x16x32_bf16 v[84:87], v[204:207], v[104:107], v[84:87]
  ds_read_b128 v[200:203], v242 offset:24576
  v_cvt_pk_bf16_f32 v161, v161, v251
  v_mfma_f32_16x16x32_bf16 v[92:95], v[204:207], v[108:111], v[92:95]
  s_waitcnt lgkmcnt(2)
  v_accvgpr_read_b32 v162, a196
  v_accvgpr_read_b32 v251, a197
  v_mfma_f32_16x16x32_bf16 v[96:99], v[208:211], v[128:131], v[192:195]
  ds_read_b128 v[204:207], v241 offset:17408
  v_mul_f32 v162, s70, v162
  v_mfma_f32_16x16x32_bf16 v[104:107], v[208:211], v[132:135], v[196:199]
  buffer_load_dwordx4 v239, s[40:43], s82 offen offset:2048 lds
  v_mfma_f32_16x16x32_bf16 v[96:99], v[212:215], v[136:139], v[96:99]
  ds_read_b128 v[208:211], v242 offset:17408
  v_mul_f32 v251, s70, v251
  v_mfma_f32_16x16x32_bf16 v[104:107], v[212:215], v[140:143], v[104:107]
  s_waitcnt lgkmcnt(2)
  v_cvt_pk_bf16_f32 v162, v162, v251
  v_accvgpr_read_b32 v163, a198
  v_mfma_f32_16x16x32_bf16 v[96:99], v[216:219], v[144:147], v[96:99]
  ds_read_b128 v[212:215], v241 offset:25600
  v_accvgpr_read_b32 v251, a199
  v_mfma_f32_16x16x32_bf16 v[104:107], v[216:219], v[148:151], v[104:107]
  v_mul_f32 v163, s70, v163
  v_mul_f32 v251, s70, v251
  v_mfma_f32_16x16x32_bf16 v[96:99], v[200:203], v[152:155], v[96:99]
  ds_read_b128 v[216:219], v242 offset:25600
  v_cvt_pk_bf16_f32 v163, v163, v251
  v_mfma_f32_16x16x32_bf16 v[104:107], v[200:203], v[156:159], v[104:107]
  s_waitcnt lgkmcnt(2)
  v_accvgpr_read_b32 v164, a200
  v_accvgpr_read_b32 v251, a201
  v_mfma_f32_16x16x32_bf16 v[100:103], v[204:207], v[128:131], v[192:195]
  ds_read_b128 v[200:203], v241 offset:18432
  v_mul_f32 v164, s70, v164
  v_mfma_f32_16x16x32_bf16 v[108:111], v[204:207], v[132:135], v[196:199]
  v_mul_f32 v251, s70, v251
  v_cvt_pk_bf16_f32 v164, v164, v251
  v_mfma_f32_16x16x32_bf16 v[100:103], v[208:211], v[136:139], v[100:103]
  ds_read_b128 v[204:207], v242 offset:18432
  v_max3_f32 v253, v96, v97, v98
  v_mfma_f32_16x16x32_bf16 v[108:111], v[208:211], v[140:143], v[108:111]
  s_waitcnt lgkmcnt(2)
  v_max3_f32 v253, v253, v99, v104
  v_max3_f32 v253, v253, v105, v106
  v_mfma_f32_16x16x32_bf16 v[100:103], v[212:215], v[144:147], v[100:103]
  ds_read_b128 v[208:211], v241 offset:26624
  v_accvgpr_read_b32 v165, a202
  v_mfma_f32_16x16x32_bf16 v[108:111], v[212:215], v[148:151], v[108:111]
  v_accvgpr_read_b32 v251, a203
  v_mul_f32 v165, s70, v165
  v_mfma_f32_16x16x32_bf16 v[100:103], v[216:219], v[152:155], v[100:103]
  ds_read_b128 v[212:215], v242 offset:26624
  v_mul_f32 v251, s70, v251
  v_mfma_f32_16x16x32_bf16 v[108:111], v[216:219], v[156:159], v[108:111]
  s_waitcnt lgkmcnt(2)
  v_cvt_pk_bf16_f32 v165, v165, v251
  v_accvgpr_read_b32 v166, a204
  v_mfma_f32_16x16x32_bf16 v[112:115], v[200:203], v[128:131], v[192:195]
  ds_read_b128 v[216:219], v241 offset:19456
  v_accvgpr_read_b32 v251, a205
  v_mfma_f32_16x16x32_bf16 v[120:123], v[200:203], v[132:135], v[196:199]
  v_mul_f32 v166, s70, v166
  v_mul_f32 v251, s70, v251
  v_mfma_f32_16x16x32_bf16 v[112:115], v[204:207], v[136:139], v[112:115]
  ds_read_b128 v[200:203], v242 offset:19456
  v_max3_f32 v253, v253, v107, v100
  v_mfma_f32_16x16x32_bf16 v[120:123], v[204:207], v[140:143], v[120:123]
  s_waitcnt lgkmcnt(2)
  v_max3_f32 v253, v253, v101, v102
  v_max3_f32 v253, v253, v103, v108
  v_mfma_f32_16x16x32_bf16 v[112:115], v[208:211], v[144:147], v[112:115]
  ds_read_b128 v[204:207], v241 offset:27648
  v_max3_f32 v253, v253, v109, v110
  v_mfma_f32_16x16x32_bf16 v[120:123], v[208:211], v[148:151], v[120:123]
  v_cvt_pk_bf16_f32 v166, v166, v251
  v_accvgpr_read_b32 v167, a206
  v_mfma_f32_16x16x32_bf16 v[112:115], v[212:215], v[152:155], v[112:115]
  ds_read_b128 v[208:211], v242 offset:27648
  v_accvgpr_read_b32 v251, a207
  v_mfma_f32_16x16x32_bf16 v[120:123], v[212:215], v[156:159], v[120:123]
  s_waitcnt lgkmcnt(2)
  v_mul_f32 v167, s70, v167
  v_mul_f32 v251, s70, v251
  v_mfma_f32_16x16x32_bf16 v[116:119], v[216:219], v[128:131], v[192:195]
  s_waitcnt vmcnt(15)
  s_barrier
  ds_read_b64_tr_b16 v[212:213], v247 offset:32768
  v_mfma_f32_16x16x32_bf16 v[124:127], v[216:219], v[132:135], v[196:199]
  ds_read_b64_tr_b16 v[214:215], v247 offset:33792
  v_cvt_pk_bf16_f32 v167, v167, v251
  v_mfma_f32_16x16x32_bf16 v[116:119], v[200:203], v[136:139], v[116:119]
  ds_read_b64_tr_b16 v[216:217], v248 offset:32768
  v_max3_f32 v253, v253, v111, v112
  v_mfma_f32_16x16x32_bf16 v[124:127], v[200:203], v[140:143], v[124:127]
  s_waitcnt lgkmcnt(3)
  ds_read_b64_tr_b16 v[218:219], v248 offset:33792
  v_max3_f32 v253, v253, v113, v114
  v_mfma_f32_16x16x32_bf16 v[116:119], v[204:207], v[144:147], v[116:119]
  ds_read_b64_tr_b16 v[200:201], v247 offset:33024
  v_max3_f32 v253, v253, v115, v120
  v_mfma_f32_16x16x32_bf16 v[124:127], v[204:207], v[148:151], v[124:127]
  ds_read_b64_tr_b16 v[202:203], v247 offset:34048
  v_max3_f32 v253, v253, v121, v122
  v_mfma_f32_16x16x32_bf16 v[116:119], v[208:211], v[152:155], v[116:119]
  ds_read_b64_tr_b16 v[204:205], v248 offset:33024
  v_accvgpr_read_b32 v168, a208
  v_mfma_f32_16x16x32_bf16 v[124:127], v[208:211], v[156:159], v[124:127]
  s_waitcnt lgkmcnt(3)
  ds_read_b64_tr_b16 v[206:207], v248 offset:34048
  v_accvgpr_read_b32 v251, a209
  v_mfma_f32_16x16x32_bf16 a[128:131], v[212:215], a[0:3], 0
  ds_read_b64_tr_b16 v[208:209], v247 offset:33280
  ds_read_b64_tr_b16 v[210:211], v247 offset:34304
  v_mfma_f32_16x16x32_bf16 a[136:139], v[212:215], a[4:7], 0
  buffer_load_dwordx4 v239, s[44:47], s82 offen offset:3072 lds
  v_mfma_f32_16x16x32_bf16 a[132:135], v[216:219], a[0:3], 0
  ds_read_b64_tr_b16 v[212:213], v248 offset:33280
  v_max3_f32 v253, v253, v123, v116
  v_mfma_f32_16x16x32_bf16 a[140:143], v[216:219], a[4:7], 0
  s_waitcnt lgkmcnt(3)
  ds_read_b64_tr_b16 v[214:215], v248 offset:34304
  v_max3_f32 v253, v253, v117, v118
  v_max3_f32 v253, v253, v119, v124
  v_mfma_f32_16x16x32_bf16 a[144:147], v[200:203], a[0:3], 0
  s_add_u32 m0, s68, 49152
  ds_read_b64_tr_b16 v[216:217], v247 offset:33536
  ds_read_b64_tr_b16 v[218:219], v247 offset:34560
  v_mfma_f32_16x16x32_bf16 a[152:155], v[200:203], a[4:7], 0
  buffer_load_dwordx4 v236, s[8:11], s91 offen nt lds
  v_mfma_f32_16x16x32_bf16 a[148:151], v[204:207], a[0:3], 0
  ds_read_b64_tr_b16 v[200:201], v248 offset:33536
  v_max3_f32 v253, v253, v125, v126
  v_mfma_f32_16x16x32_bf16 a[156:159], v[204:207], a[4:7], 0
  s_waitcnt lgkmcnt(3)
  ds_read_b64_tr_b16 v[202:203], v248 offset:34560
  v_max_f32 v253, v253, v127
  v_cmp_lt_f32 vcc, 0x41200000, v253
  v_mfma_f32_16x16x32_bf16 a[160:163], v[208:211], a[0:3], 0
  s_cbranch_vccnz L_r1_1t
L_r1_1:
  ds_read_b64_tr_b16 v[204:205], v247 offset:34816
  ds_read_b64_tr_b16 v[206:207], v247 offset:35840
  v_mfma_f32_16x16x32_bf16 a[168:171], v[208:211], a[4:7], 0
  buffer_load_dwordx4 v236, s[8:11], s91 offen offset:1024 nt lds
  v_mul_f32 v168, s70, v168
  v_mfma_f32_16x16x32_bf16 a[164:167], v[212:215], a[0:3], 0
  ds_read_b64_tr_b16 v[208:209], v248 offset:34816
  v_exp_f32 v96, v96
  v_mfma_f32_16x16x32_bf16 a[172:175], v[212:215], a[4:7], 0
  s_waitcnt lgkmcnt(3)
  ds_read_b64_tr_b16 v[210:211], v248 offset:35840
  v_mul_f32 v251, s70, v251
  v_mfma_f32_16x16x32_bf16 a[176:179], v[216:219], a[0:3], 0
  ds_read_b64_tr_b16 v[212:213], v247 offset:35072
  ds_read_b64_tr_b16 v[214:215], v247 offset:36096
  v_mfma_f32_16x16x32_bf16 a[184:187], v[216:219], a[4:7], 0
  buffer_load_dwordx4 v236, s[8:11], s91 offen offset:2048 nt lds
  v_cvt_pk_bf16_f32 v168, v168, v251
  v_mfma_f32_16x16x32_bf16 a[180:183], v[200:203], a[0:3], 0
  ds_read_b64_tr_b16 v[216:217], v248 offset:35072
  v_exp_f32 v97, v97
  v_mfma_f32_16x16x32_bf16 a[188:191], v[200:203], a[4:7], 0
  s_waitcnt lgkmcnt(3)
  ds_read_b64_tr_b16 v[218:219], v248 offset:36096
  v_cvt_pk_bf16_f32 v96, v96, v97
  v_mfma_f32_16x16x32_bf16 a[128:131], v[204:207], a[8:11], a[128:131]
  ds_read_b64_tr_b16 v[200:201], v247 offset:35328
  ds_read_b64_tr_b16 v[202:203], v247 offset:36352
  v_mfma_f32_16x16x32_bf16 a[136:139], v[204:207], a[12:15], a[136:139]
  buffer_load_dwordx4 v236, s[8:11], s91 offen offset:3072 nt lds
  v_accvgpr_read_b32 v169, a210
  v_mfma_f32_16x16x32_bf16 a[132:135], v[208:211], a[8:11], a[132:135]
  ds_read_b64_tr_b16 v[204:205], v248 offset:35328
  v_exp_f32 v98, v98
  v_mfma_f32_16x16x32_bf16 a[140:143], v[208:211], a[12:15], a[140:143]
  s_waitcnt lgkmcnt(3)
  ds_read_b64_tr_b16 v[206:207], v248 offset:36352
  v_accvgpr_read_b32 v251, a211
  v_mfma_f32_16x16x32_bf16 a[144:147], v[212:215], a[8:11], a[144:147]
  s_add_u32 m0, s68, 81920
  ds_read_b64_tr_b16 v[208:209], v247 offset:35584
  ds_read_b64_tr_b16 v[210:211], v247 offset:36608
  v_mfma_f32_16x16x32_bf16 a[152:155], v[212:215], a[12:15], a[152:155]
  buffer_load_dwordx4 v237, s[12:15], s91 offen nt lds
  v_mul_f32 v169, s70, v169
  v_mfma_f32_16x16x32_bf16 a[148:151], v[216:219], a[8:11], a[148:151]
  ds_read_b64_tr_b16 v[212:213], v248 offset:35584
  v_exp_f32 v99, v99
  v_mfma_f32_16x16x32_bf16 a[156:159], v[216:219], a[12:15], a[156:159]
  s_waitcnt lgkmcnt(3)
  ds_read_b64_tr_b16 v[214:215], v248 offset:36608
  v_cvt_pk_bf16_f32 v97, v98, v99
  v_mfma_f32_16x16x32_bf16 a[160:163], v[200:203], a[8:11], a[160:163]
  s_waitcnt vmcnt(9)
  s_barrier
  ds_read_b64_tr_b16 v[216:217], v247 offset:49152
  ds_read_b64_tr_b16 v[218:219], v247 offset:50176
  v_mfma_f32_16x16x32_bf16 a[168:171], v[200:203], a[12:15], a[168:171]
  buffer_load_dwordx4 v237, s[12:15], s91 offen offset:1024 nt lds
  v_mul_f32 v251, s70, v251
  v_mfma_f32_16x16x32_bf16 a[164:167], v[204:207], a[8:11], a[164:167]
  ds_read_b64_tr_b16 v[200:201], v248 offset:49152
  v_exp_f32 v100, v100
  v_mfma_f32_16x16x32_bf16 a[172:175], v[204:207], a[12:15], a[172:175]
  s_waitcnt lgkmcnt(3)
  ds_read_b64_tr_b16 v[202:203], v248 offset:50176
  v_cvt_pk_bf16_f32 v169, v169, v251
  v_mfma_f32_16x16x32_bf16 a[176:179], v[208:211], a[8:11], a[176:179]
  ds_read_b64_tr_b16 v[204:205], v247 offset:49408
  ds_read_b64_tr_b16 v[206:207], v247 offset:50432
  v_mfma_f32_16x16x32_bf16 a[184:187], v[208:211], a[12:15], a[184:187]
  buffer_load_dwordx4 v237, s[12:15], s91 offen offset:2048 nt lds
  v_accvgpr_read_b32 v170, a212
  v_mfma_f32_16x16x32_bf16 a[180:183], v[212:215], a[8:11], a[180:183]
  ds_read_b64_tr_b16 v[208:209], v248 offset:49408
  v_exp_f32 v101, v101
  v_mfma_f32_16x16x32_bf16 a[188:191], v[212:215], a[12:15], a[188:191]
  s_waitcnt lgkmcnt(3)
  ds_read_b64_tr_b16 v[210:211], v248 offset:50432
  v_cvt_pk_bf16_f32 v98, v100, v101
  v_mfma_f32_16x16x32_bf16 a[128:131], v[216:219], a[16:19], a[128:131]
  ds_read_b64_tr_b16 v[212:213], v247 offset:49664
  ds_read_b64_tr_b16 v[214:215], v247 offset:50688
  v_mfma_f32_16x16x32_bf16 a[136:139], v[216:219], a[20:23], a[136:139]
  buffer_load_dwordx4 v237, s[12:15], s91 offen offset:3072 nt lds
  v_accvgpr_read_b32 v251, a213
  v_mfma_f32_16x16x32_bf16 a[132:135], v[200:203], a[16:19], a[132:135]
  ds_read_b64_tr_b16 v[216:217], v248 offset:49664
  v_exp_f32 v102, v102
  v_mfma_f32_16x16x32_bf16 a[140:143], v[200:203], a[20:23], a[140:143]
  s_waitcnt lgkmcnt(3)
  ds_read_b64_tr_b16 v[218:219], v248 offset:50688
  v_mul_f32 v170, s70, v170
  v_mfma_f32_16x16x32_bf16 a[144:147], v[204:207], a[16:19], a[144:147]
  s_add_u32 m0, s68, 0
  ds_read_b64_tr_b16 v[200:201], v247 offset:49920
  ds_read_b64_tr_b16 v[202:203], v247 offset:50944
  v_mfma_f32_16x16x32_bf16 a[152:155], v[204:207], a[20:23], a[152:155]
  buffer_load_dwordx4 v236, s[8:11], s92 offen nt lds
  v_mul_f32 v251, s70, v251
  v_mfma_f32_16x16x32_bf16 a[148:151], v[208:211], a[16:19], a[148:151]
  ds_read_b64_tr_b16 v[204:205], v248 offset:49920
  v_exp_f32 v103, v103
  v_mfma_f32_16x16x32_bf16 a[156:159], v[208:211], a[20:23], a[156:159]
  s_waitcnt lgkmcnt(3)
  ds_read_b64_tr_b16 v[206:207], v248 offset:50944
  v_cvt_pk_bf16_f32 v99, v102, v103
  v_mfma_f32_16x16x32_bf16 a[160:163], v[212:215], a[16:19], a[160:163]
  ds_read_b64_tr_b16 v[208:209], v247 offset:51200
  ds_read_b64_tr_b16 v[210:211], v247 offset:52224
  v_mfma_f32_16x16x32_bf16 a[168:171], v[212:215], a[20:23], a[168:171]
  buffer_load_dwordx4 v236, s[8:11], s92 offen offset:1024 nt lds
  v_cvt_pk_bf16_f32 v170, v170, v251
  v_mfma_f32_16x16x32_bf16 v[224:227], v[220:223], v[96:99], v[224:227]
  v_exp_f32 v104, v104
  v_mfma_f32_16x16x32_bf16 a[164:167], v[216:219], a[16:19], a[164:167]
  ds_read_b64_tr_b16 v[212:213], v248 offset:51200
  v_exp_f32 v105, v105
  v_mfma_f32_16x16x32_bf16 a[172:175], v[216:219], a[20:23], a[172:175]
  s_waitcnt lgkmcnt(3)
  ds_read_b64_tr_b16 v[214:215], v248 offset:52224
  v_cvt_pk_bf16_f32 v100, v104, v105
  v_mfma_f32_16x16x32_bf16 a[176:179], v[200:203], a[16:19], a[176:179]
  ds_read_b64_tr_b16 v[216:217], v247 offset:51456
  v_exp_f32 v106, v106
  v_mfma_f32_16x16x32_bf16 a[184:187], v[200:203], a[20:23], a[184:187]
  ds_read_b64_tr_b16 v[218:219], v247 offset:52480
  v_accvgpr_read_b32 v171, a214
  v_mfma_f32_16x16x32_bf16 a[180:183], v[204:207], a[16:19], a[180:183]
  ds_read_b64_tr_b16 v[200:201], v248 offset:51456
  v_exp_f32 v107, v107
  v_mfma_f32_16x16x32_bf16 a[188:191], v[204:207], a[20:23], a[188:191]
  s_waitcnt lgkmcnt(3)
  ds_read_b64_tr_b16 v[202:203], v248 offset:52480
  v_cvt_pk_bf16_f32 v101, v106, v107
  v_accvgpr_read_b32 v251, a215
  v_mfma_f32_16x16x32_bf16 a[128:131], v[208:211], a[24:27], a[128:131]
  ds_read_b64_tr_b16 v[204:205], v247 offset:51712
  v_exp_f32 v108, v108
  v_mfma_f32_16x16x32_bf16 a[136:139], v[208:211], a[28:31], a[136:139]
  ds_read_b64_tr_b16 v[206:207], v247 offset:52736
  v_exp_f32 v109, v109
  v_mfma_f32_16x16x32_bf16 a[132:135], v[212:215], a[24:27], a[132:135]
  ds_read_b64_tr_b16 v[208:209], v248 offset:51712
  v_cvt_pk_bf16_f32 v102, v108, v109
  v_mfma_f32_16x16x32_bf16 a[140:143], v[212:215], a[28:31], a[140:143]
  s_waitcnt lgkmcnt(3)
  ds_read_b64_tr_b16 v[210:211], v248 offset:52736
  v_exp_f32 v110, v110
  v_mfma_f32_16x16x32_bf16 a[144:147], v[216:219], a[24:27], a[144:147]
  ds_read_b64_tr_b16 v[212:213], v247 offset:51968
  v_exp_f32 v111, v111
  v_mfma_f32_16x16x32_bf16 a[152:155], v[216:219], a[28:31], a[152:155]
  ds_read_b64_tr_b16 v[214:215], v247 offset:52992
  v_cvt_pk_bf16_f32 v103, v110, v111
  v_mul_f32 v171, s70, v171
  v_mfma_f32_16x16x32_bf16 a[148:151], v[200:203], a[24:27], a[148:151]
  ds_read_b64_tr_b16 v[216:217], v248 offset:51968
  v_exp_f32 v112, v112
  v_mfma_f32_16x16x32_bf16 a[156:159], v[200:203], a[28:31], a[156:159]
  s_waitcnt lgkmcnt(3)
  ds_read_b64_tr_b16 v[218:219], v248 offset:52992
  v_exp_f32 v113, v113
  v_mfma_f32_16x16x32_bf16 v[228:231], v[220:223], v[100:103], v[228:231]
  v_cvt_pk_bf16_f32 v104, v112, v113
  v_mul_f32 v251, s70, v251
  v_mfma_f32_16x16x32_bf16 a[160:163], v[204:207], a[24:27], a[160:163]
  s_waitcnt vmcnt(34)
  s_barrier
  ds_read_b64_tr_b16 v[200:201], v245 offset:0
  v_mfma_f32_16x16x32_bf16 a[168:171], v[204:207], a[28:31], a[168:171]
  ds_read_b64_tr_b16 v[202:203], v245 offset:1024
  v_cvt_pk_bf16_f32 v171, v171, v251
  v_mfma_f32_16x16x32_bf16 a[164:167], v[208:211], a[24:27], a[164:167]
  ds_read_b64_tr_b16 v[204:205], v246 offset:0
  v_exp_f32 v114, v114
  v_mfma_f32_16x16x32_bf16 a[172:175], v[208:211], a[28:31], a[172:175]
  s_waitcnt lgkmcnt(3)
  ds_read_b64_tr_b16 v[206:207], v246 offset:1024
  v_exp_f32 v115, v115
  v_mfma_f32_16x16x32_bf16 a[176:179], v[212:215], a[24:27], a[176:179]
  ds_read_b64_tr_b16 v[208:209], v245 offset:256
  v_cvt_pk_bf16_f32 v105, v114, v115
  v_mfma_f32_16x16x32_bf16 a[184:187], v[212:215], a[28:31], a[184:187]
  ds_read_b64_tr_b16 v[210:211], v245 offset:1280
  v_exp_f32 v116, v116
  v_mfma_f32_16x16x32_bf16 a[180:183], v[216:219], a[24:27], a[180:183]
  ds_read_b64_tr_b16 v[212:213], v246 offset:256
  v_exp_f32 v117, v117
  v_mfma_f32_16x16x32_bf16 a[188:191], v[216:219], a[28:31], a[188:191]
  s_waitcnt lgkmcnt(3)
  ds_read_b64_tr_b16 v[214:215], v246 offset:1280
  v_cvt_pk_bf16_f32 v106, v116, v117
  v_accvgpr_read_b32 v172, a216
  v_mfma_f32_16x16x32_bf16 v[32:35], v[200:203], v[96:99], v[32:35]
  ds_read_b64_tr_b16 v[216:217], v245 offset:512
  v_exp_f32 v118, v118
  v_mfma_f32_16x16x32_bf16 v[40:43], v[200:203], v[100:103], v[40:43]
  ds_read_b64_tr_b16 v[218:219], v245 offset:1536
  v_exp_f32 v119, v119
  v_mfma_f32_16x16x32_bf16 v[36:39], v[204:207], v[96:99], v[36:39]
  ds_read_b64_tr_b16 v[200:201], v246 offset:512
  v_cvt_pk_bf16_f32 v107, v118, v119
  v_mfma_f32_16x16x32_bf16 v[44:47], v[204:207], v[100:103], v[44:47]
  s_waitcnt lgkmcnt(3)
  ds_read_b64_tr_b16 v[202:203], v246 offset:1536
  v_exp_f32 v120, v120
  v_mfma_f32_16x16x32_bf16 v[224:227], v[220:223], v[104:107], v[224:227]
  v_exp_f32 v121, v121
  v_mfma_f32_16x16x32_bf16 v[48:51], v[208:211], v[96:99], v[48:51]
  ds_read_b64_tr_b16 v[204:205], v245 offset:768
  v_cvt_pk_bf16_f32 v108, v120, v121
  v_mfma_f32_16x16x32_bf16 v[56:59], v[208:211], v[100:103], v[56:59]
  ds_read_b64_tr_b16 v[206:207], v245 offset:1792
  v_exp_f32 v122, v122
  v_mfma_f32_16x16x32_bf16 v[52:55], v[212:215], v[96:99], v[52:55]
  ds_read_b64_tr_b16 v[208:209], v246 offset:768
  v_exp_f32 v123, v123
  v_mfma_f32_16x16x32_bf16 v[60:63], v[212:215], v[100:103], v[60:63]
  s_waitcnt lgkmcnt(3)
  ds_read_b64_tr_b16 v[210:211], v246 offset:1792
  v_cvt_pk_bf16_f32 v109, v122, v123
  v_mfma_f32_16x16x32_bf16 v[64:67], v[216:219], v[96:99], v[64:67]
  ds_read_b64_tr_b16 v[212:213], v245 offset:2048
  v_exp_f32 v124, v124
  v_mfma_f32_16x16x32_bf16 v[72:75], v[216:219], v[100:103], v[72:75]
  ds_read_b64_tr_b16 v[214:215], v245 offset:3072
  v_exp_f32 v125, v125
  v_mfma_f32_16x16x32_bf16 v[68:71], v[200:203], v[96:99], v[68:71]
  ds_read_b64_tr_b16 v[216:217], v246 offset:2048
  v_cvt_pk_bf16_f32 v110, v124, v125
  v_mfma_f32_16x16x32_bf16 v[76:79], v[200:203], v[100:103], v[76:79]
  s_waitcnt lgkmcnt(3)
  ds_read_b64_tr_b16 v[218:219], v246 offset:3072
  v_exp_f32 v126, v126
  v_mfma_f32_16x16x32_bf16 v[80:83], v[204:207], v[96:99], v[80:83]
  ds_read_b64_tr_b16 v[200:201], v245 offset:2304
  v_exp_f32 v127, v127
  v_mfma_f32_16x16x32_bf16 v[88:91], v[204:207], v[100:103], v[88:91]
  ds_read_b64_tr_b16 v[202:203], v245 offset:3328
  v_cvt_pk_bf16_f32 v111, v126, v127
  v_mfma_f32_16x16x32_bf16 v[84:87], v[208:211], v[96:99], v[84:87]
  ds_read_b64_tr_b16 v[204:205], v246 offset:2304
  v_accvgpr_read_b32 v251, a217
  v_mfma_f32_16x16x32_bf16 v[92:95], v[208:211], v[100:103], v[92:95]
  s_waitcnt lgkmcnt(3)
  ds_read_b64_tr_b16 v[206:207], v246 offset:3328
  v_mul_f32 v172, s70, v172
  v_mfma_f32_16x16x32_bf16 v[228:231], v[220:223], v[108:111], v[228:231]
  v_mul_f32 v251, s70, v251
  v_cvt_pk_bf16_f32 v172, v172, v251
  v_mfma_f32_16x16x32_bf16 v[32:35], v[212:215], v[104:107], v[32:35]
  ds_read_b64_tr_b16 v[208:209], v245 offset:2560
  ds_read_b64_tr_b16 v[210:211], v245 offset:3584
  v_mfma_f32_16x16x32_bf16 v[40:43], v[212:215], v[108:111], v[40:43]
  buffer_load_dwordx4 v236, s[8:11], s92 offen offset:2048 nt lds
  v_mfma_f32_16x16x32_bf16 v[36:39], v[216:219], v[104:107], v[36:39]
  ds_read_b64_tr_b16 v[212:213], v246 offset:2560
  v_accvgpr_read_b32 v173, a218
  v_mfma_f32_16x16x32_bf16 v[44:47], v[216:219], v[108:111], v[44:47]
  s_waitcnt lgkmcnt(3)
  ds_read_b64_tr_b16 v[214:215], v246 offset:3584
  v_accvgpr_read_b32 v251, a219
  v_mfma_f32_16x16x32_bf16 v[48:51], v[200:203], v[104:107], v[48:51]
  ds_read_b64_tr_b16 v[216:217], v245 offset:2816
  ds_read_b64_tr_b16 v[218:219], v245 offset:3840
  v_mfma_f32_16x16x32_bf16 v[56:59], v[200:203], v[108:111], v[56:59]
  buffer_load_dwordx4 v236, s[8:11], s92 offen offset:3072 nt lds
  v_mfma_f32_16x16x32_bf16 v[52:55], v[204:207], v[104:107], v[52:55]
  ds_read_b64_tr_b16 v[200:201], v246 offset:2816
  v_mul_f32 v173, s70, v173
  v_mfma_f32_16x16x32_bf16 v[60:63], v[204:207], v[108:111], v[60:63]
  s_waitcnt lgkmcnt(3)
  ds_read_b64_tr_b16 v[202:203], v246 offset:3840
  v_mul_f32 v251, s70, v251
  v_mfma_f32_16x16x32_bf16 v[64:67], v[208:211], v[104:107], v[64:67]
  s_waitcnt vmcnt(24)
  s_barrier
  s_add_u32 m0, s68, 131072
  ds_read_b128 v[204:207], v241 offset:32768
  v_mfma_f32_16x16x32_bf16 v[72:75], v[208:211], v[108:111], v[72:75]
  buffer_load_dwordx4 v239, s[32:35], s83 offen lds
  v_mfma_f32_16x16x32_bf16 v[68:71], v[212:215], v[104:107], v[68:71]
  ds_read_b128 v[208:211], v242 offset:32768
  v_cvt_pk_bf16_f32 v173, v173, v251
  v_mfma_f32_16x16x32_bf16 v[76:79], v[212:215], v[108:111], v[76:79]
  s_waitcnt lgkmcnt(2)
  v_accvgpr_read_b32 v174, a220
  v_accvgpr_read_b32 v251, a221
  v_mfma_f32_16x16x32_bf16 v[80:83], v[216:219], v[104:107], v[80:83]
  ds_read_b128 v[212:215], v241 offset:40960
  v_mul_f32 v174, s70, v174
  v_mfma_f32_16x16x32_bf16 v[88:91], v[216:219], v[108:111], v[88:91]
  buffer_load_dwordx4 v239, s[36:39], s83 offen offset:1024 lds
  v_mfma_f32_16x16x32_bf16 v[84:87], v[200:203], v[104:107], v[84:87]
  ds_read_b128 v[216:219], v242 offset:40960
  v_mul_f32 v251, s70, v251
  v_mfma_f32_16x16x32_bf16 v[92:95], v[200:203], v[108:111], v[92:95]
  s_waitcnt lgkmcnt(2)
  v_cvt_pk_bf16_f32 v174, v174, v251
  v_accvgpr_read_b32 v175, a222
  v_mfma_f32_16x16x32_bf16 v[96:99], v[204:207], v[128:131], v[192:195]
  ds_read_b128 v[200:203], v241 offset:33792
  v_accvgpr_read_b32 v251, a223
  v_mfma_f32_16x16x32_bf16 v[104:107], v[204:207], v[132:135], v[196:199]
  buffer_load_dwordx4 v239, s[40:43], s83 offen offset:2048 lds
  v_mfma_f32_16x16x32_bf16 v[96:99], v[208:211], v[136:139], v[96:99]
  ds_read_b128 v[204:207], v242 offset:33792
  v_mul_f32 v175, s70, v175
  v_mfma_f32_16x16x32_bf16 v[104:107], v[208:211], v[140:143], v[104:107]
  s_waitcnt lgkmcnt(2)
  v_mul_f32 v251, s70, v251
  v_cvt_pk_bf16_f32 v175, v175, v251
  v_mfma_f32_16x16x32_bf16 v[96:99], v[212:215], v[144:147], v[96:99]
  ds_read_b128 v[208:211], v241 offset:41984
  v_accvgpr_read_b32 v176, a224
  v_mfma_f32_16x16x32_bf16 v[104:107], v[212:215], v[148:151], v[104:107]
  s_cmp_lg_u32 s68, 0
  s_cbranch_scc1 L_noat
  s_mov_b64 exec, 1
  v_mov_b32 v254, 4
  global_atomic_add v254, v254, s[0:1] offset:-4 sc1
  s_mov_b64 exec, -1
L_noat:
  v_mfma_f32_16x16x32_bf16 v[96:99], v[216:219], v[152:155], v[96:99]
  ds_read_b128 v[212:215], v242 offset:41984
  v_accvgpr_read_b32 v251, a225
  v_mfma_f32_16x16x32_bf16 v[104:107], v[216:219], v[156:159], v[104:107]
  s_waitcnt lgkmcnt(2)
  v_mul_f32 v176, s70, v176
  v_mul_f32 v251, s70, v251
  v_mfma_f32_16x16x32_bf16 v[100:103], v[200:203], v[128:131], v[192:195]
  ds_read_b128 v[216:219], v241 offset:34816
  v_cvt_pk_bf16_f32 v176, v176, v251
  v_mfma_f32_16x16x32_bf16 v[108:111], v[200:203], v[132:135], v[196:199]
  buffer_load_dwordx4 v239, s[44:47], s83 offen offset:3072 lds
  v_mfma_f32_16x16x32_bf16 v[100:103], v[204:207], v[136:139], v[100:103]
  ds_read_b128 v[200:203], v242 offset:34816
  v_max3_f32 v253, v96, v97, v98
  v_mfma_f32_16x16x32_bf16 v[108:111], v[204:207], v[140:143], v[108:111]
  s_waitcnt lgkmcnt(2)
  v_max3_f32 v253, v253, v99, v104
  v_max3_f32 v253, v253, v105, v106
  v_mfma_f32_16x16x32_bf16 v[100:103], v[208:211], v[144:147], v[100:103]
  ds_read_b128 v[204:207], v241 offset:43008
  v_accvgpr_read_b32 v177, a226
  v_mfma_f32_16x16x32_bf16 v[108:111], v[208:211], v[148:151], v[108:111]
  v_accvgpr_read_b32 v251, a227
  v_mul_f32 v177, s70, v177
  v_mfma_f32_16x16x32_bf16 v[100:103], v[212:215], v[152:155], v[100:103]
  ds_read_b128 v[208:211], v242 offset:43008
  v_mul_f32 v251, s70, v251
  v_mfma_f32_16x16x32_bf16 v[108:111], v[212:215], v[156:159], v[108:111]
  s_waitcnt lgkmcnt(2)
  v_cvt_pk_bf16_f32 v177, v177, v251
  v_accvgpr_read_b32 v178, a228
  v_mfma_f32_16x16x32_bf16 v[112:115], v[216:219], v[128:131], v[192:195]
  ds_read_b128 v[212:215], v241 offset:35840
  v_accvgpr_read_b32 v251, a229
  v_mfma_f32_16x16x32_bf16 v[120:123], v[216:219], v[132:135], v[196:199]
  v_mul_f32 v178, s70, v178
  v_mul_f32 v251, s70, v251
  v_mfma_f32_16x16x32_bf16 v[112:115], v[200:203], v[136:139], v[112:115]
  ds_read_b128 v[216:219], v242 offset:35840
  v_max3_f32 v253, v253, v107, v100
  v_mfma_f32_16x16x32_bf16 v[120:123], v[200:203], v[140:143], v[120:123]
  s_waitcnt lgkmcnt(2)
  v_max3_f32 v253, v253, v101, v102
  v_max3_f32 v253, v253, v103, v108
  v_mfma_f32_16x16x32_bf16 v[112:115], v[204:207], v[144:147], v[112:115]
  ds_read_b128 v[200:203], v241 offset:44032
  v_max3_f32 v253, v253, v109, v110
  v_mfma_f32_16x16x32_bf16 v[120:123], v[204:207], v[148:151], v[120:123]
  v_cvt_pk_bf16_f32 v178, v178, v251
  v_accvgpr_read_b32 v179, a230
  v_mfma_f32_16x16x32_bf16 v[112:115], v[208:211], v[152:155], v[112:115]
  ds_read_b128 v[204:207], v242 offset:44032
  v_accvgpr_read_b32 v251, a231
  v_mfma_f32_16x16x32_bf16 v[120:123], v[208:211], v[156:159], v[120:123]
  s_waitcnt lgkmcnt(2)
  v_mul_f32 v179, s70, v179
  v_mul_f32 v251, s70, v251
  v_mfma_f32_16x16x32_bf16 v[116:119], v[212:215], v[128:131], v[192:195]
  s_waitcnt vmcnt(16)
  s_barrier
  ds_read_b64_tr_b16 v[208:209], v247 offset:16384
  v_mfma_f32_16x16x32_bf16 v[124:127], v[212:215], v[132:135], v[196:199]
  ds_read_b64_tr_b16 v[210:211], v247 offset:17408
  v_cvt_pk_bf16_f32 v179, v179, v251
  v_mfma_f32_16x16x32_bf16 v[116:119], v[216:219], v[136:139], v[116:119]
  ds_read_b64_tr_b16 v[212:213], v248 offset:16384
  v_max3_f32 v253, v253, v111, v112
  v_mfma_f32_16x16x32_bf16 v[124:127], v[216:219], v[140:143], v[124:127]
  s_waitcnt lgkmcnt(3)
  ds_read_b64_tr_b16 v[214:215], v248 offset:17408
  v_max3_f32 v253, v253, v113, v114
  v_mfma_f32_16x16x32_bf16 v[116:119], v[200:203], v[144:147], v[116:119]
  ds_read_b64_tr_b16 v[216:217], v247 offset:16640
  v_max3_f32 v253, v253, v115, v120
  v_mfma_f32_16x16x32_bf16 v[124:127], v[200:203], v[148:151], v[124:127]
  ds_read_b64_tr_b16 v[218:219], v247 offset:17664
  v_max3_f32 v253, v253, v121, v122
  v_mfma_f32_16x16x32_bf16 v[116:119], v[204:207], v[152:155], v[116:119]
  ds_read_b64_tr_b16 v[200:201], v248 offset:16640
  v_accvgpr_read_b32 v180, a232
  v_mfma_f32_16x16x32_bf16 v[124:127], v[204:207], v[156:159], v[124:127]
  s_waitcnt lgkmcnt(3)
  ds_read_b64_tr_b16 v[202:203], v248 offset:17664
  v_accvgpr_read_b32 v251, a233
  v_mfma_f32_16x16x32_bf16 a[128:131], v[208:211], a[32:35], a[128:131]
  ds_read_b64_tr_b16 v[204:205], v247 offset:16896
  v_mul_f32 v180, s70, v180
  v_mfma_f32_16x16x32_bf16 a[136:139], v[208:211], a[36:39], a[136:139]
  ds_read_b64_tr_b16 v[206:207], v247 offset:17920
  v_mul_f32 v251, s70, v251
  v_mfma_f32_16x16x32_bf16 a[132:135], v[212:215], a[32:35], a[132:135]
  ds_read_b64_tr_b16 v[208:209], v248 offset:16896
  v_max3_f32 v253, v253, v123, v116
  v_mfma_f32_16x16x32_bf16 a[140:143], v[212:215], a[36:39], a[140:143]
  s_waitcnt lgkmcnt(3)
  ds_read_b64_tr_b16 v[210:211], v248 offset:17920
  v_max3_f32 v253, v253, v117, v118
  v_max3_f32 v253, v253, v119, v124
  v_mfma_f32_16x16x32_bf16 a[144:147], v[216:219], a[32:35], a[144:147]
  ds_read_b64_tr_b16 v[212:213], v247 offset:17152
  v_max3_f32 v253, v253, v125, v126
  v_mfma_f32_16x16x32_bf16 a[152:155], v[216:219], a[36:39], a[152:155]
  ds_read_b64_tr_b16 v[214:215], v247 offset:18176
  v_max_f32 v253, v253, v127
  v_mfma_f32_16x16x32_bf16 a[148:151], v[200:203], a[32:35], a[148:151]
  ds_read_b64_tr_b16 v[216:217], v248 offset:17152
  v_cmp_lt_f32 vcc, 0x41200000, v253
  v_mfma_f32_16x16x32_bf16 a[156:159], v[200:203], a[36:39], a[156:159]
  s_waitcnt lgkmcnt(3)
  s_cbranch_vccnz L_r1_2t
L_r1_2:
  ds_read_b64_tr_b16 v[218:219], v248 offset:18176
  v_mfma_f32_16x16x32_bf16 a[160:163], v[204:207], a[32:35], a[160:163]
  ds_read_b64_tr_b16 v[200:201], v247 offset:18432
  v_exp_f32 v96, v96
  v_mfma_f32_16x16x32_bf16 a[168:171], v[204:207], a[36:39], a[168:171]
  ds_read_b64_tr_b16 v[202:203], v247 offset:19456
  v_cvt_pk_bf16_f32 v180, v180, v251
  v_mfma_f32_16x16x32_bf16 a[164:167], v[208:211], a[32:35], a[164:167]
  ds_read_b64_tr_b16 v[204:205], v248 offset:18432
  v_exp_f32 v97, v97
  v_mfma_f32_16x16x32_bf16 a[172:175], v[208:211], a[36:39], a[172:175]
  s_waitcnt lgkmcnt(3)
  ds_read_b64_tr_b16 v[206:207], v248 offset:19456
  v_cvt_pk_bf16_f32 v96, v96, v97
  v_mfma_f32_16x16x32_bf16 a[176:179], v[212:215], a[32:35], a[176:179]
  ds_read_b64_tr_b16 v[208:209], v247 offset:18688
  v_exp_f32 v98, v98
  v_mfma_f32_16x16x32_bf16 a[184:187], v[212:215], a[36:39], a[184:187]
  ds_read_b64_tr_b16 v[210:211], v247 offset:19712
  v_accvgpr_read_b32 v181, a234
  v_mfma_f32_16x16x32_bf16 a[180:183], v[216:219], a[32:35], a[180:183]
  ds_read_b64_tr_b16 v[212:213], v248 offset:18688
  v_exp_f32 v99, v99
  v_mfma_f32_16x16x32_bf16 a[188:191], v[216:219], a[36:39], a[188:191]
  s_waitcnt lgkmcnt(3)
  ds_read_b64_tr_b16 v[214:215], v248 offset:19712
  v_cvt_pk_bf16_f32 v97, v98, v99
  v_mfma_f32_16x16x32_bf16 a[128:131], v[200:203], a[40:43], a[128:131]
  ds_read_b64_tr_b16 v[216:217], v247 offset:18944
  v_exp_f32 v100, v100
  v_mfma_f32_16x16x32_bf16 a[136:139], v[200:203], a[44:47], a[136:139]
  ds_read_b64_tr_b16 v[218:219], v247 offset:19968
  v_accvgpr_read_b32 v251, a235
  v_mfma_f32_16x16x32_bf16 a[132:135], v[204:207], a[40:43], a[132:135]
  ds_read_b64_tr_b16 v[200:201], v248 offset:18944
  v_exp_f32 v101, v101
  v_mfma_f32_16x16x32_bf16 a[140:143], v[204:207], a[44:47], a[140:143]
  s_waitcnt lgkmcnt(3)
  ds_read_b64_tr_b16 v[202:203], v248 offset:19968
  v_cvt_pk_bf16_f32 v98, v100, v101
  v_mfma_f32_16x16x32_bf16 a[144:147], v[208:211], a[40:43], a[144:147]
  ds_read_b64_tr_b16 v[204:205], v247 offset:19200
  ds_read_b64_tr_b16 v[206:207], v247 offset:20224
  v_mfma_f32_16x16x32_bf16 a[152:155], v[208:211], a[44:47], a[152:155]
  v_exp_f32 v102, v102
  v_mfma_f32_16x16x32_bf16 a[148:151], v[212:215], a[40:43], a[148:151]
  ds_read_b64_tr_b16 v[208:209], v248 offset:19200
  ds_read_b64_tr_b16 v[210:211], v248 offset:20224
  v_mfma_f32_16x16x32_bf16 a[156:159], v[212:215], a[44:47], a[156:159]
  s_waitcnt lgkmcnt(4)
  v_exp_f32 v103, v103
  v_mfma_f32_16x16x32_bf16 a[160:163], v[216:219], a[40:43], a[160:163]
  s_waitcnt vmcnt(0)
  s_barrier
  s_add_u32 m0, s68, 147456
  ds_read_b64_tr_b16 v[212:213], v247 offset:32768
  ds_read_b64_tr_b16 v[214:215], v247 offset:33792
  v_mfma_f32_16x16x32_bf16 a[168:171], v[216:219], a[44:47], a[168:171]
  buffer_load_dwordx4 v239, s[32:35], s84 offen lds
  v_cvt_pk_bf16_f32 v99, v102, v103
  v_mfma_f32_16x16x32_bf16 a[164:167], v[200:203], a[40:43], a[164:167]
  ds_read_b64_tr_b16 v[216:217], v248 offset:32768
  v_exp_f32 v104, v104
  v_mfma_f32_16x16x32_bf16 a[172:175], v[200:203], a[44:47], a[172:175]
  s_waitcnt lgkmcnt(3)
  ds_read_b64_tr_b16 v[218:219], v248 offset:33792
  v_mul_f32 v181, s70, v181
  v_mfma_f32_16x16x32_bf16 v[224:227], v[220:223], v[96:99], v[224:227]
  v_exp_f32 v105, v105
  v_mfma_f32_16x16x32_bf16 a[176:179], v[204:207], a[40:43], a[176:179]
  ds_read_b64_tr_b16 v[200:201], v247 offset:33024
  ds_read_b64_tr_b16 v[202:203], v247 offset:34048
  v_mfma_f32_16x16x32_bf16 a[184:187], v[204:207], a[44:47], a[184:187]
  buffer_load_dwordx4 v239, s[36:39], s84 offen offset:1024 lds
  v_mfma_f32_16x16x32_bf16 a[180:183], v[208:211], a[40:43], a[180:183]
  ds_read_b64_tr_b16 v[204:205], v248 offset:33024
  v_cvt_pk_bf16_f32 v100, v104, v105
  v_mfma_f32_16x16x32_bf16 a[188:191], v[208:211], a[44:47], a[188:191]
  s_waitcnt lgkmcnt(3)
  ds_read_b64_tr_b16 v[206:207], v248 offset:34048
  v_exp_f32 v106, v106
  v_mfma_f32_16x16x32_bf16 a[128:131], v[212:215], a[48:51], a[128:131]
  ds_read_b64_tr_b16 v[208:209], v247 offset:33280
  ds_read_b64_tr_b16 v[210:211], v247 offset:34304
  v_mfma_f32_16x16x32_bf16 a[136:139], v[212:215], a[52:55], a[136:139]
  buffer_load_dwordx4 v239, s[40:43], s84 offen offset:2048 lds
  v_mul_f32 v251, s70, v251
  v_mfma_f32_16x16x32_bf16 a[132:135], v[216:219], a[48:51], a[132:135]
  ds_read_b64_tr_b16 v[212:213], v248 offset:33280
  v_exp_f32 v107, v107
  v_mfma_f32_16x16x32_bf16 a[140:143], v[216:219], a[52:55], a[140:143]
  s_waitcnt lgkmcnt(3)
  ds_read_b64_tr_b16 v[214:215], v248 offset:34304
  v_cvt_pk_bf16_f32 v101, v106, v107
  v_mfma_f32_16x16x32_bf16 a[144:147], v[200:203], a[48:51], a[144:147]
  ds_read_b64_tr_b16 v[216:217], v247 offset:33536
  ds_read_b64_tr_b16 v[218:219], v247 offset:34560
  v_mfma_f32_16x16x32_bf16 a[152:155], v[200:203], a[52:55], a[152:155]
  buffer_load_dwordx4 v239, s[44:47], s84 offen offset:3072 lds
  v_cvt_pk_bf16_f32 v181, v181, v251
  v_mfma_f32_16x16x32_bf16 a[148:151], v[204:207], a[48:51], a[148:151]
  ds_read_b64_tr_b16 v[200:201], v248 offset:33536
  v_exp_f32 v108, v108
  v_mfma_f32_16x16x32_bf16 a[156:159], v[204:207], a[52:55], a[156:159]
  s_waitcnt lgkmcnt(3)
  ds_read_b64_tr_b16 v[202:203], v248 offset:34560
  v_accvgpr_read_b32 v182, a236
  v_mfma_f32_16x16x32_bf16 a[160:163], v[208:211], a[48:51], a[160:163]
  s_add_u32 m0, s68, 65536
  ds_read_b64_tr_b16 v[204:205], v247 offset:34816
  ds_read_b64_tr_b16 v[206:207], v247 offset:35840
  v_mfma_f32_16x16x32_bf16 a[168:171], v[208:211], a[52:55], a[168:171]
  buffer_load_dwordx4 v237, s[12:15], s92 offen nt lds
  v_accvgpr_read_b32 v251, a237
  v_mfma_f32_16x16x32_bf16 a[164:167], v[212:215], a[48:51], a[164:167]
  ds_read_b64_tr_b16 v[208:209], v248 offset:34816
  v_exp_f32 v109, v109
  v_mfma_f32_16x16x32_bf16 a[172:175], v[212:215], a[52:55], a[172:175]
  s_waitcnt lgkmcnt(3)
  ds_read_b64_tr_b16 v[210:211], v248 offset:35840
  v_cvt_pk_bf16_f32 v102, v108, v109
  v_mfma_f32_16x16x32_bf16 a[176:179], v[216:219], a[48:51], a[176:179]
  ds_read_b64_tr_b16 v[212:213], v247 offset:35072
  ds_read_b64_tr_b16 v[214:215], v247 offset:36096
  v_mfma_f32_16x16x32_bf16 a[184:187], v[216:219], a[52:55], a[184:187]
  buffer_load_dwordx4 v237, s[12:15], s92 offen offset:1024 nt lds
  v_mul_f32 v182, s70, v182
  v_mfma_f32_16x16x32_bf16 a[180:183], v[200:203], a[48:51], a[180:183]
  ds_read_b64_tr_b16 v[216:217], v248 offset:35072
  v_exp_f32 v110, v110
  v_mfma_f32_16x16x32_bf16 a[188:191], v[200:203], a[52:55], a[188:191]
  s_waitcnt lgkmcnt(3)
  ds_read_b64_tr_b16 v[218:219], v248 offset:36096
  v_mul_f32 v251, s70, v251
  v_mfma_f32_16x16x32_bf16 a[128:131], v[204:207], a[56:59], a[128:131]
  ds_read_b64_tr_b16 v[200:201], v247 offset:35328
  ds_read_b64_tr_b16 v[202:203], v247 offset:36352
  v_mfma_f32_16x16x32_bf16 a[136:139], v[204:207], a[60:63], a[136:139]
  buffer_load_dwordx4 v237, s[12:15], s92 offen offset:2048 nt lds
  v_cvt_pk_bf16_f32 v182, v182, v251
  v_mfma_f32_16x16x32_bf16 a[132:135], v[208:211], a[56:59], a[132:135]
  ds_read_b64_tr_b16 v[204:205], v248 offset:35328
  v_exp_f32 v111, v111
  v_mfma_f32_16x16x32_bf16 a[140:143], v[208:211], a[60:63], a[140:143]
  s_waitcnt lgkmcnt(3)
  ds_read_b64_tr_b16 v[206:207], v248 offset:36352
  v_cvt_pk_bf16_f32 v103, v110, v111
  v_mfma_f32_16x16x32_bf16 a[144:147], v[212:215], a[56:59], a[144:147]
  ds_read_b64_tr_b16 v[208:209], v247 offset:35584
  ds_read_b64_tr_b16 v[210:211], v247 offset:36608
  v_mfma_f32_16x16x32_bf16 a[152:155], v[212:215], a[60:63], a[152:155]
  buffer_load_dwordx4 v237, s[12:15], s92 offen offset:3072 nt lds
  v_accvgpr_read_b32 v183, a238
  v_mfma_f32_16x16x32_bf16 v[228:231], v[220:223], v[100:103], v[228:231]
  v_exp_f32 v112, v112
  v_mfma_f32_16x16x32_bf16 a[148:151], v[216:219], a[56:59], a[148:151]
  ds_read_b64_tr_b16 v[212:213], v248 offset:35584
  v_exp_f32 v113, v113
  v_mfma_f32_16x16x32_bf16 a[156:159], v[216:219], a[60:63], a[156:159]
  s_waitcnt lgkmcnt(3)
  ds_read_b64_tr_b16 v[214:215], v248 offset:36608
  v_cvt_pk_bf16_f32 v104, v112, v113
  v_mfma_f32_16x16x32_bf16 a[160:163], v[200:203], a[56:59], a[160:163]
  s_waitcnt vmcnt(32)
  s_barrier
  s_add_u32 m0, s68, 114688
  ds_read_b64_tr_b16 v[216:217], v245 offset:32768
  ds_read_b64_tr_b16 v[218:219], v245 offset:33792
  v_mfma_f32_16x16x32_bf16 a[168:171], v[200:203], a[60:63], a[168:171]
  buffer_load_dwordx4 v239, s[32:35], s85 offen lds
  v_accvgpr_read_b32 v251, a239
  v_mfma_f32_16x16x32_bf16 a[164:167], v[204:207], a[56:59], a[164:167]
  ds_read_b64_tr_b16 v[200:201], v246 offset:32768
  v_exp_f32 v114, v114
  v_mfma_f32_16x16x32_bf16 a[172:175], v[204:207], a[60:63], a[172:175]
  s_waitcnt lgkmcnt(3)
  ds_read_b64_tr_b16 v[202:203], v246 offset:33792
  v_exp_f32 v115, v115
  v_mfma_f32_16x16x32_bf16 a[176:179], v[208:211], a[56:59], a[176:179]
  ds_read_b64_tr_b16 v[204:205], v245 offset:33024
  ds_read_b64_tr_b16 v[206:207], v245 offset:34048
  v_mfma_f32_16x16x32_bf16 a[184:187], v[208:211], a[60:63], a[184:187]
  buffer_load_dwordx4 v239, s[36:39], s85 offen offset:1024 lds
  v_cvt_pk_bf16_f32 v105, v114, v115
  v_mfma_f32_16x16x32_bf16 a[180:183], v[212:215], a[56:59], a[180:183]
  ds_read_b64_tr_b16 v[208:209], v246 offset:33024
  v_exp_f32 v116, v116
  v_mfma_f32_16x16x32_bf16 a[188:191], v[212:215], a[60:63], a[188:191]
  s_waitcnt lgkmcnt(3)
  ds_read_b64_tr_b16 v[210:211], v246 offset:34048
  v_exp_f32 v117, v117
  v_mfma_f32_16x16x32_bf16 v[32:35], v[216:219], v[96:99], v[32:35]
  ds_read_b64_tr_b16 v[212:213], v245 offset:33280
  ds_read_b64_tr_b16 v[214:215], v245 offset:34304
  v_mfma_f32_16x16x32_bf16 v[40:43], v[216:219], v[100:103], v[40:43]
  buffer_load_dwordx4 v239, s[40:43], s85 offen offset:2048 lds
  v_cvt_pk_bf16_f32 v106, v116, v117
  v_mfma_f32_16x16x32_bf16 v[36:39], v[200:203], v[96:99], v[36:39]
  ds_read_b64_tr_b16 v[216:217], v246 offset:33280
  v_exp_f32 v118, v118
  v_mfma_f32_16x16x32_bf16 v[44:47], v[200:203], v[100:103], v[44:47]
  s_waitcnt lgkmcnt(3)
  ds_read_b64_tr_b16 v[218:219], v246 offset:34304
  v_exp_f32 v119, v119
  v_mfma_f32_16x16x32_bf16 v[48:51], v[204:207], v[96:99], v[48:51]
  ds_read_b64_tr_b16 v[200:201], v245 offset:33536
  ds_read_b64_tr_b16 v[202:203], v245 offset:34560
  v_mfma_f32_16x16x32_bf16 v[56:59], v[204:207], v[100:103], v[56:59]
  buffer_load_dwordx4 v239, s[44:47], s85 offen offset:3072 lds
  v_cvt_pk_bf16_f32 v107, v118, v119
  v_mfma_f32_16x16x32_bf16 v[52:55], v[208:211], v[96:99], v[52:55]
  ds_read_b64_tr_b16 v[204:205], v246 offset:33536
  v_exp_f32 v120, v120
  v_mfma_f32_16x16x32_bf16 v[60:63], v[208:211], v[100:103], v[60:63]
  s_waitcnt lgkmcnt(3)
  ds_read_b64_tr_b16 v[206:207], v246 offset:34560
  v_exp_f32 v121, v121
  v_mfma_f32_16x16x32_bf16 v[224:227], v[220:223], v[104:107], v[224:227]
  v_cvt_pk_bf16_f32 v108, v120, v121
  v_mul_f32 v183, s70, v183
  v_mfma_f32_16x16x32_bf16 v[64:67], v[212:215], v[96:99], v[64:67]
  s_add_u32 m0, s68, 16384
  ds_read_b64_tr_b16 v[208:209], v245 offset:34816
  ds_read_b64_tr_b16 v[210:211], v245 offset:35840
  v_mfma_f32_16x16x32_bf16 v[72:75], v[212:215], v[100:103], v[72:75]
  buffer_load_dwordx4 v236, s[8:11], s93 offen nt lds
  v_mul_f32 v251, s70, v251
  v_mfma_f32_16x16x32_bf16 v[68:71], v[216:219], v[96:99], v[68:71]
  ds_read_b64_tr_b16 v[212:213], v246 offset:34816
  v_exp_f32 v122, v122
  v_mfma_f32_16x16x32_bf16 v[76:79], v[216:219], v[100:103], v[76:79]
  s_waitcnt lgkmcnt(3)
  ds_read_b64_tr_b16 v[214:215], v246 offset:35840
  v_exp_f32 v123, v123
  v_mfma_f32_16x16x32_bf16 v[80:83], v[200:203], v[96:99], v[80:83]
  ds_read_b64_tr_b16 v[216:217], v245 offset:35072
  ds_read_b64_tr_b16 v[218:219], v245 offset:36096
  v_mfma_f32_16x16x32_bf16 v[88:91], v[200:203], v[100:103], v[88:91]
  buffer_load_dwordx4 v236, s[8:11], s93 offen offset:1024 nt lds
  v_cvt_pk_bf16_f32 v109, v122, v123
  v_exp_f32 v124, v124
  v_exp_f32 v125, v125
  v_exp_f32 v126, v126
  v_cvt_pk_bf16_f32 v110, v124, v125
  v_exp_f32 v127, v127
  v_cvt_pk_bf16_f32 v183, v183, v251
  v_cvt_pk_bf16_f32 v111, v126, v127
  v_mfma_f32_16x16x32_bf16 v[84:87], v[204:207], v[96:99], v[84:87]
  ds_read_b64_tr_b16 v[200:201], v246 offset:35072
  v_accvgpr_read_b32 v184, a240
  v_mfma_f32_16x16x32_bf16 v[92:95], v[204:207], v[100:103], v[92:95]
  s_waitcnt lgkmcnt(3)
  ds_read_b64_tr_b16 v[202:203], v246 offset:36096
  v_accvgpr_read_b32 v251, a241
  v_mfma_f32_16x16x32_bf16 v[228:231], v[220:223], v[108:111], v[228:231]
  v_mul_f32 v184, s70, v184
  v_mul_f32 v251, s70, v251
  v_mfma_f32_16x16x32_bf16 v[32:35], v[208:211], v[104:107], v[32:35]
  ds_read_b64_tr_b16 v[204:205], v245 offset:35328
  v_cvt_pk_bf16_f32 v184, v184, v251
  v_mfma_f32_16x16x32_bf16 v[40:43], v[208:211], v[108:111], v[40:43]
  ds_read_b64_tr_b16 v[206:207], v245 offset:36352
  v_accvgpr_read_b32 v185, a242
  v_mfma_f32_16x16x32_bf16 v[36:39], v[212:215], v[104:107], v[36:39]
  ds_read_b64_tr_b16 v[208:209], v246 offset:35328
  v_accvgpr_read_b32 v251, a243
  v_mfma_f32_16x16x32_bf16 v[44:47], v[212:215], v[108:111], v[44:47]
  s_waitcnt lgkmcnt(3)
  ds_read_b64_tr_b16 v[210:211], v246 offset:36352
  v_mul_f32 v185, s70, v185
  v_mfma_f32_16x16x32_bf16 v[48:51], v[216:219], v[104:107], v[48:51]
  ds_read_b64_tr_b16 v[212:213], v245 offset:35584
  v_mul_f32 v251, s70, v251
  v_mfma_f32_16x16x32_bf16 v[56:59], v[216:219], v[108:111], v[56:59]
  ds_read_b64_tr_b16 v[214:215], v245 offset:36608
  v_cvt_pk_bf16_f32 v185, v185, v251
  v_mfma_f32_16x16x32_bf16 v[52:55], v[200:203], v[104:107], v[52:55]
  ds_read_b64_tr_b16 v[216:217], v246 offset:35584
  v_accvgpr_read_b32 v186, a244
  v_mfma_f32_16x16x32_bf16 v[60:63], v[200:203], v[108:111], v[60:63]
  s_waitcnt lgkmcnt(3)
  ds_read_b64_tr_b16 v[218:219], v246 offset:36608
  v_accvgpr_read_b32 v251, a245
  v_mfma_f32_16x16x32_bf16 v[64:67], v[204:207], v[104:107], v[64:67]
  s_waitcnt vmcnt(26)
  s_barrier
  ds_read_b128 v[200:203], v241 offset:49152
  v_mfma_f32_16x16x32_bf16 v[72:75], v[204:207], v[108:111], v[72:75]
  v_mul_f32 v186, s70, v186
  v_mul_f32 v251, s70, v251
  v_mfma_f32_16x16x32_bf16 v[68:71], v[208:211], v[104:107], v[68:71]
  ds_read_b128 v[204:207], v242 offset:49152
  v_cvt_pk_bf16_f32 v186, v186, v251
  v_mfma_f32_16x16x32_bf16 v[76:79], v[208:211], v[108:111], v[76:79]
  s_waitcnt lgkmcnt(2)
  v_accvgpr_read_b32 v187, a246
  v_accvgpr_read_b32 v251, a247
  v_mfma_f32_16x16x32_bf16 v[80:83], v[212:215], v[104:107], v[80:83]
  ds_read_b128 v[208:211], v241 offset:57344
  v_mul_f32 v187, s70, v187
  v_mfma_f32_16x16x32_bf16 v[88:91], v[212:215], v[108:111], v[88:91]
  v_mul_f32 v251, s70, v251
  v_cvt_pk_bf16_f32 v187, v187, v251
  v_mfma_f32_16x16x32_bf16 v[84:87], v[216:219], v[104:107], v[84:87]
  ds_read_b128 v[212:215], v242 offset:57344
  v_accvgpr_read_b32 v188, a248
  v_mfma_f32_16x16x32_bf16 v[92:95], v[216:219], v[108:111], v[92:95]
  s_waitcnt lgkmcnt(2)
  v_accvgpr_read_b32 v251, a249
  v_mul_f32 v188, s70, v188
  v_mfma_f32_16x16x32_bf16 v[96:99], v[200:203], v[128:131], v[192:195]
  ds_read_b128 v[216:219], v241 offset:50176
  v_mul_f32 v251, s70, v251
  v_mfma_f32_16x16x32_bf16 v[104:107], v[200:203], v[132:135], v[196:199]
  v_cvt_pk_bf16_f32 v188, v188, v251
  v_accvgpr_read_b32 v189, a250
  v_mfma_f32_16x16x32_bf16 v[96:99], v[204:207], v[136:139], v[96:99]
  ds_read_b128 v[200:203], v242 offset:50176
  v_accvgpr_read_b32 v251, a251
  v_mfma_f32_16x16x32_bf16 v[104:107], v[204:207], v[140:143], v[104:107]
  s_waitcnt lgkmcnt(2)
  v_mul_f32 v189, s70, v189
  v_mul_f32 v251, s70, v251
  v_mfma_f32_16x16x32_bf16 v[96:99], v[208:211], v[144:147], v[96:99]
  ds_read_b128 v[204:207], v241 offset:58368
  v_cvt_pk_bf16_f32 v189, v189, v251
  v_mfma_f32_16x16x32_bf16 v[104:107], v[208:211], v[148:151], v[104:107]
  v_accvgpr_read_b32 v190, a252
  v_accvgpr_read_b32 v251, a253
  v_mfma_f32_16x16x32_bf16 v[96:99], v[212:215], v[152:155], v[96:99]
  ds_read_b128 v[208:211], v242 offset:58368
  v_mul_f32 v190, s70, v190
  v_mfma_f32_16x16x32_bf16 v[104:107], v[212:215], v[156:159], v[104:107]
  s_waitcnt lgkmcnt(2)
  v_mul_f32 v251, s70, v251
  v_cvt_pk_bf16_f32 v190, v190, v251
  v_mfma_f32_16x16x32_bf16 v[100:103], v[216:219], v[128:131], v[192:195]
  ds_read_b128 v[212:215], v241 offset:51200
  v_accvgpr_read_b32 v191, a254
  v_mfma_f32_16x16x32_bf16 v[108:111], v[216:219], v[132:135], v[196:199]
  v_accvgpr_read_b32 v251, a255
  v_mul_f32 v191, s70, v191
  v_mfma_f32_16x16x32_bf16 v[100:103], v[200:203], v[136:139], v[100:103]
  ds_read_b128 v[216:219], v242 offset:51200
  v_max3_f32 v253, v96, v97, v98
  v_mfma_f32_16x16x32_bf16 v[108:111], v[200:203], v[140:143], v[108:111]
  s_waitcnt lgkmcnt(2)
  v_max3_f32 v253, v253, v99, v104
  v_max3_f32 v253, v253, v105, v106
  v_mfma_f32_16x16x32_bf16 v[100:103], v[204:207], v[144:147], v[100:103]
  ds_read_b128 v[200:203], v241 offset:59392
  v_mul_f32 v251, s70, v251
  v_mfma_f32_16x16x32_bf16 v[108:111], v[204:207], v[148:151], v[108:111]
  v_cvt_pk_bf16_f32 v191, v191, v251
  v_permlane16_swap_b32 v160, v162
  v_mfma_f32_16x16x32_bf16 v[100:103], v[208:211], v[152:155], v[100:103]
  ds_read_b128 v[204:207], v242 offset:59392
  v_permlane16_swap_b32 v161, v163
  v_mfma_f32_16x16x32_bf16 v[108:111], v[208:211], v[156:159], v[108:111]
  s_waitcnt lgkmcnt(2)
  buffer_load_dwordx4 v236, s[8:11], s93 offen offset:2048 nt lds
  v_mfma_f32_16x16x32_bf16 v[112:115], v[212:215], v[128:131], v[192:195]
  ds_read_b128 v[208:211], v241 offset:52224
  v_permlane16_swap_b32 v164, v166
  v_mfma_f32_16x16x32_bf16 v[120:123], v[212:215], v[132:135], v[196:199]
  v_permlane16_swap_b32 v165, v167
  v_permlane16_swap_b32 v168, v170
  v_mfma_f32_16x16x32_bf16 v[112:115], v[216:219], v[136:139], v[112:115]
  ds_read_b128 v[212:215], v242 offset:52224
  v_max3_f32 v253, v253, v107, v100
  v_mfma_f32_16x16x32_bf16 v[120:123], v[216:219], v[140:143], v[120:123]
  s_waitcnt lgkmcnt(2)
  buffer_load_dwordx4 v236, s[8:11], s93 offen offset:3072 nt lds
  v_mfma_f32_16x16x32_bf16 v[112:115], v[200:203], v[144:147], v[112:115]
  ds_read_b128 v[216:219], v241 offset:60416
  v_max3_f32 v253, v253, v101, v102
  v_mfma_f32_16x16x32_bf16 v[120:123], v[200:203], v[148:151], v[120:123]
  v_max3_f32 v253, v253, v103, v108
  v_max3_f32 v253, v253, v109, v110
  v_mfma_f32_16x16x32_bf16 v[112:115], v[204:207], v[152:155], v[112:115]
  s_add_u32 m0, s68, 131072
  ds_read_b128 v[200:203], v242 offset:60416
  v_permlane16_swap_b32 v169, v171
  v_mfma_f32_16x16x32_bf16 v[120:123], v[204:207], v[156:159], v[120:123]
  s_waitcnt lgkmcnt(2)
  buffer_load_dwordx4 v239, s[32:35], s86 offen lds
  v_mfma_f32_16x16x32_bf16 v[116:119], v[208:211], v[128:131], v[192:195]
  s_waitcnt vmcnt(13)
  s_barrier
  ds_read_b64_tr_b16 v[204:205], v247 offset:49152
  v_mfma_f32_16x16x32_bf16 v[124:127], v[208:211], v[132:135], v[196:199]
  ds_read_b64_tr_b16 v[206:207], v247 offset:50176
  v_permlane16_swap_b32 v172, v174
  v_mfma_f32_16x16x32_bf16 v[116:119], v[212:215], v[136:139], v[116:119]
  ds_read_b64_tr_b16 v[208:209], v248 offset:49152
  ds_read_b64_tr_b16 v[210:211], v248 offset:50176
  v_mfma_f32_16x16x32_bf16 v[124:127], v[212:215], v[140:143], v[124:127]
  s_waitcnt lgkmcnt(4)
  buffer_load_dwordx4 v239, s[36:39], s86 offen offset:1024 lds
  v_mfma_f32_16x16x32_bf16 v[116:119], v[216:219], v[144:147], v[116:119]
  ds_read_b64_tr_b16 v[212:213], v247 offset:49408
  v_max3_f32 v253, v253, v111, v112
  v_mfma_f32_16x16x32_bf16 v[124:127], v[216:219], v[148:151], v[124:127]
  ds_read_b64_tr_b16 v[214:215], v247 offset:50432
  v_max3_f32 v253, v253, v113, v114
  v_mfma_f32_16x16x32_bf16 v[116:119], v[200:203], v[152:155], v[116:119]
  ds_read_b64_tr_b16 v[216:217], v248 offset:49408
  ds_read_b64_tr_b16 v[218:219], v248 offset:50432
  v_mfma_f32_16x16x32_bf16 v[124:127], v[200:203], v[156:159], v[124:127]
  s_waitcnt lgkmcnt(4)
  buffer_load_dwordx4 v239, s[40:43], s86 offen offset:2048 lds
  v_mfma_f32_16x16x32_bf16 a[128:131], v[204:207], a[64:67], a[128:131]
  ds_read_b64_tr_b16 v[200:201], v247 offset:49664
  v_max3_f32 v253, v253, v115, v120
  v_mfma_f32_16x16x32_bf16 a[136:139], v[204:207], a[68:71], a[136:139]
  ds_read_b64_tr_b16 v[202:203], v247 offset:50688
  v_max3_f32 v253, v253, v121, v122
  v_mfma_f32_16x16x32_bf16 a[132:135], v[208:211], a[64:67], a[132:135]
  ds_read_b64_tr_b16 v[204:205], v248 offset:49664
  ds_read_b64_tr_b16 v[206:207], v248 offset:50688
  v_mfma_f32_16x16x32_bf16 a[140:143], v[208:211], a[68:71], a[140:143]
  s_waitcnt lgkmcnt(4)
  buffer_load_dwordx4 v239, s[44:47], s86 offen offset:3072 lds
  v_max3_f32 v253, v253, v123, v116
  v_mfma_f32_16x16x32_bf16 a[144:147], v[212:215], a[64:67], a[144:147]
  ds_read_b64_tr_b16 v[208:209], v247 offset:49920
  v_max3_f32 v253, v253, v117, v118
  v_mfma_f32_16x16x32_bf16 a[152:155], v[212:215], a[68:71], a[152:155]
  ds_read_b64_tr_b16 v[210:211], v247 offset:50944
  v_max3_f32 v253, v253, v119, v124
  v_max3_f32 v253, v253, v125, v126
  v_mfma_f32_16x16x32_bf16 a[148:151], v[216:219], a[64:67], a[148:151]
  s_add_u32 m0, s68, 98304
  ds_read_b64_tr_b16 v[212:213], v248 offset:49920
  ds_read_b64_tr_b16 v[214:215], v248 offset:50944
  v_mfma_f32_16x16x32_bf16 a[156:159], v[216:219], a[68:71], a[156:159]
  s_waitcnt lgkmcnt(4)
  buffer_load_dwordx4 v237, s[12:15], s93 offen nt lds
  v_max_f32 v253, v253, v127
  v_mfma_f32_16x16x32_bf16 a[160:163], v[200:203], a[64:67], a[160:163]
  ds_read_b64_tr_b16 v[216:217], v247 offset:51200
  v_cmp_lt_f32 vcc, 0x41200000, v253
  v_mfma_f32_16x16x32_bf16 a[168:171], v[200:203], a[68:71], a[168:171]
  s_cbranch_vccnz L_r1_3t
L_r1_3:
  ds_read_b64_tr_b16 v[218:219], v247 offset:52224
  v_exp_f32 v96, v96
  v_mfma_f32_16x16x32_bf16 a[164:167], v[204:207], a[64:67], a[164:167]
  ds_read_b64_tr_b16 v[200:201], v248 offset:51200
  ds_read_b64_tr_b16 v[202:203], v248 offset:52224
  v_mfma_f32_16x16x32_bf16 a[172:175], v[204:207], a[68:71], a[172:175]
  s_waitcnt lgkmcnt(4)
  buffer_load_dwordx4 v237, s[12:15], s93 offen offset:1024 nt lds
  v_permlane16_swap_b32 v173, v175
  v_mfma_f32_16x16x32_bf16 a[176:179], v[208:211], a[64:67], a[176:179]
  ds_read_b64_tr_b16 v[204:205], v247 offset:51456
  v_exp_f32 v97, v97
  v_mfma_f32_16x16x32_bf16 a[184:187], v[208:211], a[68:71], a[184:187]
  ds_read_b64_tr_b16 v[206:207], v247 offset:52480
  v_cvt_pk_bf16_f32 v96, v96, v97
  v_mfma_f32_16x16x32_bf16 a[180:183], v[212:215], a[64:67], a[180:183]
  ds_read_b64_tr_b16 v[208:209], v248 offset:51456
  v_exp_f32 v98, v98
  v_mfma_f32_16x16x32_bf16 a[188:191], v[212:215], a[68:71], a[188:191]
  s_waitcnt lgkmcnt(3)
  ds_read_b64_tr_b16 v[210:211], v248 offset:52480
  v_permlane16_swap_b32 v176, v178
  v_mfma_f32_16x16x32_bf16 a[128:131], v[216:219], a[72:75], a[128:131]
  ds_read_b64_tr_b16 v[212:213], v247 offset:51712
  v_exp_f32 v99, v99
  v_mfma_f32_16x16x32_bf16 a[136:139], v[216:219], a[76:79], a[136:139]
  ds_read_b64_tr_b16 v[214:215], v247 offset:52736
  v_cvt_pk_bf16_f32 v97, v98, v99
  v_mfma_f32_16x16x32_bf16 a[132:135], v[200:203], a[72:75], a[132:135]
  ds_read_b64_tr_b16 v[216:217], v248 offset:51712
  v_exp_f32 v100, v100
  v_mfma_f32_16x16x32_bf16 a[140:143], v[200:203], a[76:79], a[140:143]
  s_waitcnt lgkmcnt(3)
  ds_read_b64_tr_b16 v[218:219], v248 offset:52736
  v_permlane16_swap_b32 v177, v179
  v_mfma_f32_16x16x32_bf16 a[144:147], v[204:207], a[72:75], a[144:147]
  ds_read_b64_tr_b16 v[200:201], v247 offset:51968
  v_exp_f32 v101, v101
  v_mfma_f32_16x16x32_bf16 a[152:155], v[204:207], a[76:79], a[152:155]
  ds_read_b64_tr_b16 v[202:203], v247 offset:52992
  v_cvt_pk_bf16_f32 v98, v100, v101
  v_mfma_f32_16x16x32_bf16 a[148:151], v[208:211], a[72:75], a[148:151]
  ds_read_b64_tr_b16 v[204:205], v248 offset:51968
  v_exp_f32 v102, v102
  v_mfma_f32_16x16x32_bf16 a[156:159], v[208:211], a[76:79], a[156:159]
  s_waitcnt lgkmcnt(3)
  ds_read_b64_tr_b16 v[206:207], v248 offset:52992
  v_permlane16_swap_b32 v180, v182
  v_mfma_f32_16x16x32_bf16 a[160:163], v[212:215], a[72:75], a[160:163]
  s_waitcnt vmcnt(10)
  s_barrier
  ds_read_b64_tr_b16 v[208:209], v247 offset:16384
  v_mfma_f32_16x16x32_bf16 a[168:171], v[212:215], a[76:79], a[168:171]
  ds_read_b64_tr_b16 v[210:211], v247 offset:17408
  v_permlane16_swap_b32 v181, v183
  v_mfma_f32_16x16x32_bf16 a[164:167], v[216:219], a[72:75], a[164:167]
  ds_read_b64_tr_b16 v[212:213], v248 offset:16384
  v_exp_f32 v103, v103
  v_mfma_f32_16x16x32_bf16 a[172:175], v[216:219], a[76:79], a[172:175]
  s_waitcnt lgkmcnt(3)
  ds_read_b64_tr_b16 v[214:215], v248 offset:17408
  v_cvt_pk_bf16_f32 v99, v102, v103
  v_mfma_f32_16x16x32_bf16 a[176:179], v[200:203], a[72:75], a[176:179]
  ds_read_b64_tr_b16 v[216:217], v247 offset:16640
  v_exp_f32 v104, v104
  v_mfma_f32_16x16x32_bf16 a[184:187], v[200:203], a[76:79], a[184:187]
  ds_read_b64_tr_b16 v[218:219], v247 offset:17664
  v_permlane16_swap_b32 v184, v186
  v_mfma_f32_16x16x32_bf16 v[224:227], v[220:223], v[96:99], v[224:227]
  v_exp_f32 v105, v105
  v_mfma_f32_16x16x32_bf16 a[180:183], v[204:207], a[72:75], a[180:183]
  ds_read_b64_tr_b16 v[200:201], v248 offset:16640
  v_cvt_pk_bf16_f32 v100, v104, v105
  v_mfma_f32_16x16x32_bf16 a[188:191], v[204:207], a[76:79], a[188:191]
  s_waitcnt lgkmcnt(3)
  ds_read_b64_tr_b16 v[202:203], v248 offset:17664
  v_exp_f32 v106, v106
  v_mfma_f32_16x16x32_bf16 a[128:131], v[208:211], a[80:83], a[128:131]
  ds_read_b64_tr_b16 v[204:205], v247 offset:16896
  v_exp_f32 v107, v107
  v_mfma_f32_16x16x32_bf16 a[136:139], v[208:211], a[84:87], a[136:139]
  ds_read_b64_tr_b16 v[206:207], v247 offset:17920
  v_cvt_pk_bf16_f32 v101, v106, v107
  v_mfma_f32_16x16x32_bf16 a[132:135], v[212:215], a[80:83], a[132:135]
  ds_read_b64_tr_b16 v[208:209], v248 offset:16896
  v_exp_f32 v108, v108
  v_mfma_f32_16x16x32_bf16 a[140:143], v[212:215], a[84:87], a[140:143]
  s_waitcnt lgkmcnt(3)
  ds_read_b64_tr_b16 v[210:211], v248 offset:17920
  v_permlane16_swap_b32 v185, v187
  v_mfma_f32_16x16x32_bf16 a[144:147], v[216:219], a[80:83], a[144:147]
  ds_read_b64_tr_b16 v[212:213], v247 offset:17152
  v_exp_f32 v109, v109
  v_mfma_f32_16x16x32_bf16 a[152:155], v[216:219], a[84:87], a[152:155]
  ds_read_b64_tr_b16 v[214:215], v247 offset:18176
  v_cvt_pk_bf16_f32 v102, v108, v109
  v_mfma_f32_16x16x32_bf16 a[148:151], v[200:203], a[80:83], a[148:151]
  ds_read_b64_tr_b16 v[216:217], v248 offset:17152
  ds_read_b64_tr_b16 v[218:219], v248 offset:18176
  v_mfma_f32_16x16x32_bf16 a[156:159], v[200:203], a[84:87], a[156:159]
  s_waitcnt lgkmcnt(4)
  v_exp_f32 v110, v110
  v_mfma_f32_16x16x32_bf16 a[160:163], v[204:207], a[80:83], a[160:163]
  ds_read_b64_tr_b16 v[200:201], v247 offset:18432
  v_exp_f32 v111, v111
  v_mfma_f32_16x16x32_bf16 a[168:171], v[204:207], a[84:87], a[168:171]
  ds_read_b64_tr_b16 v[202:203], v247 offset:19456
  v_cvt_pk_bf16_f32 v103, v110, v111
  v_mfma_f32_16x16x32_bf16 a[164:167], v[208:211], a[80:83], a[164:167]
  ds_read_b64_tr_b16 v[204:205], v248 offset:18432
  ds_read_b64_tr_b16 v[206:207], v248 offset:19456
  v_mfma_f32_16x16x32_bf16 a[172:175], v[208:211], a[84:87], a[172:175]
  s_waitcnt lgkmcnt(4)
  v_exp_f32 v112, v112
  v_mfma_f32_16x16x32_bf16 v[228:231], v[220:223], v[100:103], v[228:231]
  v_exp_f32 v113, v113
  v_mfma_f32_16x16x32_bf16 a[176:179], v[212:215], a[80:83], a[176:179]
  ds_read_b64_tr_b16 v[208:209], v247 offset:18688
  v_cvt_pk_bf16_f32 v104, v112, v113
  v_mfma_f32_16x16x32_bf16 a[184:187], v[212:215], a[84:87], a[184:187]
  ds_read_b64_tr_b16 v[210:211], v247 offset:19712
  v_permlane16_swap_b32 v188, v190
  v_mfma_f32_16x16x32_bf16 a[180:183], v[216:219], a[80:83], a[180:183]
  ds_read_b64_tr_b16 v[212:213], v248 offset:18688
  ds_read_b64_tr_b16 v[214:215], v248 offset:19712
  v_mfma_f32_16x16x32_bf16 a[188:191], v[216:219], a[84:87], a[188:191]
  s_waitcnt lgkmcnt(4)
  v_exp_f32 v114, v114
  v_mfma_f32_16x16x32_bf16 a[128:131], v[200:203], a[88:91], a[128:131]
  ds_read_b64_tr_b16 v[216:217], v247 offset:18944
  ds_read_b64_tr_b16 v[218:219], v247 offset:19968
  v_mfma_f32_16x16x32_bf16 a[136:139], v[200:203], a[92:95], a[136:139]
  v_exp_f32 v115, v115
  v_mfma_f32_16x16x32_bf16 a[132:135], v[204:207], a[88:91], a[132:135]
  ds_read_b64_tr_b16 v[200:201], v248 offset:18944
  v_cvt_pk_bf16_f32 v105, v114, v115
  v_mfma_f32_16x16x32_bf16 a[140:143], v[204:207], a[92:95], a[140:143]
  s_waitcnt lgkmcnt(3)
  ds_read_b64_tr_b16 v[202:203], v248 offset:19968
  v_permlane16_swap_b32 v189, v191
  v_mfma_f32_16x16x32_bf16 a[144:147], v[208:211], a[88:91], a[144:147]
  ds_read_b64_tr_b16 v[204:205], v247 offset:19200
  ds_read_b64_tr_b16 v[206:207], v247 offset:20224
  v_mfma_f32_16x16x32_bf16 a[152:155], v[208:211], a[92:95], a[152:155]
  v_exp_f32 v116, v116
  v_mfma_f32_16x16x32_bf16 a[148:151], v[212:215], a[88:91], a[148:151]
  ds_read_b64_tr_b16 v[208:209], v248 offset:19200
  ds_read_b64_tr_b16 v[210:211], v248 offset:20224
  v_mfma_f32_16x16x32_bf16 a[156:159], v[212:215], a[92:95], a[156:159]
  s_waitcnt lgkmcnt(4)
  buffer_load_dwordx4 v237, s[12:15], s93 offen offset:2048 nt lds
  v_mfma_f32_16x16x32_bf16 a[160:163], v[216:219], a[88:91], a[160:163]
  s_waitcnt vmcnt(31)
  s_barrier
  ds_read_b64_tr_b16 v[212:213], v245 offset:16384
  ds_read_b64_tr_b16 v[214:215], v245 offset:17408
  v_mfma_f32_16x16x32_bf16 a[168:171], v[216:219], a[92:95], a[168:171]
  v_exp_f32 v117, v117
  v_mfma_f32_16x16x32_bf16 a[164:167], v[200:203], a[88:91], a[164:167]
  ds_read_b64_tr_b16 v[216:217], v246 offset:16384
  ds_read_b64_tr_b16 v[218:219], v246 offset:17408
  v_mfma_f32_16x16x32_bf16 a[172:175], v[200:203], a[92:95], a[172:175]
  s_waitcnt lgkmcnt(4)
  buffer_load_dwordx4 v237, s[12:15], s93 offen offset:3072 nt lds
  v_cvt_pk_bf16_f32 v106, v116, v117
  v_mfma_f32_16x16x32_bf16 a[176:179], v[204:207], a[88:91], a[176:179]
  ds_read_b64_tr_b16 v[200:201], v245 offset:16640
  ds_read_b64_tr_b16 v[202:203], v245 offset:17664
  v_mfma_f32_16x16x32_bf16 a[184:187], v[204:207], a[92:95], a[184:187]
  v_exp_f32 v118, v118
  v_mfma_f32_16x16x32_bf16 a[180:183], v[208:211], a[88:91], a[180:183]
  s_add_u32 m0, s68, 147456
  ds_read_b64_tr_b16 v[204:205], v246 offset:16640
  ds_read_b64_tr_b16 v[206:207], v246 offset:17664
  v_mfma_f32_16x16x32_bf16 a[188:191], v[208:211], a[92:95], a[188:191]
  s_waitcnt lgkmcnt(4)
  buffer_load_dwordx4 v239, s[32:35], s87 offen lds
  v_mfma_f32_16x16x32_bf16 v[32:35], v[212:215], v[96:99], v[32:35]
  ds_read_b64_tr_b16 v[208:209], v245 offset:16896
  ds_read_b64_tr_b16 v[210:211], v245 offset:17920
  v_mfma_f32_16x16x32_bf16 v[40:43], v[212:215], v[100:103], v[40:43]
  v_exp_f32 v119, v119
  v_mfma_f32_16x16x32_bf16 v[36:39], v[216:219], v[96:99], v[36:39]
  ds_read_b64_tr_b16 v[212:213], v246 offset:16896
  ds_read_b64_tr_b16 v[214:215], v246 offset:17920
  v_mfma_f32_16x16x32_bf16 v[44:47], v[216:219], v[100:103], v[44:47]
  s_waitcnt lgkmcnt(4)
  buffer_load_dwordx4 v239, s[36:39], s87 offen offset:1024 lds
  v_cvt_pk_bf16_f32 v107, v118, v119
  v_mfma_f32_16x16x32_bf16 v[48:51], v[200:203], v[96:99], v[48:51]
  ds_read_b64_tr_b16 v[216:217], v245 offset:17152
  ds_read_b64_tr_b16 v[218:219], v245 offset:18176
  v_mfma_f32_16x16x32_bf16 v[56:59], v[200:203], v[100:103], v[56:59]
  v_exp_f32 v120, v120
  v_mfma_f32_16x16x32_bf16 v[224:227], v[220:223], v[104:107], v[224:227]
  v_exp_f32 v121, v121
  v_mfma_f32_16x16x32_bf16 v[52:55], v[204:207], v[96:99], v[52:55]
  ds_read_b64_tr_b16 v[200:201], v246 offset:17152
  ds_read_b64_tr_b16 v[202:203], v246 offset:18176
  v_mfma_f32_16x16x32_bf16 v[60:63], v[204:207], v[100:103], v[60:63]
  s_waitcnt lgkmcnt(4)
  buffer_load_dwordx4 v239, s[40:43], s87 offen offset:2048 lds
  v_cvt_pk_bf16_f32 v108, v120, v121
  v_mfma_f32_16x16x32_bf16 v[64:67], v[208:211], v[96:99], v[64:67]
  ds_read_b64_tr_b16 v[204:205], v245 offset:18432
  ds_read_b64_tr_b16 v[206:207], v245 offset:19456
  v_mfma_f32_16x16x32_bf16 v[72:75], v[208:211], v[100:103], v[72:75]
  v_exp_f32 v122, v122
  v_mfma_f32_16x16x32_bf16 v[68:71], v[212:215], v[96:99], v[68:71]
  ds_read_b64_tr_b16 v[208:209], v246 offset:18432
  ds_read_b64_tr_b16 v[210:211], v246 offset:19456
  v_mfma_f32_16x16x32_bf16 v[76:79], v[212:215], v[100:103], v[76:79]
  s_waitcnt lgkmcnt(4)
  buffer_load_dwordx4 v239, s[44:47], s87 offen offset:3072 lds
  v_mfma_f32_16x16x32_bf16 v[80:83], v[216:219], v[96:99], v[80:83]
  ds_read_b64_tr_b16 v[212:213], v245 offset:18688
  ds_read_b64_tr_b16 v[214:215], v245 offset:19712
  v_mfma_f32_16x16x32_bf16 v[88:91], v[216:219], v[100:103], v[88:91]
  v_exp_f32 v123, v123
  v_exp_f32 v124, v124
  v_cvt_pk_bf16_f32 v109, v122, v123
  v_exp_f32 v125, v125
  v_exp_f32 v126, v126
  v_cvt_pk_bf16_f32 v110, v124, v125
  v_exp_f32 v127, v127
  s_nop 0
  v_cvt_pk_bf16_f32 v111, v126, v127
  v_mfma_f32_16x16x32_bf16 v[84:87], v[200:203], v[96:99], v[84:87]
  ds_read_b64_tr_b16 v[216:217], v246 offset:18688
  v_mfma_f32_16x16x32_bf16 v[92:95], v[200:203], v[100:103], v[92:95]
  s_waitcnt lgkmcnt(3)
  ds_read_b64_tr_b16 v[218:219], v246 offset:19712
  v_mfma_f32_16x16x32_bf16 v[32:35], v[204:207], v[104:107], v[32:35]
  ds_read_b64_tr_b16 v[200:201], v245 offset:18944
  v_mfma_f32_16x16x32_bf16 v[40:43], v[204:207], v[108:111], v[40:43]
  ds_read_b64_tr_b16 v[202:203], v245 offset:19968
  v_mfma_f32_16x16x32_bf16 v[36:39], v[208:211], v[104:107], v[36:39]
  ds_read_b64_tr_b16 v[204:205], v246 offset:18944
  v_mfma_f32_16x16x32_bf16 v[44:47], v[208:211], v[108:111], v[44:47]
  s_waitcnt lgkmcnt(3)
  ds_read_b64_tr_b16 v[206:207], v246 offset:19968
  v_mfma_f32_16x16x32_bf16 v[48:51], v[212:215], v[104:107], v[48:51]
  ds_read_b64_tr_b16 v[208:209], v245 offset:19200
  v_mfma_f32_16x16x32_bf16 v[56:59], v[212:215], v[108:111], v[56:59]
  ds_read_b64_tr_b16 v[210:211], v245 offset:20224
  v_mfma_f32_16x16x32_bf16 v[52:55], v[216:219], v[104:107], v[52:55]
  ds_read_b64_tr_b16 v[212:213], v246 offset:19200
  v_mfma_f32_16x16x32_bf16 v[60:63], v[216:219], v[108:111], v[60:63]
  s_waitcnt lgkmcnt(3)
  ds_read_b64_tr_b16 v[214:215], v246 offset:20224
  v_mfma_f32_16x16x32_bf16 v[64:67], v[200:203], v[104:107], v[64:67]
  s_waitcnt vmcnt(32)
  s_barrier
  s_add_u32 m0, s68, 114688
  ds_read_b128 v[216:219], v241 offset:0
  v_mfma_f32_16x16x32_bf16 v[72:75], v[200:203], v[108:111], v[72:75]
  buffer_load_dwordx4 v240, s[48:51], s72 offen lds
  v_mfma_f32_16x16x32_bf16 v[68:71], v[204:207], v[104:107], v[68:71]
  ds_read_b128 v[200:203], v242 offset:0
  v_mfma_f32_16x16x32_bf16 v[76:79], v[204:207], v[108:111], v[76:79]
  s_waitcnt lgkmcnt(2)
  v_mfma_f32_16x16x32_bf16 v[228:231], v[220:223], v[108:111], v[228:231]
  v_mfma_f32_16x16x32_bf16 v[80:83], v[208:211], v[104:107], v[80:83]
  ds_read_b128 v[204:207], v241 offset:8192
  v_mfma_f32_16x16x32_bf16 v[88:91], v[208:211], v[108:111], v[88:91]
  buffer_load_dwordx4 v240, s[52:55], s72 offen offset:1024 lds
  v_mfma_f32_16x16x32_bf16 v[84:87], v[212:215], v[104:107], v[84:87]
  ds_read_b128 v[208:211], v242 offset:8192
  v_mfma_f32_16x16x32_bf16 v[92:95], v[212:215], v[108:111], v[92:95]
  s_waitcnt lgkmcnt(2)
  v_mfma_f32_16x16x32_bf16 v[96:99], v[216:219], v[128:131], v[192:195]
  ds_read_b128 v[212:215], v241 offset:1024
  v_mfma_f32_16x16x32_bf16 v[104:107], v[216:219], v[132:135], v[196:199]
  v_mfma_f32_16x16x32_bf16 v[96:99], v[200:203], v[136:139], v[96:99]
  ds_read_b128 v[216:219], v242 offset:1024
  v_mfma_f32_16x16x32_bf16 v[104:107], v[200:203], v[140:143], v[104:107]
  s_waitcnt lgkmcnt(2)
  v_mfma_f32_16x16x32_bf16 v[96:99], v[204:207], v[144:147], v[96:99]
  ds_read_b128 v[200:203], v241 offset:9216
  v_mfma_f32_16x16x32_bf16 v[104:107], v[204:207], v[148:151], v[104:107]
  v_mfma_f32_16x16x32_bf16 v[96:99], v[208:211], v[152:155], v[96:99]
  ds_read_b128 v[204:207], v242 offset:9216
  v_mfma_f32_16x16x32_bf16 v[104:107], v[208:211], v[156:159], v[104:107]
  s_waitcnt lgkmcnt(2)
  v_mfma_f32_16x16x32_bf16 v[100:103], v[212:215], v[128:131], v[192:195]
  ds_read_b128 v[208:211], v241 offset:2048
  v_mfma_f32_16x16x32_bf16 v[108:111], v[212:215], v[132:135], v[196:199]
  v_mfma_f32_16x16x32_bf16 v[100:103], v[216:219], v[136:139], v[100:103]
  ds_read_b128 v[212:215], v242 offset:2048
  v_max3_f32 v253, v96, v97, v98
  v_mfma_f32_16x16x32_bf16 v[108:111], v[216:219], v[140:143], v[108:111]
  s_waitcnt lgkmcnt(2)
  v_max3_f32 v253, v253, v99, v104
  v_max3_f32 v253, v253, v105, v106
  v_mfma_f32_16x16x32_bf16 v[100:103], v[200:203], v[144:147], v[100:103]
  ds_read_b128 v[216:219], v241 offset:10240
  v_mfma_f32_16x16x32_bf16 v[108:111], v[200:203], v[148:151], v[108:111]
  v_mfma_f32_16x16x32_bf16 v[100:103], v[204:207], v[152:155], v[100:103]
  ds_read_b128 v[200:203], v242 offset:10240
  v_mfma_f32_16x16x32_bf16 v[108:111], v[204:207], v[156:159], v[108:111]
  s_waitcnt lgkmcnt(2)
  v_mfma_f32_16x16x32_bf16 v[112:115], v[208:211], v[128:131], v[192:195]
  ds_read_b128 v[204:207], v241 offset:3072
  v_mfma_f32_16x16x32_bf16 v[120:123], v[208:211], v[132:135], v[196:199]
  v_mfma_f32_16x16x32_bf16 v[112:115], v[212:215], v[136:139], v[112:115]
  ds_read_b128 v[208:211], v242 offset:3072
  v_max3_f32 v253, v253, v107, v100
  v_mfma_f32_16x16x32_bf16 v[120:123], v[212:215], v[140:143], v[120:123]
  s_waitcnt lgkmcnt(2)
  v_max3_f32 v253, v253, v101, v102
  v_max3_f32 v253, v253, v103, v108
  v_mfma_f32_16x16x32_bf16 v[112:115], v[216:219], v[144:147], v[112:115]
  ds_read_b128 v[212:215], v241 offset:11264
  v_max3_f32 v253, v253, v109, v110
  v_mfma_f32_16x16x32_bf16 v[120:123], v[216:219], v[148:151], v[120:123]
  v_mfma_f32_16x16x32_bf16 v[112:115], v[200:203], v[152:155], v[112:115]
  ds_read_b128 v[216:219], v242 offset:11264
  v_mfma_f32_16x16x32_bf16 v[120:123], v[200:203], v[156:159], v[120:123]
  s_waitcnt lgkmcnt(2)
  v_mfma_f32_16x16x32_bf16 v[116:119], v[204:207], v[128:131], v[192:195]
  s_waitcnt vmcnt(10)
  s_barrier
  ds_read_b64_tr_b16 v[200:201], v247 offset:32768
  v_mfma_f32_16x16x32_bf16 v[124:127], v[204:207], v[132:135], v[196:199]
  ds_read_b64_tr_b16 v[202:203], v247 offset:33792
  v_mfma_f32_16x16x32_bf16 v[116:119], v[208:211], v[136:139], v[116:119]
  ds_read_b64_tr_b16 v[204:205], v248 offset:32768
  v_max3_f32 v253, v253, v111, v112
  v_mfma_f32_16x16x32_bf16 v[124:127], v[208:211], v[140:143], v[124:127]
  s_waitcnt lgkmcnt(3)
  ds_read_b64_tr_b16 v[206:207], v248 offset:33792
  v_max3_f32 v253, v253, v113, v114
  v_mfma_f32_16x16x32_bf16 v[116:119], v[212:215], v[144:147], v[116:119]
  ds_read_b64_tr_b16 v[208:209], v247 offset:33024
  v_max3_f32 v253, v253, v115, v120
  v_mfma_f32_16x16x32_bf16 v[124:127], v[212:215], v[148:151], v[124:127]
  ds_read_b64_tr_b16 v[210:211], v247 offset:34048
  v_max3_f32 v253, v253, v121, v122
  v_mfma_f32_16x16x32_bf16 v[116:119], v[216:219], v[152:155], v[116:119]
  ds_read_b64_tr_b16 v[212:213], v248 offset:33024
  v_mfma_f32_16x16x32_bf16 v[124:127], v[216:219], v[156:159], v[124:127]
  s_waitcnt lgkmcnt(3)
  ds_read_b64_tr_b16 v[214:215], v248 offset:34048
  v_mfma_f32_16x16x32_bf16 a[128:131], v[200:203], a[96:99], a[128:131]
  ds_read_b64_tr_b16 v[216:217], v247 offset:33280
  ds_read_b64_tr_b16 v[218:219], v247 offset:34304
  v_mfma_f32_16x16x32_bf16 a[136:139], v[200:203], a[100:103], a[136:139]
  buffer_load_dwordx4 v240, s[56:59], s72 offen offset:2048 lds
  v_mfma_f32_16x16x32_bf16 a[132:135], v[204:207], a[96:99], a[132:135]
  ds_read_b64_tr_b16 v[200:201], v248 offset:33280
  v_max3_f32 v253, v253, v123, v116
  v_mfma_f32_16x16x32_bf16 a[140:143], v[204:207], a[100:103], a[140:143]
  s_waitcnt lgkmcnt(3)
  ds_read_b64_tr_b16 v[202:203], v248 offset:34304
  v_max3_f32 v253, v253, v117, v118
  v_max3_f32 v253, v253, v119, v124
  v_mfma_f32_16x16x32_bf16 a[144:147], v[208:211], a[96:99], a[144:147]
  ds_read_b64_tr_b16 v[204:205], v247 offset:33536
  v_max3_f32 v253, v253, v125, v126
  v_mfma_f32_16x16x32_bf16 a[152:155], v[208:211], a[100:103], a[152:155]
  ds_read_b64_tr_b16 v[206:207], v247 offset:34560
  v_max_f32 v253, v253, v127
  v_mfma_f32_16x16x32_bf16 a[148:151], v[212:215], a[96:99], a[148:151]
  ds_read_b64_tr_b16 v[208:209], v248 offset:33536
  ds_read_b64_tr_b16 v[210:211], v248 offset:34560
  v_mfma_f32_16x16x32_bf16 a[156:159], v[212:215], a[100:103], a[156:159]
  s_waitcnt lgkmcnt(4)
  buffer_load_dwordx4 v240, s[60:63], s72 offen offset:3072 lds
  v_mfma_f32_16x16x32_bf16 a[160:163], v[216:219], a[96:99], a[160:163]
  ds_read_b64_tr_b16 v[212:213], v247 offset:34816
  v_cmp_lt_f32 vcc, 0x41200000, v253
  v_mfma_f32_16x16x32_bf16 a[168:171], v[216:219], a[100:103], a[168:171]
  s_cbranch_vccnz L_r1_4t
L_r1_4:
  ds_read_b64_tr_b16 v[214:215], v247 offset:35840
  v_exp_f32 v96, v96
  v_mfma_f32_16x16x32_bf16 a[164:167], v[200:203], a[96:99], a[164:167]
  ds_read_b64_tr_b16 v[216:217], v248 offset:34816
  ds_read_b64_tr_b16 v[218:219], v248 offset:35840
  v_mfma_f32_16x16x32_bf16 a[172:175], v[200:203], a[100:103], a[172:175]
  s_waitcnt lgkmcnt(4)
  v_exp_f32 v97, v97
  v_mfma_f32_16x16x32_bf16 a[176:179], v[204:207], a[96:99], a[176:179]
  ds_read_b64_tr_b16 v[200:201], v247 offset:35072
  v_cvt_pk_bf16_f32 v96, v96, v97
  v_mfma_f32_16x16x32_bf16 a[184:187], v[204:207], a[100:103], a[184:187]
  ds_read_b64_tr_b16 v[202:203], v247 offset:36096
  v_exp_f32 v98, v98
  v_mfma_f32_16x16x32_bf16 a[180:183], v[208:211], a[96:99], a[180:183]
  ds_read_b64_tr_b16 v[204:205], v248 offset:35072
  ds_read_b64_tr_b16 v[206:207], v248 offset:36096
  v_mfma_f32_16x16x32_bf16 a[188:191], v[208:211], a[100:103], a[188:191]
  s_waitcnt lgkmcnt(4)
  v_exp_f32 v99, v99
  v_mfma_f32_16x16x32_bf16 a[128:131], v[212:215], a[104:107], a[128:131]
  ds_read_b64_tr_b16 v[208:209], v247 offset:35328
  v_cvt_pk_bf16_f32 v97, v98, v99
  v_mfma_f32_16x16x32_bf16 a[136:139], v[212:215], a[108:111], a[136:139]
  ds_read_b64_tr_b16 v[210:211], v247 offset:36352
  v_exp_f32 v100, v100
  v_mfma_f32_16x16x32_bf16 a[132:135], v[216:219], a[104:107], a[132:135]
  ds_read_b64_tr_b16 v[212:213], v248 offset:35328
  ds_read_b64_tr_b16 v[214:215], v248 offset:36352
  v_mfma_f32_16x16x32_bf16 a[140:143], v[216:219], a[108:111], a[140:143]
  s_waitcnt lgkmcnt(4)
  v_exp_f32 v101, v101
  v_mfma_f32_16x16x32_bf16 a[144:147], v[200:203], a[104:107], a[144:147]
  ds_read_b64_tr_b16 v[216:217], v247 offset:35584
  v_cvt_pk_bf16_f32 v98, v100, v101
  v_mfma_f32_16x16x32_bf16 a[152:155], v[200:203], a[108:111], a[152:155]
  ds_read_b64_tr_b16 v[218:219], v247 offset:36608
  v_exp_f32 v102, v102
  v_mfma_f32_16x16x32_bf16 a[148:151], v[204:207], a[104:107], a[148:151]
  ds_read_b64_tr_b16 v[200:201], v248 offset:35584
  ds_read_b64_tr_b16 v[202:203], v248 offset:36608
  v_mfma_f32_16x16x32_bf16 a[156:159], v[204:207], a[108:111], a[156:159]
  s_waitcnt lgkmcnt(4)
  v_exp_f32 v103, v103
  v_mfma_f32_16x16x32_bf16 a[160:163], v[208:211], a[104:107], a[160:163]
  s_waitcnt vmcnt(4)
  s_barrier
  s_add_u32 m0, s68, 0
  ds_read_b64_tr_b16 v[204:205], v247 offset:49152
  ds_read_b64_tr_b16 v[206:207], v247 offset:50176
  v_mfma_f32_16x16x32_bf16 a[168:171], v[208:211], a[108:111], a[168:171]
  buffer_load_dwordx4 v236, s[8:11], s94 offen nt lds
  v_cvt_pk_bf16_f32 v99, v102, v103
  v_mfma_f32_16x16x32_bf16 a[164:167], v[212:215], a[104:107], a[164:167]
  ds_read_b64_tr_b16 v[208:209], v248 offset:49152
  ds_read_b64_tr_b16 v[210:211], v248 offset:50176
  v_mfma_f32_16x16x32_bf16 a[172:175], v[212:215], a[108:111], a[172:175]
  s_waitcnt lgkmcnt(4)
  v_exp_f32 v104, v104
  v_mfma_f32_16x16x32_bf16 v[224:227], v[220:223], v[96:99], v[224:227]
  v_exp_f32 v105, v105
  v_mfma_f32_16x16x32_bf16 a[176:179], v[216:219], a[104:107], a[176:179]
  ds_read_b64_tr_b16 v[212:213], v247 offset:49408
  ds_read_b64_tr_b16 v[214:215], v247 offset:50432
  v_mfma_f32_16x16x32_bf16 a[184:187], v[216:219], a[108:111], a[184:187]
  buffer_load_dwordx4 v236, s[8:11], s94 offen offset:1024 nt lds
  v_mfma_f32_16x16x32_bf16 a[180:183], v[200:203], a[104:107], a[180:183]
  ds_read_b64_tr_b16 v[216:217], v248 offset:49408
  v_cvt_pk_bf16_f32 v100, v104, v105
  v_mfma_f32_16x16x32_bf16 a[188:191], v[200:203], a[108:111], a[188:191]
  s_waitcnt lgkmcnt(3)
  ds_read_b64_tr_b16 v[218:219], v248 offset:50432
  v_exp_f32 v106, v106
  v_mfma_f32_16x16x32_bf16 a[128:131], v[204:207], a[112:115], a[128:131]
  ds_read_b64_tr_b16 v[200:201], v247 offset:49664
  ds_read_b64_tr_b16 v[202:203], v247 offset:50688
  v_mfma_f32_16x16x32_bf16 a[136:139], v[204:207], a[116:119], a[136:139]
  buffer_load_dwordx4 v236, s[8:11], s94 offen offset:2048 nt lds
  v_mbcnt_lo_u32_b32 v243, -1, 0
  v_mfma_f32_16x16x32_bf16 a[132:135], v[208:211], a[112:115], a[132:135]
  ds_read_b64_tr_b16 v[204:205], v248 offset:49664
  v_mbcnt_hi_u32_b32 v243, -1, v243
  v_mfma_f32_16x16x32_bf16 a[140:143], v[208:211], a[116:119], a[140:143]
  s_waitcnt lgkmcnt(3)
  ds_read_b64_tr_b16 v[206:207], v248 offset:50688
  v_lshlrev_b32 v243, 3, v243
  v_add_lshl_u32 v243, v243, s68, 1
  v_mfma_f32_16x16x32_bf16 a[144:147], v[212:215], a[112:115], a[144:147]
  ds_read_b64_tr_b16 v[208:209], v247 offset:49920
  ds_read_b64_tr_b16 v[210:211], v247 offset:50944
  v_mfma_f32_16x16x32_bf16 a[152:155], v[212:215], a[116:119], a[152:155]
  buffer_load_dwordx4 v236, s[8:11], s94 offen offset:3072 nt lds
  v_mfma_f32_16x16x32_bf16 a[148:151], v[216:219], a[112:115], a[148:151]
  ds_read_b64_tr_b16 v[212:213], v248 offset:49920
  ds_read_b64_tr_b16 v[214:215], v248 offset:50944
  v_mfma_f32_16x16x32_bf16 a[156:159], v[216:219], a[116:119], a[156:159]
  s_waitcnt lgkmcnt(4)
  v_exp_f32 v107, v107
  v_mfma_f32_16x16x32_bf16 a[160:163], v[200:203], a[112:115], a[160:163]
  s_add_u32 m0, s68, 81920
  ds_read_b64_tr_b16 v[216:217], v247 offset:51200
  ds_read_b64_tr_b16 v[218:219], v247 offset:52224
  v_mfma_f32_16x16x32_bf16 a[168:171], v[200:203], a[116:119], a[168:171]
  buffer_load_dwordx4 v237, s[12:15], s94 offen nt lds
  v_cvt_pk_bf16_f32 v101, v106, v107
  v_mfma_f32_16x16x32_bf16 a[164:167], v[204:207], a[112:115], a[164:167]
  ds_read_b64_tr_b16 v[200:201], v248 offset:51200
  ds_read_b64_tr_b16 v[202:203], v248 offset:52224
  v_mfma_f32_16x16x32_bf16 a[172:175], v[204:207], a[116:119], a[172:175]
  s_waitcnt lgkmcnt(4)
  v_exp_f32 v108, v108
  v_mfma_f32_16x16x32_bf16 a[176:179], v[208:211], a[112:115], a[176:179]
  ds_read_b64_tr_b16 v[204:205], v247 offset:51456
  ds_read_b64_tr_b16 v[206:207], v247 offset:52480
  v_mfma_f32_16x16x32_bf16 a[184:187], v[208:211], a[116:119], a[184:187]
  buffer_load_dwordx4 v237, s[12:15], s94 offen offset:1024 nt lds
  v_mfma_f32_16x16x32_bf16 a[180:183], v[212:215], a[112:115], a[180:183]
  ds_read_b64_tr_b16 v[208:209], v248 offset:51456
  ds_read_b64_tr_b16 v[210:211], v248 offset:52480
  v_mfma_f32_16x16x32_bf16 a[188:191], v[212:215], a[116:119], a[188:191]
  s_waitcnt lgkmcnt(4)
  v_exp_f32 v109, v109
  v_mfma_f32_16x16x32_bf16 a[128:131], v[216:219], a[120:123], a[128:131]
  ds_read_b64_tr_b16 v[212:213], v247 offset:51712
  v_cvt_pk_bf16_f32 v102, v108, v109
  v_mfma_f32_16x16x32_bf16 a[136:139], v[216:219], a[124:127], a[136:139]
  ds_read_b64_tr_b16 v[214:215], v247 offset:52736
  v_exp_f32 v110, v110
  v_mfma_f32_16x16x32_bf16 a[132:135], v[200:203], a[120:123], a[132:135]
  ds_read_b64_tr_b16 v[216:217], v248 offset:51712
  ds_read_b64_tr_b16 v[218:219], v248 offset:52736
  v_mfma_f32_16x16x32_bf16 a[140:143], v[200:203], a[124:127], a[140:143]
  s_waitcnt lgkmcnt(4)
  v_exp_f32 v111, v111
  v_mfma_f32_16x16x32_bf16 a[144:147], v[204:207], a[120:123], a[144:147]
  ds_read_b64_tr_b16 v[200:201], v247 offset:51968
  v_cvt_pk_bf16_f32 v103, v110, v111
  v_mfma_f32_16x16x32_bf16 a[152:155], v[204:207], a[124:127], a[152:155]
  ds_read_b64_tr_b16 v[202:203], v247 offset:52992
  v_exp_f32 v112, v112
  v_mfma_f32_16x16x32_bf16 v[228:231], v[220:223], v[100:103], v[228:231]
  v_exp_f32 v113, v113
  v_mfma_f32_16x16x32_bf16 a[148:151], v[208:211], a[120:123], a[148:151]
  ds_read_b64_tr_b16 v[204:205], v248 offset:51968
  v_cvt_pk_bf16_f32 v104, v112, v113
  v_mfma_f32_16x16x32_bf16 a[156:159], v[208:211], a[124:127], a[156:159]
  s_waitcnt lgkmcnt(3)
  ds_read_b64_tr_b16 v[206:207], v248 offset:52992
  v_exp_f32 v114, v114
  v_mfma_f32_16x16x32_bf16 a[160:163], v[212:215], a[120:123], a[160:163]
  s_waitcnt vmcnt(30)
  s_barrier
  ds_read_b64_tr_b16 v[208:209], v245 offset:0
  v_mfma_f32_16x16x32_bf16 a[168:171], v[212:215], a[124:127], a[168:171]
  ds_read_b64_tr_b16 v[210:211], v245 offset:1024
  v_accvgpr_read_b32 v232, a128
  v_mfma_f32_16x16x32_bf16 a[164:167], v[216:219], a[120:123], a[164:167]
  ds_read_b64_tr_b16 v[212:213], v246 offset:0
  v_exp_f32 v115, v115
  v_mfma_f32_16x16x32_bf16 a[172:175], v[216:219], a[124:127], a[172:175]
  s_waitcnt lgkmcnt(3)
  ds_read_b64_tr_b16 v[214:215], v246 offset:1024
  v_cvt_pk_bf16_f32 v105, v114, v115
  v_accvgpr_read_b32 v251, a129
  v_mfma_f32_16x16x32_bf16 a[176:179], v[200:203], a[120:123], a[176:179]
  ds_read_b64_tr_b16 v[216:217], v245 offset:256
  v_exp_f32 v116, v116
  v_mfma_f32_16x16x32_bf16 a[184:187], v[200:203], a[124:127], a[184:187]
  ds_read_b64_tr_b16 v[218:219], v245 offset:1280
  v_exp_f32 v117, v117
  v_mfma_f32_16x16x32_bf16 a[180:183], v[204:207], a[120:123], a[180:183]
  ds_read_b64_tr_b16 v[200:201], v246 offset:256
  v_cvt_pk_bf16_f32 v106, v116, v117
  v_mfma_f32_16x16x32_bf16 a[188:191], v[204:207], a[124:127], a[188:191]
  s_waitcnt lgkmcnt(3)
  ds_read_b64_tr_b16 v[202:203], v246 offset:1280
  v_exp_f32 v118, v118
  v_mfma_f32_16x16x32_bf16 v[32:35], v[208:211], v[96:99], v[32:35]
  ds_read_b64_tr_b16 v[204:205], v245 offset:512
  v_exp_f32 v119, v119
  v_mfma_f32_16x16x32_bf16 v[40:43], v[208:211], v[100:103], v[40:43]
  ds_read_b64_tr_b16 v[206:207], v245 offset:1536
  v_cvt_pk_bf16_f32 v107, v118, v119
  v_mul_f32 v232, s70, v232
  v_mfma_f32_16x16x32_bf16 v[36:39], v[212:215], v[96:99], v[36:39]
  ds_read_b64_tr_b16 v[208:209], v246 offset:512
  v_exp_f32 v120, v120
  v_mfma_f32_16x16x32_bf16 v[44:47], v[212:215], v[100:103], v[44:47]
  s_waitcnt lgkmcnt(3)
  ds_read_b64_tr_b16 v[210:211], v246 offset:1536
  v_exp_f32 v121, v121
  v_mfma_f32_16x16x32_bf16 v[224:227], v[220:223], v[104:107], v[224:227]
  v_cvt_pk_bf16_f32 v108, v120, v121
  v_mul_f32 v251, s70, v251
  v_mfma_f32_16x16x32_bf16 v[48:51], v[216:219], v[96:99], v[48:51]
  ds_read_b64_tr_b16 v[212:213], v245 offset:768
  v_exp_f32 v122, v122
  v_mfma_f32_16x16x32_bf16 v[56:59], v[216:219], v[100:103], v[56:59]
  ds_read_b64_tr_b16 v[214:215], v245 offset:1792
  v_cvt_pk_bf16_f32 v232, v232, v251
  v_mfma_f32_16x16x32_bf16 v[52:55], v[200:203], v[96:99], v[52:55]
  ds_read_b64_tr_b16 v[216:217], v246 offset:768
  v_exp_f32 v123, v123
  v_mfma_f32_16x16x32_bf16 v[60:63], v[200:203], v[100:103], v[60:63]
  s_waitcnt lgkmcnt(3)
  ds_read_b64_tr_b16 v[218:219], v246 offset:1792
  v_cvt_pk_bf16_f32 v109, v122, v123
  v_mfma_f32_16x16x32_bf16 v[64:67], v[204:207], v[96:99], v[64:67]
  ds_read_b64_tr_b16 v[200:201], v245 offset:2048
  v_exp_f32 v124, v124
  v_mfma_f32_16x16x32_bf16 v[72:75], v[204:207], v[100:103], v[72:75]
  ds_read_b64_tr_b16 v[202:203], v245 offset:3072
  v_exp_f32 v125, v125
  v_mfma_f32_16x16x32_bf16 v[68:71], v[208:211], v[96:99], v[68:71]
  ds_read_b64_tr_b16 v[204:205], v246 offset:2048
  v_cvt_pk_bf16_f32 v110, v124, v125
  v_mfma_f32_16x16x32_bf16 v[76:79], v[208:211], v[100:103], v[76:79]
  s_waitcnt lgkmcnt(3)
  ds_read_b64_tr_b16 v[206:207], v246 offset:3072
  v_exp_f32 v126, v126
  v_mfma_f32_16x16x32_bf16 v[80:83], v[212:215], v[96:99], v[80:83]
  ds_read_b64_tr_b16 v[208:209], v245 offset:2304
  ds_read_b64_tr_b16 v[210:211], v245 offset:3328
  v_mfma_f32_16x16x32_bf16 v[88:91], v[212:215], v[100:103], v[88:91]
  buffer_load_dwordx4 v237, s[12:15], s94 offen offset:2048 nt lds
  v_exp_f32 v127, v127
  v_accvgpr_read_b32 v233, a130
  v_cvt_pk_bf16_f32 v111, v126, v127
  v_mfma_f32_16x16x32_bf16 v[84:87], v[216:219], v[96:99], v[84:87]
  ds_read_b64_tr_b16 v[212:213], v246 offset:2304
  v_accvgpr_read_b32 v251, a131
  v_mfma_f32_16x16x32_bf16 v[92:95], v[216:219], v[100:103], v[92:95]
  s_waitcnt lgkmcnt(3)
  ds_read_b64_tr_b16 v[214:215], v246 offset:3328
  v_mul_f32 v233, s70, v233
  v_mfma_f32_16x16x32_bf16 v[228:231], v[220:223], v[108:111], v[228:231]
  v_mul_f32 v251, s70, v251
  v_cvt_pk_bf16_f32 v233, v233, v251
  v_mfma_f32_16x16x32_bf16 v[32:35], v[200:203], v[104:107], v[32:35]
  ds_read_b64_tr_b16 v[216:217], v245 offset:2560
  ds_read_b64_tr_b16 v[218:219], v245 offset:3584
  v_mfma_f32_16x16x32_bf16 v[40:43], v[200:203], v[108:111], v[40:43]
  buffer_load_dwordx4 v237, s[12:15], s94 offen offset:3072 nt lds
  v_mfma_f32_16x16x32_bf16 v[36:39], v[204:207], v[104:107], v[36:39]
  ds_read_b64_tr_b16 v[200:201], v246 offset:2560
  v_accvgpr_read_b32 v234, a132
  v_mfma_f32_16x16x32_bf16 v[44:47], v[204:207], v[108:111], v[44:47]
  s_waitcnt lgkmcnt(3)
  ds_read_b64_tr_b16 v[202:203], v246 offset:3584
  v_accvgpr_read_b32 v251, a133
  v_mfma_f32_16x16x32_bf16 v[48:51], v[208:211], v[104:107], v[48:51]
  s_add_u32 m0, s68, 131072
  ds_read_b64_tr_b16 v[204:205], v245 offset:2816
  ds_read_b64_tr_b16 v[206:207], v245 offset:3840
  v_mfma_f32_16x16x32_bf16 v[56:59], v[208:211], v[108:111], v[56:59]
  buffer_load_dwordx4 v240, s[48:51], s73 offen lds
  v_mfma_f32_16x16x32_bf16 v[52:55], v[212:215], v[104:107], v[52:55]
  ds_read_b64_tr_b16 v[208:209], v246 offset:2816
  v_mul_f32 v234, s70, v234
  v_mfma_f32_16x16x32_bf16 v[60:63], v[212:215], v[108:111], v[60:63]
  s_waitcnt lgkmcnt(3)
  ds_read_b64_tr_b16 v[210:211], v246 offset:3840
  v_mul_f32 v251, s70, v251
  v_mfma_f32_16x16x32_bf16 v[64:67], v[216:219], v[104:107], v[64:67]
  s_waitcnt vmcnt(25)
  s_barrier
  ds_read_b128 v[212:215], v241 offset:16384
  v_mfma_f32_16x16x32_bf16 v[72:75], v[216:219], v[108:111], v[72:75]
  buffer_load_dwordx4 v240, s[52:55], s73 offen offset:1024 lds
  v_mfma_f32_16x16x32_bf16 v[68:71], v[200:203], v[104:107], v[68:71]
  ds_read_b128 v[216:219], v242 offset:16384
  v_cvt_pk_bf16_f32 v234, v234, v251
  v_mfma_f32_16x16x32_bf16 v[76:79], v[200:203], v[108:111], v[76:79]
  s_waitcnt lgkmcnt(2)
  v_accvgpr_read_b32 v235, a134
  v_accvgpr_read_b32 v251, a135
  v_mfma_f32_16x16x32_bf16 v[80:83], v[204:207], v[104:107], v[80:83]
  ds_read_b128 v[200:203], v241 offset:24576
  v_mul_f32 v235, s70, v235
  v_mfma_f32_16x16x32_bf16 v[88:91], v[204:207], v[108:111], v[88:91]
  buffer_load_dwordx4 v240, s[56:59], s73 offen offset:2048 lds
  v_mfma_f32_16x16x32_bf16 v[84:87], v[208:211], v[104:107], v[84:87]
  ds_read_b128 v[204:207], v242 offset:24576
  v_mul_f32 v251, s70, v251
  v_mfma_f32_16x16x32_bf16 v[92:95], v[208:211], v[108:111], v[92:95]
  s_waitcnt lgkmcnt(2)
  v_cvt_pk_bf16_f32 v235, v235, v251
  v_permlane16_swap_b32 v232, v234
  v_mfma_f32_16x16x32_bf16 v[96:99], v[212:215], v[128:131], v[192:195]
  ds_read_b128 v[208:211], v241 offset:17408
  v_permlane16_swap_b32 v233, v235
  v_mfma_f32_16x16x32_bf16 v[104:107], v[212:215], v[132:135], v[196:199]
  ds_write_b128 v243, v[232:235] offset:32768
  v_mfma_f32_16x16x32_bf16 v[96:99], v[216:219], v[136:139], v[96:99]
  ds_read_b128 v[212:215], v242 offset:17408
  v_accvgpr_read_b32 v232, a136
  v_mfma_f32_16x16x32_bf16 v[104:107], v[216:219], v[140:143], v[104:107]
  s_waitcnt lgkmcnt(3)
  buffer_load_dwordx4 v240, s[60:63], s73 offen offset:3072 lds
  v_mfma_f32_16x16x32_bf16 v[96:99], v[200:203], v[144:147], v[96:99]
  ds_read_b128 v[216:219], v241 offset:25600
  v_accvgpr_read_b32 v251, a137
  v_mfma_f32_16x16x32_bf16 v[104:107], v[200:203], v[148:151], v[104:107]
  v_mul_f32 v232, s70, v232
  v_mul_f32 v251, s70, v251
  v_mfma_f32_16x16x32_bf16 v[96:99], v[204:207], v[152:155], v[96:99]
  s_add_u32 m0, s68, 147456
  ds_read_b128 v[200:203], v242 offset:25600
  v_cvt_pk_bf16_f32 v232, v232, v251
  v_mfma_f32_16x16x32_bf16 v[104:107], v[204:207], v[156:159], v[104:107]
  s_waitcnt lgkmcnt(2)
  buffer_load_dwordx4 v240, s[48:51], s74 offen lds
  v_mfma_f32_16x16x32_bf16 v[100:103], v[208:211], v[128:131], v[192:195]
  ds_read_b128 v[204:207], v241 offset:18432
  v_accvgpr_read_b32 v233, a138
  v_mfma_f32_16x16x32_bf16 v[108:111], v[208:211], v[132:135], v[196:199]
  v_accvgpr_read_b32 v251, a139
  v_mul_f32 v233, s70, v233
  v_mfma_f32_16x16x32_bf16 v[100:103], v[212:215], v[136:139], v[100:103]
  ds_read_b128 v[208:211], v242 offset:18432
  v_max3_f32 v253, v96, v97, v98
  v_mfma_f32_16x16x32_bf16 v[108:111], v[212:215], v[140:143], v[108:111]
  s_waitcnt lgkmcnt(2)
  v_max3_f32 v253, v253, v99, v104
  v_max3_f32 v253, v253, v105, v106
  v_mfma_f32_16x16x32_bf16 v[100:103], v[216:219], v[144:147], v[100:103]
  ds_read_b128 v[212:215], v241 offset:26624
  v_mul_f32 v251, s70, v251
  v_mfma_f32_16x16x32_bf16 v[108:111], v[216:219], v[148:151], v[108:111]
  v_cvt_pk_bf16_f32 v233, v233, v251
  v_accvgpr_read_b32 v234, a140
  v_mfma_f32_16x16x32_bf16 v[100:103], v[200:203], v[152:155], v[100:103]
  ds_read_b128 v[216:219], v242 offset:26624
  v_accvgpr_read_b32 v251, a141
  v_mfma_f32_16x16x32_bf16 v[108:111], v[200:203], v[156:159], v[108:111]
  s_waitcnt lgkmcnt(2)
  v_mul_f32 v234, s70, v234
  v_mul_f32 v251, s70, v251
  v_mfma_f32_16x16x32_bf16 v[112:115], v[204:207], v[128:131], v[192:195]
  ds_read_b128 v[200:203], v241 offset:19456
  v_cvt_pk_bf16_f32 v234, v234, v251
  v_mfma_f32_16x16x32_bf16 v[120:123], v[204:207], v[132:135], v[196:199]
  v_accvgpr_read_b32 v235, a142
  v_accvgpr_read_b32 v251, a143
  v_mfma_f32_16x16x32_bf16 v[112:115], v[208:211], v[136:139], v[112:115]
  ds_read_b128 v[204:207], v242 offset:19456
  v_max3_f32 v253, v253, v107, v100
  v_mfma_f32_16x16x32_bf16 v[120:123], v[208:211], v[140:143], v[120:123]
  s_waitcnt lgkmcnt(2)
  v_max3_f32 v253, v253, v101, v102
  v_max3_f32 v253, v253, v103, v108
  v_mfma_f32_16x16x32_bf16 v[112:115], v[212:215], v[144:147], v[112:115]
  ds_read_b128 v[208:211], v241 offset:27648
  v_max3_f32 v253, v253, v109, v110
  v_mfma_f32_16x16x32_bf16 v[120:123], v[212:215], v[148:151], v[120:123]
  v_mul_f32 v235, s70, v235
  v_mul_f32 v251, s70, v251
  v_mfma_f32_16x16x32_bf16 v[112:115], v[216:219], v[152:155], v[112:115]
  ds_read_b128 v[212:215], v242 offset:27648
  v_cvt_pk_bf16_f32 v235, v235, v251
  v_mfma_f32_16x16x32_bf16 v[120:123], v[216:219], v[156:159], v[120:123]
  s_waitcnt lgkmcnt(2)
  v_permlane16_swap_b32 v232, v234
  v_permlane16_swap_b32 v233, v235
  v_mfma_f32_16x16x32_bf16 v[116:119], v[200:203], v[128:131], v[192:195]
  s_waitcnt vmcnt(13)
  s_barrier
  ds_read_b64_tr_b16 v[216:217], v249 offset:16384
  ds_read_b64_tr_b16 v[218:219], v249 offset:18432
  v_mfma_f32_16x16x32_bf16 v[124:127], v[200:203], v[132:135], v[196:199]
  ds_write_b128 v243, v[232:235] offset:33792
  v_mfma_f32_16x16x32_bf16 v[116:119], v[204:207], v[136:139], v[116:119]
  ds_read_b64_tr_b16 v[200:201], v250 offset:16384
  v_max3_f32 v253, v253, v111, v112
  v_mfma_f32_16x16x32_bf16 v[124:127], v[204:207], v[140:143], v[124:127]
  s_waitcnt lgkmcnt(4)
  ds_read_b64_tr_b16 v[202:203], v250 offset:18432
  v_max3_f32 v253, v253, v113, v114
  v_mfma_f32_16x16x32_bf16 v[116:119], v[208:211], v[144:147], v[116:119]
  ds_read_b64_tr_b16 v[204:205], v249 offset:16640
  v_max3_f32 v253, v253, v115, v120
  v_mfma_f32_16x16x32_bf16 v[124:127], v[208:211], v[148:151], v[124:127]
  ds_read_b64_tr_b16 v[206:207], v249 offset:18688
  v_max3_f32 v253, v253, v121, v122
  v_mfma_f32_16x16x32_bf16 v[116:119], v[212:215], v[152:155], v[116:119]
  ds_read_b64_tr_b16 v[208:209], v250 offset:16640
  v_accvgpr_read_b32 v232, a144
  v_mfma_f32_16x16x32_bf16 v[124:127], v[212:215], v[156:159], v[124:127]
  s_waitcnt lgkmcnt(3)
  ds_read_b64_tr_b16 v[210:211], v250 offset:18688
  v_accvgpr_read_b32 v251, a145
  v_mfma_f32_16x16x32_bf16 a[0:3], v[216:219], v[0:3], 0
  ds_read_b64_tr_b16 v[212:213], v249 offset:20480
  v_mul_f32 v232, s70, v232
  v_mfma_f32_16x16x32_bf16 a[8:11], v[216:219], v[4:7], 0
  ds_read_b64_tr_b16 v[214:215], v249 offset:22528
  v_mul_f32 v251, s70, v251
  v_mfma_f32_16x16x32_bf16 a[4:7], v[200:203], v[0:3], 0
  ds_read_b64_tr_b16 v[216:217], v250 offset:20480
  v_max3_f32 v253, v253, v123, v116
  v_mfma_f32_16x16x32_bf16 a[12:15], v[200:203], v[4:7], 0
  s_waitcnt lgkmcnt(3)
  ds_read_b64_tr_b16 v[218:219], v250 offset:22528
  v_max3_f32 v253, v253, v117, v118
  v_max3_f32 v253, v253, v119, v124
  v_mfma_f32_16x16x32_bf16 a[16:19], v[204:207], v[0:3], 0
  ds_read_b64_tr_b16 v[200:201], v249 offset:20736
  v_max3_f32 v253, v253, v125, v126
  v_mfma_f32_16x16x32_bf16 a[24:27], v[204:207], v[4:7], 0
  ds_read_b64_tr_b16 v[202:203], v249 offset:22784
  v_max_f32 v253, v253, v127
  v_mfma_f32_16x16x32_bf16 a[20:23], v[208:211], v[0:3], 0
  ds_read_b64_tr_b16 v[204:205], v250 offset:20736
  v_cmp_lt_f32 vcc, 0x41200000, v253
  v_mfma_f32_16x16x32_bf16 a[28:31], v[208:211], v[4:7], 0
  s_waitcnt lgkmcnt(3)
  s_cbranch_vccnz L_r1_5t
L_r1_5:
  ds_read_b64_tr_b16 v[206:207], v250 offset:22784
  v_mfma_f32_16x16x32_bf16 a[0:3], v[212:215], v[8:11], a[0:3]
  ds_read_b64_tr_b16 v[208:209], v249 offset:24576
  v_exp_f32 v96, v96
  v_mfma_f32_16x16x32_bf16 a[8:11], v[212:215], v[12:15], a[8:11]
  ds_read_b64_tr_b16 v[210:211], v249 offset:26624
  v_cvt_pk_bf16_f32 v232, v232, v251
  v_mfma_f32_16x16x32_bf16 a[4:7], v[216:219], v[8:11], a[4:7]
  ds_read_b64_tr_b16 v[212:213], v250 offset:24576
  v_exp_f32 v97, v97
  v_mfma_f32_16x16x32_bf16 a[12:15], v[216:219], v[12:15], a[12:15]
  s_waitcnt lgkmcnt(3)
  ds_read_b64_tr_b16 v[214:215], v250 offset:26624
  v_cvt_pk_bf16_f32 v96, v96, v97
  v_mfma_f32_16x16x32_bf16 a[16:19], v[200:203], v[8:11], a[16:19]
  ds_read_b64_tr_b16 v[216:217], v249 offset:24832
  v_exp_f32 v98, v98
  v_mfma_f32_16x16x32_bf16 a[24:27], v[200:203], v[12:15], a[24:27]
  ds_read_b64_tr_b16 v[218:219], v249 offset:26880
  v_accvgpr_read_b32 v233, a146
  v_mfma_f32_16x16x32_bf16 a[20:23], v[204:207], v[8:11], a[20:23]
  ds_read_b64_tr_b16 v[200:201], v250 offset:24832
  v_exp_f32 v99, v99
  v_mfma_f32_16x16x32_bf16 a[28:31], v[204:207], v[12:15], a[28:31]
  s_waitcnt lgkmcnt(3)
  ds_read_b64_tr_b16 v[202:203], v250 offset:26880
  v_cvt_pk_bf16_f32 v97, v98, v99
  v_mfma_f32_16x16x32_bf16 a[0:3], v[208:211], v[16:19], a[0:3]
  ds_read_b64_tr_b16 v[204:205], v249 offset:28672
  ds_read_b64_tr_b16 v[206:207], v249 offset:30720
  v_mfma_f32_16x16x32_bf16 a[8:11], v[208:211], v[20:23], a[8:11]
  buffer_load_dwordx4 v240, s[52:55], s74 offen offset:1024 lds
  v_accvgpr_read_b32 v251, a147
  v_mfma_f32_16x16x32_bf16 a[4:7], v[212:215], v[16:19], a[4:7]
  ds_read_b64_tr_b16 v[208:209], v250 offset:28672
  v_exp_f32 v100, v100
  v_mfma_f32_16x16x32_bf16 a[12:15], v[212:215], v[20:23], a[12:15]
  s_waitcnt lgkmcnt(3)
  ds_read_b64_tr_b16 v[210:211], v250 offset:30720
  v_mul_f32 v233, s70, v233
  v_mfma_f32_16x16x32_bf16 a[16:19], v[216:219], v[16:19], a[16:19]
  ds_read_b64_tr_b16 v[212:213], v249 offset:28928
  ds_read_b64_tr_b16 v[214:215], v249 offset:30976
  v_mfma_f32_16x16x32_bf16 a[24:27], v[216:219], v[20:23], a[24:27]
  buffer_load_dwordx4 v240, s[56:59], s74 offen offset:2048 lds
  v_mul_f32 v251, s70, v251
  v_mfma_f32_16x16x32_bf16 a[20:23], v[200:203], v[16:19], a[20:23]
  ds_read_b64_tr_b16 v[216:217], v250 offset:28928
  v_exp_f32 v101, v101
  v_mfma_f32_16x16x32_bf16 a[28:31], v[200:203], v[20:23], a[28:31]
  s_waitcnt lgkmcnt(3)
  ds_read_b64_tr_b16 v[218:219], v250 offset:30976
  v_cvt_pk_bf16_f32 v98, v100, v101
  v_mfma_f32_16x16x32_bf16 a[0:3], v[204:207], v[24:27], a[0:3]
  s_waitcnt vmcnt(3)
  s_barrier
  ds_read_b64_tr_b16 v[200:201], v249 offset:32768
  ds_read_b64_tr_b16 v[202:203], v249 offset:34816
  v_mfma_f32_16x16x32_bf16 a[8:11], v[204:207], v[28:31], a[8:11]
  buffer_load_dwordx4 v240, s[60:63], s74 offen offset:3072 lds
  v_cvt_pk_bf16_f32 v233, v233, v251
  v_mfma_f32_16x16x32_bf16 a[4:7], v[208:211], v[24:27], a[4:7]
  ds_read_b64_tr_b16 v[204:205], v250 offset:32768
  v_exp_f32 v102, v102
  v_mfma_f32_16x16x32_bf16 a[12:15], v[208:211], v[28:31], a[12:15]
  s_waitcnt lgkmcnt(3)
  ds_read_b64_tr_b16 v[206:207], v250 offset:34816
  v_accvgpr_read_b32 v234, a148
  v_mfma_f32_16x16x32_bf16 a[16:19], v[212:215], v[24:27], a[16:19]
  s_add_u32 m0, s68, 16384
  ds_read_b64_tr_b16 v[208:209], v249 offset:33024
  ds_read_b64_tr_b16 v[210:211], v249 offset:35072
  v_mfma_f32_16x16x32_bf16 a[24:27], v[212:215], v[28:31], a[24:27]
  buffer_load_dwordx4 v236, s[8:11], s95 offen nt lds
  v_accvgpr_read_b32 v251, a149
  v_mfma_f32_16x16x32_bf16 a[20:23], v[216:219], v[24:27], a[20:23]
  ds_read_b64_tr_b16 v[212:213], v250 offset:33024
  v_exp_f32 v103, v103
  v_mfma_f32_16x16x32_bf16 a[28:31], v[216:219], v[28:31], a[28:31]
  s_waitcnt lgkmcnt(3)
  ds_read_b64_tr_b16 v[214:215], v250 offset:35072
  v_cvt_pk_bf16_f32 v99, v102, v103
  v_mfma_f32_16x16x32_bf16 a[32:35], v[200:203], v[0:3], 0
  ds_read_b64_tr_b16 v[216:217], v249 offset:36864
  ds_read_b64_tr_b16 v[218:219], v249 offset:38912
  v_mfma_f32_16x16x32_bf16 a[40:43], v[200:203], v[4:7], 0
  buffer_load_dwordx4 v236, s[8:11], s95 offen offset:1024 nt lds
  v_mul_f32 v234, s70, v234
  v_mfma_f32_16x16x32_bf16 v[224:227], v[220:223], v[96:99], v[224:227]
  v_exp_f32 v104, v104
  v_mfma_f32_16x16x32_bf16 a[36:39], v[204:207], v[0:3], 0
  ds_read_b64_tr_b16 v[200:201], v250 offset:36864
  v_exp_f32 v105, v105
  v_mfma_f32_16x16x32_bf16 a[44:47], v[204:207], v[4:7], 0
  s_waitcnt lgkmcnt(3)
  ds_read_b64_tr_b16 v[202:203], v250 offset:38912
  v_cvt_pk_bf16_f32 v100, v104, v105
  v_mfma_f32_16x16x32_bf16 a[48:51], v[208:211], v[0:3], 0
  ds_read_b64_tr_b16 v[204:205], v249 offset:37120
  ds_read_b64_tr_b16 v[206:207], v249 offset:39168
  v_mfma_f32_16x16x32_bf16 a[56:59], v[208:211], v[4:7], 0
  buffer_load_dwordx4 v236, s[8:11], s95 offen offset:2048 nt lds
  v_mul_f32 v251, s70, v251
  v_mfma_f32_16x16x32_bf16 a[52:55], v[212:215], v[0:3], 0
  ds_read_b64_tr_b16 v[208:209], v250 offset:37120
  v_exp_f32 v106, v106
  v_mfma_f32_16x16x32_bf16 a[60:63], v[212:215], v[4:7], 0
  s_waitcnt lgkmcnt(3)
  ds_read_b64_tr_b16 v[210:211], v250 offset:39168
  v_cvt_pk_bf16_f32 v234, v234, v251
  v_mfma_f32_16x16x32_bf16 a[32:35], v[216:219], v[8:11], a[32:35]
  ds_read_b64_tr_b16 v[212:213], v249 offset:40960
  ds_read_b64_tr_b16 v[214:215], v249 offset:43008
  v_mfma_f32_16x16x32_bf16 a[40:43], v[216:219], v[12:15], a[40:43]
  buffer_load_dwordx4 v236, s[8:11], s95 offen offset:3072 nt lds
  v_add_u32 v236, 262144, v236
  v_mfma_f32_16x16x32_bf16 a[36:39], v[200:203], v[8:11], a[36:39]
  ds_read_b64_tr_b16 v[216:217], v250 offset:40960
  v_exp_f32 v107, v107
  v_mfma_f32_16x16x32_bf16 a[44:47], v[200:203], v[12:15], a[44:47]
  s_waitcnt lgkmcnt(3)
  ds_read_b64_tr_b16 v[218:219], v250 offset:43008
  v_cvt_pk_bf16_f32 v101, v106, v107
  v_mfma_f32_16x16x32_bf16 a[48:51], v[204:207], v[8:11], a[48:51]
  s_add_u32 m0, s68, 65536
  ds_read_b64_tr_b16 v[200:201], v249 offset:41216
  ds_read_b64_tr_b16 v[202:203], v249 offset:43264
  v_mfma_f32_16x16x32_bf16 a[56:59], v[204:207], v[12:15], a[56:59]
  buffer_load_dwordx4 v237, s[12:15], s95 offen nt lds
  v_accvgpr_read_b32 v235, a150
  v_mfma_f32_16x16x32_bf16 a[52:55], v[208:211], v[8:11], a[52:55]
  ds_read_b64_tr_b16 v[204:205], v250 offset:41216
  v_exp_f32 v108, v108
  v_mfma_f32_16x16x32_bf16 a[60:63], v[208:211], v[12:15], a[60:63]
  s_waitcnt lgkmcnt(3)
  ds_read_b64_tr_b16 v[206:207], v250 offset:43264
  v_accvgpr_read_b32 v251, a151
  v_mfma_f32_16x16x32_bf16 a[32:35], v[212:215], v[16:19], a[32:35]
  ds_read_b64_tr_b16 v[208:209], v249 offset:45056
  ds_read_b64_tr_b16 v[210:211], v249 offset:47104
  v_mfma_f32_16x16x32_bf16 a[40:43], v[212:215], v[20:23], a[40:43]
  buffer_load_dwordx4 v237, s[12:15], s95 offen offset:1024 nt lds
  v_mul_f32 v235, s70, v235
  v_mfma_f32_16x16x32_bf16 a[36:39], v[216:219], v[16:19], a[36:39]
  ds_read_b64_tr_b16 v[212:213], v250 offset:45056
  v_exp_f32 v109, v109
  v_mfma_f32_16x16x32_bf16 a[44:47], v[216:219], v[20:23], a[44:47]
  s_waitcnt lgkmcnt(3)
  ds_read_b64_tr_b16 v[214:215], v250 offset:47104
  v_cvt_pk_bf16_f32 v102, v108, v109
  v_mul_f32 v251, s70, v251
  v_mfma_f32_16x16x32_bf16 a[48:51], v[200:203], v[16:19], a[48:51]
  ds_read_b64_tr_b16 v[216:217], v249 offset:45312
  ds_read_b64_tr_b16 v[218:219], v249 offset:47360
  v_mfma_f32_16x16x32_bf16 a[56:59], v[200:203], v[20:23], a[56:59]
  buffer_load_dwordx4 v237, s[12:15], s95 offen offset:2048 nt lds
  v_cvt_pk_bf16_f32 v235, v235, v251
  v_mfma_f32_16x16x32_bf16 a[52:55], v[204:207], v[16:19], a[52:55]
  ds_read_b64_tr_b16 v[200:201], v250 offset:45312
  v_exp_f32 v110, v110
  v_mfma_f32_16x16x32_bf16 a[60:63], v[204:207], v[20:23], a[60:63]
  s_waitcnt lgkmcnt(3)
  ds_read_b64_tr_b16 v[202:203], v250 offset:47360
  v_exp_f32 v111, v111
  v_mfma_f32_16x16x32_bf16 a[32:35], v[208:211], v[24:27], a[32:35]
  s_waitcnt vmcnt(31)
  s_barrier
  ds_read_b64_tr_b16 v[204:205], v245 offset:32768
  ds_read_b64_tr_b16 v[206:207], v245 offset:33792
  v_mfma_f32_16x16x32_bf16 a[40:43], v[208:211], v[28:31], a[40:43]
  buffer_load_dwordx4 v237, s[12:15], s95 offen offset:3072 nt lds
  v_add_u32 v237, 262144, v237
  v_mfma_f32_16x16x32_bf16 a[36:39], v[212:215], v[24:27], a[36:39]
  ds_read_b64_tr_b16 v[208:209], v246 offset:32768
  v_cvt_pk_bf16_f32 v103, v110, v111
  v_mfma_f32_16x16x32_bf16 a[44:47], v[212:215], v[28:31], a[44:47]
  s_waitcnt lgkmcnt(3)
  ds_read_b64_tr_b16 v[210:211], v246 offset:33792
  v_exp_f32 v112, v112
  v_mfma_f32_16x16x32_bf16 v[228:231], v[220:223], v[100:103], v[228:231]
  v_exp_f32 v113, v113
  v_mfma_f32_16x16x32_bf16 a[48:51], v[216:219], v[24:27], a[48:51]
  s_add_u32 m0, s68, 114688
  ds_read_b64_tr_b16 v[212:213], v245 offset:33024
  ds_read_b64_tr_b16 v[214:215], v245 offset:34048
  v_mfma_f32_16x16x32_bf16 a[56:59], v[216:219], v[28:31], a[56:59]
  buffer_load_dwordx4 v240, s[48:51], s75 offen lds
  v_cvt_pk_bf16_f32 v104, v112, v113
  v_mfma_f32_16x16x32_bf16 a[52:55], v[200:203], v[24:27], a[52:55]
  ds_read_b64_tr_b16 v[216:217], v246 offset:33024
  v_exp_f32 v114, v114
  v_mfma_f32_16x16x32_bf16 a[60:63], v[200:203], v[28:31], a[60:63]
  s_waitcnt lgkmcnt(3)
  ds_read_b64_tr_b16 v[218:219], v246 offset:34048
  v_exp_f32 v115, v115
  v_mfma_f32_16x16x32_bf16 v[32:35], v[204:207], v[96:99], v[32:35]
  ds_read_b64_tr_b16 v[200:201], v245 offset:33280
  ds_read_b64_tr_b16 v[202:203], v245 offset:34304
  v_mfma_f32_16x16x32_bf16 v[40:43], v[204:207], v[100:103], v[40:43]
  buffer_load_dwordx4 v240, s[52:55], s75 offen offset:1024 lds
  v_cvt_pk_bf16_f32 v105, v114, v115
  v_mfma_f32_16x16x32_bf16 v[36:39], v[208:211], v[96:99], v[36:39]
  ds_read_b64_tr_b16 v[204:205], v246 offset:33280
  v_exp_f32 v116, v116
  v_mfma_f32_16x16x32_bf16 v[44:47], v[208:211], v[100:103], v[44:47]
  s_waitcnt lgkmcnt(3)
  ds_read_b64_tr_b16 v[206:207], v246 offset:34304
  v_exp_f32 v117, v117
  v_mfma_f32_16x16x32_bf16 v[48:51], v[212:215], v[96:99], v[48:51]
  ds_read_b64_tr_b16 v[208:209], v245 offset:33536
  v_cvt_pk_bf16_f32 v106, v116, v117
  v_mfma_f32_16x16x32_bf16 v[56:59], v[212:215], v[100:103], v[56:59]
  ds_read_b64_tr_b16 v[210:211], v245 offset:34560
  v_exp_f32 v118, v118
  v_mfma_f32_16x16x32_bf16 v[52:55], v[216:219], v[96:99], v[52:55]
  ds_read_b64_tr_b16 v[212:213], v246 offset:33536
  v_exp_f32 v119, v119
  v_mfma_f32_16x16x32_bf16 v[60:63], v[216:219], v[100:103], v[60:63]
  s_waitcnt lgkmcnt(3)
  ds_read_b64_tr_b16 v[214:215], v246 offset:34560
  v_cvt_pk_bf16_f32 v107, v118, v119
  v_permlane16_swap_b32 v232, v234
  v_mfma_f32_16x16x32_bf16 v[64:67], v[200:203], v[96:99], v[64:67]
  ds_read_b64_tr_b16 v[216:217], v245 offset:34816
  v_exp_f32 v120, v120
  v_mfma_f32_16x16x32_bf16 v[72:75], v[200:203], v[100:103], v[72:75]
  ds_read_b64_tr_b16 v[218:219], v245 offset:35840
  v_exp_f32 v121, v121
  v_mfma_f32_16x16x32_bf16 v[224:227], v[220:223], v[104:107], v[224:227]
  v_cvt_pk_bf16_f32 v108, v120, v121
  v_permlane16_swap_b32 v233, v235
  v_mfma_f32_16x16x32_bf16 v[68:71], v[204:207], v[96:99], v[68:71]
  ds_read_b64_tr_b16 v[200:201], v246 offset:34816
  ds_read_b64_tr_b16 v[202:203], v246 offset:35840
  v_mfma_f32_16x16x32_bf16 v[76:79], v[204:207], v[100:103], v[76:79]
  s_waitcnt lgkmcnt(4)
  ds_write_b128 v243, v[232:235] offset:34816
  v_accvgpr_read_b32 v232, a152
  v_mfma_f32_16x16x32_bf16 v[80:83], v[208:211], v[96:99], v[80:83]
  ds_read_b64_tr_b16 v[204:205], v245 offset:35072
  v_exp_f32 v122, v122
  v_mfma_f32_16x16x32_bf16 v[88:91], v[208:211], v[100:103], v[88:91]
  ds_read_b64_tr_b16 v[206:207], v245 offset:36096
  v_exp_f32 v123, v123
  v_exp_f32 v124, v124
  v_cvt_pk_bf16_f32 v109, v122, v123
  v_exp_f32 v125, v125
  v_exp_f32 v126, v126
  v_cvt_pk_bf16_f32 v110, v124, v125
  v_exp_f32 v127, v127
  v_accvgpr_read_b32 v251, a153
  v_cvt_pk_bf16_f32 v111, v126, v127
  v_mfma_f32_16x16x32_bf16 v[84:87], v[212:215], v[96:99], v[84:87]
  ds_read_b64_tr_b16 v[208:209], v246 offset:35072
  v_mul_f32 v232, s70, v232
  v_mfma_f32_16x16x32_bf16 v[92:95], v[212:215], v[100:103], v[92:95]
  s_waitcnt lgkmcnt(4)
  ds_read_b64_tr_b16 v[210:211], v246 offset:36096
  v_mul_f32 v251, s70, v251
  v_mfma_f32_16x16x32_bf16 v[228:231], v[220:223], v[108:111], v[228:231]
  v_cvt_pk_bf16_f32 v232, v232, v251
  v_accvgpr_read_b32 v233, a154
  v_mfma_f32_16x16x32_bf16 v[32:35], v[216:219], v[104:107], v[32:35]
  ds_read_b64_tr_b16 v[212:213], v245 offset:35328
  v_accvgpr_read_b32 v251, a155
  v_mfma_f32_16x16x32_bf16 v[40:43], v[216:219], v[108:111], v[40:43]
  ds_read_b64_tr_b16 v[214:215], v245 offset:36352
  v_mul_f32 v233, s70, v233
  v_mfma_f32_16x16x32_bf16 v[36:39], v[200:203], v[104:107], v[36:39]
  ds_read_b64_tr_b16 v[216:217], v246 offset:35328
  v_mul_f32 v251, s70, v251
  v_mfma_f32_16x16x32_bf16 v[44:47], v[200:203], v[108:111], v[44:47]
  s_waitcnt lgkmcnt(3)
  ds_read_b64_tr_b16 v[218:219], v246 offset:36352
  v_cvt_pk_bf16_f32 v233, v233, v251
  v_mfma_f32_16x16x32_bf16 v[48:51], v[204:207], v[104:107], v[48:51]
  ds_read_b64_tr_b16 v[200:201], v245 offset:35584
  v_accvgpr_read_b32 v234, a156
  v_mfma_f32_16x16x32_bf16 v[56:59], v[204:207], v[108:111], v[56:59]
  ds_read_b64_tr_b16 v[202:203], v245 offset:36608
  v_accvgpr_read_b32 v251, a157
  v_mfma_f32_16x16x32_bf16 v[52:55], v[208:211], v[104:107], v[52:55]
  ds_read_b64_tr_b16 v[204:205], v246 offset:35584
  v_mul_f32 v234, s70, v234
  v_mfma_f32_16x16x32_bf16 v[60:63], v[208:211], v[108:111], v[60:63]
  s_waitcnt lgkmcnt(3)
  ds_read_b64_tr_b16 v[206:207], v246 offset:36608
  v_mul_f32 v251, s70, v251
  v_mfma_f32_16x16x32_bf16 v[64:67], v[212:215], v[104:107], v[64:67]
  s_waitcnt vmcnt(22)
  s_barrier
  ds_read_b128 v[208:211], v241 offset:0
  v_mfma_f32_16x16x32_bf16 v[72:75], v[212:215], v[108:111], v[72:75]
  v_cvt_pk_bf16_f32 v234, v234, v251
  v_accvgpr_read_b32 v235, a158
  v_mfma_f32_16x16x32_bf16 v[68:71], v[216:219], v[104:107], v[68:71]
  ds_read_b128 v[212:215], v242 offset:0
  v_accvgpr_read_b32 v251, a159
  v_mfma_f32_16x16x32_bf16 v[76:79], v[216:219], v[108:111], v[76:79]
  s_waitcnt lgkmcnt(2)
  v_mul_f32 v235, s70, v235
  v_mul_f32 v251, s70, v251
  v_mfma_f32_16x16x32_bf16 v[80:83], v[200:203], v[104:107], v[80:83]
  ds_read_b128 v[216:219], v241 offset:8192
  v_cvt_pk_bf16_f32 v235, v235, v251
  v_mfma_f32_16x16x32_bf16 v[88:91], v[200:203], v[108:111], v[88:91]
  v_permlane16_swap_b32 v232, v234
  v_permlane16_swap_b32 v233, v235
  v_mfma_f32_16x16x32_bf16 v[84:87], v[204:207], v[104:107], v[84:87]
  ds_read_b128 v[200:203], v242 offset:8192
  v_mfma_f32_16x16x32_bf16 v[92:95], v[204:207], v[108:111], v[92:95]
  s_waitcnt lgkmcnt(2)
  ds_write_b128 v243, v[232:235] offset:35840
  v_mfma_f32_16x16x32_bf16 v[96:99], v[208:211], v[128:131], v[192:195]
  ds_read_b128 v[204:207], v241 offset:1024
  v_accvgpr_read_b32 v232, a160
  v_mfma_f32_16x16x32_bf16 v[104:107], v[208:211], v[132:135], v[196:199]
  buffer_load_dwordx4 v240, s[56:59], s75 offen offset:2048 lds
  v_mfma_f32_16x16x32_bf16 v[96:99], v[212:215], v[136:139], v[96:99]
  ds_read_b128 v[208:211], v242 offset:1024
  v_accvgpr_read_b32 v251, a161
  v_mfma_f32_16x16x32_bf16 v[104:107], v[212:215], v[140:143], v[104:107]
  s_waitcnt lgkmcnt(3)
  v_mul_f32 v232, s70, v232
  v_mul_f32 v251, s70, v251
  v_mfma_f32_16x16x32_bf16 v[96:99], v[216:219], v[144:147], v[96:99]
  ds_read_b128 v[212:215], v241 offset:9216
  v_cvt_pk_bf16_f32 v232, v232, v251
  v_mfma_f32_16x16x32_bf16 v[104:107], v[216:219], v[148:151], v[104:107]
  buffer_load_dwordx4 v240, s[60:63], s75 offen offset:3072 lds
  v_mfma_f32_16x16x32_bf16 v[96:99], v[200:203], v[152:155], v[96:99]
  ds_read_b128 v[216:219], v242 offset:9216
  v_accvgpr_read_b32 v233, a162
  v_mfma_f32_16x16x32_bf16 v[104:107], v[200:203], v[156:159], v[104:107]
  s_waitcnt lgkmcnt(2)
  v_accvgpr_read_b32 v251, a163
  v_mul_f32 v233, s70, v233
  v_mfma_f32_16x16x32_bf16 v[100:103], v[204:207], v[128:131], v[192:195]
  s_add_u32 m0, s68, 131072
  ds_read_b128 v[200:203], v241 offset:2048
  v_mul_f32 v251, s70, v251
  v_mfma_f32_16x16x32_bf16 v[108:111], v[204:207], v[132:135], v[196:199]
  buffer_load_dwordx4 v240, s[48:51], s76 offen lds
  v_mfma_f32_16x16x32_bf16 v[100:103], v[208:211], v[136:139], v[100:103]
  ds_read_b128 v[204:207], v242 offset:2048
  v_max3_f32 v253, v96, v97, v98
  v_mfma_f32_16x16x32_bf16 v[108:111], v[208:211], v[140:143], v[108:111]
  s_waitcnt lgkmcnt(2)
  v_max3_f32 v253, v253, v99, v104
  v_max3_f32 v253, v253, v105, v106
  v_mfma_f32_16x16x32_bf16 v[100:103], v[212:215], v[144:147], v[100:103]
  ds_read_b128 v[208:211], v241 offset:10240
  v_cvt_pk_bf16_f32 v233, v233, v251
  v_mfma_f32_16x16x32_bf16 v[108:111], v[212:215], v[148:151], v[108:111]
  buffer_load_dwordx4 v240, s[52:55], s76 offen offset:1024 lds
  v_mfma_f32_16x16x32_bf16 v[100:103], v[216:219], v[152:155], v[100:103]
  ds_read_b128 v[212:215], v242 offset:10240
  v_accvgpr_read_b32 v234, a164
  v_mfma_f32_16x16x32_bf16 v[108:111], v[216:219], v[156:159], v[108:111]
  s_waitcnt lgkmcnt(2)
  v_accvgpr_read_b32 v251, a165
  v_mul_f32 v234, s70, v234
  v_mfma_f32_16x16x32_bf16 v[112:115], v[200:203], v[128:131], v[192:195]
  ds_read_b128 v[216:219], v241 offset:3072
  v_mul_f32 v251, s70, v251
  v_mfma_f32_16x16x32_bf16 v[120:123], v[200:203], v[132:135], v[196:199]
  buffer_load_dwordx4 v240, s[56:59], s76 offen offset:2048 lds
  v_mfma_f32_16x16x32_bf16 v[112:115], v[204:207], v[136:139], v[112:115]
  ds_read_b128 v[200:203], v242 offset:3072
  v_max3_f32 v253, v253, v107, v100
  v_mfma_f32_16x16x32_bf16 v[120:123], v[204:207], v[140:143], v[120:123]
  s_waitcnt lgkmcnt(2)
  v_max3_f32 v253, v253, v101, v102
  v_max3_f32 v253, v253, v103, v108
  v_mfma_f32_16x16x32_bf16 v[112:115], v[208:211], v[144:147], v[112:115]
  ds_read_b128 v[204:207], v241 offset:11264
  v_max3_f32 v253, v253, v109, v110
  v_mfma_f32_16x16x32_bf16 v[120:123], v[208:211], v[148:151], v[120:123]
  buffer_load_dwordx4 v240, s[60:63], s76 offen offset:3072 lds
  v_mfma_f32_16x16x32_bf16 v[112:115], v[212:215], v[152:155], v[112:115]
  ds_read_b128 v[208:211], v242 offset:11264
  v_cvt_pk_bf16_f32 v234, v234, v251
  v_mfma_f32_16x16x32_bf16 v[120:123], v[212:215], v[156:159], v[120:123]
  s_waitcnt lgkmcnt(2)
  v_accvgpr_read_b32 v235, a166
  v_accvgpr_read_b32 v251, a167
  v_mfma_f32_16x16x32_bf16 v[116:119], v[216:219], v[128:131], v[192:195]
  s_waitcnt vmcnt(16)
  s_barrier
  ds_read_b64_tr_b16 v[212:213], v249 offset:49152
  v_mfma_f32_16x16x32_bf16 v[124:127], v[216:219], v[132:135], v[196:199]
  ds_read_b64_tr_b16 v[214:215], v249 offset:51200
  v_mul_f32 v235, s70, v235
  v_mfma_f32_16x16x32_bf16 v[116:119], v[200:203], v[136:139], v[116:119]
  ds_read_b64_tr_b16 v[216:217], v250 offset:49152
  v_max3_f32 v253, v253, v111, v112
  v_mfma_f32_16x16x32_bf16 v[124:127], v[200:203], v[140:143], v[124:127]
  s_waitcnt lgkmcnt(3)
  ds_read_b64_tr_b16 v[218:219], v250 offset:51200
  v_max3_f32 v253, v253, v113, v114
  v_mfma_f32_16x16x32_bf16 v[116:119], v[204:207], v[144:147], v[116:119]
  ds_read_b64_tr_b16 v[200:201], v249 offset:49408
  v_max3_f32 v253, v253, v115, v120
  v_mfma_f32_16x16x32_bf16 v[124:127], v[204:207], v[148:151], v[124:127]
  ds_read_b64_tr_b16 v[202:203], v249 offset:51456
  v_max3_f32 v253, v253, v121, v122
  v_mfma_f32_16x16x32_bf16 v[116:119], v[208:211], v[152:155], v[116:119]
  ds_read_b64_tr_b16 v[204:205], v250 offset:49408
  v_mul_f32 v251, s70, v251
  v_mfma_f32_16x16x32_bf16 v[124:127], v[208:211], v[156:159], v[124:127]
  s_waitcnt lgkmcnt(3)
  ds_read_b64_tr_b16 v[206:207], v250 offset:51456
  v_cvt_pk_bf16_f32 v235, v235, v251
  v_mfma_f32_16x16x32_bf16 a[64:67], v[212:215], v[0:3], 0
  ds_read_b64_tr_b16 v[208:209], v249 offset:53248
  v_permlane16_swap_b32 v232, v234
  v_mfma_f32_16x16x32_bf16 a[72:75], v[212:215], v[4:7], 0
  ds_read_b64_tr_b16 v[210:211], v249 offset:55296
  v_permlane16_swap_b32 v233, v235
  v_mfma_f32_16x16x32_bf16 a[68:71], v[216:219], v[0:3], 0
  ds_read_b64_tr_b16 v[212:213], v250 offset:53248
  ds_read_b64_tr_b16 v[214:215], v250 offset:55296
  v_mfma_f32_16x16x32_bf16 a[76:79], v[216:219], v[4:7], 0
  s_waitcnt lgkmcnt(4)
  ds_write_b128 v243, v[232:235] offset:36864
  v_max3_f32 v253, v253, v123, v116
  v_mfma_f32_16x16x32_bf16 a[80:83], v[200:203], v[0:3], 0
  ds_read_b64_tr_b16 v[216:217], v249 offset:53504
  v_max3_f32 v253, v253, v117, v118
  v_mfma_f32_16x16x32_bf16 a[88:91], v[200:203], v[4:7], 0
  ds_read_b64_tr_b16 v[218:219], v249 offset:55552
  v_max3_f32 v253, v253, v119, v124
  v_max3_f32 v253, v253, v125, v126
  v_mfma_f32_16x16x32_bf16 a[84:87], v[204:207], v[0:3], 0
  ds_read_b64_tr_b16 v[200:201], v250 offset:53504
  v_max_f32 v253, v253, v127
  v_mfma_f32_16x16x32_bf16 a[92:95], v[204:207], v[4:7], 0
  s_waitcnt lgkmcnt(4)
  ds_read_b64_tr_b16 v[202:203], v250 offset:55552
  v_cmp_lt_f32 vcc, 0x41200000, v253
  v_accvgpr_read_b32 v232, a168
  v_mfma_f32_16x16x32_bf16 a[64:67], v[208:211], v[8:11], a[64:67]
  s_cbranch_vccnz L_r1_6t
L_r1_6:
  ds_read_b64_tr_b16 v[204:205], v249 offset:57344
  v_exp_f32 v96, v96
  v_mfma_f32_16x16x32_bf16 a[72:75], v[208:211], v[12:15], a[72:75]
  ds_read_b64_tr_b16 v[206:207], v249 offset:59392
  v_accvgpr_read_b32 v251, a169
  v_mfma_f32_16x16x32_bf16 a[68:71], v[212:215], v[8:11], a[68:71]
  ds_read_b64_tr_b16 v[208:209], v250 offset:57344
  v_exp_f32 v97, v97
  v_mfma_f32_16x16x32_bf16 a[76:79], v[212:215], v[12:15], a[76:79]
  s_waitcnt lgkmcnt(3)
  ds_read_b64_tr_b16 v[210:211], v250 offset:59392
  v_cvt_pk_bf16_f32 v96, v96, v97
  v_mfma_f32_16x16x32_bf16 a[80:83], v[216:219], v[8:11], a[80:83]
  ds_read_b64_tr_b16 v[212:213], v249 offset:57600
  v_exp_f32 v98, v98
  v_mfma_f32_16x16x32_bf16 a[88:91], v[216:219], v[12:15], a[88:91]
  ds_read_b64_tr_b16 v[214:215], v249 offset:59648
  v_mul_f32 v232, s70, v232
  v_mfma_f32_16x16x32_bf16 a[84:87], v[200:203], v[8:11], a[84:87]
  ds_read_b64_tr_b16 v[216:217], v250 offset:57600
  v_exp_f32 v99, v99
  v_mfma_f32_16x16x32_bf16 a[92:95], v[200:203], v[12:15], a[92:95]
  s_waitcnt lgkmcnt(3)
  ds_read_b64_tr_b16 v[218:219], v250 offset:59648
  v_cvt_pk_bf16_f32 v97, v98, v99
  v_mfma_f32_16x16x32_bf16 a[64:67], v[204:207], v[16:19], a[64:67]
  ds_read_b64_tr_b16 v[200:201], v249 offset:61440
  v_exp_f32 v100, v100
  v_mfma_f32_16x16x32_bf16 a[72:75], v[204:207], v[20:23], a[72:75]
  ds_read_b64_tr_b16 v[202:203], v249 offset:63488
  v_mul_f32 v251, s70, v251
  v_mfma_f32_16x16x32_bf16 a[68:71], v[208:211], v[16:19], a[68:71]
  ds_read_b64_tr_b16 v[204:205], v250 offset:61440
  v_exp_f32 v101, v101
  v_mfma_f32_16x16x32_bf16 a[76:79], v[208:211], v[20:23], a[76:79]
  s_waitcnt lgkmcnt(3)
  ds_read_b64_tr_b16 v[206:207], v250 offset:63488
  v_cvt_pk_bf16_f32 v98, v100, v101
  v_mfma_f32_16x16x32_bf16 a[80:83], v[212:215], v[16:19], a[80:83]
  ds_read_b64_tr_b16 v[208:209], v249 offset:61696
  ds_read_b64_tr_b16 v[210:211], v249 offset:63744
  v_mfma_f32_16x16x32_bf16 a[88:91], v[212:215], v[20:23], a[88:91]
  v_exp_f32 v102, v102
  v_mfma_f32_16x16x32_bf16 a[84:87], v[216:219], v[16:19], a[84:87]
  ds_read_b64_tr_b16 v[212:213], v250 offset:61696
  ds_read_b64_tr_b16 v[214:215], v250 offset:63744
  v_mfma_f32_16x16x32_bf16 a[92:95], v[216:219], v[20:23], a[92:95]
  s_waitcnt lgkmcnt(4)
  v_exp_f32 v103, v103
  v_mfma_f32_16x16x32_bf16 a[64:67], v[200:203], v[24:27], a[64:67]
  s_waitcnt vmcnt(4)
  s_barrier
  s_add_u32 m0, s68, 0
  ds_read_b64_tr_b16 v[216:217], v249 offset:16384
  ds_read_b64_tr_b16 v[218:219], v249 offset:18432
  v_mfma_f32_16x16x32_bf16 a[72:75], v[200:203], v[28:31], a[72:75]
  buffer_load_dwordx4 v236, s[8:11], s88 offen nt lds
  v_cvt_pk_bf16_f32 v99, v102, v103
  v_mfma_f32_16x16x32_bf16 a[68:71], v[204:207], v[24:27], a[68:71]
  ds_read_b64_tr_b16 v[200:201], v250 offset:16384
  v_exp_f32 v104, v104
  v_mfma_f32_16x16x32_bf16 a[76:79], v[204:207], v[28:31], a[76:79]
  s_waitcnt lgkmcnt(3)
  ds_read_b64_tr_b16 v[202:203], v250 offset:18432
  v_cvt_pk_bf16_f32 v232, v232, v251
  v_mfma_f32_16x16x32_bf16 v[224:227], v[220:223], v[96:99], v[224:227]
  v_exp_f32 v105, v105
  v_mfma_f32_16x16x32_bf16 a[80:83], v[208:211], v[24:27], a[80:83]
  ds_read_b64_tr_b16 v[204:205], v249 offset:16640
  ds_read_b64_tr_b16 v[206:207], v249 offset:18688
  v_mfma_f32_16x16x32_bf16 a[88:91], v[208:211], v[28:31], a[88:91]
  buffer_load_dwordx4 v236, s[8:11], s88 offen offset:1024 nt lds
  v_mfma_f32_16x16x32_bf16 a[84:87], v[212:215], v[24:27], a[84:87]
  ds_read_b64_tr_b16 v[208:209], v250 offset:16640
  v_cvt_pk_bf16_f32 v100, v104, v105
  v_mfma_f32_16x16x32_bf16 a[92:95], v[212:215], v[28:31], a[92:95]
  s_waitcnt lgkmcnt(3)
  ds_read_b64_tr_b16 v[210:211], v250 offset:18688
  v_exp_f32 v106, v106
  v_mfma_f32_16x16x32_bf16 a[96:99], v[216:219], v[0:3], 0
  ds_read_b64_tr_b16 v[212:213], v249 offset:20480
  ds_read_b64_tr_b16 v[214:215], v249 offset:22528
  v_mfma_f32_16x16x32_bf16 a[104:107], v[216:219], v[4:7], 0
  buffer_load_dwordx4 v236, s[8:11], s88 offen offset:2048 nt lds
  v_accvgpr_read_b32 v233, a170
  v_mfma_f32_16x16x32_bf16 a[100:103], v[200:203], v[0:3], 0
  ds_read_b64_tr_b16 v[216:217], v250 offset:20480
  v_exp_f32 v107, v107
  v_mfma_f32_16x16x32_bf16 a[108:111], v[200:203], v[4:7], 0
  s_waitcnt lgkmcnt(3)
  ds_read_b64_tr_b16 v[218:219], v250 offset:22528
  v_cvt_pk_bf16_f32 v101, v106, v107
  v_mfma_f32_16x16x32_bf16 a[112:115], v[204:207], v[0:3], 0
  ds_read_b64_tr_b16 v[200:201], v249 offset:20736
  ds_read_b64_tr_b16 v[202:203], v249 offset:22784
  v_mfma_f32_16x16x32_bf16 a[120:123], v[204:207], v[4:7], 0
  buffer_load_dwordx4 v236, s[8:11], s88 offen offset:3072 nt lds
  v_accvgpr_read_b32 v251, a171
  v_mfma_f32_16x16x32_bf16 a[116:119], v[208:211], v[0:3], 0
  ds_read_b64_tr_b16 v[204:205], v250 offset:20736
  v_exp_f32 v108, v108
  v_mfma_f32_16x16x32_bf16 a[124:127], v[208:211], v[4:7], 0
  s_waitcnt lgkmcnt(3)
  ds_read_b64_tr_b16 v[206:207], v250 offset:22784
  v_mul_f32 v233, s70, v233
  v_mfma_f32_16x16x32_bf16 a[96:99], v[212:215], v[8:11], a[96:99]
  s_add_u32 m0, s68, 98304
  ds_read_b64_tr_b16 v[208:209], v249 offset:24576
  ds_read_b64_tr_b16 v[210:211], v249 offset:26624
  v_mfma_f32_16x16x32_bf16 a[104:107], v[212:215], v[12:15], a[104:107]
  buffer_load_dwordx4 v237, s[12:15], s88 offen nt lds
  v_mul_f32 v251, s70, v251
  v_mfma_f32_16x16x32_bf16 a[100:103], v[216:219], v[8:11], a[100:103]
  ds_read_b64_tr_b16 v[212:213], v250 offset:24576
  v_exp_f32 v109, v109
  v_mfma_f32_16x16x32_bf16 a[108:111], v[216:219], v[12:15], a[108:111]
  s_waitcnt lgkmcnt(3)
  ds_read_b64_tr_b16 v[214:215], v250 offset:26624
  v_cvt_pk_bf16_f32 v102, v108, v109
  v_mfma_f32_16x16x32_bf16 a[112:115], v[200:203], v[8:11], a[112:115]
  ds_read_b64_tr_b16 v[216:217], v249 offset:24832
  ds_read_b64_tr_b16 v[218:219], v249 offset:26880
  v_mfma_f32_16x16x32_bf16 a[120:123], v[200:203], v[12:15], a[120:123]
  buffer_load_dwordx4 v237, s[12:15], s88 offen offset:1024 nt lds
  v_cvt_pk_bf16_f32 v233, v233, v251
  v_mfma_f32_16x16x32_bf16 a[116:119], v[204:207], v[8:11], a[116:119]
  ds_read_b64_tr_b16 v[200:201], v250 offset:24832
  v_exp_f32 v110, v110
  v_mfma_f32_16x16x32_bf16 a[124:127], v[204:207], v[12:15], a[124:127]
  s_waitcnt lgkmcnt(3)
  ds_read_b64_tr_b16 v[202:203], v250 offset:26880
  v_accvgpr_read_b32 v234, a172
  v_mfma_f32_16x16x32_bf16 a[96:99], v[208:211], v[16:19], a[96:99]
  ds_read_b64_tr_b16 v[204:205], v249 offset:28672
  ds_read_b64_tr_b16 v[206:207], v249 offset:30720
  v_mfma_f32_16x16x32_bf16 a[104:107], v[208:211], v[20:23], a[104:107]
  buffer_load_dwordx4 v237, s[12:15], s88 offen offset:2048 nt lds
  v_accvgpr_read_b32 v251, a173
  v_mfma_f32_16x16x32_bf16 a[100:103], v[212:215], v[16:19], a[100:103]
  ds_read_b64_tr_b16 v[208:209], v250 offset:28672
  v_exp_f32 v111, v111
  v_mfma_f32_16x16x32_bf16 a[108:111], v[212:215], v[20:23], a[108:111]
  s_waitcnt lgkmcnt(3)
  ds_read_b64_tr_b16 v[210:211], v250 offset:30720
  v_cvt_pk_bf16_f32 v103, v110, v111
  v_mfma_f32_16x16x32_bf16 a[112:115], v[216:219], v[16:19], a[112:115]
  ds_read_b64_tr_b16 v[212:213], v249 offset:28928
  ds_read_b64_tr_b16 v[214:215], v249 offset:30976
  v_mfma_f32_16x16x32_bf16 a[120:123], v[216:219], v[20:23], a[120:123]
  buffer_load_dwordx4 v237, s[12:15], s88 offen offset:3072 nt lds
  v_mul_f32 v234, s70, v234
  v_mfma_f32_16x16x32_bf16 v[228:231], v[220:223], v[100:103], v[228:231]
  v_exp_f32 v112, v112
  v_mfma_f32_16x16x32_bf16 a[116:119], v[200:203], v[16:19], a[116:119]
  ds_read_b64_tr_b16 v[216:217], v250 offset:28928
  v_exp_f32 v113, v113
  v_mfma_f32_16x16x32_bf16 a[124:127], v[200:203], v[20:23], a[124:127]
  s_waitcnt lgkmcnt(3)
  ds_read_b64_tr_b16 v[218:219], v250 offset:30976
  v_cvt_pk_bf16_f32 v104, v112, v113
  v_mfma_f32_16x16x32_bf16 a[96:99], v[204:207], v[24:27], a[96:99]
  s_waitcnt vmcnt(32)
  s_barrier
  s_add_u32 m0, s68, 147456
  ds_read_b64_tr_b16 v[200:201], v245 offset:16384
  ds_read_b64_tr_b16 v[202:203], v245 offset:17408
  v_mfma_f32_16x16x32_bf16 a[104:107], v[204:207], v[28:31], a[104:107]
  buffer_load_dwordx4 v240, s[48:51], s77 offen lds
  v_mul_f32 v251, s70, v251
  v_mfma_f32_16x16x32_bf16 a[100:103], v[208:211], v[24:27], a[100:103]
  ds_read_b64_tr_b16 v[204:205], v246 offset:16384
  v_exp_f32 v114, v114
  v_mfma_f32_16x16x32_bf16 a[108:111], v[208:211], v[28:31], a[108:111]
  s_waitcnt lgkmcnt(3)
  ds_read_b64_tr_b16 v[206:207], v246 offset:17408
  v_exp_f32 v115, v115
  v_mfma_f32_16x16x32_bf16 a[112:115], v[212:215], v[24:27], a[112:115]
  ds_read_b64_tr_b16 v[208:209], v245 offset:16640
  ds_read_b64_tr_b16 v[210:211], v245 offset:17664
  v_mfma_f32_16x16x32_bf16 a[120:123], v[212:215], v[28:31], a[120:123]
  buffer_load_dwordx4 v240, s[52:55], s77 offen offset:1024 lds
  v_cvt_pk_bf16_f32 v105, v114, v115
  v_mfma_f32_16x16x32_bf16 a[116:119], v[216:219], v[24:27], a[116:119]
  ds_read_b64_tr_b16 v[212:213], v246 offset:16640
  v_exp_f32 v116, v116
  v_mfma_f32_16x16x32_bf16 a[124:127], v[216:219], v[28:31], a[124:127]
  s_waitcnt lgkmcnt(3)
  ds_read_b64_tr_b16 v[214:215], v246 offset:17664
  v_exp_f32 v117, v117
  v_mfma_f32_16x16x32_bf16 v[32:35], v[200:203], v[96:99], v[32:35]
  ds_read_b64_tr_b16 v[216:217], v245 offset:16896
  v_cvt_pk_bf16_f32 v106, v116, v117
  v_mfma_f32_16x16x32_bf16 v[40:43], v[200:203], v[100:103], v[40:43]
  ds_read_b64_tr_b16 v[218:219], v245 offset:17920
  v_exp_f32 v118, v118
  v_mfma_f32_16x16x32_bf16 v[36:39], v[204:207], v[96:99], v[36:39]
  ds_read_b64_tr_b16 v[200:201], v246 offset:16896
  v_exp_f32 v119, v119
  v_mfma_f32_16x16x32_bf16 v[44:47], v[204:207], v[100:103], v[44:47]
  s_waitcnt lgkmcnt(3)
  ds_read_b64_tr_b16 v[202:203], v246 offset:17920
  v_cvt_pk_bf16_f32 v107, v118, v119
  v_cvt_pk_bf16_f32 v234, v234, v251
  v_mfma_f32_16x16x32_bf16 v[48:51], v[208:211], v[96:99], v[48:51]
  ds_read_b64_tr_b16 v[204:205], v245 offset:17152
  v_exp_f32 v120, v120
  v_mfma_f32_16x16x32_bf16 v[56:59], v[208:211], v[100:103], v[56:59]
  ds_read_b64_tr_b16 v[206:207], v245 offset:18176
  v_exp_f32 v121, v121
  v_mfma_f32_16x16x32_bf16 v[224:227], v[220:223], v[104:107], v[224:227]
  v_cvt_pk_bf16_f32 v108, v120, v121
  v_accvgpr_read_b32 v235, a174
  v_mfma_f32_16x16x32_bf16 v[52:55], v[212:215], v[96:99], v[52:55]
  ds_read_b64_tr_b16 v[208:209], v246 offset:17152
  v_exp_f32 v122, v122
  v_mfma_f32_16x16x32_bf16 v[60:63], v[212:215], v[100:103], v[60:63]
  s_waitcnt lgkmcnt(3)
  ds_read_b64_tr_b16 v[210:211], v246 offset:18176
  v_exp_f32 v123, v123
  v_mfma_f32_16x16x32_bf16 v[64:67], v[216:219], v[96:99], v[64:67]
  ds_read_b64_tr_b16 v[212:213], v245 offset:18432
  v_cvt_pk_bf16_f32 v109, v122, v123
  v_mfma_f32_16x16x32_bf16 v[72:75], v[216:219], v[100:103], v[72:75]
  ds_read_b64_tr_b16 v[214:215], v245 offset:19456
  v_exp_f32 v124, v124
  v_mfma_f32_16x16x32_bf16 v[68:71], v[200:203], v[96:99], v[68:71]
  ds_read_b64_tr_b16 v[216:217], v246 offset:18432
  v_exp_f32 v125, v125
  v_mfma_f32_16x16x32_bf16 v[76:79], v[200:203], v[100:103], v[76:79]
  s_waitcnt lgkmcnt(3)
  ds_read_b64_tr_b16 v[218:219], v246 offset:19456
  v_cvt_pk_bf16_f32 v110, v124, v125
  v_accvgpr_read_b32 v251, a175
  v_mfma_f32_16x16x32_bf16 v[80:83], v[204:207], v[96:99], v[80:83]
  ds_read_b64_tr_b16 v[200:201], v245 offset:18688
  v_exp_f32 v126, v126
  v_mfma_f32_16x16x32_bf16 v[88:91], v[204:207], v[100:103], v[88:91]
  ds_read_b64_tr_b16 v[202:203], v245 offset:19712
  v_exp_f32 v127, v127
  v_mul_f32 v235, s70, v235
  v_cvt_pk_bf16_f32 v111, v126, v127
  v_mfma_f32_16x16x32_bf16 v[84:87], v[208:211], v[96:99], v[84:87]
  ds_read_b64_tr_b16 v[204:205], v246 offset:18688
  v_mul_f32 v251, s70, v251
  v_mfma_f32_16x16x32_bf16 v[92:95], v[208:211], v[100:103], v[92:95]
  s_waitcnt lgkmcnt(3)
  ds_read_b64_tr_b16 v[206:207], v246 offset:19712
  v_cvt_pk_bf16_f32 v235, v235, v251
  v_mfma_f32_16x16x32_bf16 v[228:231], v[220:223], v[108:111], v[228:231]
  v_permlane16_swap_b32 v232, v234
  v_permlane16_swap_b32 v233, v235
  v_mfma_f32_16x16x32_bf16 v[32:35], v[212:215], v[104:107], v[32:35]
  ds_read_b64_tr_b16 v[208:209], v245 offset:18944
  ds_read_b64_tr_b16 v[210:211], v245 offset:19968
  v_mfma_f32_16x16x32_bf16 v[40:43], v[212:215], v[108:111], v[40:43]
  ds_write_b128 v243, v[232:235] offset:37888
  v_mfma_f32_16x16x32_bf16 v[36:39], v[216:219], v[104:107], v[36:39]
  ds_read_b64_tr_b16 v[212:213], v246 offset:18944
  v_accvgpr_read_b32 v232, a176
  v_mfma_f32_16x16x32_bf16 v[44:47], v[216:219], v[108:111], v[44:47]
  s_waitcnt lgkmcnt(4)
  ds_read_b64_tr_b16 v[214:215], v246 offset:19968
  v_accvgpr_read_b32 v251, a177
  v_mfma_f32_16x16x32_bf16 v[48:51], v[200:203], v[104:107], v[48:51]
  ds_read_b64_tr_b16 v[216:217], v245 offset:19200
  v_mul_f32 v232, s70, v232
  v_mfma_f32_16x16x32_bf16 v[56:59], v[200:203], v[108:111], v[56:59]
  ds_read_b64_tr_b16 v[218:219], v245 offset:20224
  v_mul_f32 v251, s70, v251
  v_mfma_f32_16x16x32_bf16 v[52:55], v[204:207], v[104:107], v[52:55]
  ds_read_b64_tr_b16 v[200:201], v246 offset:19200
  v_cvt_pk_bf16_f32 v232, v232, v251
  v_mfma_f32_16x16x32_bf16 v[60:63], v[204:207], v[108:111], v[60:63]
  s_waitcnt lgkmcnt(3)
  ds_read_b64_tr_b16 v[202:203], v246 offset:20224
  v_accvgpr_read_b32 v233, a178
  v_mfma_f32_16x16x32_bf16 v[64:67], v[208:211], v[104:107], v[64:67]
  s_waitcnt vmcnt(22)
  s_barrier
  ds_read_b128 v[204:207], v241 offset:16384
  v_mfma_f32_16x16x32_bf16 v[72:75], v[208:211], v[108:111], v[72:75]
  v_accvgpr_read_b32 v251, a179
  v_mul_f32 v233, s70, v233
  v_mfma_f32_16x16x32_bf16 v[68:71], v[212:215], v[104:107], v[68:71]
  ds_read_b128 v[208:211], v242 offset:16384
  v_mul_f32 v251, s70, v251
  v_mfma_f32_16x16x32_bf16 v[76:79], v[212:215], v[108:111], v[76:79]
  s_waitcnt lgkmcnt(2)
  buffer_load_dwordx4 v240, s[56:59], s77 offen offset:2048 lds
  v_mfma_f32_16x16x32_bf16 v[80:83], v[216:219], v[104:107], v[80:83]
  ds_read_b128 v[212:215], v241 offset:24576
  v_cvt_pk_bf16_f32 v233, v233, v251
  v_mfma_f32_16x16x32_bf16 v[88:91], v[216:219], v[108:111], v[88:91]
  v_accvgpr_read_b32 v234, a180
  v_accvgpr_read_b32 v251, a181
  v_mfma_f32_16x16x32_bf16 v[84:87], v[200:203], v[104:107], v[84:87]
  ds_read_b128 v[216:219], v242 offset:24576
  v_mul_f32 v234, s70, v234
  v_mfma_f32_16x16x32_bf16 v[92:95], v[200:203], v[108:111], v[92:95]
  s_waitcnt lgkmcnt(2)
  v_mul_f32 v251, s70, v251
  v_cvt_pk_bf16_f32 v234, v234, v251
  v_mfma_f32_16x16x32_bf16 v[96:99], v[204:207], v[128:131], v[192:195]
  ds_read_b128 v[200:203], v241 offset:17408
  v_accvgpr_read_b32 v235, a182
  v_mfma_f32_16x16x32_bf16 v[104:107], v[204:207], v[132:135], v[196:199]
  buffer_load_dwordx4 v240, s[60:63], s77 offen offset:3072 lds
  v_mfma_f32_16x16x32_bf16 v[96:99], v[208:211], v[136:139], v[96:99]
  ds_read_b128 v[204:207], v242 offset:17408
  v_accvgpr_read_b32 v251, a183
  v_mfma_f32_16x16x32_bf16 v[104:107], v[208:211], v[140:143], v[104:107]
  s_waitcnt lgkmcnt(2)
  v_mul_f32 v235, s70, v235
  v_mul_f32 v251, s70, v251
  v_mfma_f32_16x16x32_bf16 v[96:99], v[212:215], v[144:147], v[96:99]
  s_add_u32 m0, s68, 114688
  ds_read_b128 v[208:211], v241 offset:25600
  v_cvt_pk_bf16_f32 v235, v235, v251
  v_mfma_f32_16x16x32_bf16 v[104:107], v[212:215], v[148:151], v[104:107]
  buffer_load_dwordx4 v240, s[48:51], s78 offen lds
  v_mfma_f32_16x16x32_bf16 v[96:99], v[216:219], v[152:155], v[96:99]
  ds_read_b128 v[212:215], v242 offset:25600
  v_permlane16_swap_b32 v232, v234
  v_mfma_f32_16x16x32_bf16 v[104:107], v[216:219], v[156:159], v[104:107]
  s_waitcnt lgkmcnt(2)
  v_permlane16_swap_b32 v233, v235
  v_mfma_f32_16x16x32_bf16 v[100:103], v[200:203], v[128:131], v[192:195]
  ds_read_b128 v[216:219], v241 offset:18432
  v_mfma_f32_16x16x32_bf16 v[108:111], v[200:203], v[132:135], v[196:199]
  buffer_load_dwordx4 v240, s[52:55], s78 offen offset:1024 lds
  v_mfma_f32_16x16x32_bf16 v[100:103], v[204:207], v[136:139], v[100:103]
  ds_read_b128 v[200:203], v242 offset:18432
  v_max3_f32 v253, v96, v97, v98
  v_mfma_f32_16x16x32_bf16 v[108:111], v[204:207], v[140:143], v[108:111]
  s_waitcnt lgkmcnt(2)
  ds_write_b128 v243, v[232:235] offset:38912
  v_mfma_f32_16x16x32_bf16 v[100:103], v[208:211], v[144:147], v[100:103]
  ds_read_b128 v[204:207], v241 offset:26624
  v_accvgpr_read_b32 v232, a184
  v_mfma_f32_16x16x32_bf16 v[108:111], v[208:211], v[148:151], v[108:111]
  buffer_load_dwordx4 v240, s[56:59], s78 offen offset:2048 lds
  v_mfma_f32_16x16x32_bf16 v[100:103], v[212:215], v[152:155], v[100:103]
  ds_read_b128 v[208:211], v242 offset:26624
  v_accvgpr_read_b32 v251, a185
  v_mfma_f32_16x16x32_bf16 v[108:111], v[212:215], v[156:159], v[108:111]
  s_waitcnt lgkmcnt(3)
  v_mul_f32 v232, s70, v232
  v_mul_f32 v251, s70, v251
  v_mfma_f32_16x16x32_bf16 v[112:115], v[216:219], v[128:131], v[192:195]
  ds_read_b128 v[212:215], v241 offset:19456
  v_cvt_pk_bf16_f32 v232, v232, v251
  v_mfma_f32_16x16x32_bf16 v[120:123], v[216:219], v[132:135], v[196:199]
  buffer_load_dwordx4 v240, s[60:63], s78 offen offset:3072 lds
  v_mfma_f32_16x16x32_bf16 v[112:115], v[200:203], v[136:139], v[112:115]
  ds_read_b128 v[216:219], v242 offset:19456
  v_accvgpr_read_b32 v233, a186
  v_mfma_f32_16x16x32_bf16 v[120:123], v[200:203], v[140:143], v[120:123]
  s_waitcnt lgkmcnt(2)
  v_accvgpr_read_b32 v251, a187
  v_mul_f32 v233, s70, v233
  v_mfma_f32_16x16x32_bf16 v[112:115], v[204:207], v[144:147], v[112:115]
  ds_read_b128 v[200:203], v241 offset:27648
  v_mul_f32 v251, s70, v251
  v_mfma_f32_16x16x32_bf16 v[120:123], v[204:207], v[148:151], v[120:123]
  v_cvt_pk_bf16_f32 v233, v233, v251
  v_accvgpr_read_b32 v234, a188
  v_mfma_f32_16x16x32_bf16 v[112:115], v[208:211], v[152:155], v[112:115]
  ds_read_b128 v[204:207], v242 offset:27648
  v_accvgpr_read_b32 v251, a189
  v_mfma_f32_16x16x32_bf16 v[120:123], v[208:211], v[156:159], v[120:123]
  s_waitcnt lgkmcnt(2)
  v_mul_f32 v234, s70, v234
  v_mul_f32 v251, s70, v251
  v_mfma_f32_16x16x32_bf16 v[116:119], v[212:215], v[128:131], v[192:195]
  s_waitcnt vmcnt(16)
  s_barrier
  ds_read_b64_tr_b16 v[208:209], v249 offset:32768
  v_mfma_f32_16x16x32_bf16 v[124:127], v[212:215], v[132:135], v[196:199]
  ds_read_b64_tr_b16 v[210:211], v249 offset:34816
  v_cvt_pk_bf16_f32 v234, v234, v251
  v_mfma_f32_16x16x32_bf16 v[116:119], v[216:219], v[136:139], v[116:119]
  ds_read_b64_tr_b16 v[212:213], v250 offset:32768
  v_accvgpr_read_b32 v235, a190
  v_mfma_f32_16x16x32_bf16 v[124:127], v[216:219], v[140:143], v[124:127]
  s_waitcnt lgkmcnt(3)
  ds_read_b64_tr_b16 v[214:215], v250 offset:34816
  v_accvgpr_read_b32 v251, a191
  v_mfma_f32_16x16x32_bf16 v[116:119], v[200:203], v[144:147], v[116:119]
  ds_read_b64_tr_b16 v[216:217], v249 offset:33024
  v_mul_f32 v235, s70, v235
  v_mfma_f32_16x16x32_bf16 v[124:127], v[200:203], v[148:151], v[124:127]
  ds_read_b64_tr_b16 v[218:219], v249 offset:35072
  v_mul_f32 v251, s70, v251
  v_mfma_f32_16x16x32_bf16 v[116:119], v[204:207], v[152:155], v[116:119]
  ds_read_b64_tr_b16 v[200:201], v250 offset:33024
  v_cvt_pk_bf16_f32 v235, v235, v251
  v_mfma_f32_16x16x32_bf16 v[124:127], v[204:207], v[156:159], v[124:127]
  s_waitcnt lgkmcnt(3)
  ds_read_b64_tr_b16 v[202:203], v250 offset:35072
  v_permlane16_swap_b32 v232, v234
  v_mfma_f32_16x16x32_bf16 a[128:131], v[208:211], v[0:3], 0
  ds_read_b64_tr_b16 v[204:205], v249 offset:36864
  v_permlane16_swap_b32 v233, v235
  v_mfma_f32_16x16x32_bf16 a[136:139], v[208:211], v[4:7], 0
  ds_read_b64_tr_b16 v[206:207], v249 offset:38912
  ds_write_b128 v243, v[232:235] offset:39936
  v_mfma_f32_16x16x32_bf16 a[132:135], v[212:215], v[0:3], 0
  ds_read_b64_tr_b16 v[208:209], v250 offset:36864
  v_max3_f32 v253, v253, v99, v104
  v_mfma_f32_16x16x32_bf16 a[140:143], v[212:215], v[4:7], 0
  s_waitcnt lgkmcnt(4)
  ds_read_b64_tr_b16 v[210:211], v250 offset:38912
  v_max3_f32 v253, v253, v105, v106
  v_max3_f32 v253, v253, v107, v100
  v_mfma_f32_16x16x32_bf16 a[144:147], v[216:219], v[0:3], 0
  ds_read_b64_tr_b16 v[212:213], v249 offset:37120
  v_max3_f32 v253, v253, v101, v102
  v_mfma_f32_16x16x32_bf16 a[152:155], v[216:219], v[4:7], 0
  ds_read_b64_tr_b16 v[214:215], v249 offset:39168
  v_max3_f32 v253, v253, v103, v108
  v_max3_f32 v253, v253, v109, v110
  v_mfma_f32_16x16x32_bf16 a[148:151], v[200:203], v[0:3], 0
  ds_read_b64_tr_b16 v[216:217], v250 offset:37120
  v_max3_f32 v253, v253, v111, v112
  v_mfma_f32_16x16x32_bf16 a[156:159], v[200:203], v[4:7], 0
  s_waitcnt lgkmcnt(3)
  ds_read_b64_tr_b16 v[218:219], v250 offset:39168
  v_max3_f32 v253, v253, v113, v114
  v_max3_f32 v253, v253, v115, v120
  v_mfma_f32_16x16x32_bf16 a[128:131], v[204:207], v[8:11], a[128:131]
  ds_read_b64_tr_b16 v[200:201], v249 offset:40960
  v_max3_f32 v253, v253, v121, v122
  v_mfma_f32_16x16x32_bf16 a[136:139], v[204:207], v[12:15], a[136:139]
  ds_read_b64_tr_b16 v[202:203], v249 offset:43008
  v_max3_f32 v253, v253, v123, v116
  v_max3_f32 v253, v253, v117, v118
  v_mfma_f32_16x16x32_bf16 a[132:135], v[208:211], v[8:11], a[132:135]
  ds_read_b64_tr_b16 v[204:205], v250 offset:40960
  v_max3_f32 v253, v253, v119, v124
  v_mfma_f32_16x16x32_bf16 a[140:143], v[208:211], v[12:15], a[140:143]
  s_waitcnt lgkmcnt(3)
  ds_read_b64_tr_b16 v[206:207], v250 offset:43008
  v_max3_f32 v253, v253, v125, v126
  v_max_f32 v253, v253, v127
  v_mfma_f32_16x16x32_bf16 a[144:147], v[212:215], v[8:11], a[144:147]
  ds_read_b64_tr_b16 v[208:209], v249 offset:41216
  v_cmp_lt_f32 vcc, 0x41200000, v253
  v_mfma_f32_16x16x32_bf16 a[152:155], v[212:215], v[12:15], a[152:155]
  s_cbranch_vccnz L_r1_7t
L_r1_7:
  ds_read_b64_tr_b16 v[210:211], v249 offset:43264
  v_exp_f32 v96, v96
  v_mfma_f32_16x16x32_bf16 a[148:151], v[216:219], v[8:11], a[148:151]
  ds_read_b64_tr_b16 v[212:213], v250 offset:41216
  ds_read_b64_tr_b16 v[214:215], v250 offset:43264
  v_mfma_f32_16x16x32_bf16 a[156:159], v[216:219], v[12:15], a[156:159]
  s_waitcnt lgkmcnt(4)
  v_exp_f32 v97, v97
  v_mfma_f32_16x16x32_bf16 a[128:131], v[200:203], v[16:19], a[128:131]
  ds_read_b64_tr_b16 v[216:217], v249 offset:45056
  v_cvt_pk_bf16_f32 v96, v96, v97
  v_mfma_f32_16x16x32_bf16 a[136:139], v[200:203], v[20:23], a[136:139]
  ds_read_b64_tr_b16 v[218:219], v249 offset:47104
  v_exp_f32 v98, v98
  v_mfma_f32_16x16x32_bf16 a[132:135], v[204:207], v[16:19], a[132:135]
  ds_read_b64_tr_b16 v[200:201], v250 offset:45056
  ds_read_b64_tr_b16 v[202:203], v250 offset:47104
  v_mfma_f32_16x16x32_bf16 a[140:143], v[204:207], v[20:23], a[140:143]
  s_waitcnt lgkmcnt(4)
  v_exp_f32 v99, v99
  v_mfma_f32_16x16x32_bf16 a[144:147], v[208:211], v[16:19], a[144:147]
  ds_read_b64_tr_b16 v[204:205], v249 offset:45312
  v_cvt_pk_bf16_f32 v97, v98, v99
  v_mfma_f32_16x16x32_bf16 a[152:155], v[208:211], v[20:23], a[152:155]
  ds_read_b64_tr_b16 v[206:207], v249 offset:47360
  v_exp_f32 v100, v100
  v_mfma_f32_16x16x32_bf16 a[148:151], v[212:215], v[16:19], a[148:151]
  ds_read_b64_tr_b16 v[208:209], v250 offset:45312
  ds_read_b64_tr_b16 v[210:211], v250 offset:47360
  v_mfma_f32_16x16x32_bf16 a[156:159], v[212:215], v[20:23], a[156:159]
  s_waitcnt lgkmcnt(4)
  v_exp_f32 v101, v101
  v_mfma_f32_16x16x32_bf16 a[128:131], v[216:219], v[24:27], a[128:131]
  s_waitcnt vmcnt(4)
  s_barrier
  s_add_u32 m0, s68, 16384
  ds_read_b64_tr_b16 v[212:213], v249 offset:49152
  ds_read_b64_tr_b16 v[214:215], v249 offset:51200
  v_mfma_f32_16x16x32_bf16 a[136:139], v[216:219], v[28:31], a[136:139]
  buffer_load_dwordx4 v236, s[8:11], s89 offen nt lds
  v_cvt_pk_bf16_f32 v98, v100, v101
  v_mfma_f32_16x16x32_bf16 a[132:135], v[200:203], v[24:27], a[132:135]
  ds_read_b64_tr_b16 v[216:217], v250 offset:49152
  ds_read_b64_tr_b16 v[218:219], v250 offset:51200
  v_mfma_f32_16x16x32_bf16 a[140:143], v[200:203], v[28:31], a[140:143]
  s_waitcnt lgkmcnt(4)
  v_exp_f32 v102, v102
  v_mfma_f32_16x16x32_bf16 a[144:147], v[204:207], v[24:27], a[144:147]
  ds_read_b64_tr_b16 v[200:201], v249 offset:49408
  ds_read_b64_tr_b16 v[202:203], v249 offset:51456
  v_mfma_f32_16x16x32_bf16 a[152:155], v[204:207], v[28:31], a[152:155]
  buffer_load_dwordx4 v236, s[8:11], s89 offen offset:1024 nt lds
  v_mfma_f32_16x16x32_bf16 a[148:151], v[208:211], v[24:27], a[148:151]
  ds_read_b64_tr_b16 v[204:205], v250 offset:49408
  ds_read_b64_tr_b16 v[206:207], v250 offset:51456
  v_mfma_f32_16x16x32_bf16 a[156:159], v[208:211], v[28:31], a[156:159]
  s_waitcnt lgkmcnt(4)
  v_exp_f32 v103, v103
  v_mfma_f32_16x16x32_bf16 a[160:163], v[212:215], v[0:3], 0
  ds_read_b64_tr_b16 v[208:209], v249 offset:53248
  ds_read_b64_tr_b16 v[210:211], v249 offset:55296
  v_mfma_f32_16x16x32_bf16 a[168:171], v[212:215], v[4:7], 0
  buffer_load_dwordx4 v236, s[8:11], s89 offen offset:2048 nt lds
  v_cvt_pk_bf16_f32 v99, v102, v103
  v_mfma_f32_16x16x32_bf16 a[164:167], v[216:219], v[0:3], 0
  ds_read_b64_tr_b16 v[212:213], v250 offset:53248
  ds_read_b64_tr_b16 v[214:215], v250 offset:55296
  v_mfma_f32_16x16x32_bf16 a[172:175], v[216:219], v[4:7], 0
  s_waitcnt lgkmcnt(4)
  v_exp_f32 v104, v104
  v_mfma_f32_16x16x32_bf16 v[224:227], v[220:223], v[96:99], v[224:227]
  v_exp_f32 v105, v105
  v_mfma_f32_16x16x32_bf16 a[176:179], v[200:203], v[0:3], 0
  ds_read_b64_tr_b16 v[216:217], v249 offset:53504
  ds_read_b64_tr_b16 v[218:219], v249 offset:55552
  v_mfma_f32_16x16x32_bf16 a[184:187], v[200:203], v[4:7], 0
  buffer_load_dwordx4 v236, s[8:11], s89 offen offset:3072 nt lds
  v_cvt_pk_bf16_f32 v100, v104, v105
  v_mfma_f32_16x16x32_bf16 a[180:183], v[204:207], v[0:3], 0
  ds_read_b64_tr_b16 v[200:201], v250 offset:53504
  ds_read_b64_tr_b16 v[202:203], v250 offset:55552
  v_mfma_f32_16x16x32_bf16 a[188:191], v[204:207], v[4:7], 0
  s_waitcnt lgkmcnt(4)
  v_exp_f32 v106, v106
  v_mfma_f32_16x16x32_bf16 a[160:163], v[208:211], v[8:11], a[160:163]
  s_add_u32 m0, s68, 81920
  ds_read_b64_tr_b16 v[204:205], v249 offset:57344
  ds_read_b64_tr_b16 v[206:207], v249 offset:59392
  v_mfma_f32_16x16x32_bf16 a[168:171], v[208:211], v[12:15], a[168:171]
  buffer_load_dwordx4 v237, s[12:15], s89 offen nt lds
  v_mfma_f32_16x16x32_bf16 a[164:167], v[212:215], v[8:11], a[164:167]
  ds_read_b64_tr_b16 v[208:209], v250 offset:57344
  ds_read_b64_tr_b16 v[210:211], v250 offset:59392
  v_mfma_f32_16x16x32_bf16 a[172:175], v[212:215], v[12:15], a[172:175]
  s_waitcnt lgkmcnt(4)
  v_exp_f32 v107, v107
  v_mfma_f32_16x16x32_bf16 a[176:179], v[216:219], v[8:11], a[176:179]
  ds_read_b64_tr_b16 v[212:213], v249 offset:57600
  ds_read_b64_tr_b16 v[214:215], v249 offset:59648
  v_mfma_f32_16x16x32_bf16 a[184:187], v[216:219], v[12:15], a[184:187]
  buffer_load_dwordx4 v237, s[12:15], s89 offen offset:1024 nt lds
  v_cvt_pk_bf16_f32 v101, v106, v107
  v_mfma_f32_16x16x32_bf16 a[180:183], v[200:203], v[8:11], a[180:183]
  ds_read_b64_tr_b16 v[216:217], v250 offset:57600
  ds_read_b64_tr_b16 v[218:219], v250 offset:59648
  v_mfma_f32_16x16x32_bf16 a[188:191], v[200:203], v[12:15], a[188:191]
  s_waitcnt lgkmcnt(4)
  v_exp_f32 v108, v108
  v_mfma_f32_16x16x32_bf16 a[160:163], v[204:207], v[16:19], a[160:163]
  ds_read_b64_tr_b16 v[200:201], v249 offset:61440
  ds_read_b64_tr_b16 v[202:203], v249 offset:63488
  v_mfma_f32_16x16x32_bf16 a[168:171], v[204:207], v[20:23], a[168:171]
  buffer_load_dwordx4 v237, s[12:15], s89 offen offset:2048 nt lds
  v_mfma_f32_16x16x32_bf16 a[164:167], v[208:211], v[16:19], a[164:167]
  ds_read_b64_tr_b16 v[204:205], v250 offset:61440
  ds_read_b64_tr_b16 v[206:207], v250 offset:63488
  v_mfma_f32_16x16x32_bf16 a[172:175], v[208:211], v[20:23], a[172:175]
  s_waitcnt lgkmcnt(4)
  v_exp_f32 v109, v109
  v_mfma_f32_16x16x32_bf16 a[176:179], v[212:215], v[16:19], a[176:179]
  ds_read_b64_tr_b16 v[208:209], v249 offset:61696
  ds_read_b64_tr_b16 v[210:211], v249 offset:63744
  v_mfma_f32_16x16x32_bf16 a[184:187], v[212:215], v[20:23], a[184:187]
  buffer_load_dwordx4 v237, s[12:15], s89 offen offset:3072 nt lds
  v_cvt_pk_bf16_f32 v102, v108, v109
  v_mfma_f32_16x16x32_bf16 a[180:183], v[216:219], v[16:19], a[180:183]
  ds_read_b64_tr_b16 v[212:213], v250 offset:61696
  ds_read_b64_tr_b16 v[214:215], v250 offset:63744
  v_mfma_f32_16x16x32_bf16 a[188:191], v[216:219], v[20:23], a[188:191]
  s_waitcnt lgkmcnt(4)
  v_exp_f32 v110, v110
  v_mfma_f32_16x16x32_bf16 a[160:163], v[200:203], v[24:27], a[160:163]
  s_waitcnt vmcnt(32)
  s_barrier
  s_add_u32 m0, s68, 131072
  ds_read_b64_tr_b16 v[216:217], v245 offset:0
  ds_read_b64_tr_b16 v[218:219], v245 offset:1024
  v_mfma_f32_16x16x32_bf16 a[168:171], v[200:203], v[28:31], a[168:171]
  buffer_load_dwordx4 v240, s[48:51], s79 offen lds
  v_mfma_f32_16x16x32_bf16 a[164:167], v[204:207], v[24:27], a[164:167]
  ds_read_b64_tr_b16 v[200:201], v246 offset:0
  ds_read_b64_tr_b16 v[202:203], v246 offset:1024
  v_mfma_f32_16x16x32_bf16 a[172:175], v[204:207], v[28:31], a[172:175]
  s_waitcnt lgkmcnt(4)
  v_exp_f32 v111, v111
  v_mfma_f32_16x16x32_bf16 a[176:179], v[208:211], v[24:27], a[176:179]
  ds_read_b64_tr_b16 v[204:205], v245 offset:256
  ds_read_b64_tr_b16 v[206:207], v245 offset:1280
  v_mfma_f32_16x16x32_bf16 a[184:187], v[208:211], v[28:31], a[184:187]
  buffer_load_dwordx4 v240, s[52:55], s79 offen offset:1024 lds
  v_cvt_pk_bf16_f32 v103, v110, v111
  v_mfma_f32_16x16x32_bf16 a[180:183], v[212:215], v[24:27], a[180:183]
  ds_read_b64_tr_b16 v[208:209], v246 offset:256
  ds_read_b64_tr_b16 v[210:211], v246 offset:1280
  v_mfma_f32_16x16x32_bf16 a[188:191], v[212:215], v[28:31], a[188:191]
  s_waitcnt lgkmcnt(4)
  v_exp_f32 v112, v112
  v_mfma_f32_16x16x32_bf16 v[228:231], v[220:223], v[100:103], v[228:231]
  v_exp_f32 v113, v113
  v_mfma_f32_16x16x32_bf16 v[32:35], v[216:219], v[96:99], v[32:35]
  ds_read_b64_tr_b16 v[212:213], v245 offset:512
  v_cvt_pk_bf16_f32 v104, v112, v113
  v_mfma_f32_16x16x32_bf16 v[40:43], v[216:219], v[100:103], v[40:43]
  ds_read_b64_tr_b16 v[214:215], v245 offset:1536
  v_exp_f32 v114, v114
  v_mfma_f32_16x16x32_bf16 v[36:39], v[200:203], v[96:99], v[36:39]
  ds_read_b64_tr_b16 v[216:217], v246 offset:512
  ds_read_b64_tr_b16 v[218:219], v246 offset:1536
  v_mfma_f32_16x16x32_bf16 v[44:47], v[200:203], v[100:103], v[44:47]
  s_waitcnt lgkmcnt(4)
  v_exp_f32 v115, v115
  v_mfma_f32_16x16x32_bf16 v[48:51], v[204:207], v[96:99], v[48:51]
  ds_read_b64_tr_b16 v[200:201], v245 offset:768
  v_cvt_pk_bf16_f32 v105, v114, v115
  v_mfma_f32_16x16x32_bf16 v[56:59], v[204:207], v[100:103], v[56:59]
  ds_read_b64_tr_b16 v[202:203], v245 offset:1792
  v_exp_f32 v116, v116
  v_mfma_f32_16x16x32_bf16 v[52:55], v[208:211], v[96:99], v[52:55]
  ds_read_b64_tr_b16 v[204:205], v246 offset:768
  ds_read_b64_tr_b16 v[206:207], v246 offset:1792
  v_mfma_f32_16x16x32_bf16 v[60:63], v[208:211], v[100:103], v[60:63]
  s_waitcnt lgkmcnt(4)
  v_exp_f32 v117, v117
  v_mfma_f32_16x16x32_bf16 v[64:67], v[212:215], v[96:99], v[64:67]
  ds_read_b64_tr_b16 v[208:209], v245 offset:2048
  v_cvt_pk_bf16_f32 v106, v116, v117
  v_mfma_f32_16x16x32_bf16 v[72:75], v[212:215], v[100:103], v[72:75]
  ds_read_b64_tr_b16 v[210:211], v245 offset:3072
  v_exp_f32 v118, v118
  v_mfma_f32_16x16x32_bf16 v[68:71], v[216:219], v[96:99], v[68:71]
  ds_read_b64_tr_b16 v[212:213], v246 offset:2048
  ds_read_b64_tr_b16 v[214:215], v246 offset:3072
  v_mfma_f32_16x16x32_bf16 v[76:79], v[216:219], v[100:103], v[76:79]
  s_waitcnt lgkmcnt(4)
  v_exp_f32 v119, v119
  v_mfma_f32_16x16x32_bf16 v[80:83], v[200:203], v[96:99], v[80:83]
  ds_read_b64_tr_b16 v[216:217], v245 offset:2304
  v_cvt_pk_bf16_f32 v107, v118, v119
  v_mfma_f32_16x16x32_bf16 v[88:91], v[200:203], v[100:103], v[88:91]
  ds_read_b64_tr_b16 v[218:219], v245 offset:3328
  v_exp_f32 v120, v120
  v_exp_f32 v121, v121
  v_exp_f32 v122, v122
  v_cvt_pk_bf16_f32 v108, v120, v121
  v_exp_f32 v123, v123
  v_exp_f32 v124, v124
  v_cvt_pk_bf16_f32 v109, v122, v123
  v_exp_f32 v125, v125
  v_exp_f32 v126, v126
  v_cvt_pk_bf16_f32 v110, v124, v125
  v_exp_f32 v127, v127
  s_nop 0
  v_cvt_pk_bf16_f32 v111, v126, v127
  v_mfma_f32_16x16x32_bf16 v[84:87], v[204:207], v[96:99], v[84:87]
  ds_read_b64_tr_b16 v[200:201], v246 offset:2304
  v_mfma_f32_16x16x32_bf16 v[92:95], v[204:207], v[100:103], v[92:95]
  s_waitcnt lgkmcnt(3)
  ds_read_b64_tr_b16 v[202:203], v246 offset:3328
  v_mfma_f32_16x16x32_bf16 v[32:35], v[208:211], v[104:107], v[32:35]
  ds_read_b64_tr_b16 v[204:205], v245 offset:2560
  v_mfma_f32_16x16x32_bf16 v[40:43], v[208:211], v[108:111], v[40:43]
  ds_read_b64_tr_b16 v[206:207], v245 offset:3584
  v_mfma_f32_16x16x32_bf16 v[36:39], v[212:215], v[104:107], v[36:39]
  ds_read_b64_tr_b16 v[208:209], v246 offset:2560
  v_mfma_f32_16x16x32_bf16 v[44:47], v[212:215], v[108:111], v[44:47]
  s_waitcnt lgkmcnt(3)
  ds_read_b64_tr_b16 v[210:211], v246 offset:3584
  v_mfma_f32_16x16x32_bf16 v[48:51], v[216:219], v[104:107], v[48:51]
  ds_read_b64_tr_b16 v[212:213], v245 offset:2816
  v_mfma_f32_16x16x32_bf16 v[56:59], v[216:219], v[108:111], v[56:59]
  ds_read_b64_tr_b16 v[214:215], v245 offset:3840
  v_mfma_f32_16x16x32_bf16 v[52:55], v[200:203], v[104:107], v[52:55]
  ds_read_b64_tr_b16 v[216:217], v246 offset:2816
  v_mfma_f32_16x16x32_bf16 v[60:63], v[200:203], v[108:111], v[60:63]
  s_waitcnt lgkmcnt(3)
  ds_read_b64_tr_b16 v[218:219], v246 offset:3840
  v_mfma_f32_16x16x32_bf16 v[64:67], v[204:207], v[104:107], v[64:67]
  s_waitcnt vmcnt(22)
  s_barrier
  ds_read_b128 v[200:203], v241 offset:0
  v_mfma_f32_16x16x32_bf16 v[72:75], v[204:207], v[108:111], v[72:75]
  v_mfma_f32_16x16x32_bf16 v[224:227], v[220:223], v[104:107], v[224:227]
  v_mfma_f32_16x16x32_bf16 v[68:71], v[208:211], v[104:107], v[68:71]
  ds_read_b128 v[204:207], v242 offset:0
  v_mfma_f32_16x16x32_bf16 v[76:79], v[208:211], v[108:111], v[76:79]
  s_waitcnt lgkmcnt(2)
  v_mfma_f32_16x16x32_bf16 v[228:231], v[220:223], v[108:111], v[228:231]
  v_mfma_f32_16x16x32_bf16 v[80:83], v[212:215], v[104:107], v[80:83]
  ds_read_b128 v[208:211], v241 offset:8192
  v_mfma_f32_16x16x32_bf16 v[88:91], v[212:215], v[108:111], v[88:91]
  buffer_load_dwordx4 v240, s[56:59], s79 offen offset:2048 lds
  v_mfma_f32_16x16x32_bf16 v[84:87], v[216:219], v[104:107], v[84:87]
  ds_read_b128 v[212:215], v242 offset:8192
  v_mfma_f32_16x16x32_bf16 v[92:95], v[216:219], v[108:111], v[92:95]
  s_waitcnt lgkmcnt(2)
  v_rcp_f32 v238, v224
  v_mfma_f32_16x16x32_bf16 v[96:99], v[200:203], v[160:163], 0
  ds_read_b128 v[216:219], v241 offset:1024
  v_mfma_f32_16x16x32_bf16 v[104:107], v[200:203], v[164:167], 0
  v_rcp_f32 v244, v228
  v_mfma_f32_16x16x32_bf16 v[96:99], v[204:207], v[168:171], v[96:99]
  ds_read_b128 v[200:203], v242 offset:1024
  v_mul_f32 v32, v238, v32
  v_mfma_f32_16x16x32_bf16 v[104:107], v[204:207], v[172:175], v[104:107]
  s_waitcnt lgkmcnt(2)
  buffer_load_dwordx4 v240, s[60:63], s79 offen offset:3072 lds
  v_add_u32 v240, 262144, v240
  v_mfma_f32_16x16x32_bf16 v[96:99], v[208:211], v[176:179], v[96:99]
  ds_read_b128 v[204:207], v241 offset:9216
  v_mul_f32 v33, v238, v33
  v_mfma_f32_16x16x32_bf16 v[104:107], v[208:211], v[180:183], v[104:107]
  v_cvt_pk_bf16_f32 v128, v32, v33
  v_mul_f32 v34, v238, v34
  v_mul_f32 v35, v238, v35
  v_mfma_f32_16x16x32_bf16 v[96:99], v[212:215], v[184:187], v[96:99]
  s_add_u32 m0, s68, 147456
  ds_read_b128 v[208:211], v242 offset:9216
  v_cvt_pk_bf16_f32 v129, v34, v35
  v_mfma_f32_16x16x32_bf16 v[104:107], v[212:215], v[188:191], v[104:107]
  s_waitcnt lgkmcnt(2)
  buffer_load_dwordx4 v240, s[48:51], s72 offen lds
  v_mul_f32 v36, v238, v36
  v_mfma_f32_16x16x32_bf16 v[100:103], v[216:219], v[160:163], 0
  ds_read_b128 v[212:215], v241 offset:2048
  v_mul_f32 v37, v238, v37
  v_mfma_f32_16x16x32_bf16 v[108:111], v[216:219], v[164:167], 0
  v_cvt_pk_bf16_f32 v130, v36, v37
  v_mul_f32 v38, v238, v38
  v_mul_f32 v39, v238, v39
  v_mfma_f32_16x16x32_bf16 v[100:103], v[200:203], v[168:171], v[100:103]
  ds_read_b128 v[216:219], v242 offset:2048
  v_max3_f32 v193, v96, v97, v98
  v_mfma_f32_16x16x32_bf16 v[108:111], v[200:203], v[172:175], v[108:111]
  s_waitcnt lgkmcnt(2)
  buffer_load_dwordx4 v240, s[52:55], s72 offen offset:1024 lds
  v_max3_f32 v197, v104, v105, v106
  v_mfma_f32_16x16x32_bf16 v[100:103], v[204:207], v[176:179], v[100:103]
  ds_read_b128 v[200:203], v241 offset:10240
  v_cvt_pk_bf16_f32 v131, v38, v39
  v_mfma_f32_16x16x32_bf16 v[108:111], v[204:207], v[180:183], v[108:111]
  v_mul_f32 v40, v244, v40
  v_mul_f32 v41, v244, v41
  v_cvt_pk_bf16_f32 v132, v40, v41
  v_mfma_f32_16x16x32_bf16 v[100:103], v[208:211], v[184:187], v[100:103]
  ds_read_b128 v[204:207], v242 offset:10240
  v_mul_f32 v42, v244, v42
  v_mfma_f32_16x16x32_bf16 v[108:111], v[208:211], v[188:191], v[108:111]
  s_waitcnt lgkmcnt(2)
  buffer_load_dwordx4 v240, s[56:59], s72 offen offset:2048 lds
  v_mul_f32 v43, v244, v43
  v_mfma_f32_16x16x32_bf16 v[112:115], v[212:215], v[160:163], 0
  ds_read_b128 v[208:211], v241 offset:3072
  v_cvt_pk_bf16_f32 v133, v42, v43
  v_mfma_f32_16x16x32_bf16 v[120:123], v[212:215], v[164:167], 0
  v_mul_f32 v44, v244, v44
  v_mul_f32 v45, v244, v45
  v_cvt_pk_bf16_f32 v134, v44, v45
  v_mfma_f32_16x16x32_bf16 v[112:115], v[216:219], v[168:171], v[112:115]
  ds_read_b128 v[212:215], v242 offset:3072
  v_max3_f32 v193, v193, v99, v100
  v_mfma_f32_16x16x32_bf16 v[120:123], v[216:219], v[172:175], v[120:123]
  s_waitcnt lgkmcnt(2)
  buffer_load_dwordx4 v240, s[60:63], s72 offen offset:3072 lds
  v_max3_f32 v193, v193, v101, v102
  v_mfma_f32_16x16x32_bf16 v[112:115], v[200:203], v[176:179], v[112:115]
  ds_read_b128 v[216:219], v241 offset:11264
  v_max3_f32 v197, v197, v107, v108
  v_mfma_f32_16x16x32_bf16 v[120:123], v[200:203], v[180:183], v[120:123]
  v_max3_f32 v197, v197, v109, v110
  v_mul_f32 v46, v244, v46
  v_mul_f32 v47, v244, v47
  v_mfma_f32_16x16x32_bf16 v[112:115], v[204:207], v[184:187], v[112:115]
  ds_read_b128 v[200:203], v242 offset:11264
  v_cvt_pk_bf16_f32 v135, v46, v47
  v_mfma_f32_16x16x32_bf16 v[120:123], v[204:207], v[188:191], v[120:123]
  s_waitcnt lgkmcnt(2)
  v_mul_f32 v48, v238, v48
  v_mul_f32 v49, v238, v49
  v_cvt_pk_bf16_f32 v136, v48, v49
  v_mfma_f32_16x16x32_bf16 v[116:119], v[208:211], v[160:163], 0
  s_waitcnt vmcnt(16)
  s_barrier
  ds_read_b64_tr_b16 v[204:205], v249 offset:16384
  v_mfma_f32_16x16x32_bf16 v[124:127], v[208:211], v[164:167], 0
  ds_read_b64_tr_b16 v[206:207], v249 offset:18432
  v_mul_f32 v50, v238, v50
  v_mfma_f32_16x16x32_bf16 v[116:119], v[212:215], v[168:171], v[116:119]
  ds_read_b64_tr_b16 v[208:209], v250 offset:16384
  v_max3_f32 v193, v193, v103, v112
  v_mfma_f32_16x16x32_bf16 v[124:127], v[212:215], v[172:175], v[124:127]
  s_waitcnt lgkmcnt(3)
  ds_read_b64_tr_b16 v[210:211], v250 offset:18432
  v_max3_f32 v193, v193, v113, v114
  v_max3_f32 v197, v197, v111, v120
  v_mfma_f32_16x16x32_bf16 v[116:119], v[216:219], v[176:179], v[116:119]
  ds_read_b64_tr_b16 v[212:213], v249 offset:16640
  v_max3_f32 v197, v197, v121, v122
  v_mfma_f32_16x16x32_bf16 v[124:127], v[216:219], v[180:183], v[124:127]
  ds_read_b64_tr_b16 v[214:215], v249 offset:18688
  v_mul_f32 v51, v238, v51
  v_cvt_pk_bf16_f32 v137, v50, v51
  v_mfma_f32_16x16x32_bf16 v[116:119], v[200:203], v[184:187], v[116:119]
  ds_read_b64_tr_b16 v[216:217], v250 offset:16640
  v_mul_f32 v52, v238, v52
  v_mfma_f32_16x16x32_bf16 v[124:127], v[200:203], v[188:191], v[124:127]
  s_waitcnt lgkmcnt(3)
  ds_read_b64_tr_b16 v[218:219], v250 offset:18688
  v_mul_f32 v53, v238, v53
  v_cvt_pk_bf16_f32 v138, v52, v53
  v_mfma_f32_16x16x32_bf16 a[192:195], v[204:207], v[0:3], 0
  ds_read_b64_tr_b16 v[200:201], v249 offset:20480
  v_mul_f32 v54, v238, v54
  v_mfma_f32_16x16x32_bf16 a[200:203], v[204:207], v[4:7], 0
  ds_read_b64_tr_b16 v[202:203], v249 offset:22528
  v_mul_f32 v55, v238, v55
  v_cvt_pk_bf16_f32 v139, v54, v55
  v_mfma_f32_16x16x32_bf16 a[196:199], v[208:211], v[0:3], 0
  ds_read_b64_tr_b16 v[204:205], v250 offset:20480
  v_max3_f32 v193, v193, v115, v116
  v_mfma_f32_16x16x32_bf16 a[204:207], v[208:211], v[4:7], 0
  s_waitcnt lgkmcnt(3)
  ds_read_b64_tr_b16 v[206:207], v250 offset:22528
  v_max3_f32 v193, v193, v117, v118
  v_max_f32 v193, v193, v119
  v_mfma_f32_16x16x32_bf16 a[208:211], v[212:215], v[0:3], 0
  ds_read_b64_tr_b16 v[208:209], v249 offset:20736
  v_mov_b32 v194, v193
  v_mfma_f32_16x16x32_bf16 a[216:219], v[212:215], v[4:7], 0
  ds_read_b64_tr_b16 v[210:211], v249 offset:22784
  v_max3_f32 v197, v197, v123, v124
  v_max3_f32 v197, v197, v125, v126
  v_mfma_f32_16x16x32_bf16 a[212:215], v[216:219], v[0:3], 0
  ds_read_b64_tr_b16 v[212:213], v250 offset:20736
  v_max_f32 v197, v197, v127
  v_mfma_f32_16x16x32_bf16 a[220:223], v[216:219], v[4:7], 0
  s_waitcnt lgkmcnt(3)
  ds_read_b64_tr_b16 v[214:215], v250 offset:22784
  v_mov_b32 v198, v197
  v_permlane32_swap_b32 v194, v193
  v_mfma_f32_16x16x32_bf16 a[192:195], v[200:203], v[8:11], a[192:195]
  ds_read_b64_tr_b16 v[216:217], v249 offset:24576
  v_max_f32 v193, v193, v194
  v_mfma_f32_16x16x32_bf16 a[200:203], v[200:203], v[12:15], a[200:203]
  ds_read_b64_tr_b16 v[218:219], v249 offset:26624
  v_mov_b32 v194, v193
  v_permlane32_swap_b32 v198, v197
  v_mfma_f32_16x16x32_bf16 a[196:199], v[204:207], v[8:11], a[196:199]
  ds_read_b64_tr_b16 v[200:201], v250 offset:24576
  v_max_f32 v197, v197, v198
  v_mfma_f32_16x16x32_bf16 a[204:207], v[204:207], v[12:15], a[204:207]
  s_waitcnt lgkmcnt(3)
  ds_read_b64_tr_b16 v[202:203], v250 offset:26624
  v_mov_b32 v198, v197
  v_permlane16_swap_b32 v194, v193
  v_mfma_f32_16x16x32_bf16 a[208:211], v[208:211], v[8:11], a[208:211]
  ds_read_b64_tr_b16 v[204:205], v249 offset:24832
  v_max_f32 v193, v193, v194
  v_mfma_f32_16x16x32_bf16 a[216:219], v[208:211], v[12:15], a[216:219]
  ds_read_b64_tr_b16 v[206:207], v249 offset:26880
  v_sub_f32 v192, 0, v193
  v_permlane16_swap_b32 v198, v197
  v_mfma_f32_16x16x32_bf16 a[212:215], v[212:215], v[8:11], a[212:215]
  ds_read_b64_tr_b16 v[208:209], v250 offset:24832
  v_max_f32 v197, v197, v198
  v_mfma_f32_16x16x32_bf16 a[220:223], v[212:215], v[12:15], a[220:223]
  s_waitcnt lgkmcnt(3)
  ds_read_b64_tr_b16 v[210:211], v250 offset:26880
  v_sub_f32 v196, 0, v197
  v_add_f32 v96, v96, v192
  v_mfma_f32_16x16x32_bf16 a[192:195], v[216:219], v[16:19], a[192:195]
  ds_read_b64_tr_b16 v[212:213], v249 offset:28672
  v_exp_f32 v96, v96
  v_mfma_f32_16x16x32_bf16 a[200:203], v[216:219], v[20:23], a[200:203]
  ds_read_b64_tr_b16 v[214:215], v249 offset:30720
  v_add_f32 v97, v97, v192
  v_mul_f32 v56, v244, v56
  v_mfma_f32_16x16x32_bf16 a[196:199], v[200:203], v[16:19], a[196:199]
  ds_read_b64_tr_b16 v[216:217], v250 offset:28672
  v_exp_f32 v97, v97
  v_mfma_f32_16x16x32_bf16 a[204:207], v[200:203], v[20:23], a[204:207]
  s_waitcnt lgkmcnt(3)
  ds_read_b64_tr_b16 v[218:219], v250 offset:30720
  v_cvt_pk_bf16_f32 v96, v96, v97
  v_add_f32 v98, v98, v192
  v_mfma_f32_16x16x32_bf16 a[208:211], v[204:207], v[16:19], a[208:211]
  ds_read_b64_tr_b16 v[200:201], v249 offset:28928
  v_exp_f32 v98, v98
  v_mfma_f32_16x16x32_bf16 a[216:219], v[204:207], v[20:23], a[216:219]
  ds_read_b64_tr_b16 v[202:203], v249 offset:30976
  v_add_f32 v99, v99, v192
  v_mul_f32 v57, v244, v57
  v_mfma_f32_16x16x32_bf16 a[212:215], v[208:211], v[16:19], a[212:215]
  ds_read_b64_tr_b16 v[204:205], v250 offset:28928
  v_exp_f32 v99, v99
  v_mfma_f32_16x16x32_bf16 a[220:223], v[208:211], v[20:23], a[220:223]
  s_waitcnt lgkmcnt(3)
  ds_read_b64_tr_b16 v[206:207], v250 offset:30976
  v_cvt_pk_bf16_f32 v97, v98, v99
  v_add_f32 v100, v100, v192
  v_mfma_f32_16x16x32_bf16 a[192:195], v[212:215], v[24:27], a[192:195]
  s_waitcnt vmcnt(24)
  s_barrier
  s_add_u32 m0, s68, 0
  ds_read_b64_tr_b16 v[208:209], v245 offset:32768
  ds_read_b64_tr_b16 v[210:211], v245 offset:33792
  v_mfma_f32_16x16x32_bf16 a[200:203], v[212:215], v[28:31], a[200:203]
  buffer_load_dwordx4 v236, s[8:11], s90 offen nt lds
  v_cvt_pk_bf16_f32 v140, v56, v57
  v_mfma_f32_16x16x32_bf16 a[196:199], v[216:219], v[24:27], a[196:199]
  ds_read_b64_tr_b16 v[212:213], v246 offset:32768
  v_exp_f32 v100, v100
  v_mfma_f32_16x16x32_bf16 a[204:207], v[216:219], v[28:31], a[204:207]
  s_waitcnt lgkmcnt(3)
  ds_read_b64_tr_b16 v[214:215], v246 offset:33792
  v_add_f32 v101, v101, v192
  v_mul_f32 v58, v244, v58
  v_mfma_f32_16x16x32_bf16 a[208:211], v[200:203], v[24:27], a[208:211]
  ds_read_b64_tr_b16 v[216:217], v245 offset:33024
  v_exp_f32 v101, v101
  v_mfma_f32_16x16x32_bf16 a[216:219], v[200:203], v[28:31], a[216:219]
  ds_read_b64_tr_b16 v[218:219], v245 offset:34048
  v_cvt_pk_bf16_f32 v98, v100, v101
  v_add_f32 v102, v102, v192
  v_exp_f32 v102, v102
  v_add_f32 v103, v103, v192
  v_exp_f32 v103, v103
  v_add_f32 v104, v104, v196
  v_cvt_pk_bf16_f32 v99, v102, v103
  v_exp_f32 v104, v104
  v_add_f32 v105, v105, v196
  v_exp_f32 v105, v105
  v_add_f32 v106, v106, v196
  v_cvt_pk_bf16_f32 v100, v104, v105
  v_exp_f32 v106, v106
  v_add_f32 v107, v107, v196
  v_exp_f32 v107, v107
  v_add_f32 v108, v108, v196
  v_cvt_pk_bf16_f32 v101, v106, v107
  v_exp_f32 v108, v108
  v_add_f32 v109, v109, v196
  v_exp_f32 v109, v109
  v_add_f32 v110, v110, v196
  v_cvt_pk_bf16_f32 v102, v108, v109
  v_exp_f32 v110, v110
  v_add_f32 v111, v111, v196
  v_exp_f32 v111, v111
  v_mul_f32 v59, v244, v59
  v_cvt_pk_bf16_f32 v103, v110, v111
  v_mfma_f32_16x16x32_bf16 a[212:215], v[204:207], v[24:27], a[212:215]
  ds_read_b64_tr_b16 v[200:201], v246 offset:33024
  ds_read_b64_tr_b16 v[202:203], v246 offset:34048
  v_mfma_f32_16x16x32_bf16 a[220:223], v[204:207], v[28:31], a[220:223]
  s_waitcnt lgkmcnt(4)
  buffer_load_dwordx4 v236, s[8:11], s90 offen offset:1024 nt lds
  v_cvt_pk_bf16_f32 v141, v58, v59
  v_mfma_f32_16x16x32_bf16 v[224:227], v[220:223], v[96:99], 0
  v_mul_f32 v60, v244, v60
  v_mul_f32 v61, v244, v61
  v_mfma_f32_16x16x32_bf16 v[32:35], v[208:211], v[96:99], 0
  ds_read_b64_tr_b16 v[204:205], v245 offset:33280
  v_cvt_pk_bf16_f32 v142, v60, v61
  v_mfma_f32_16x16x32_bf16 v[40:43], v[208:211], v[100:103], 0
  ds_read_b64_tr_b16 v[206:207], v245 offset:34304
  v_mul_f32 v62, v244, v62
  v_mul_f32 v63, v244, v63
  v_cvt_pk_bf16_f32 v143, v62, v63
  v_mfma_f32_16x16x32_bf16 v[228:231], v[220:223], v[100:103], 0
  v_mul_f32 v64, v238, v64
  v_mul_f32 v65, v238, v65
  v_mfma_f32_16x16x32_bf16 v[36:39], v[212:215], v[96:99], 0
  ds_read_b64_tr_b16 v[208:209], v246 offset:33280
  ds_read_b64_tr_b16 v[210:211], v246 offset:34304
  v_mfma_f32_16x16x32_bf16 v[44:47], v[212:215], v[100:103], 0
  s_waitcnt lgkmcnt(4)
  buffer_load_dwordx4 v236, s[8:11], s90 offen offset:2048 nt lds
  v_cvt_pk_bf16_f32 v144, v64, v65
  v_mfma_f32_16x16x32_bf16 v[48:51], v[216:219], v[96:99], 0
  ds_read_b64_tr_b16 v[212:213], v245 offset:33536
  v_mul_f32 v66, v238, v66
  v_mfma_f32_16x16x32_bf16 v[56:59], v[216:219], v[100:103], 0
  ds_read_b64_tr_b16 v[214:215], v245 offset:34560
  v_mul_f32 v67, v238, v67
  v_cvt_pk_bf16_f32 v145, v66, v67
  v_mul_f32 v68, v238, v68
  v_mul_f32 v69, v238, v69
  v_cvt_pk_bf16_f32 v146, v68, v69
  v_mul_f32 v70, v238, v70
  v_mul_f32 v71, v238, v71
  v_cvt_pk_bf16_f32 v147, v70, v71
  v_mul_f32 v72, v244, v72
  v_mul_f32 v73, v244, v73
  v_cvt_pk_bf16_f32 v148, v72, v73
  v_mul_f32 v74, v244, v74
  v_mul_f32 v75, v244, v75
  v_cvt_pk_bf16_f32 v149, v74, v75
  v_mul_f32 v76, v244, v76
  v_mul_f32 v77, v244, v77
  v_cvt_pk_bf16_f32 v150, v76, v77
  v_mul_f32 v78, v244, v78
  v_mul_f32 v79, v244, v79
  v_cvt_pk_bf16_f32 v151, v78, v79
  v_mfma_f32_16x16x32_bf16 v[52:55], v[200:203], v[96:99], 0
  ds_read_b64_tr_b16 v[216:217], v246 offset:33536
  ds_read_b64_tr_b16 v[218:219], v246 offset:34560
  v_mfma_f32_16x16x32_bf16 v[60:63], v[200:203], v[100:103], 0
  s_waitcnt lgkmcnt(4)
  buffer_load_dwordx4 v236, s[8:11], s90 offen offset:3072 nt lds
  v_mul_f32 v80, v238, v80
  v_mfma_f32_16x16x32_bf16 v[64:67], v[204:207], v[96:99], 0
  ds_read_b64_tr_b16 v[200:201], v245 offset:34816
  v_mul_f32 v81, v238, v81
  v_mfma_f32_16x16x32_bf16 v[72:75], v[204:207], v[100:103], 0
  ds_read_b64_tr_b16 v[202:203], v245 offset:35840
  v_cvt_pk_bf16_f32 v152, v80, v81
  v_mul_f32 v82, v238, v82
  v_mul_f32 v83, v238, v83
  v_cvt_pk_bf16_f32 v153, v82, v83
  v_mul_f32 v84, v238, v84
  v_mul_f32 v85, v238, v85
  v_cvt_pk_bf16_f32 v154, v84, v85
  v_mul_f32 v86, v238, v86
  v_mul_f32 v87, v238, v87
  v_cvt_pk_bf16_f32 v155, v86, v87
  v_mul_f32 v88, v244, v88
  v_mul_f32 v89, v244, v89
  v_cvt_pk_bf16_f32 v156, v88, v89
  v_mul_f32 v90, v244, v90
  v_mul_f32 v91, v244, v91
  v_cvt_pk_bf16_f32 v157, v90, v91
  v_mul_f32 v92, v244, v92
  v_mul_f32 v93, v244, v93
  v_cvt_pk_bf16_f32 v158, v92, v93
  v_mul_f32 v94, v244, v94
  v_mul_f32 v95, v244, v95
  v_cvt_pk_bf16_f32 v159, v94, v95
  v_mfma_f32_16x16x32_bf16 v[68:71], v[208:211], v[96:99], 0
  s_add_u32 m0, s68, 65536
  ds_read_b64_tr_b16 v[204:205], v246 offset:34816
  ds_read_b64_tr_b16 v[206:207], v246 offset:35840
  v_mfma_f32_16x16x32_bf16 v[76:79], v[208:211], v[100:103], 0
  s_waitcnt lgkmcnt(4)
  buffer_load_dwordx4 v237, s[12:15], s90 offen nt lds
  v_add_f32 v112, v112, v192
  v_mfma_f32_16x16x32_bf16 v[80:83], v[212:215], v[96:99], 0
  ds_read_b64_tr_b16 v[208:209], v245 offset:35072
  v_exp_f32 v112, v112
  v_mfma_f32_16x16x32_bf16 v[88:91], v[212:215], v[100:103], 0
  ds_read_b64_tr_b16 v[210:211], v245 offset:36096
  v_add_f32 v113, v113, v192
  v_exp_f32 v113, v113
  v_add_f32 v114, v114, v192
  v_cvt_pk_bf16_f32 v104, v112, v113
  v_exp_f32 v114, v114
  v_add_f32 v115, v115, v192
  v_exp_f32 v115, v115
  v_add_f32 v116, v116, v192
  v_cvt_pk_bf16_f32 v105, v114, v115
  v_exp_f32 v116, v116
  v_add_f32 v117, v117, v192
  v_exp_f32 v117, v117
  v_add_f32 v118, v118, v192
  v_cvt_pk_bf16_f32 v106, v116, v117
  v_exp_f32 v118, v118
  v_add_f32 v119, v119, v192
  v_exp_f32 v119, v119
  v_add_f32 v120, v120, v196
  v_cvt_pk_bf16_f32 v107, v118, v119
  v_exp_f32 v120, v120
  v_add_f32 v121, v121, v196
  v_exp_f32 v121, v121
  v_add_f32 v122, v122, v196
  v_cvt_pk_bf16_f32 v108, v120, v121
  v_exp_f32 v122, v122
  v_add_f32 v123, v123, v196
  v_exp_f32 v123, v123
  v_add_f32 v124, v124, v196
  v_cvt_pk_bf16_f32 v109, v122, v123
  v_exp_f32 v124, v124
  v_add_f32 v125, v125, v196
  v_exp_f32 v125, v125
  v_add_f32 v126, v126, v196
  v_cvt_pk_bf16_f32 v110, v124, v125
  v_exp_f32 v126, v126
  v_add_f32 v127, v127, v196
  v_exp_f32 v127, v127
  v_mov_b32 v193, v192
  v_cvt_pk_bf16_f32 v111, v126, v127
  v_mfma_f32_16x16x32_bf16 v[84:87], v[216:219], v[96:99], 0
  ds_read_b64_tr_b16 v[212:213], v246 offset:35072
  ds_read_b64_tr_b16 v[214:215], v246 offset:36096
  v_mfma_f32_16x16x32_bf16 v[92:95], v[216:219], v[100:103], 0
  s_waitcnt lgkmcnt(4)
  buffer_load_dwordx4 v237, s[12:15], s90 offen offset:1024 nt lds
  v_mfma_f32_16x16x32_bf16 v[224:227], v[220:223], v[104:107], v[224:227]
  v_mov_b32 v194, v192
  v_mov_b32 v195, v192
  v_mfma_f32_16x16x32_bf16 v[32:35], v[200:203], v[104:107], v[32:35]
  ds_read_b64_tr_b16 v[216:217], v245 offset:35328
  v_mov_b32 v197, v196
  v_mfma_f32_16x16x32_bf16 v[40:43], v[200:203], v[108:111], v[40:43]
  ds_read_b64_tr_b16 v[218:219], v245 offset:36352
  v_mov_b32 v198, v196
  v_mfma_f32_16x16x32_bf16 v[228:231], v[220:223], v[108:111], v[228:231]
  v_mov_b32 v199, v196
  v_mfma_f32_16x16x32_bf16 v[36:39], v[204:207], v[104:107], v[36:39]
  ds_read_b64_tr_b16 v[200:201], v246 offset:35328
  ds_read_b64_tr_b16 v[202:203], v246 offset:36352
  v_mfma_f32_16x16x32_bf16 v[44:47], v[204:207], v[108:111], v[44:47]
  s_waitcnt lgkmcnt(4)
  buffer_load_dwordx4 v237, s[12:15], s90 offen offset:2048 nt lds
  v_mfma_f32_16x16x32_bf16 v[48:51], v[208:211], v[104:107], v[48:51]
  ds_read_b64_tr_b16 v[204:205], v245 offset:35584
  v_mfma_f32_16x16x32_bf16 v[56:59], v[208:211], v[108:111], v[56:59]
  ds_read_b64_tr_b16 v[206:207], v245 offset:36608
  v_mfma_f32_16x16x32_bf16 v[52:55], v[212:215], v[104:107], v[52:55]
  ds_read_b64_tr_b16 v[208:209], v246 offset:35584
  ds_read_b64_tr_b16 v[210:211], v246 offset:36608
  v_mfma_f32_16x16x32_bf16 v[60:63], v[212:215], v[108:111], v[60:63]
  s_waitcnt lgkmcnt(4)
  buffer_load_dwordx4 v237, s[12:15], s90 offen offset:3072 nt lds
  v_mfma_f32_16x16x32_bf16 v[64:67], v[216:219], v[104:107], v[64:67]
  s_waitcnt vmcnt(20)
  s_barrier
  ds_read_b128 v[212:215], v241 offset:16384
  v_mfma_f32_16x16x32_bf16 v[72:75], v[216:219], v[108:111], v[72:75]
  v_mfma_f32_16x16x32_bf16 v[68:71], v[200:203], v[104:107], v[68:71]
  ds_read_b128 v[216:219], v242 offset:16384
  v_mfma_f32_16x16x32_bf16 v[76:79], v[200:203], v[108:111], v[76:79]
  s_waitcnt lgkmcnt(2)
  v_mfma_f32_16x16x32_bf16 v[80:83], v[204:207], v[104:107], v[80:83]
  ds_read_b128 v[200:203], v241 offset:24576
  v_mfma_f32_16x16x32_bf16 v[88:91], v[204:207], v[108:111], v[88:91]
  v_mfma_f32_16x16x32_bf16 v[84:87], v[208:211], v[104:107], v[84:87]
  ds_read_b128 v[204:207], v242 offset:24576
  v_mfma_f32_16x16x32_bf16 v[92:95], v[208:211], v[108:111], v[92:95]
  s_waitcnt lgkmcnt(2)
  v_mfma_f32_16x16x32_bf16 v[96:99], v[212:215], v[160:163], v[192:195]
  ds_read_b128 v[208:211], v241 offset:17408
  v_mfma_f32_16x16x32_bf16 v[104:107], v[212:215], v[164:167], v[196:199]
  v_mfma_f32_16x16x32_bf16 v[96:99], v[216:219], v[168:171], v[96:99]
  ds_read_b128 v[212:215], v242 offset:17408
  v_mfma_f32_16x16x32_bf16 v[104:107], v[216:219], v[172:175], v[104:107]
  s_waitcnt lgkmcnt(2)
  v_mfma_f32_16x16x32_bf16 v[96:99], v[200:203], v[176:179], v[96:99]
  ds_read_b128 v[216:219], v241 offset:25600
  v_mfma_f32_16x16x32_bf16 v[104:107], v[200:203], v[180:183], v[104:107]
  v_mfma_f32_16x16x32_bf16 v[96:99], v[204:207], v[184:187], v[96:99]
  ds_read_b128 v[200:203], v242 offset:25600
  v_mfma_f32_16x16x32_bf16 v[104:107], v[204:207], v[188:191], v[104:107]
  s_waitcnt lgkmcnt(2)
  v_mfma_f32_16x16x32_bf16 v[100:103], v[208:211], v[160:163], v[192:195]
  ds_read_b128 v[204:207], v241 offset:18432
  v_mfma_f32_16x16x32_bf16 v[108:111], v[208:211], v[164:167], v[196:199]
  v_mfma_f32_16x16x32_bf16 v[100:103], v[212:215], v[168:171], v[100:103]
  ds_read_b128 v[208:211], v242 offset:18432
  v_max3_f32 v253, v96, v97, v98
  v_mfma_f32_16x16x32_bf16 v[108:111], v[212:215], v[172:175], v[108:111]
  s_waitcnt lgkmcnt(2)
  v_max3_f32 v253, v253, v99, v104
  v_max3_f32 v253, v253, v105, v106
  v_mfma_f32_16x16x32_bf16 v[100:103], v[216:219], v[176:179], v[100:103]
  ds_read_b128 v[212:215], v241 offset:26624
  v_mfma_f32_16x16x32_bf16 v[108:111], v[216:219], v[180:183], v[108:111]
  v_mfma_f32_16x16x32_bf16 v[100:103], v[200:203], v[184:187], v[100:103]
  s_add_u32 m0, s68, 114688
  ds_read_b128 v[216:219], v242 offset:26624
  v_mfma_f32_16x16x32_bf16 v[108:111], v[200:203], v[188:191], v[108:111]
  s_waitcnt lgkmcnt(2)
  buffer_load_dwordx4 v240, s[48:51], s73 offen lds
  v_mfma_f32_16x16x32_bf16 v[112:115], v[204:207], v[160:163], v[192:195]
  ds_read_b128 v[200:203], v241 offset:19456
  v_mfma_f32_16x16x32_bf16 v[120:123], v[204:207], v[164:167], v[196:199]
  v_mfma_f32_16x16x32_bf16 v[112:115], v[208:211], v[168:171], v[112:115]
  ds_read_b128 v[204:207], v242 offset:19456
  v_max3_f32 v253, v253, v107, v100
  v_mfma_f32_16x16x32_bf16 v[120:123], v[208:211], v[172:175], v[120:123]
  s_waitcnt lgkmcnt(2)
  buffer_load_dwordx4 v240, s[52:55], s73 offen offset:1024 lds
  v_mfma_f32_16x16x32_bf16 v[112:115], v[212:215], v[176:179], v[112:115]
  ds_read_b128 v[208:211], v241 offset:27648
  v_max3_f32 v253, v253, v101, v102
  v_mfma_f32_16x16x32_bf16 v[120:123], v[212:215], v[180:183], v[120:123]
  v_max3_f32 v253, v253, v103, v108
  v_max3_f32 v253, v253, v109, v110
  v_mfma_f32_16x16x32_bf16 v[112:115], v[216:219], v[184:187], v[112:115]
  ds_read_b128 v[212:215], v242 offset:27648
  v_mfma_f32_16x16x32_bf16 v[120:123], v[216:219], v[188:191], v[120:123]
  s_waitcnt lgkmcnt(2)
  buffer_load_dwordx4 v240, s[56:59], s73 offen offset:2048 lds
  v_mfma_f32_16x16x32_bf16 v[116:119], v[200:203], v[160:163], v[192:195]
  s_waitcnt vmcnt(15)
  s_barrier
  ds_read_b64_tr_b16 v[216:217], v249 offset:32768
  v_mfma_f32_16x16x32_bf16 v[124:127], v[200:203], v[164:167], v[196:199]
  ds_read_b64_tr_b16 v[218:219], v249 offset:34816
  v_mfma_f32_16x16x32_bf16 v[116:119], v[204:207], v[168:171], v[116:119]
  ds_read_b64_tr_b16 v[200:201], v250 offset:32768
  ds_read_b64_tr_b16 v[202:203], v250 offset:34816
  v_mfma_f32_16x16x32_bf16 v[124:127], v[204:207], v[172:175], v[124:127]
  s_waitcnt lgkmcnt(4)
  buffer_load_dwordx4 v240, s[60:63], s73 offen offset:3072 lds
  v_mfma_f32_16x16x32_bf16 v[116:119], v[208:211], v[176:179], v[116:119]
  ds_read_b64_tr_b16 v[204:205], v249 offset:33024
  v_max3_f32 v253, v253, v111, v112
  v_mfma_f32_16x16x32_bf16 v[124:127], v[208:211], v[180:183], v[124:127]
  ds_read_b64_tr_b16 v[206:207], v249 offset:35072
  v_max3_f32 v253, v253, v113, v114
  v_mfma_f32_16x16x32_bf16 v[116:119], v[212:215], v[184:187], v[116:119]
  ds_read_b64_tr_b16 v[208:209], v250 offset:33024
  v_max3_f32 v253, v253, v115, v120
  v_mfma_f32_16x16x32_bf16 v[124:127], v[212:215], v[188:191], v[124:127]
  s_waitcnt lgkmcnt(3)
  ds_read_b64_tr_b16 v[210:211], v250 offset:35072
  v_max3_f32 v253, v253, v121, v122
  v_mfma_f32_16x16x32_bf16 a[224:227], v[216:219], v[0:3], 0
  ds_read_b64_tr_b16 v[212:213], v249 offset:36864
  v_mfma_f32_16x16x32_bf16 a[232:235], v[216:219], v[4:7], 0
  ds_read_b64_tr_b16 v[214:215], v249 offset:38912
  v_mfma_f32_16x16x32_bf16 a[228:231], v[200:203], v[0:3], 0
  ds_read_b64_tr_b16 v[216:217], v250 offset:36864
  v_max3_f32 v253, v253, v123, v116
  v_mfma_f32_16x16x32_bf16 a[236:239], v[200:203], v[4:7], 0
  s_waitcnt lgkmcnt(3)
  ds_read_b64_tr_b16 v[218:219], v250 offset:38912
  v_max3_f32 v253, v253, v117, v118
  v_max3_f32 v253, v253, v119, v124
  v_mfma_f32_16x16x32_bf16 a[240:243], v[204:207], v[0:3], 0
  ds_read_b64_tr_b16 v[200:201], v249 offset:37120
  v_max3_f32 v253, v253, v125, v126
  v_mfma_f32_16x16x32_bf16 a[248:251], v[204:207], v[4:7], 0
  ds_read_b64_tr_b16 v[202:203], v249 offset:39168
  v_max_f32 v253, v253, v127
  v_cmp_lt_f32 vcc, 0x41200000, v253
  v_mfma_f32_16x16x32_bf16 a[244:247], v[208:211], v[0:3], 0
  s_cbranch_vccnz L_r2_1t
L_r2_1:
  ds_read_b64_tr_b16 v[204:205], v250 offset:37120
  ds_read_b64_tr_b16 v[206:207], v250 offset:39168
  v_mfma_f32_16x16x32_bf16 a[252:255], v[208:211], v[4:7], 0
  s_waitcnt lgkmcnt(4)
  v_exp_f32 v96, v96
  v_mfma_f32_16x16x32_bf16 a[224:227], v[212:215], v[8:11], a[224:227]
  ds_read_b64_tr_b16 v[208:209], v249 offset:40960
  ds_read_b64_tr_b16 v[210:211], v249 offset:43008
  v_mfma_f32_16x16x32_bf16 a[232:235], v[212:215], v[12:15], a[232:235]
  v_exp_f32 v97, v97
  v_mfma_f32_16x16x32_bf16 a[228:231], v[216:219], v[8:11], a[228:231]
  ds_read_b64_tr_b16 v[212:213], v250 offset:40960
  v_cvt_pk_bf16_f32 v96, v96, v97
  v_mfma_f32_16x16x32_bf16 a[236:239], v[216:219], v[12:15], a[236:239]
  s_waitcnt lgkmcnt(3)
  ds_read_b64_tr_b16 v[214:215], v250 offset:43008
  v_exp_f32 v98, v98
  v_mfma_f32_16x16x32_bf16 a[240:243], v[200:203], v[8:11], a[240:243]
  ds_read_b64_tr_b16 v[216:217], v249 offset:41216
  ds_read_b64_tr_b16 v[218:219], v249 offset:43264
  v_mfma_f32_16x16x32_bf16 a[248:251], v[200:203], v[12:15], a[248:251]
  v_exp_f32 v99, v99
  v_mfma_f32_16x16x32_bf16 a[244:247], v[204:207], v[8:11], a[244:247]
  ds_read_b64_tr_b16 v[200:201], v250 offset:41216
  v_cvt_pk_bf16_f32 v97, v98, v99
  v_mfma_f32_16x16x32_bf16 a[252:255], v[204:207], v[12:15], a[252:255]
  s_waitcnt lgkmcnt(3)
  ds_read_b64_tr_b16 v[202:203], v250 offset:43264
  v_exp_f32 v100, v100
  v_mfma_f32_16x16x32_bf16 a[224:227], v[208:211], v[16:19], a[224:227]
  ds_read_b64_tr_b16 v[204:205], v249 offset:45056
  ds_read_b64_tr_b16 v[206:207], v249 offset:47104
  v_mfma_f32_16x16x32_bf16 a[232:235], v[208:211], v[20:23], a[232:235]
  v_exp_f32 v101, v101
  v_mfma_f32_16x16x32_bf16 a[228:231], v[212:215], v[16:19], a[228:231]
  ds_read_b64_tr_b16 v[208:209], v250 offset:45056
  v_cvt_pk_bf16_f32 v98, v100, v101
  v_mfma_f32_16x16x32_bf16 a[236:239], v[212:215], v[20:23], a[236:239]
  s_waitcnt lgkmcnt(3)
  ds_read_b64_tr_b16 v[210:211], v250 offset:47104
  v_exp_f32 v102, v102
  v_mfma_f32_16x16x32_bf16 a[240:243], v[216:219], v[16:19], a[240:243]
  ds_read_b64_tr_b16 v[212:213], v249 offset:45312
  ds_read_b64_tr_b16 v[214:215], v249 offset:47360
  v_mfma_f32_16x16x32_bf16 a[248:251], v[216:219], v[20:23], a[248:251]
  v_exp_f32 v103, v103
  v_mfma_f32_16x16x32_bf16 a[244:247], v[200:203], v[16:19], a[244:247]
  ds_read_b64_tr_b16 v[216:217], v250 offset:45312
  v_cvt_pk_bf16_f32 v99, v102, v103
  v_mfma_f32_16x16x32_bf16 a[252:255], v[200:203], v[20:23], a[252:255]
  s_waitcnt lgkmcnt(3)
  ds_read_b64_tr_b16 v[218:219], v250 offset:47360
  v_exp_f32 v104, v104
  v_mfma_f32_16x16x32_bf16 v[224:227], v[220:223], v[96:99], v[224:227]
  v_exp_f32 v105, v105
  v_mfma_f32_16x16x32_bf16 a[224:227], v[204:207], v[24:27], a[224:227]
  s_waitcnt vmcnt(20)
  s_barrier
  s_add_u32 m0, s68, 16384
  ds_read_b64_tr_b16 v[200:201], v245 offset:16384
  ds_read_b64_tr_b16 v[202:203], v245 offset:17408
  v_mfma_f32_16x16x32_bf16 a[232:235], v[204:207], v[28:31], a[232:235]
  buffer_load_dwordx4 v236, s[8:11], s91 offen nt lds
  v_cvt_pk_bf16_f32 v100, v104, v105
  v_mfma_f32_16x16x32_bf16 a[228:231], v[208:211], v[24:27], a[228:231]
  ds_read_b64_tr_b16 v[204:205], v246 offset:16384
  ds_read_b64_tr_b16 v[206:207], v246 offset:17408
  v_mfma_f32_16x16x32_bf16 a[236:239], v[208:211], v[28:31], a[236:239]
  s_waitcnt lgkmcnt(4)
  v_exp_f32 v106, v106
  v_mfma_f32_16x16x32_bf16 a[240:243], v[212:215], v[24:27], a[240:243]
  ds_read_b64_tr_b16 v[208:209], v245 offset:16640
  ds_read_b64_tr_b16 v[210:211], v245 offset:17664
  v_mfma_f32_16x16x32_bf16 a[248:251], v[212:215], v[28:31], a[248:251]
  buffer_load_dwordx4 v236, s[8:11], s91 offen offset:1024 nt lds
  v_exp_f32 v107, v107
  v_exp_f32 v108, v108
  v_cvt_pk_bf16_f32 v101, v106, v107
  v_exp_f32 v109, v109
  v_exp_f32 v110, v110
  v_cvt_pk_bf16_f32 v102, v108, v109
  v_exp_f32 v111, v111
  v_exp_f32 v112, v112
  v_cvt_pk_bf16_f32 v103, v110, v111
  v_mfma_f32_16x16x32_bf16 a[244:247], v[216:219], v[24:27], a[244:247]
  ds_read_b64_tr_b16 v[212:213], v246 offset:16640
  ds_read_b64_tr_b16 v[214:215], v246 offset:17664
  v_mfma_f32_16x16x32_bf16 a[252:255], v[216:219], v[28:31], a[252:255]
  s_waitcnt lgkmcnt(4)
  v_exp_f32 v113, v113
  v_mfma_f32_16x16x32_bf16 v[228:231], v[220:223], v[100:103], v[228:231]
  v_cvt_pk_bf16_f32 v104, v112, v113
  v_mfma_f32_16x16x32_bf16 v[32:35], v[200:203], v[96:99], v[32:35]
  ds_read_b64_tr_b16 v[216:217], v245 offset:16896
  ds_read_b64_tr_b16 v[218:219], v245 offset:17920
  v_mfma_f32_16x16x32_bf16 v[40:43], v[200:203], v[100:103], v[40:43]
  buffer_load_dwordx4 v236, s[8:11], s91 offen offset:2048 nt lds
  v_mfma_f32_16x16x32_bf16 v[36:39], v[204:207], v[96:99], v[36:39]
  ds_read_b64_tr_b16 v[200:201], v246 offset:16896
  ds_read_b64_tr_b16 v[202:203], v246 offset:17920
  v_mfma_f32_16x16x32_bf16 v[44:47], v[204:207], v[100:103], v[44:47]
  s_waitcnt lgkmcnt(4)
  ds_read_b128 v[0:3], v243 offset:32768
  v_exp_f32 v114, v114
  v_mfma_f32_16x16x32_bf16 v[48:51], v[208:211], v[96:99], v[48:51]
  ds_read_b64_tr_b16 v[204:205], v245 offset:17152
  ds_read_b64_tr_b16 v[206:207], v245 offset:18176
  v_mfma_f32_16x16x32_bf16 v[56:59], v[208:211], v[100:103], v[56:59]
  ds_read_b128 v[4:7], v243 offset:33792
  v_exp_f32 v115, v115
  v_mfma_f32_16x16x32_bf16 v[52:55], v[212:215], v[96:99], v[52:55]
  ds_read_b64_tr_b16 v[208:209], v246 offset:17152
  ds_read_b64_tr_b16 v[210:211], v246 offset:18176
  v_mfma_f32_16x16x32_bf16 v[60:63], v[212:215], v[100:103], v[60:63]
  s_waitcnt lgkmcnt(6)
  ds_read_b128 v[8:11], v243 offset:34816
  v_cvt_pk_bf16_f32 v105, v114, v115
  v_mfma_f32_16x16x32_bf16 v[64:67], v[216:219], v[96:99], v[64:67]
  ds_read_b64_tr_b16 v[212:213], v245 offset:18432
  ds_read_b64_tr_b16 v[214:215], v245 offset:19456
  v_mfma_f32_16x16x32_bf16 v[72:75], v[216:219], v[100:103], v[72:75]
  ds_read_b128 v[12:15], v243 offset:35840
  v_exp_f32 v116, v116
  v_mfma_f32_16x16x32_bf16 v[68:71], v[200:203], v[96:99], v[68:71]
  ds_read_b64_tr_b16 v[216:217], v246 offset:18432
  ds_read_b64_tr_b16 v[218:219], v246 offset:19456
  v_mfma_f32_16x16x32_bf16 v[76:79], v[200:203], v[100:103], v[76:79]
  s_waitcnt lgkmcnt(6)
  ds_read_b128 v[16:19], v243 offset:36864
  v_exp_f32 v117, v117
  v_mfma_f32_16x16x32_bf16 v[80:83], v[204:207], v[96:99], v[80:83]
  ds_read_b64_tr_b16 v[200:201], v245 offset:18688
  ds_read_b64_tr_b16 v[202:203], v245 offset:19712
  v_mfma_f32_16x16x32_bf16 v[88:91], v[204:207], v[100:103], v[88:91]
  ds_read_b128 v[20:23], v243 offset:37888
  v_cvt_pk_bf16_f32 v106, v116, v117
  v_exp_f32 v118, v118
  v_exp_f32 v119, v119
  v_exp_f32 v120, v120
  v_cvt_pk_bf16_f32 v107, v118, v119
  v_exp_f32 v121, v121
  v_exp_f32 v122, v122
  v_cvt_pk_bf16_f32 v108, v120, v121
  v_exp_f32 v123, v123
  v_exp_f32 v124, v124
  v_cvt_pk_bf16_f32 v109, v122, v123
  v_exp_f32 v125, v125
  v_exp_f32 v126, v126
  v_cvt_pk_bf16_f32 v110, v124, v125
  v_exp_f32 v127, v127
  s_nop 0
  v_cvt_pk_bf16_f32 v111, v126, v127
  v_mfma_f32_16x16x32_bf16 v[84:87], v[208:211], v[96:99], v[84:87]
  ds_read_b64_tr_b16 v[204:205], v246 offset:18688
  ds_read_b64_tr_b16 v[206:207], v246 offset:19712
  v_mfma_f32_16x16x32_bf16 v[92:95], v[208:211], v[100:103], v[92:95]
  s_waitcnt lgkmcnt(6)
  buffer_load_dwordx4 v236, s[8:11], s91 offen offset:3072 nt lds
  v_mfma_f32_16x16x32_bf16 v[32:35], v[212:215], v[104:107], v[32:35]
  ds_read_b64_tr_b16 v[208:209], v245 offset:18944
  ds_read_b64_tr_b16 v[210:211], v245 offset:19968
  v_mfma_f32_16x16x32_bf16 v[40:43], v[212:215], v[108:111], v[40:43]
  ds_read_b128 v[24:27], v243 offset:38912
  v_mfma_f32_16x16x32_bf16 v[36:39], v[216:219], v[104:107], v[36:39]
  s_add_u32 m0, s68, 98304
  ds_read_b64_tr_b16 v[212:213], v246 offset:18944
  ds_read_b64_tr_b16 v[214:215], v246 offset:19968
  v_mfma_f32_16x16x32_bf16 v[44:47], v[216:219], v[108:111], v[44:47]
  s_waitcnt lgkmcnt(5)
  buffer_load_dwordx4 v237, s[12:15], s91 offen nt lds
  v_mfma_f32_16x16x32_bf16 v[48:51], v[200:203], v[104:107], v[48:51]
  ds_read_b64_tr_b16 v[216:217], v245 offset:19200
  ds_read_b64_tr_b16 v[218:219], v245 offset:20224
  v_mfma_f32_16x16x32_bf16 v[56:59], v[200:203], v[108:111], v[56:59]
  ds_read_b128 v[28:31], v243 offset:39936
  v_mfma_f32_16x16x32_bf16 v[52:55], v[204:207], v[104:107], v[52:55]
  ds_read_b64_tr_b16 v[200:201], v246 offset:19200
  ds_read_b64_tr_b16 v[202:203], v246 offset:20224
  v_mfma_f32_16x16x32_bf16 v[60:63], v[204:207], v[108:111], v[60:63]
  s_waitcnt lgkmcnt(5)
  buffer_load_dwordx4 v237, s[12:15], s91 offen offset:1024 nt lds
  v_mfma_f32_16x16x32_bf16 v[64:67], v[208:211], v[104:107], v[64:67]
  s_waitcnt vmcnt(14)
  s_barrier
  ds_read_b128 v[204:207], v241 offset:0
  v_mfma_f32_16x16x32_bf16 v[72:75], v[208:211], v[108:111], v[72:75]
  v_mfma_f32_16x16x32_bf16 v[224:227], v[220:223], v[104:107], v[224:227]
  v_mfma_f32_16x16x32_bf16 v[68:71], v[212:215], v[104:107], v[68:71]
  ds_read_b128 v[208:211], v242 offset:0
  v_mfma_f32_16x16x32_bf16 v[76:79], v[212:215], v[108:111], v[76:79]
  s_waitcnt lgkmcnt(2)
  buffer_load_dwordx4 v237, s[12:15], s91 offen offset:2048 nt lds
  v_mfma_f32_16x16x32_bf16 v[228:231], v[220:223], v[108:111], v[228:231]
  v_mfma_f32_16x16x32_bf16 v[80:83], v[216:219], v[104:107], v[80:83]
  ds_read_b128 v[212:215], v241 offset:8192
  v_mfma_f32_16x16x32_bf16 v[88:91], v[216:219], v[108:111], v[88:91]
  v_mfma_f32_16x16x32_bf16 v[84:87], v[200:203], v[104:107], v[84:87]
  ds_read_b128 v[216:219], v242 offset:8192
  v_mfma_f32_16x16x32_bf16 v[92:95], v[200:203], v[108:111], v[92:95]
  s_waitcnt lgkmcnt(2)
  buffer_load_dwordx4 v237, s[12:15], s91 offen offset:3072 nt lds
  v_mfma_f32_16x16x32_bf16 v[96:99], v[204:207], v[160:163], v[192:195]
  ds_read_b128 v[200:203], v241 offset:1024
  v_mfma_f32_16x16x32_bf16 v[104:107], v[204:207], v[164:167], v[196:199]
  v_mfma_f32_16x16x32_bf16 v[96:99], v[208:211], v[168:171], v[96:99]
  s_add_u32 m0, s68, 131072
  ds_read_b128 v[204:207], v242 offset:1024
  v_mfma_f32_16x16x32_bf16 v[104:107], v[208:211], v[172:175], v[104:107]
  s_waitcnt lgkmcnt(2)
  buffer_load_dwordx4 v240, s[48:51], s74 offen lds
  v_mfma_f32_16x16x32_bf16 v[96:99], v[212:215], v[176:179], v[96:99]
  ds_read_b128 v[208:211], v241 offset:9216
  v_mfma_f32_16x16x32_bf16 v[104:107], v[212:215], v[180:183], v[104:107]
  v_mfma_f32_16x16x32_bf16 v[96:99], v[216:219], v[184:187], v[96:99]
  ds_read_b128 v[212:215], v242 offset:9216
  v_mfma_f32_16x16x32_bf16 v[104:107], v[216:219], v[188:191], v[104:107]
  s_waitcnt lgkmcnt(2)
  buffer_load_dwordx4 v240, s[52:55], s74 offen offset:1024 lds
  v_mfma_f32_16x16x32_bf16 v[100:103], v[200:203], v[160:163], v[192:195]
  ds_read_b128 v[216:219], v241 offset:2048
  v_mfma_f32_16x16x32_bf16 v[108:111], v[200:203], v[164:167], v[196:199]
  v_mfma_f32_16x16x32_bf16 v[100:103], v[204:207], v[168:171], v[100:103]
  ds_read_b128 v[200:203], v242 offset:2048
  v_max3_f32 v253, v96, v97, v98
  v_mfma_f32_16x16x32_bf16 v[108:111], v[204:207], v[172:175], v[108:111]
  s_waitcnt lgkmcnt(2)
  v_max3_f32 v253, v253, v99, v104
  v_max3_f32 v253, v253, v105, v106
  v_mfma_f32_16x16x32_bf16 v[100:103], v[208:211], v[176:179], v[100:103]
  ds_read_b128 v[204:207], v241 offset:10240
  v_mfma_f32_16x16x32_bf16 v[108:111], v[208:211], v[180:183], v[108:111]
  v_mfma_f32_16x16x32_bf16 v[100:103], v[212:215], v[184:187], v[100:103]
  ds_read_b128 v[208:211], v242 offset:10240
  v_mfma_f32_16x16x32_bf16 v[108:111], v[212:215], v[188:191], v[108:111]
  s_waitcnt lgkmcnt(2)
  v_mfma_f32_16x16x32_bf16 v[112:115], v[216:219], v[160:163], v[192:195]
  ds_read_b128 v[212:215], v241 offset:3072
  v_mfma_f32_16x16x32_bf16 v[120:123], v[216:219], v[164:167], v[196:199]
  v_mfma_f32_16x16x32_bf16 v[112:115], v[200:203], v[168:171], v[112:115]
  ds_read_b128 v[216:219], v242 offset:3072
  v_max3_f32 v253, v253, v107, v100
  v_mfma_f32_16x16x32_bf16 v[120:123], v[200:203], v[172:175], v[120:123]
  s_waitcnt lgkmcnt(2)
  v_max3_f32 v253, v253, v101, v102
  v_max3_f32 v253, v253, v103, v108
  v_mfma_f32_16x16x32_bf16 v[112:115], v[204:207], v[176:179], v[112:115]
  ds_read_b128 v[200:203], v241 offset:11264
  v_max3_f32 v253, v253, v109, v110
  v_mfma_f32_16x16x32_bf16 v[120:123], v[204:207], v[180:183], v[120:123]
  v_mfma_f32_16x16x32_bf16 v[112:115], v[208:211], v[184:187], v[112:115]
  ds_read_b128 v[204:207], v242 offset:11264
  v_mfma_f32_16x16x32_bf16 v[120:123], v[208:211], v[188:191], v[120:123]
  s_waitcnt lgkmcnt(2)
  v_mfma_f32_16x16x32_bf16 v[116:119], v[212:215], v[160:163], v[192:195]
  s_waitcnt vmcnt(22)
  s_barrier
  ds_read_b64_tr_b16 v[208:209], v249 offset:49152
  v_mfma_f32_16x16x32_bf16 v[124:127], v[212:215], v[164:167], v[196:199]
  ds_read_b64_tr_b16 v[210:211], v249 offset:51200
  v_mfma_f32_16x16x32_bf16 v[116:119], v[216:219], v[168:171], v[116:119]
  ds_read_b64_tr_b16 v[212:213], v250 offset:49152
  v_max3_f32 v253, v253, v111, v112
  v_mfma_f32_16x16x32_bf16 v[124:127], v[216:219], v[172:175], v[124:127]
  s_waitcnt lgkmcnt(3)
  ds_read_b64_tr_b16 v[214:215], v250 offset:51200
  v_max3_f32 v253, v253, v113, v114
  v_mfma_f32_16x16x32_bf16 v[116:119], v[200:203], v[176:179], v[116:119]
  ds_read_b64_tr_b16 v[216:217], v249 offset:49408
  v_max3_f32 v253, v253, v115, v120
  v_mfma_f32_16x16x32_bf16 v[124:127], v[200:203], v[180:183], v[124:127]
  ds_read_b64_tr_b16 v[218:219], v249 offset:51456
  v_max3_f32 v253, v253, v121, v122
  v_mfma_f32_16x16x32_bf16 v[116:119], v[204:207], v[184:187], v[116:119]
  ds_read_b64_tr_b16 v[200:201], v250 offset:49408
  v_mfma_f32_16x16x32_bf16 v[124:127], v[204:207], v[188:191], v[124:127]
  s_waitcnt lgkmcnt(3)
  ds_read_b64_tr_b16 v[202:203], v250 offset:51456
  v_mfma_f32_16x16x32_bf16 a[0:3], v[208:211], v[128:131], a[0:3]
  ds_read_b64_tr_b16 v[204:205], v249 offset:53248
  v_mfma_f32_16x16x32_bf16 a[8:11], v[208:211], v[132:135], a[8:11]
  ds_read_b64_tr_b16 v[206:207], v249 offset:55296
  v_mfma_f32_16x16x32_bf16 a[4:7], v[212:215], v[128:131], a[4:7]
  ds_read_b64_tr_b16 v[208:209], v250 offset:53248
  v_max3_f32 v253, v253, v123, v116
  v_mfma_f32_16x16x32_bf16 a[12:15], v[212:215], v[132:135], a[12:15]
  s_waitcnt lgkmcnt(3)
  ds_read_b64_tr_b16 v[210:211], v250 offset:55296
  v_max3_f32 v253, v253, v117, v118
  v_max3_f32 v253, v253, v119, v124
  v_mfma_f32_16x16x32_bf16 a[16:19], v[216:219], v[128:131], a[16:19]
  ds_read_b64_tr_b16 v[212:213], v249 offset:53504
  v_max3_f32 v253, v253, v125, v126
  v_mfma_f32_16x16x32_bf16 a[24:27], v[216:219], v[132:135], a[24:27]
  ds_read_b64_tr_b16 v[214:215], v249 offset:55552
  v_max_f32 v253, v253, v127
  v_cmp_lt_f32 vcc, 0x41200000, v253
  v_mfma_f32_16x16x32_bf16 a[20:23], v[200:203], v[128:131], a[20:23]
  s_cbranch_vccnz L_r2_2t
L_r2_2:
  ds_read_b64_tr_b16 v[216:217], v250 offset:53504
  ds_read_b64_tr_b16 v[218:219], v250 offset:55552
  v_mfma_f32_16x16x32_bf16 a[28:31], v[200:203], v[132:135], a[28:31]
  s_waitcnt lgkmcnt(4)
  v_exp_f32 v96, v96
  v_mfma_f32_16x16x32_bf16 a[0:3], v[204:207], v[136:139], a[0:3]
  ds_read_b64_tr_b16 v[200:201], v249 offset:57344
  ds_read_b64_tr_b16 v[202:203], v249 offset:59392
  v_mfma_f32_16x16x32_bf16 a[8:11], v[204:207], v[140:143], a[8:11]
  v_exp_f32 v97, v97
  v_mfma_f32_16x16x32_bf16 a[4:7], v[208:211], v[136:139], a[4:7]
  ds_read_b64_tr_b16 v[204:205], v250 offset:57344
  v_cvt_pk_bf16_f32 v96, v96, v97
  v_mfma_f32_16x16x32_bf16 a[12:15], v[208:211], v[140:143], a[12:15]
  s_waitcnt lgkmcnt(3)
  ds_read_b64_tr_b16 v[206:207], v250 offset:59392
  v_exp_f32 v98, v98
  v_mfma_f32_16x16x32_bf16 a[16:19], v[212:215], v[136:139], a[16:19]
  ds_read_b64_tr_b16 v[208:209], v249 offset:57600
  ds_read_b64_tr_b16 v[210:211], v249 offset:59648
  v_mfma_f32_16x16x32_bf16 a[24:27], v[212:215], v[140:143], a[24:27]
  v_exp_f32 v99, v99
  v_mfma_f32_16x16x32_bf16 a[20:23], v[216:219], v[136:139], a[20:23]
  ds_read_b64_tr_b16 v[212:213], v250 offset:57600
  v_cvt_pk_bf16_f32 v97, v98, v99
  v_mfma_f32_16x16x32_bf16 a[28:31], v[216:219], v[140:143], a[28:31]
  s_waitcnt lgkmcnt(3)
  ds_read_b64_tr_b16 v[214:215], v250 offset:59648
  v_exp_f32 v100, v100
  v_mfma_f32_16x16x32_bf16 a[0:3], v[200:203], v[144:147], a[0:3]
  ds_read_b64_tr_b16 v[216:217], v249 offset:61440
  ds_read_b64_tr_b16 v[218:219], v249 offset:63488
  v_mfma_f32_16x16x32_bf16 a[8:11], v[200:203], v[148:151], a[8:11]
  v_exp_f32 v101, v101
  v_mfma_f32_16x16x32_bf16 a[4:7], v[204:207], v[144:147], a[4:7]
  ds_read_b64_tr_b16 v[200:201], v250 offset:61440
  v_cvt_pk_bf16_f32 v98, v100, v101
  v_mfma_f32_16x16x32_bf16 a[12:15], v[204:207], v[148:151], a[12:15]
  s_waitcnt lgkmcnt(3)
  ds_read_b64_tr_b16 v[202:203], v250 offset:63488
  v_exp_f32 v102, v102
  v_mfma_f32_16x16x32_bf16 a[16:19], v[208:211], v[144:147], a[16:19]
  ds_read_b64_tr_b16 v[204:205], v249 offset:61696
  ds_read_b64_tr_b16 v[206:207], v249 offset:63744
  v_mfma_f32_16x16x32_bf16 a[24:27], v[208:211], v[148:151], a[24:27]
  v_exp_f32 v103, v103
  v_mfma_f32_16x16x32_bf16 a[20:23], v[212:215], v[144:147], a[20:23]
  ds_read_b64_tr_b16 v[208:209], v250 offset:61696
  ds_read_b64_tr_b16 v[210:211], v250 offset:63744
  v_mfma_f32_16x16x32_bf16 a[28:31], v[212:215], v[148:151], a[28:31]
  s_waitcnt lgkmcnt(4)
  buffer_load_dwordx4 v240, s[56:59], s74 offen offset:2048 lds
  v_cvt_pk_bf16_f32 v99, v102, v103
  v_mfma_f32_16x16x32_bf16 a[0:3], v[216:219], v[152:155], a[0:3]
  s_waitcnt vmcnt(15)
  s_barrier
  ds_read_b64_tr_b16 v[212:213], v245 offset:0
  ds_read_b64_tr_b16 v[214:215], v245 offset:1024
  v_mfma_f32_16x16x32_bf16 a[8:11], v[216:219], v[156:159], a[8:11]
  v_exp_f32 v104, v104
  v_mfma_f32_16x16x32_bf16 v[224:227], v[220:223], v[96:99], v[224:227]
  v_exp_f32 v105, v105
  v_mfma_f32_16x16x32_bf16 a[4:7], v[200:203], v[152:155], a[4:7]
  ds_read_b64_tr_b16 v[216:217], v246 offset:0
  ds_read_b64_tr_b16 v[218:219], v246 offset:1024
  v_mfma_f32_16x16x32_bf16 a[12:15], v[200:203], v[156:159], a[12:15]
  s_waitcnt lgkmcnt(4)
  buffer_load_dwordx4 v240, s[60:63], s74 offen offset:3072 lds
  v_cvt_pk_bf16_f32 v100, v104, v105
  v_mfma_f32_16x16x32_bf16 a[16:19], v[204:207], v[152:155], a[16:19]
  ds_read_b64_tr_b16 v[200:201], v245 offset:256
  ds_read_b64_tr_b16 v[202:203], v245 offset:1280
  v_mfma_f32_16x16x32_bf16 a[24:27], v[204:207], v[156:159], a[24:27]
  v_exp_f32 v106, v106
  v_exp_f32 v107, v107
  v_exp_f32 v108, v108
  v_cvt_pk_bf16_f32 v101, v106, v107
  v_exp_f32 v109, v109
  v_exp_f32 v110, v110
  v_cvt_pk_bf16_f32 v102, v108, v109
  v_exp_f32 v111, v111
  v_exp_f32 v112, v112
  v_cvt_pk_bf16_f32 v103, v110, v111
  v_mfma_f32_16x16x32_bf16 a[20:23], v[208:211], v[152:155], a[20:23]
  s_add_u32 m0, s68, 32768
  ds_read_b64_tr_b16 v[204:205], v246 offset:256
  ds_read_b64_tr_b16 v[206:207], v246 offset:1280
  v_mfma_f32_16x16x32_bf16 a[28:31], v[208:211], v[156:159], a[28:31]
  s_waitcnt lgkmcnt(4)
  buffer_load_dwordx4 v236, s[8:11], s92 offen nt lds
  v_mfma_f32_16x16x32_bf16 v[228:231], v[220:223], v[100:103], v[228:231]
  v_exp_f32 v113, v113
  v_mfma_f32_16x16x32_bf16 v[32:35], v[212:215], v[96:99], v[32:35]
  ds_read_b64_tr_b16 v[208:209], v245 offset:512
  v_cvt_pk_bf16_f32 v104, v112, v113
  v_mfma_f32_16x16x32_bf16 v[40:43], v[212:215], v[100:103], v[40:43]
  ds_read_b64_tr_b16 v[210:211], v245 offset:1536
  v_exp_f32 v114, v114
  v_mfma_f32_16x16x32_bf16 v[36:39], v[216:219], v[96:99], v[36:39]
  ds_read_b64_tr_b16 v[212:213], v246 offset:512
  ds_read_b64_tr_b16 v[214:215], v246 offset:1536
  v_mfma_f32_16x16x32_bf16 v[44:47], v[216:219], v[100:103], v[44:47]
  s_waitcnt lgkmcnt(4)
  buffer_load_dwordx4 v236, s[8:11], s92 offen offset:1024 nt lds
  v_mfma_f32_16x16x32_bf16 v[48:51], v[200:203], v[96:99], v[48:51]
  ds_read_b64_tr_b16 v[216:217], v245 offset:768
  ds_read_b64_tr_b16 v[218:219], v245 offset:1792
  v_mfma_f32_16x16x32_bf16 v[56:59], v[200:203], v[100:103], v[56:59]
  v_exp_f32 v115, v115
  v_mfma_f32_16x16x32_bf16 v[52:55], v[204:207], v[96:99], v[52:55]
  ds_read_b64_tr_b16 v[200:201], v246 offset:768
  ds_read_b64_tr_b16 v[202:203], v246 offset:1792
  v_mfma_f32_16x16x32_bf16 v[60:63], v[204:207], v[100:103], v[60:63]
  s_waitcnt lgkmcnt(4)
  buffer_load_dwordx4 v236, s[8:11], s92 offen offset:2048 nt lds
  v_cvt_pk_bf16_f32 v105, v114, v115
  v_mfma_f32_16x16x32_bf16 v[64:67], v[208:211], v[96:99], v[64:67]
  ds_read_b64_tr_b16 v[204:205], v245 offset:2048
  ds_read_b64_tr_b16 v[206:207], v245 offset:3072
  v_mfma_f32_16x16x32_bf16 v[72:75], v[208:211], v[100:103], v[72:75]
  v_exp_f32 v116, v116
  v_mfma_f32_16x16x32_bf16 v[68:71], v[212:215], v[96:99], v[68:71]
  ds_read_b64_tr_b16 v[208:209], v246 offset:2048
  ds_read_b64_tr_b16 v[210:211], v246 offset:3072
  v_mfma_f32_16x16x32_bf16 v[76:79], v[212:215], v[100:103], v[76:79]
  s_waitcnt lgkmcnt(4)
  buffer_load_dwordx4 v236, s[8:11], s92 offen offset:3072 nt lds
  v_mfma_f32_16x16x32_bf16 v[80:83], v[216:219], v[96:99], v[80:83]
  ds_read_b64_tr_b16 v[212:213], v245 offset:2304
  ds_read_b64_tr_b16 v[214:215], v245 offset:3328
  v_mfma_f32_16x16x32_bf16 v[88:91], v[216:219], v[100:103], v[88:91]
  v_exp_f32 v117, v117
  v_exp_f32 v118, v118
  v_cvt_pk_bf16_f32 v106, v116, v117
  v_exp_f32 v119, v119
  v_exp_f32 v120, v120
  v_cvt_pk_bf16_f32 v107, v118, v119
  v_exp_f32 v121, v121
  v_exp_f32 v122, v122
  v_cvt_pk_bf16_f32 v108, v120, v121
  v_exp_f32 v123, v123
  v_exp_f32 v124, v124
  v_cvt_pk_bf16_f32 v109, v122, v123
  v_exp_f32 v125, v125
  v_exp_f32 v126, v126
  v_cvt_pk_bf16_f32 v110, v124, v125
  v_exp_f32 v127, v127
  s_nop 0
  v_cvt_pk_bf16_f32 v111, v126, v127
  v_mfma_f32_16x16x32_bf16 v[84:87], v[200:203], v[96:99], v[84:87]
  s_add_u32 m0, s68, 81920
  ds_read_b64_tr_b16 v[216:217], v246 offset:2304
  ds_read_b64_tr_b16 v[218:219], v246 offset:3328
  v_mfma_f32_16x16x32_bf16 v[92:95], v[200:203], v[100:103], v[92:95]
  s_waitcnt lgkmcnt(4)
  buffer_load_dwordx4 v237, s[12:15], s92 offen nt lds
  v_mfma_f32_16x16x32_bf16 v[32:35], v[204:207], v[104:107], v[32:35]
  ds_read_b64_tr_b16 v[200:201], v245 offset:2560
  v_mfma_f32_16x16x32_bf16 v[40:43], v[204:207], v[108:111], v[40:43]
  ds_read_b64_tr_b16 v[202:203], v245 offset:3584
  v_mfma_f32_16x16x32_bf16 v[36:39], v[208:211], v[104:107], v[36:39]
  ds_read_b64_tr_b16 v[204:205], v246 offset:2560
  v_mfma_f32_16x16x32_bf16 v[44:47], v[208:211], v[108:111], v[44:47]
  s_waitcnt lgkmcnt(3)
  ds_read_b64_tr_b16 v[206:207], v246 offset:3584
  v_mfma_f32_16x16x32_bf16 v[48:51], v[212:215], v[104:107], v[48:51]
  ds_read_b64_tr_b16 v[208:209], v245 offset:2816
  v_mfma_f32_16x16x32_bf16 v[56:59], v[212:215], v[108:111], v[56:59]
  ds_read_b64_tr_b16 v[210:211], v245 offset:3840
  v_mfma_f32_16x16x32_bf16 v[52:55], v[216:219], v[104:107], v[52:55]
  ds_read_b64_tr_b16 v[212:213], v246 offset:2816
  v_mfma_f32_16x16x32_bf16 v[60:63], v[216:219], v[108:111], v[60:63]
  s_waitcnt lgkmcnt(3)
  ds_read_b64_tr_b16 v[214:215], v246 offset:3840
  v_mfma_f32_16x16x32_bf16 v[64:67], v[200:203], v[104:107], v[64:67]
  s_waitcnt vmcnt(13)
  s_barrier
  ds_read_b128 v[216:219], v241 offset:16384
  v_mfma_f32_16x16x32_bf16 v[72:75], v[200:203], v[108:111], v[72:75]
  v_mfma_f32_16x16x32_bf16 v[224:227], v[220:223], v[104:107], v[224:227]
  v_mfma_f32_16x16x32_bf16 v[68:71], v[204:207], v[104:107], v[68:71]
  ds_read_b128 v[200:203], v242 offset:16384
  v_mfma_f32_16x16x32_bf16 v[76:79], v[204:207], v[108:111], v[76:79]
  s_waitcnt lgkmcnt(2)
  v_mfma_f32_16x16x32_bf16 v[228:231], v[220:223], v[108:111], v[228:231]
  v_mfma_f32_16x16x32_bf16 v[80:83], v[208:211], v[104:107], v[80:83]
  ds_read_b128 v[204:207], v241 offset:24576
  v_mfma_f32_16x16x32_bf16 v[88:91], v[208:211], v[108:111], v[88:91]
  v_mfma_f32_16x16x32_bf16 v[84:87], v[212:215], v[104:107], v[84:87]
  ds_read_b128 v[208:211], v242 offset:24576
  v_mfma_f32_16x16x32_bf16 v[92:95], v[212:215], v[108:111], v[92:95]
  s_waitcnt lgkmcnt(2)
  v_mfma_f32_16x16x32_bf16 v[96:99], v[216:219], v[160:163], v[192:195]
  ds_read_b128 v[212:215], v241 offset:17408
  v_mfma_f32_16x16x32_bf16 v[104:107], v[216:219], v[164:167], v[196:199]
  v_mfma_f32_16x16x32_bf16 v[96:99], v[200:203], v[168:171], v[96:99]
  ds_read_b128 v[216:219], v242 offset:17408
  v_mfma_f32_16x16x32_bf16 v[104:107], v[200:203], v[172:175], v[104:107]
  s_waitcnt lgkmcnt(2)
  v_mfma_f32_16x16x32_bf16 v[96:99], v[204:207], v[176:179], v[96:99]
  ds_read_b128 v[200:203], v241 offset:25600
  v_mfma_f32_16x16x32_bf16 v[104:107], v[204:207], v[180:183], v[104:107]
  v_mfma_f32_16x16x32_bf16 v[96:99], v[208:211], v[184:187], v[96:99]
  ds_read_b128 v[204:207], v242 offset:25600
  v_mfma_f32_16x16x32_bf16 v[104:107], v[208:211], v[188:191], v[104:107]
  s_waitcnt lgkmcnt(2)
  v_mfma_f32_16x16x32_bf16 v[100:103], v[212:215], v[160:163], v[192:195]
  ds_read_b128 v[208:211], v241 offset:18432
  v_mfma_f32_16x16x32_bf16 v[108:111], v[212:215], v[164:167], v[196:199]
  v_mfma_f32_16x16x32_bf16 v[100:103], v[216:219], v[168:171], v[100:103]
  ds_read_b128 v[212:215], v242 offset:18432
  v_max3_f32 v253, v96, v97, v98
  v_mfma_f32_16x16x32_bf16 v[108:111], v[216:219], v[172:175], v[108:111]
  s_waitcnt lgkmcnt(2)
  v_max3_f32 v253, v253, v99, v104
  v_max3_f32 v253, v253, v105, v106
  v_mfma_f32_16x16x32_bf16 v[100:103], v[200:203], v[176:179], v[100:103]
  ds_read_b128 v[216:219], v241 offset:26624
  v_mfma_f32_16x16x32_bf16 v[108:111], v[200:203], v[180:183], v[108:111]
  v_mfma_f32_16x16x32_bf16 v[100:103], v[204:207], v[184:187], v[100:103]
  ds_read_b128 v[200:203], v242 offset:26624
  v_mfma_f32_16x16x32_bf16 v[108:111], v[204:207], v[188:191], v[108:111]
  s_waitcnt lgkmcnt(2)
  v_mfma_f32_16x16x32_bf16 v[112:115], v[208:211], v[160:163], v[192:195]
  ds_read_b128 v[204:207], v241 offset:19456
  v_mfma_f32_16x16x32_bf16 v[120:123], v[208:211], v[164:167], v[196:199]
  v_mfma_f32_16x16x32_bf16 v[112:115], v[212:215], v[168:171], v[112:115]
  ds_read_b128 v[208:211], v242 offset:19456
  v_max3_f32 v253, v253, v107, v100
  v_mfma_f32_16x16x32_bf16 v[120:123], v[212:215], v[172:175], v[120:123]
  s_waitcnt lgkmcnt(2)
  buffer_load_dwordx4 v237, s[12:15], s92 offen offset:1024 nt lds
  v_mfma_f32_16x16x32_bf16 v[112:115], v[216:219], v[176:179], v[112:115]
  ds_read_b128 v[212:215], v241 offset:27648
  v_max3_f32 v253, v253, v101, v102
  v_mfma_f32_16x16x32_bf16 v[120:123], v[216:219], v[180:183], v[120:123]
  v_max3_f32 v253, v253, v103, v108
  v_max3_f32 v253, v253, v109, v110
  v_mfma_f32_16x16x32_bf16 v[112:115], v[200:203], v[184:187], v[112:115]
  ds_read_b128 v[216:219], v242 offset:27648
  v_mfma_f32_16x16x32_bf16 v[120:123], v[200:203], v[188:191], v[120:123]
  s_waitcnt lgkmcnt(2)
  buffer_load_dwordx4 v237, s[12:15], s92 offen offset:2048 nt lds
  v_mfma_f32_16x16x32_bf16 v[116:119], v[204:207], v[160:163], v[192:195]
  s_waitcnt vmcnt(19)
  s_barrier
  ds_read_b64_tr_b16 v[200:201], v249 offset:16384
  v_mfma_f32_16x16x32_bf16 v[124:127], v[204:207], v[164:167], v[196:199]
  ds_read_b64_tr_b16 v[202:203], v249 offset:18432
  v_mfma_f32_16x16x32_bf16 v[116:119], v[208:211], v[168:171], v[116:119]
  ds_read_b64_tr_b16 v[204:205], v250 offset:16384
  ds_read_b64_tr_b16 v[206:207], v250 offset:18432
  v_mfma_f32_16x16x32_bf16 v[124:127], v[208:211], v[172:175], v[124:127]
  s_waitcnt lgkmcnt(4)
  buffer_load_dwordx4 v237, s[12:15], s92 offen offset:3072 nt lds
  v_mfma_f32_16x16x32_bf16 v[116:119], v[212:215], v[176:179], v[116:119]
  ds_read_b64_tr_b16 v[208:209], v249 offset:16640
  v_max3_f32 v253, v253, v111, v112
  v_mfma_f32_16x16x32_bf16 v[124:127], v[212:215], v[180:183], v[124:127]
  ds_read_b64_tr_b16 v[210:211], v249 offset:18688
  v_max3_f32 v253, v253, v113, v114
  v_mfma_f32_16x16x32_bf16 v[116:119], v[216:219], v[184:187], v[116:119]
  s_add_u32 m0, s68, 147456
  ds_read_b64_tr_b16 v[212:213], v250 offset:16640
  ds_read_b64_tr_b16 v[214:215], v250 offset:18688
  v_mfma_f32_16x16x32_bf16 v[124:127], v[216:219], v[188:191], v[124:127]
  s_waitcnt lgkmcnt(4)
  buffer_load_dwordx4 v240, s[48:51], s75 offen lds
  v_mfma_f32_16x16x32_bf16 a[32:35], v[200:203], v[128:131], a[32:35]
  ds_read_b64_tr_b16 v[216:217], v249 offset:20480
  v_max3_f32 v253, v253, v115, v120
  v_mfma_f32_16x16x32_bf16 a[40:43], v[200:203], v[132:135], a[40:43]
  ds_read_b64_tr_b16 v[218:219], v249 offset:22528
  v_max3_f32 v253, v253, v121, v122
  v_mfma_f32_16x16x32_bf16 a[36:39], v[204:207], v[128:131], a[36:39]
  ds_read_b64_tr_b16 v[200:201], v250 offset:20480
  ds_read_b64_tr_b16 v[202:203], v250 offset:22528
  v_mfma_f32_16x16x32_bf16 a[44:47], v[204:207], v[132:135], a[44:47]
  s_waitcnt lgkmcnt(4)
  buffer_load_dwordx4 v240, s[52:55], s75 offen offset:1024 lds
  v_max3_f32 v253, v253, v123, v116
  v_mfma_f32_16x16x32_bf16 a[48:51], v[208:211], v[128:131], a[48:51]
  ds_read_b64_tr_b16 v[204:205], v249 offset:20736
  v_max3_f32 v253, v253, v117, v118
  v_mfma_f32_16x16x32_bf16 a[56:59], v[208:211], v[132:135], a[56:59]
  ds_read_b64_tr_b16 v[206:207], v249 offset:22784
  v_max3_f32 v253, v253, v119, v124
  v_max3_f32 v253, v253, v125, v126
  v_mfma_f32_16x16x32_bf16 a[52:55], v[212:215], v[128:131], a[52:55]
  ds_read_b64_tr_b16 v[208:209], v250 offset:20736
  ds_read_b64_tr_b16 v[210:211], v250 offset:22784
  v_mfma_f32_16x16x32_bf16 a[60:63], v[212:215], v[132:135], a[60:63]
  s_waitcnt lgkmcnt(4)
  buffer_load_dwordx4 v240, s[56:59], s75 offen offset:2048 lds
  v_max_f32 v253, v253, v127
  v_mfma_f32_16x16x32_bf16 a[32:35], v[216:219], v[136:139], a[32:35]
  ds_read_b64_tr_b16 v[212:213], v249 offset:24576
  v_cmp_lt_f32 vcc, 0x41200000, v253
  v_mfma_f32_16x16x32_bf16 a[40:43], v[216:219], v[140:143], a[40:43]
  s_cbranch_vccnz L_r2_3t
L_r2_3:
  ds_read_b64_tr_b16 v[214:215], v249 offset:26624
  v_exp_f32 v96, v96
  v_mfma_f32_16x16x32_bf16 a[36:39], v[200:203], v[136:139], a[36:39]
  ds_read_b64_tr_b16 v[216:217], v250 offset:24576
  ds_read_b64_tr_b16 v[218:219], v250 offset:26624
  v_mfma_f32_16x16x32_bf16 a[44:47], v[200:203], v[140:143], a[44:47]
  s_waitcnt lgkmcnt(4)
  buffer_load_dwordx4 v240, s[60:63], s75 offen offset:3072 lds
  v_mfma_f32_16x16x32_bf16 a[48:51], v[204:207], v[136:139], a[48:51]
  ds_read_b64_tr_b16 v[200:201], v249 offset:24832
  ds_read_b64_tr_b16 v[202:203], v249 offset:26880
  v_mfma_f32_16x16x32_bf16 a[56:59], v[204:207], v[140:143], a[56:59]
  v_exp_f32 v97, v97
  v_mfma_f32_16x16x32_bf16 a[52:55], v[208:211], v[136:139], a[52:55]
  ds_read_b64_tr_b16 v[204:205], v250 offset:24832
  v_cvt_pk_bf16_f32 v96, v96, v97
  v_mfma_f32_16x16x32_bf16 a[60:63], v[208:211], v[140:143], a[60:63]
  s_waitcnt lgkmcnt(3)
  ds_read_b64_tr_b16 v[206:207], v250 offset:26880
  v_exp_f32 v98, v98
  v_mfma_f32_16x16x32_bf16 a[32:35], v[212:215], v[144:147], a[32:35]
  ds_read_b64_tr_b16 v[208:209], v249 offset:28672
  ds_read_b64_tr_b16 v[210:211], v249 offset:30720
  v_mfma_f32_16x16x32_bf16 a[40:43], v[212:215], v[148:151], a[40:43]
  v_exp_f32 v99, v99
  v_mfma_f32_16x16x32_bf16 a[36:39], v[216:219], v[144:147], a[36:39]
  ds_read_b64_tr_b16 v[212:213], v250 offset:28672
  v_cvt_pk_bf16_f32 v97, v98, v99
  v_mfma_f32_16x16x32_bf16 a[44:47], v[216:219], v[148:151], a[44:47]
  s_waitcnt lgkmcnt(3)
  ds_read_b64_tr_b16 v[214:215], v250 offset:30720
  v_exp_f32 v100, v100
  v_mfma_f32_16x16x32_bf16 a[48:51], v[200:203], v[144:147], a[48:51]
  ds_read_b64_tr_b16 v[216:217], v249 offset:28928
  ds_read_b64_tr_b16 v[218:219], v249 offset:30976
  v_mfma_f32_16x16x32_bf16 a[56:59], v[200:203], v[148:151], a[56:59]
  v_exp_f32 v101, v101
  v_mfma_f32_16x16x32_bf16 a[52:55], v[204:207], v[144:147], a[52:55]
  ds_read_b64_tr_b16 v[200:201], v250 offset:28928
  v_cvt_pk_bf16_f32 v98, v100, v101
  v_mfma_f32_16x16x32_bf16 a[60:63], v[204:207], v[148:151], a[60:63]
  s_waitcnt lgkmcnt(3)
  ds_read_b64_tr_b16 v[202:203], v250 offset:30976
  v_exp_f32 v102, v102
  v_mfma_f32_16x16x32_bf16 a[32:35], v[208:211], v[152:155], a[32:35]
  s_waitcnt vmcnt(16)
  s_barrier
  ds_read_b64_tr_b16 v[204:205], v245 offset:32768
  ds_read_b64_tr_b16 v[206:207], v245 offset:33792
  v_mfma_f32_16x16x32_bf16 a[40:43], v[208:211], v[156:159], a[40:43]
  v_exp_f32 v103, v103
  v_mfma_f32_16x16x32_bf16 a[36:39], v[212:215], v[152:155], a[36:39]
  ds_read_b64_tr_b16 v[208:209], v246 offset:32768
  v_cvt_pk_bf16_f32 v99, v102, v103
  v_mfma_f32_16x16x32_bf16 a[44:47], v[212:215], v[156:159], a[44:47]
  s_waitcnt lgkmcnt(3)
  ds_read_b64_tr_b16 v[210:211], v246 offset:33792
  v_exp_f32 v104, v104
  v_mfma_f32_16x16x32_bf16 v[224:227], v[220:223], v[96:99], v[224:227]
  v_exp_f32 v105, v105
  v_mfma_f32_16x16x32_bf16 a[48:51], v[216:219], v[152:155], a[48:51]
  ds_read_b64_tr_b16 v[212:213], v245 offset:33024
  v_cvt_pk_bf16_f32 v100, v104, v105
  v_mfma_f32_16x16x32_bf16 a[56:59], v[216:219], v[156:159], a[56:59]
  ds_read_b64_tr_b16 v[214:215], v245 offset:34048
  v_exp_f32 v106, v106
  v_exp_f32 v107, v107
  v_exp_f32 v108, v108
  v_cvt_pk_bf16_f32 v101, v106, v107
  v_exp_f32 v109, v109
  v_exp_f32 v110, v110
  v_cvt_pk_bf16_f32 v102, v108, v109
  v_exp_f32 v111, v111
  v_exp_f32 v112, v112
  v_cvt_pk_bf16_f32 v103, v110, v111
  v_mfma_f32_16x16x32_bf16 a[52:55], v[200:203], v[152:155], a[52:55]
  ds_read_b64_tr_b16 v[216:217], v246 offset:33024
  ds_read_b64_tr_b16 v[218:219], v246 offset:34048
  v_mfma_f32_16x16x32_bf16 a[60:63], v[200:203], v[156:159], a[60:63]
  s_waitcnt lgkmcnt(4)
  v_exp_f32 v113, v113
  v_mfma_f32_16x16x32_bf16 v[228:231], v[220:223], v[100:103], v[228:231]
  v_cvt_pk_bf16_f32 v104, v112, v113
  v_mfma_f32_16x16x32_bf16 v[32:35], v[204:207], v[96:99], v[32:35]
  ds_read_b64_tr_b16 v[200:201], v245 offset:33280
  ds_read_b64_tr_b16 v[202:203], v245 offset:34304
  v_mfma_f32_16x16x32_bf16 v[40:43], v[204:207], v[100:103], v[40:43]
  v_exp_f32 v114, v114
  v_mfma_f32_16x16x32_bf16 v[36:39], v[208:211], v[96:99], v[36:39]
  ds_read_b64_tr_b16 v[204:205], v246 offset:33280
  ds_read_b64_tr_b16 v[206:207], v246 offset:34304
  v_mfma_f32_16x16x32_bf16 v[44:47], v[208:211], v[100:103], v[44:47]
  s_waitcnt lgkmcnt(4)
  v_exp_f32 v115, v115
  v_mfma_f32_16x16x32_bf16 v[48:51], v[212:215], v[96:99], v[48:51]
  ds_read_b64_tr_b16 v[208:209], v245 offset:33536
  v_cvt_pk_bf16_f32 v105, v114, v115
  v_mfma_f32_16x16x32_bf16 v[56:59], v[212:215], v[100:103], v[56:59]
  ds_read_b64_tr_b16 v[210:211], v245 offset:34560
  v_exp_f32 v116, v116
  v_mfma_f32_16x16x32_bf16 v[52:55], v[216:219], v[96:99], v[52:55]
  ds_read_b64_tr_b16 v[212:213], v246 offset:33536
  ds_read_b64_tr_b16 v[214:215], v246 offset:34560
  v_mfma_f32_16x16x32_bf16 v[60:63], v[216:219], v[100:103], v[60:63]
  s_waitcnt lgkmcnt(4)
  v_exp_f32 v117, v117
  v_mfma_f32_16x16x32_bf16 v[64:67], v[200:203], v[96:99], v[64:67]
  ds_read_b64_tr_b16 v[216:217], v245 offset:34816
  v_cvt_pk_bf16_f32 v106, v116, v117
  v_mfma_f32_16x16x32_bf16 v[72:75], v[200:203], v[100:103], v[72:75]
  ds_read_b64_tr_b16 v[218:219], v245 offset:35840
  v_exp_f32 v118, v118
  v_mfma_f32_16x16x32_bf16 v[68:71], v[204:207], v[96:99], v[68:71]
  ds_read_b64_tr_b16 v[200:201], v246 offset:34816
  ds_read_b64_tr_b16 v[202:203], v246 offset:35840
  v_mfma_f32_16x16x32_bf16 v[76:79], v[204:207], v[100:103], v[76:79]
  s_waitcnt lgkmcnt(4)
  v_exp_f32 v119, v119
  v_mfma_f32_16x16x32_bf16 v[80:83], v[208:211], v[96:99], v[80:83]
  ds_read_b64_tr_b16 v[204:205], v245 offset:35072
  v_cvt_pk_bf16_f32 v107, v118, v119
  v_mfma_f32_16x16x32_bf16 v[88:91], v[208:211], v[100:103], v[88:91]
  ds_read_b64_tr_b16 v[206:207], v245 offset:36096
  v_exp_f32 v120, v120
  v_exp_f32 v121, v121
  v_exp_f32 v122, v122
  v_cvt_pk_bf16_f32 v108, v120, v121
  v_exp_f32 v123, v123
  v_exp_f32 v124, v124
  v_cvt_pk_bf16_f32 v109, v122, v123
  v_exp_f32 v125, v125
  v_exp_f32 v126, v126
  v_cvt_pk_bf16_f32 v110, v124, v125
  v_exp_f32 v127, v127
  s_nop 0
  v_cvt_pk_bf16_f32 v111, v126, v127
  v_mfma_f32_16x16x32_bf16 v[84:87], v[212:215], v[96:99], v[84:87]
  ds_read_b64_tr_b16 v[208:209], v246 offset:35072
  v_mfma_f32_16x16x32_bf16 v[92:95], v[212:215], v[100:103], v[92:95]
  s_waitcnt lgkmcnt(3)
  ds_read_b64_tr_b16 v[210:211], v246 offset:36096
  v_mfma_f32_16x16x32_bf16 v[32:35], v[216:219], v[104:107], v[32:35]
  s_add_u32 m0, s68, 49152
  ds_read_b64_tr_b16 v[212:213], v245 offset:35328
  ds_read_b64_tr_b16 v[214:215], v245 offset:36352
  v_mfma_f32_16x16x32_bf16 v[40:43], v[216:219], v[108:111], v[40:43]
  buffer_load_dwordx4 v236, s[8:11], s93 offen nt lds
  v_mfma_f32_16x16x32_bf16 v[36:39], v[200:203], v[104:107], v[36:39]
  ds_read_b64_tr_b16 v[216:217], v246 offset:35328
  v_mfma_f32_16x16x32_bf16 v[44:47], v[200:203], v[108:111], v[44:47]
  s_waitcnt lgkmcnt(3)
  ds_read_b64_tr_b16 v[218:219], v246 offset:36352
  v_mfma_f32_16x16x32_bf16 v[48:51], v[204:207], v[104:107], v[48:51]
  ds_read_b64_tr_b16 v[200:201], v245 offset:35584
  ds_read_b64_tr_b16 v[202:203], v245 offset:36608
  v_mfma_f32_16x16x32_bf16 v[56:59], v[204:207], v[108:111], v[56:59]
  buffer_load_dwordx4 v236, s[8:11], s93 offen offset:1024 nt lds
  v_mfma_f32_16x16x32_bf16 v[52:55], v[208:211], v[104:107], v[52:55]
  ds_read_b64_tr_b16 v[204:205], v246 offset:35584
  v_mfma_f32_16x16x32_bf16 v[60:63], v[208:211], v[108:111], v[60:63]
  s_waitcnt lgkmcnt(3)
  ds_read_b64_tr_b16 v[206:207], v246 offset:36608
  v_mfma_f32_16x16x32_bf16 v[64:67], v[212:215], v[104:107], v[64:67]
  s_waitcnt vmcnt(10)
  s_barrier
  ds_read_b128 v[208:211], v241 offset:32768
  v_mfma_f32_16x16x32_bf16 v[72:75], v[212:215], v[108:111], v[72:75]
  buffer_load_dwordx4 v236, s[8:11], s93 offen offset:2048 nt lds
  v_mfma_f32_16x16x32_bf16 v[224:227], v[220:223], v[104:107], v[224:227]
  v_mfma_f32_16x16x32_bf16 v[68:71], v[216:219], v[104:107], v[68:71]
  ds_read_b128 v[212:215], v242 offset:32768
  v_mfma_f32_16x16x32_bf16 v[76:79], v[216:219], v[108:111], v[76:79]
  s_waitcnt lgkmcnt(2)
  v_mfma_f32_16x16x32_bf16 v[228:231], v[220:223], v[108:111], v[228:231]
  v_mfma_f32_16x16x32_bf16 v[80:83], v[200:203], v[104:107], v[80:83]
  ds_read_b128 v[216:219], v241 offset:40960
  v_mfma_f32_16x16x32_bf16 v[88:91], v[200:203], v[108:111], v[88:91]
  buffer_load_dwordx4 v236, s[8:11], s93 offen offset:3072 nt lds
  v_mfma_f32_16x16x32_bf16 v[84:87], v[204:207], v[104:107], v[84:87]
  ds_read_b128 v[200:203], v242 offset:40960
  v_mfma_f32_16x16x32_bf16 v[92:95], v[204:207], v[108:111], v[92:95]
  s_waitcnt lgkmcnt(2)
  v_mfma_f32_16x16x32_bf16 v[96:99], v[208:211], v[160:163], v[192:195]
  s_add_u32 m0, s68, 114688
  ds_read_b128 v[204:207], v241 offset:33792
  v_mfma_f32_16x16x32_bf16 v[104:107], v[208:211], v[164:167], v[196:199]
  buffer_load_dwordx4 v240, s[48:51], s76 offen lds
  v_mfma_f32_16x16x32_bf16 v[96:99], v[212:215], v[168:171], v[96:99]
  ds_read_b128 v[208:211], v242 offset:33792
  v_mfma_f32_16x16x32_bf16 v[104:107], v[212:215], v[172:175], v[104:107]
  s_waitcnt lgkmcnt(2)
  v_mfma_f32_16x16x32_bf16 v[96:99], v[216:219], v[176:179], v[96:99]
  ds_read_b128 v[212:215], v241 offset:41984
  v_mfma_f32_16x16x32_bf16 v[104:107], v[216:219], v[180:183], v[104:107]
  buffer_load_dwordx4 v240, s[52:55], s76 offen offset:1024 lds
  v_mfma_f32_16x16x32_bf16 v[96:99], v[200:203], v[184:187], v[96:99]
  ds_read_b128 v[216:219], v242 offset:41984
  v_mfma_f32_16x16x32_bf16 v[104:107], v[200:203], v[188:191], v[104:107]
  s_waitcnt lgkmcnt(2)
  v_mfma_f32_16x16x32_bf16 v[100:103], v[204:207], v[160:163], v[192:195]
  ds_read_b128 v[200:203], v241 offset:34816
  v_mfma_f32_16x16x32_bf16 v[108:111], v[204:207], v[164:167], v[196:199]
  buffer_load_dwordx4 v240, s[56:59], s76 offen offset:2048 lds
  v_mfma_f32_16x16x32_bf16 v[100:103], v[208:211], v[168:171], v[100:103]
  ds_read_b128 v[204:207], v242 offset:34816
  v_max3_f32 v253, v96, v97, v98
  v_mfma_f32_16x16x32_bf16 v[108:111], v[208:211], v[172:175], v[108:111]
  s_waitcnt lgkmcnt(2)
  v_max3_f32 v253, v253, v99, v104
  v_max3_f32 v253, v253, v105, v106
  v_mfma_f32_16x16x32_bf16 v[100:103], v[212:215], v[176:179], v[100:103]
  ds_read_b128 v[208:211], v241 offset:43008
  v_mfma_f32_16x16x32_bf16 v[108:111], v[212:215], v[180:183], v[108:111]
  buffer_load_dwordx4 v240, s[60:63], s76 offen offset:3072 lds
  v_mfma_f32_16x16x32_bf16 v[100:103], v[216:219], v[184:187], v[100:103]
  ds_read_b128 v[212:215], v242 offset:43008
  v_mfma_f32_16x16x32_bf16 v[108:111], v[216:219], v[188:191], v[108:111]
  s_waitcnt lgkmcnt(2)
  v_mfma_f32_16x16x32_bf16 v[112:115], v[200:203], v[160:163], v[192:195]
  s_add_u32 m0, s68, 65536
  ds_read_b128 v[216:219], v241 offset:35840
  v_mfma_f32_16x16x32_bf16 v[120:123], v[200:203], v[164:167], v[196:199]
  buffer_load_dwordx4 v237, s[12:15], s93 offen nt lds
  v_mfma_f32_16x16x32_bf16 v[112:115], v[204:207], v[168:171], v[112:115]
  ds_read_b128 v[200:203], v242 offset:35840
  v_max3_f32 v253, v253, v107, v100
  v_mfma_f32_16x16x32_bf16 v[120:123], v[204:207], v[172:175], v[120:123]
  s_waitcnt lgkmcnt(2)
  v_max3_f32 v253, v253, v101, v102
  v_max3_f32 v253, v253, v103, v108
  v_mfma_f32_16x16x32_bf16 v[112:115], v[208:211], v[176:179], v[112:115]
  ds_read_b128 v[204:207], v241 offset:44032
  v_max3_f32 v253, v253, v109, v110
  v_mfma_f32_16x16x32_bf16 v[120:123], v[208:211], v[180:183], v[120:123]
  buffer_load_dwordx4 v237, s[12:15], s93 offen offset:1024 nt lds
  v_mfma_f32_16x16x32_bf16 v[112:115], v[212:215], v[184:187], v[112:115]
  ds_read_b128 v[208:211], v242 offset:44032
  v_mfma_f32_16x16x32_bf16 v[120:123], v[212:215], v[188:191], v[120:123]
  s_waitcnt lgkmcnt(2)
  v_mfma_f32_16x16x32_bf16 v[116:119], v[216:219], v[160:163], v[192:195]
  s_waitcnt vmcnt(22)
  s_barrier
  ds_read_b64_tr_b16 v[212:213], v249 offset:32768
  v_mfma_f32_16x16x32_bf16 v[124:127], v[216:219], v[164:167], v[196:199]
  ds_read_b64_tr_b16 v[214:215], v249 offset:34816
  v_mfma_f32_16x16x32_bf16 v[116:119], v[200:203], v[168:171], v[116:119]
  ds_read_b64_tr_b16 v[216:217], v250 offset:32768
  v_max3_f32 v253, v253, v111, v112
  v_mfma_f32_16x16x32_bf16 v[124:127], v[200:203], v[172:175], v[124:127]
  s_waitcnt lgkmcnt(3)
  ds_read_b64_tr_b16 v[218:219], v250 offset:34816
  v_max3_f32 v253, v253, v113, v114
  v_mfma_f32_16x16x32_bf16 v[116:119], v[204:207], v[176:179], v[116:119]
  ds_read_b64_tr_b16 v[200:201], v249 offset:33024
  v_max3_f32 v253, v253, v115, v120
  v_mfma_f32_16x16x32_bf16 v[124:127], v[204:207], v[180:183], v[124:127]
  ds_read_b64_tr_b16 v[202:203], v249 offset:35072
  v_max3_f32 v253, v253, v121, v122
  v_mfma_f32_16x16x32_bf16 v[116:119], v[208:211], v[184:187], v[116:119]
  ds_read_b64_tr_b16 v[204:205], v250 offset:33024
  v_mfma_f32_16x16x32_bf16 v[124:127], v[208:211], v[188:191], v[124:127]
  s_waitcnt lgkmcnt(3)
  ds_read_b64_tr_b16 v[206:207], v250 offset:35072
  v_mfma_f32_16x16x32_bf16 a[64:67], v[212:215], v[128:131], a[64:67]
  ds_read_b64_tr_b16 v[208:209], v249 offset:36864
  v_mfma_f32_16x16x32_bf16 a[72:75], v[212:215], v[132:135], a[72:75]
  ds_read_b64_tr_b16 v[210:211], v249 offset:38912
  v_mfma_f32_16x16x32_bf16 a[68:71], v[216:219], v[128:131], a[68:71]
  ds_read_b64_tr_b16 v[212:213], v250 offset:36864
  v_max3_f32 v253, v253, v123, v116
  v_mfma_f32_16x16x32_bf16 a[76:79], v[216:219], v[132:135], a[76:79]
  s_waitcnt lgkmcnt(3)
  ds_read_b64_tr_b16 v[214:215], v250 offset:38912
  v_max3_f32 v253, v253, v117, v118
  v_max3_f32 v253, v253, v119, v124
  v_mfma_f32_16x16x32_bf16 a[80:83], v[200:203], v[128:131], a[80:83]
  ds_read_b64_tr_b16 v[216:217], v249 offset:37120
  v_max3_f32 v253, v253, v125, v126
  v_mfma_f32_16x16x32_bf16 a[88:91], v[200:203], v[132:135], a[88:91]
  ds_read_b64_tr_b16 v[218:219], v249 offset:39168
  v_max_f32 v253, v253, v127
  v_cmp_lt_f32 vcc, 0x41200000, v253
  v_mfma_f32_16x16x32_bf16 a[84:87], v[204:207], v[128:131], a[84:87]
  s_cbranch_vccnz L_r2_4t
L_r2_4:
  ds_read_b64_tr_b16 v[200:201], v250 offset:37120
  ds_read_b64_tr_b16 v[202:203], v250 offset:39168
  v_mfma_f32_16x16x32_bf16 a[92:95], v[204:207], v[132:135], a[92:95]
  s_waitcnt lgkmcnt(4)
  v_exp_f32 v96, v96
  v_mfma_f32_16x16x32_bf16 a[64:67], v[208:211], v[136:139], a[64:67]
  ds_read_b64_tr_b16 v[204:205], v249 offset:40960
  ds_read_b64_tr_b16 v[206:207], v249 offset:43008
  v_mfma_f32_16x16x32_bf16 a[72:75], v[208:211], v[140:143], a[72:75]
  v_exp_f32 v97, v97
  v_mfma_f32_16x16x32_bf16 a[68:71], v[212:215], v[136:139], a[68:71]
  ds_read_b64_tr_b16 v[208:209], v250 offset:40960
  v_cvt_pk_bf16_f32 v96, v96, v97
  v_mfma_f32_16x16x32_bf16 a[76:79], v[212:215], v[140:143], a[76:79]
  s_waitcnt lgkmcnt(3)
  ds_read_b64_tr_b16 v[210:211], v250 offset:43008
  v_exp_f32 v98, v98
  v_mfma_f32_16x16x32_bf16 a[80:83], v[216:219], v[136:139], a[80:83]
  ds_read_b64_tr_b16 v[212:213], v249 offset:41216
  ds_read_b64_tr_b16 v[214:215], v249 offset:43264
  v_mfma_f32_16x16x32_bf16 a[88:91], v[216:219], v[140:143], a[88:91]
  v_exp_f32 v99, v99
  v_mfma_f32_16x16x32_bf16 a[84:87], v[200:203], v[136:139], a[84:87]
  ds_read_b64_tr_b16 v[216:217], v250 offset:41216
  v_cvt_pk_bf16_f32 v97, v98, v99
  v_mfma_f32_16x16x32_bf16 a[92:95], v[200:203], v[140:143], a[92:95]
  s_waitcnt lgkmcnt(3)
  ds_read_b64_tr_b16 v[218:219], v250 offset:43264
  v_exp_f32 v100, v100
  v_mfma_f32_16x16x32_bf16 a[64:67], v[204:207], v[144:147], a[64:67]
  ds_read_b64_tr_b16 v[200:201], v249 offset:45056
  ds_read_b64_tr_b16 v[202:203], v249 offset:47104
  v_mfma_f32_16x16x32_bf16 a[72:75], v[204:207], v[148:151], a[72:75]
  v_exp_f32 v101, v101
  v_mfma_f32_16x16x32_bf16 a[68:71], v[208:211], v[144:147], a[68:71]
  ds_read_b64_tr_b16 v[204:205], v250 offset:45056
  v_cvt_pk_bf16_f32 v98, v100, v101
  v_mfma_f32_16x16x32_bf16 a[76:79], v[208:211], v[148:151], a[76:79]
  s_waitcnt lgkmcnt(3)
  ds_read_b64_tr_b16 v[206:207], v250 offset:47104
  v_exp_f32 v102, v102
  v_mfma_f32_16x16x32_bf16 a[80:83], v[212:215], v[144:147], a[80:83]
  ds_read_b64_tr_b16 v[208:209], v249 offset:45312
  ds_read_b64_tr_b16 v[210:211], v249 offset:47360
  v_mfma_f32_16x16x32_bf16 a[88:91], v[212:215], v[148:151], a[88:91]
  v_exp_f32 v103, v103
  v_mfma_f32_16x16x32_bf16 a[84:87], v[216:219], v[144:147], a[84:87]
  ds_read_b64_tr_b16 v[212:213], v250 offset:45312
  v_cvt_pk_bf16_f32 v99, v102, v103
  v_mfma_f32_16x16x32_bf16 a[92:95], v[216:219], v[148:151], a[92:95]
  s_waitcnt lgkmcnt(3)
  ds_read_b64_tr_b16 v[214:215], v250 offset:47360
  v_exp_f32 v104, v104
  v_mfma_f32_16x16x32_bf16 v[224:227], v[220:223], v[96:99], v[224:227]
  v_exp_f32 v105, v105
  v_mfma_f32_16x16x32_bf16 a[64:67], v[200:203], v[152:155], a[64:67]
  s_waitcnt vmcnt(14)
  s_barrier
  ds_read_b64_tr_b16 v[216:217], v245 offset:16384
  v_mfma_f32_16x16x32_bf16 a[72:75], v[200:203], v[156:159], a[72:75]
  ds_read_b64_tr_b16 v[218:219], v245 offset:17408
  v_cvt_pk_bf16_f32 v100, v104, v105
  v_mfma_f32_16x16x32_bf16 a[68:71], v[204:207], v[152:155], a[68:71]
  ds_read_b64_tr_b16 v[200:201], v246 offset:16384
  ds_read_b64_tr_b16 v[202:203], v246 offset:17408
  v_mfma_f32_16x16x32_bf16 a[76:79], v[204:207], v[156:159], a[76:79]
  s_waitcnt lgkmcnt(4)
  v_exp_f32 v106, v106
  v_mfma_f32_16x16x32_bf16 a[80:83], v[208:211], v[152:155], a[80:83]
  ds_read_b64_tr_b16 v[204:205], v245 offset:16640
  ds_read_b64_tr_b16 v[206:207], v245 offset:17664
  v_mfma_f32_16x16x32_bf16 a[88:91], v[208:211], v[156:159], a[88:91]
  v_exp_f32 v107, v107
  v_exp_f32 v108, v108
  v_cvt_pk_bf16_f32 v101, v106, v107
  v_exp_f32 v109, v109
  v_exp_f32 v110, v110
  v_cvt_pk_bf16_f32 v102, v108, v109
  v_exp_f32 v111, v111
  v_exp_f32 v112, v112
  v_cvt_pk_bf16_f32 v103, v110, v111
  v_mfma_f32_16x16x32_bf16 a[84:87], v[212:215], v[152:155], a[84:87]
  ds_read_b64_tr_b16 v[208:209], v246 offset:16640
  ds_read_b64_tr_b16 v[210:211], v246 offset:17664
  v_mfma_f32_16x16x32_bf16 a[92:95], v[212:215], v[156:159], a[92:95]
  s_waitcnt lgkmcnt(4)
  buffer_load_dwordx4 v237, s[12:15], s93 offen offset:2048 nt lds
  v_mfma_f32_16x16x32_bf16 v[228:231], v[220:223], v[100:103], v[228:231]
  v_exp_f32 v113, v113
  v_mfma_f32_16x16x32_bf16 v[32:35], v[216:219], v[96:99], v[32:35]
  ds_read_b64_tr_b16 v[212:213], v245 offset:16896
  v_cvt_pk_bf16_f32 v104, v112, v113
  v_mfma_f32_16x16x32_bf16 v[40:43], v[216:219], v[100:103], v[40:43]
  ds_read_b64_tr_b16 v[214:215], v245 offset:17920
  v_exp_f32 v114, v114
  v_mfma_f32_16x16x32_bf16 v[36:39], v[200:203], v[96:99], v[36:39]
  ds_read_b64_tr_b16 v[216:217], v246 offset:16896
  ds_read_b64_tr_b16 v[218:219], v246 offset:17920
  v_mfma_f32_16x16x32_bf16 v[44:47], v[200:203], v[100:103], v[44:47]
  s_waitcnt lgkmcnt(4)
  buffer_load_dwordx4 v237, s[12:15], s93 offen offset:3072 nt lds
  v_mfma_f32_16x16x32_bf16 v[48:51], v[204:207], v[96:99], v[48:51]
  ds_read_b64_tr_b16 v[200:201], v245 offset:17152
  ds_read_b64_tr_b16 v[202:203], v245 offset:18176
  v_mfma_f32_16x16x32_bf16 v[56:59], v[204:207], v[100:103], v[56:59]
  v_exp_f32 v115, v115
  v_mfma_f32_16x16x32_bf16 v[52:55], v[208:211], v[96:99], v[52:55]
  s_add_u32 m0, s68, 0
  ds_read_b64_tr_b16 v[204:205], v246 offset:17152
  ds_read_b64_tr_b16 v[206:207], v246 offset:18176
  v_mfma_f32_16x16x32_bf16 v[60:63], v[208:211], v[100:103], v[60:63]
  s_waitcnt lgkmcnt(4)
  buffer_load_dwordx4 v236, s[8:11], s94 offen nt lds
  v_cvt_pk_bf16_f32 v105, v114, v115
  v_mfma_f32_16x16x32_bf16 v[64:67], v[212:215], v[96:99], v[64:67]
  ds_read_b64_tr_b16 v[208:209], v245 offset:18432
  ds_read_b64_tr_b16 v[210:211], v245 offset:19456
  v_mfma_f32_16x16x32_bf16 v[72:75], v[212:215], v[100:103], v[72:75]
  v_exp_f32 v116, v116
  v_mfma_f32_16x16x32_bf16 v[68:71], v[216:219], v[96:99], v[68:71]
  ds_read_b64_tr_b16 v[212:213], v246 offset:18432
  ds_read_b64_tr_b16 v[214:215], v246 offset:19456
  v_mfma_f32_16x16x32_bf16 v[76:79], v[216:219], v[100:103], v[76:79]
  s_waitcnt lgkmcnt(4)
  buffer_load_dwordx4 v236, s[8:11], s94 offen offset:1024 nt lds
  v_mfma_f32_16x16x32_bf16 v[80:83], v[200:203], v[96:99], v[80:83]
  ds_read_b64_tr_b16 v[216:217], v245 offset:18688
  ds_read_b64_tr_b16 v[218:219], v245 offset:19712
  v_mfma_f32_16x16x32_bf16 v[88:91], v[200:203], v[100:103], v[88:91]
  v_exp_f32 v117, v117
  v_exp_f32 v118, v118
  v_cvt_pk_bf16_f32 v106, v116, v117
  v_exp_f32 v119, v119
  v_exp_f32 v120, v120
  v_cvt_pk_bf16_f32 v107, v118, v119
  v_exp_f32 v121, v121
  v_exp_f32 v122, v122
  v_cvt_pk_bf16_f32 v108, v120, v121
  v_exp_f32 v123, v123
  v_exp_f32 v124, v124
  v_cvt_pk_bf16_f32 v109, v122, v123
  v_exp_f32 v125, v125
  v_exp_f32 v126, v126
  v_cvt_pk_bf16_f32 v110, v124, v125
  v_exp_f32 v127, v127
  s_nop 0
  v_cvt_pk_bf16_f32 v111, v126, v127
  v_mfma_f32_16x16x32_bf16 v[84:87], v[204:207], v[96:99], v[84:87]
  ds_read_b64_tr_b16 v[200:201], v246 offset:18688
  ds_read_b64_tr_b16 v[202:203], v246 offset:19712
  v_mfma_f32_16x16x32_bf16 v[92:95], v[204:207], v[100:103], v[92:95]
  s_waitcnt lgkmcnt(4)
  buffer_load_dwordx4 v236, s[8:11], s94 offen offset:2048 nt lds
  v_mfma_f32_16x16x32_bf16 v[32:35], v[208:211], v[104:107], v[32:35]
  ds_read_b64_tr_b16 v[204:205], v245 offset:18944
  v_mfma_f32_16x16x32_bf16 v[40:43], v[208:211], v[108:111], v[40:43]
  ds_read_b64_tr_b16 v[206:207], v245 offset:19968
  v_mfma_f32_16x16x32_bf16 v[36:39], v[212:215], v[104:107], v[36:39]
  ds_read_b64_tr_b16 v[208:209], v246 offset:18944
  ds_read_b64_tr_b16 v[210:211], v246 offset:19968
  v_mfma_f32_16x16x32_bf16 v[44:47], v[212:215], v[108:111], v[44:47]
  s_waitcnt lgkmcnt(4)
  buffer_load_dwordx4 v236, s[8:11], s94 offen offset:3072 nt lds
  v_mfma_f32_16x16x32_bf16 v[48:51], v[216:219], v[104:107], v[48:51]
  ds_read_b64_tr_b16 v[212:213], v245 offset:19200
  v_mfma_f32_16x16x32_bf16 v[56:59], v[216:219], v[108:111], v[56:59]
  ds_read_b64_tr_b16 v[214:215], v245 offset:20224
  v_mfma_f32_16x16x32_bf16 v[52:55], v[200:203], v[104:107], v[52:55]
  s_add_u32 m0, s68, 98304
  ds_read_b64_tr_b16 v[216:217], v246 offset:19200
  ds_read_b64_tr_b16 v[218:219], v246 offset:20224
  v_mfma_f32_16x16x32_bf16 v[60:63], v[200:203], v[108:111], v[60:63]
  s_waitcnt lgkmcnt(4)
  buffer_load_dwordx4 v237, s[12:15], s94 offen nt lds
  v_mfma_f32_16x16x32_bf16 v[64:67], v[204:207], v[104:107], v[64:67]
  s_waitcnt vmcnt(13)
  s_barrier
  ds_read_b128 v[200:203], v241 offset:49152
  v_mfma_f32_16x16x32_bf16 v[72:75], v[204:207], v[108:111], v[72:75]
  v_mfma_f32_16x16x32_bf16 v[224:227], v[220:223], v[104:107], v[224:227]
  v_mfma_f32_16x16x32_bf16 v[68:71], v[208:211], v[104:107], v[68:71]
  ds_read_b128 v[204:207], v242 offset:49152
  v_mfma_f32_16x16x32_bf16 v[76:79], v[208:211], v[108:111], v[76:79]
  s_waitcnt lgkmcnt(2)
  buffer_load_dwordx4 v237, s[12:15], s94 offen offset:1024 nt lds
  v_mfma_f32_16x16x32_bf16 v[228:231], v[220:223], v[108:111], v[228:231]
  v_mfma_f32_16x16x32_bf16 v[80:83], v[212:215], v[104:107], v[80:83]
  ds_read_b128 v[208:211], v241 offset:57344
  v_mfma_f32_16x16x32_bf16 v[88:91], v[212:215], v[108:111], v[88:91]
  v_mfma_f32_16x16x32_bf16 v[84:87], v[216:219], v[104:107], v[84:87]
  ds_read_b128 v[212:215], v242 offset:57344
  v_mfma_f32_16x16x32_bf16 v[92:95], v[216:219], v[108:111], v[92:95]
  s_waitcnt lgkmcnt(2)
  v_mfma_f32_16x16x32_bf16 v[96:99], v[200:203], v[160:163], v[192:195]
  ds_read_b128 v[216:219], v241 offset:50176
  v_mfma_f32_16x16x32_bf16 v[104:107], v[200:203], v[164:167], v[196:199]
  v_mfma_f32_16x16x32_bf16 v[96:99], v[204:207], v[168:171], v[96:99]
  ds_read_b128 v[200:203], v242 offset:50176
  v_mfma_f32_16x16x32_bf16 v[104:107], v[204:207], v[172:175], v[104:107]
  s_waitcnt lgkmcnt(2)
  v_mfma_f32_16x16x32_bf16 v[96:99], v[208:211], v[176:179], v[96:99]
  ds_read_b128 v[204:207], v241 offset:58368
  v_mfma_f32_16x16x32_bf16 v[104:107], v[208:211], v[180:183], v[104:107]
  v_mfma_f32_16x16x32_bf16 v[96:99], v[212:215], v[184:187], v[96:99]
  ds_read_b128 v[208:211], v242 offset:58368
  v_mfma_f32_16x16x32_bf16 v[104:107], v[212:215], v[188:191], v[104:107]
  s_waitcnt lgkmcnt(2)
  v_mfma_f32_16x16x32_bf16 v[100:103], v[216:219], v[160:163], v[192:195]
  ds_read_b128 v[212:215], v241 offset:51200
  v_mfma_f32_16x16x32_bf16 v[108:111], v[216:219], v[164:167], v[196:199]
  v_mfma_f32_16x16x32_bf16 v[100:103], v[200:203], v[168:171], v[100:103]
  ds_read_b128 v[216:219], v242 offset:51200
  v_max3_f32 v253, v96, v97, v98
  v_mfma_f32_16x16x32_bf16 v[108:111], v[200:203], v[172:175], v[108:111]
  s_waitcnt lgkmcnt(2)
  v_max3_f32 v253, v253, v99, v104
  v_max3_f32 v253, v253, v105, v106
  v_mfma_f32_16x16x32_bf16 v[100:103], v[204:207], v[176:179], v[100:103]
  ds_read_b128 v[200:203], v241 offset:59392
  v_mfma_f32_16x16x32_bf16 v[108:111], v[204:207], v[180:183], v[108:111]
  v_mfma_f32_16x16x32_bf16 v[100:103], v[208:211], v[184:187], v[100:103]
  ds_read_b128 v[204:207], v242 offset:59392
  v_mfma_f32_16x16x32_bf16 v[108:111], v[208:211], v[188:191], v[108:111]
  s_waitcnt lgkmcnt(2)
  v_mfma_f32_16x16x32_bf16 v[112:115], v[212:215], v[160:163], v[192:195]
  ds_read_b128 v[208:211], v241 offset:52224
  v_mfma_f32_16x16x32_bf16 v[120:123], v[212:215], v[164:167], v[196:199]
  v_mfma_f32_16x16x32_bf16 v[112:115], v[216:219], v[168:171], v[112:115]
  ds_read_b128 v[212:215], v242 offset:52224
  v_max3_f32 v253, v253, v107, v100
  v_mfma_f32_16x16x32_bf16 v[120:123], v[216:219], v[172:175], v[120:123]
  s_waitcnt lgkmcnt(2)
  v_max3_f32 v253, v253, v101, v102
  v_max3_f32 v253, v253, v103, v108
  v_mfma_f32_16x16x32_bf16 v[112:115], v[200:203], v[176:179], v[112:115]
  ds_read_b128 v[216:219], v241 offset:60416
  v_max3_f32 v253, v253, v109, v110
  v_mfma_f32_16x16x32_bf16 v[120:123], v[200:203], v[180:183], v[120:123]
  v_mfma_f32_16x16x32_bf16 v[112:115], v[204:207], v[184:187], v[112:115]
  ds_read_b128 v[200:203], v242 offset:60416
  v_mfma_f32_16x16x32_bf16 v[120:123], v[204:207], v[188:191], v[120:123]
  s_waitcnt lgkmcnt(2)
  v_mfma_f32_16x16x32_bf16 v[116:119], v[208:211], v[160:163], v[192:195]
  s_waitcnt vmcnt(18)
  s_barrier
  ds_read_b64_tr_b16 v[204:205], v249 offset:49152
  v_mfma_f32_16x16x32_bf16 v[124:127], v[208:211], v[164:167], v[196:199]
  ds_read_b64_tr_b16 v[206:207], v249 offset:51200
  v_mfma_f32_16x16x32_bf16 v[116:119], v[212:215], v[168:171], v[116:119]
  ds_read_b64_tr_b16 v[208:209], v250 offset:49152
  v_max3_f32 v253, v253, v111, v112
  v_mfma_f32_16x16x32_bf16 v[124:127], v[212:215], v[172:175], v[124:127]
  s_waitcnt lgkmcnt(3)
  ds_read_b64_tr_b16 v[210:211], v250 offset:51200
  v_max3_f32 v253, v253, v113, v114
  v_mfma_f32_16x16x32_bf16 v[116:119], v[216:219], v[176:179], v[116:119]
  ds_read_b64_tr_b16 v[212:213], v249 offset:49408
  v_max3_f32 v253, v253, v115, v120
  v_mfma_f32_16x16x32_bf16 v[124:127], v[216:219], v[180:183], v[124:127]
  ds_read_b64_tr_b16 v[214:215], v249 offset:51456
  v_max3_f32 v253, v253, v121, v122
  v_mfma_f32_16x16x32_bf16 v[116:119], v[200:203], v[184:187], v[116:119]
  ds_read_b64_tr_b16 v[216:217], v250 offset:49408
  v_mfma_f32_16x16x32_bf16 v[124:127], v[200:203], v[188:191], v[124:127]
  s_waitcnt lgkmcnt(3)
  ds_read_b64_tr_b16 v[218:219], v250 offset:51456
  v_mfma_f32_16x16x32_bf16 a[96:99], v[204:207], v[128:131], a[96:99]
  ds_read_b64_tr_b16 v[200:201], v249 offset:53248
  v_mfma_f32_16x16x32_bf16 a[104:107], v[204:207], v[132:135], a[104:107]
  ds_read_b64_tr_b16 v[202:203], v249 offset:55296
  v_mfma_f32_16x16x32_bf16 a[100:103], v[208:211], v[128:131], a[100:103]
  ds_read_b64_tr_b16 v[204:205], v250 offset:53248
  ds_read_b64_tr_b16 v[206:207], v250 offset:55296
  v_mfma_f32_16x16x32_bf16 a[108:111], v[208:211], v[132:135], a[108:111]
  s_waitcnt lgkmcnt(4)
  buffer_load_dwordx4 v237, s[12:15], s94 offen offset:2048 nt lds
  v_max3_f32 v253, v253, v123, v116
  v_mfma_f32_16x16x32_bf16 a[112:115], v[212:215], v[128:131], a[112:115]
  ds_read_b64_tr_b16 v[208:209], v249 offset:53504
  v_max3_f32 v253, v253, v117, v118
  v_mfma_f32_16x16x32_bf16 a[120:123], v[212:215], v[132:135], a[120:123]
  ds_read_b64_tr_b16 v[210:211], v249 offset:55552
  v_max3_f32 v253, v253, v119, v124
  v_max3_f32 v253, v253, v125, v126
  v_mfma_f32_16x16x32_bf16 a[116:119], v[216:219], v[128:131], a[116:119]
  ds_read_b64_tr_b16 v[212:213], v250 offset:53504
  ds_read_b64_tr_b16 v[214:215], v250 offset:55552
  v_mfma_f32_16x16x32_bf16 a[124:127], v[216:219], v[132:135], a[124:127]
  s_waitcnt lgkmcnt(4)
  buffer_load_dwordx4 v237, s[12:15], s94 offen offset:3072 nt lds
  v_max_f32 v253, v253, v127
  v_mfma_f32_16x16x32_bf16 a[96:99], v[200:203], v[136:139], a[96:99]
  ds_read_b64_tr_b16 v[216:217], v249 offset:57344
  v_cmp_lt_f32 vcc, 0x41200000, v253
  v_mfma_f32_16x16x32_bf16 a[104:107], v[200:203], v[140:143], a[104:107]
  s_cbranch_vccnz L_r2_5t
L_r2_5:
  ds_read_b64_tr_b16 v[218:219], v249 offset:59392
  v_exp_f32 v96, v96
  v_mfma_f32_16x16x32_bf16 a[100:103], v[204:207], v[136:139], a[100:103]
  s_add_u32 m0, s68, 131072
  ds_read_b64_tr_b16 v[200:201], v250 offset:57344
  ds_read_b64_tr_b16 v[202:203], v250 offset:59392
  v_mfma_f32_16x16x32_bf16 a[108:111], v[204:207], v[140:143], a[108:111]
  s_waitcnt lgkmcnt(4)
  buffer_load_dwordx4 v240, s[48:51], s77 offen lds
  v_mfma_f32_16x16x32_bf16 a[112:115], v[208:211], v[136:139], a[112:115]
  ds_read_b64_tr_b16 v[204:205], v249 offset:57600
  ds_read_b64_tr_b16 v[206:207], v249 offset:59648
  v_mfma_f32_16x16x32_bf16 a[120:123], v[208:211], v[140:143], a[120:123]
  v_exp_f32 v97, v97
  v_mfma_f32_16x16x32_bf16 a[116:119], v[212:215], v[136:139], a[116:119]
  ds_read_b64_tr_b16 v[208:209], v250 offset:57600
  ds_read_b64_tr_b16 v[210:211], v250 offset:59648
  v_mfma_f32_16x16x32_bf16 a[124:127], v[212:215], v[140:143], a[124:127]
  s_waitcnt lgkmcnt(4)
  buffer_load_dwordx4 v240, s[52:55], s77 offen offset:1024 lds
  v_cvt_pk_bf16_f32 v96, v96, v97
  v_mfma_f32_16x16x32_bf16 a[96:99], v[216:219], v[144:147], a[96:99]
  ds_read_b64_tr_b16 v[212:213], v249 offset:61440
  ds_read_b64_tr_b16 v[214:215], v249 offset:63488
  v_mfma_f32_16x16x32_bf16 a[104:107], v[216:219], v[148:151], a[104:107]
  v_exp_f32 v98, v98
  v_mfma_f32_16x16x32_bf16 a[100:103], v[200:203], v[144:147], a[100:103]
  ds_read_b64_tr_b16 v[216:217], v250 offset:61440
  ds_read_b64_tr_b16 v[218:219], v250 offset:63488
  v_mfma_f32_16x16x32_bf16 a[108:111], v[200:203], v[148:151], a[108:111]
  s_waitcnt lgkmcnt(4)
  buffer_load_dwordx4 v240, s[56:59], s77 offen offset:2048 lds
  v_mfma_f32_16x16x32_bf16 a[112:115], v[204:207], v[144:147], a[112:115]
  ds_read_b64_tr_b16 v[200:201], v249 offset:61696
  ds_read_b64_tr_b16 v[202:203], v249 offset:63744
  v_mfma_f32_16x16x32_bf16 a[120:123], v[204:207], v[148:151], a[120:123]
  v_exp_f32 v99, v99
  v_mfma_f32_16x16x32_bf16 a[116:119], v[208:211], v[144:147], a[116:119]
  ds_read_b64_tr_b16 v[204:205], v250 offset:61696
  ds_read_b64_tr_b16 v[206:207], v250 offset:63744
  v_mfma_f32_16x16x32_bf16 a[124:127], v[208:211], v[148:151], a[124:127]
  s_waitcnt lgkmcnt(4)
  buffer_load_dwordx4 v240, s[60:63], s77 offen offset:3072 lds
  v_cvt_pk_bf16_f32 v97, v98, v99
  v_mfma_f32_16x16x32_bf16 a[96:99], v[212:215], v[152:155], a[96:99]
  s_waitcnt vmcnt(12)
  s_barrier
  ds_read_b64_tr_b16 v[208:209], v245 offset:0
  ds_read_b64_tr_b16 v[210:211], v245 offset:1024
  v_mfma_f32_16x16x32_bf16 a[104:107], v[212:215], v[156:159], a[104:107]
  v_exp_f32 v100, v100
  v_mfma_f32_16x16x32_bf16 a[100:103], v[216:219], v[152:155], a[100:103]
  s_add_u32 m0, s68, 16384
  ds_read_b64_tr_b16 v[212:213], v246 offset:0
  ds_read_b64_tr_b16 v[214:215], v246 offset:1024
  v_mfma_f32_16x16x32_bf16 a[108:111], v[216:219], v[156:159], a[108:111]
  s_waitcnt lgkmcnt(4)
  buffer_load_dwordx4 v236, s[8:11], s95 offen nt lds
  v_mfma_f32_16x16x32_bf16 a[112:115], v[200:203], v[152:155], a[112:115]
  ds_read_b64_tr_b16 v[216:217], v245 offset:256
  ds_read_b64_tr_b16 v[218:219], v245 offset:1280
  v_mfma_f32_16x16x32_bf16 a[120:123], v[200:203], v[156:159], a[120:123]
  v_exp_f32 v101, v101
  v_exp_f32 v102, v102
  v_cvt_pk_bf16_f32 v98, v100, v101
  v_exp_f32 v103, v103
  v_exp_f32 v104, v104
  v_cvt_pk_bf16_f32 v99, v102, v103
  v_exp_f32 v105, v105
  v_exp_f32 v106, v106
  v_cvt_pk_bf16_f32 v100, v104, v105
  v_exp_f32 v107, v107
  v_exp_f32 v108, v108
  v_cvt_pk_bf16_f32 v101, v106, v107
  v_exp_f32 v109, v109
  v_exp_f32 v110, v110
  v_cvt_pk_bf16_f32 v102, v108, v109
  v_exp_f32 v111, v111
  v_exp_f32 v112, v112
  v_cvt_pk_bf16_f32 v103, v110, v111
  v_mfma_f32_16x16x32_bf16 a[116:119], v[204:207], v[152:155], a[116:119]
  ds_read_b64_tr_b16 v[200:201], v246 offset:256
  ds_read_b64_tr_b16 v[202:203], v246 offset:1280
  v_mfma_f32_16x16x32_bf16 a[124:127], v[204:207], v[156:159], a[124:127]
  s_waitcnt lgkmcnt(4)
  v_exp_f32 v113, v113
  v_mfma_f32_16x16x32_bf16 v[224:227], v[220:223], v[96:99], v[224:227]
  v_cvt_pk_bf16_f32 v104, v112, v113
  v_mfma_f32_16x16x32_bf16 v[32:35], v[208:211], v[96:99], v[32:35]
  ds_read_b64_tr_b16 v[204:205], v245 offset:512
  ds_read_b64_tr_b16 v[206:207], v245 offset:1536
  v_mfma_f32_16x16x32_bf16 v[40:43], v[208:211], v[100:103], v[40:43]
  v_exp_f32 v114, v114
  v_mfma_f32_16x16x32_bf16 v[228:231], v[220:223], v[100:103], v[228:231]
  v_exp_f32 v115, v115
  v_mfma_f32_16x16x32_bf16 v[36:39], v[212:215], v[96:99], v[36:39]
  ds_read_b64_tr_b16 v[208:209], v246 offset:512
  v_cvt_pk_bf16_f32 v105, v114, v115
  v_mfma_f32_16x16x32_bf16 v[44:47], v[212:215], v[100:103], v[44:47]
  s_waitcnt lgkmcnt(3)
  ds_read_b64_tr_b16 v[210:211], v246 offset:1536
  v_exp_f32 v116, v116
  v_mfma_f32_16x16x32_bf16 v[48:51], v[216:219], v[96:99], v[48:51]
  ds_read_b64_tr_b16 v[212:213], v245 offset:768
  ds_read_b64_tr_b16 v[214:215], v245 offset:1792
  v_mfma_f32_16x16x32_bf16 v[56:59], v[216:219], v[100:103], v[56:59]
  v_exp_f32 v117, v117
  v_mfma_f32_16x16x32_bf16 v[52:55], v[200:203], v[96:99], v[52:55]
  ds_read_b64_tr_b16 v[216:217], v246 offset:768
  v_cvt_pk_bf16_f32 v106, v116, v117
  v_mfma_f32_16x16x32_bf16 v[60:63], v[200:203], v[100:103], v[60:63]
  s_waitcnt lgkmcnt(3)
  ds_read_b64_tr_b16 v[218:219], v246 offset:1792
  v_exp_f32 v118, v118
  v_mfma_f32_16x16x32_bf16 v[64:67], v[204:207], v[96:99], v[64:67]
  ds_read_b64_tr_b16 v[200:201], v245 offset:2048
  ds_read_b64_tr_b16 v[202:203], v245 offset:3072
  v_mfma_f32_16x16x32_bf16 v[72:75], v[204:207], v[100:103], v[72:75]
  v_exp_f32 v119, v119
  v_mfma_f32_16x16x32_bf16 v[68:71], v[208:211], v[96:99], v[68:71]
  ds_read_b64_tr_b16 v[204:205], v246 offset:2048
  v_cvt_pk_bf16_f32 v107, v118, v119
  v_mfma_f32_16x16x32_bf16 v[76:79], v[208:211], v[100:103], v[76:79]
  s_waitcnt lgkmcnt(3)
  ds_read_b64_tr_b16 v[206:207], v246 offset:3072
  v_exp_f32 v120, v120
  v_mfma_f32_16x16x32_bf16 v[224:227], v[220:223], v[104:107], v[224:227]
  v_exp_f32 v121, v121
  v_mfma_f32_16x16x32_bf16 v[80:83], v[212:215], v[96:99], v[80:83]
  ds_read_b64_tr_b16 v[208:209], v245 offset:2304
  v_cvt_pk_bf16_f32 v108, v120, v121
  v_mfma_f32_16x16x32_bf16 v[88:91], v[212:215], v[100:103], v[88:91]
  ds_read_b64_tr_b16 v[210:211], v245 offset:3328
  v_exp_f32 v122, v122
  v_exp_f32 v123, v123
  v_exp_f32 v124, v124
  v_cvt_pk_bf16_f32 v109, v122, v123
  v_exp_f32 v125, v125
  v_exp_f32 v126, v126
  v_cvt_pk_bf16_f32 v110, v124, v125
  v_exp_f32 v127, v127
  s_nop 0
  v_cvt_pk_bf16_f32 v111, v126, v127
  v_mfma_f32_16x16x32_bf16 v[84:87], v[216:219], v[96:99], v[84:87]
  ds_read_b64_tr_b16 v[212:213], v246 offset:2304
  v_mfma_f32_16x16x32_bf16 v[92:95], v[216:219], v[100:103], v[92:95]
  s_waitcnt lgkmcnt(3)
  ds_read_b64_tr_b16 v[214:215], v246 offset:3328
  v_mfma_f32_16x16x32_bf16 v[32:35], v[200:203], v[104:107], v[32:35]
  ds_read_b64_tr_b16 v[216:217], v245 offset:2560
  v_mfma_f32_16x16x32_bf16 v[40:43], v[200:203], v[108:111], v[40:43]
  ds_read_b64_tr_b16 v[218:219], v245 offset:3584
  v_mfma_f32_16x16x32_bf16 v[36:39], v[204:207], v[104:107], v[36:39]
  ds_read_b64_tr_b16 v[200:201], v246 offset:2560
  v_mfma_f32_16x16x32_bf16 v[44:47], v[204:207], v[108:111], v[44:47]
  s_waitcnt lgkmcnt(3)
  ds_read_b64_tr_b16 v[202:203], v246 offset:3584
  v_mfma_f32_16x16x32_bf16 v[48:51], v[208:211], v[104:107], v[48:51]
  ds_read_b64_tr_b16 v[204:205], v245 offset:2816
  v_mfma_f32_16x16x32_bf16 v[56:59], v[208:211], v[108:111], v[56:59]
  ds_read_b64_tr_b16 v[206:207], v245 offset:3840
  v_mfma_f32_16x16x32_bf16 v[52:55], v[212:215], v[104:107], v[52:55]
  ds_read_b64_tr_b16 v[208:209], v246 offset:2816
  v_mfma_f32_16x16x32_bf16 v[60:63], v[212:215], v[108:111], v[60:63]
  s_waitcnt lgkmcnt(3)
  ds_read_b64_tr_b16 v[210:211], v246 offset:3840
  v_mfma_f32_16x16x32_bf16 v[64:67], v[216:219], v[104:107], v[64:67]
  s_waitcnt vmcnt(9)
  s_barrier
  ds_read_b128 v[212:215], v241 offset:0
  v_mfma_f32_16x16x32_bf16 v[72:75], v[216:219], v[108:111], v[72:75]
  buffer_load_dwordx4 v236, s[8:11], s95 offen offset:1024 nt lds
  v_mfma_f32_16x16x32_bf16 v[68:71], v[200:203], v[104:107], v[68:71]
  ds_read_b128 v[216:219], v242 offset:0
  v_mfma_f32_16x16x32_bf16 v[76:79], v[200:203], v[108:111], v[76:79]
  s_waitcnt lgkmcnt(2)
  v_mfma_f32_16x16x32_bf16 v[228:231], v[220:223], v[108:111], v[228:231]
  v_mfma_f32_16x16x32_bf16 v[80:83], v[204:207], v[104:107], v[80:83]
  ds_read_b128 v[200:203], v241 offset:8192
  v_mfma_f32_16x16x32_bf16 v[88:91], v[204:207], v[108:111], v[88:91]
  buffer_load_dwordx4 v236, s[8:11], s95 offen offset:2048 nt lds
  v_mfma_f32_16x16x32_bf16 v[84:87], v[208:211], v[104:107], v[84:87]
  ds_read_b128 v[204:207], v242 offset:8192
  v_mfma_f32_16x16x32_bf16 v[92:95], v[208:211], v[108:111], v[92:95]
  s_waitcnt lgkmcnt(2)
  v_mfma_f32_16x16x32_bf16 v[96:99], v[212:215], v[160:163], v[192:195]
  ds_read_b128 v[208:211], v241 offset:1024
  v_mfma_f32_16x16x32_bf16 v[104:107], v[212:215], v[164:167], v[196:199]
  buffer_load_dwordx4 v236, s[8:11], s95 offen offset:3072 nt lds
  v_add_u32 v236, 262144, v236
  v_mfma_f32_16x16x32_bf16 v[96:99], v[216:219], v[168:171], v[96:99]
  ds_read_b128 v[212:215], v242 offset:1024
  v_mfma_f32_16x16x32_bf16 v[104:107], v[216:219], v[172:175], v[104:107]
  s_waitcnt lgkmcnt(2)
  v_mfma_f32_16x16x32_bf16 v[96:99], v[200:203], v[176:179], v[96:99]
  s_add_u32 m0, s68, 147456
  ds_read_b128 v[216:219], v241 offset:9216
  v_mfma_f32_16x16x32_bf16 v[104:107], v[200:203], v[180:183], v[104:107]
  buffer_load_dwordx4 v240, s[48:51], s78 offen lds
  v_mfma_f32_16x16x32_bf16 v[96:99], v[204:207], v[184:187], v[96:99]
  ds_read_b128 v[200:203], v242 offset:9216
  v_mfma_f32_16x16x32_bf16 v[104:107], v[204:207], v[188:191], v[104:107]
  s_waitcnt lgkmcnt(2)
  v_mfma_f32_16x16x32_bf16 v[100:103], v[208:211], v[160:163], v[192:195]
  ds_read_b128 v[204:207], v241 offset:2048
  v_mfma_f32_16x16x32_bf16 v[108:111], v[208:211], v[164:167], v[196:199]
  buffer_load_dwordx4 v240, s[52:55], s78 offen offset:1024 lds
  v_mfma_f32_16x16x32_bf16 v[100:103], v[212:215], v[168:171], v[100:103]
  ds_read_b128 v[208:211], v242 offset:2048
  v_max3_f32 v253, v96, v97, v98
  v_mfma_f32_16x16x32_bf16 v[108:111], v[212:215], v[172:175], v[108:111]
  s_waitcnt lgkmcnt(2)
  v_max3_f32 v253, v253, v99, v104
  v_max3_f32 v253, v253, v105, v106
  v_mfma_f32_16x16x32_bf16 v[100:103], v[216:219], v[176:179], v[100:103]
  ds_read_b128 v[212:215], v241 offset:10240
  v_mfma_f32_16x16x32_bf16 v[108:111], v[216:219], v[180:183], v[108:111]
  buffer_load_dwordx4 v240, s[56:59], s78 offen offset:2048 lds
  v_mfma_f32_16x16x32_bf16 v[100:103], v[200:203], v[184:187], v[100:103]
  ds_read_b128 v[216:219], v242 offset:10240
  v_mfma_f32_16x16x32_bf16 v[108:111], v[200:203], v[188:191], v[108:111]
  s_waitcnt lgkmcnt(2)
  v_mfma_f32_16x16x32_bf16 v[112:115], v[204:207], v[160:163], v[192:195]
  ds_read_b128 v[200:203], v241 offset:3072
  v_mfma_f32_16x16x32_bf16 v[120:123], v[204:207], v[164:167], v[196:199]
  buffer_load_dwordx4 v240, s[60:63], s78 offen offset:3072 lds
  v_add_u32 v240, 262144, v240
  v_mfma_f32_16x16x32_bf16 v[112:115], v[208:211], v[168:171], v[112:115]
  ds_read_b128 v[204:207], v242 offset:3072
  v_max3_f32 v253, v253, v107, v100
  v_mfma_f32_16x16x32_bf16 v[120:123], v[208:211], v[172:175], v[120:123]
  s_waitcnt lgkmcnt(2)
  v_max3_f32 v253, v253, v101, v102
  v_max3_f32 v253, v253, v103, v108
  v_mfma_f32_16x16x32_bf16 v[112:115], v[212:215], v[176:179], v[112:115]
  s_add_u32 m0, s68, 81920
  ds_read_b128 v[208:211], v241 offset:11264
  v_max3_f32 v253, v253, v109, v110
  v_mfma_f32_16x16x32_bf16 v[120:123], v[212:215], v[180:183], v[120:123]
  buffer_load_dwordx4 v237, s[12:15], s95 offen nt lds
  v_mfma_f32_16x16x32_bf16 v[112:115], v[216:219], v[184:187], v[112:115]
  ds_read_b128 v[212:215], v242 offset:11264
  v_mfma_f32_16x16x32_bf16 v[120:123], v[216:219], v[188:191], v[120:123]
  s_waitcnt lgkmcnt(2)
  v_mfma_f32_16x16x32_bf16 v[116:119], v[200:203], v[160:163], v[192:195]
  s_waitcnt vmcnt(25)
  s_barrier
  ds_read_b64_tr_b16 v[216:217], v249 offset:16384
  ds_read_b64_tr_b16 v[218:219], v249 offset:18432
  v_mfma_f32_16x16x32_bf16 v[124:127], v[200:203], v[164:167], v[196:199]
  buffer_load_dwordx4 v237, s[12:15], s95 offen offset:1024 nt lds
  v_mfma_f32_16x16x32_bf16 v[116:119], v[204:207], v[168:171], v[116:119]
  ds_read_b64_tr_b16 v[200:201], v250 offset:16384
  v_max3_f32 v253, v253, v111, v112
  v_mfma_f32_16x16x32_bf16 v[124:127], v[204:207], v[172:175], v[124:127]
  s_waitcnt lgkmcnt(3)
  ds_read_b64_tr_b16 v[202:203], v250 offset:18432
  v_max3_f32 v253, v253, v113, v114
  v_mfma_f32_16x16x32_bf16 v[116:119], v[208:211], v[176:179], v[116:119]
  ds_read_b64_tr_b16 v[204:205], v249 offset:16640
  v_max3_f32 v253, v253, v115, v120
  v_mfma_f32_16x16x32_bf16 v[124:127], v[208:211], v[180:183], v[124:127]
  ds_read_b64_tr_b16 v[206:207], v249 offset:18688
  v_max3_f32 v253, v253, v121, v122
  v_mfma_f32_16x16x32_bf16 v[116:119], v[212:215], v[184:187], v[116:119]
  ds_read_b64_tr_b16 v[208:209], v250 offset:16640
  v_mfma_f32_16x16x32_bf16 v[124:127], v[212:215], v[188:191], v[124:127]
  s_waitcnt lgkmcnt(3)
  ds_read_b64_tr_b16 v[210:211], v250 offset:18688
  v_mfma_f32_16x16x32_bf16 a[128:131], v[216:219], v[128:131], a[128:131]
  ds_read_b64_tr_b16 v[212:213], v249 offset:20480
  v_mfma_f32_16x16x32_bf16 a[136:139], v[216:219], v[132:135], a[136:139]
  ds_read_b64_tr_b16 v[214:215], v249 offset:22528
  v_mfma_f32_16x16x32_bf16 a[132:135], v[200:203], v[128:131], a[132:135]
  ds_read_b64_tr_b16 v[216:217], v250 offset:20480
  v_max3_f32 v253, v253, v123, v116
  v_mfma_f32_16x16x32_bf16 a[140:143], v[200:203], v[132:135], a[140:143]
  s_waitcnt lgkmcnt(3)
  ds_read_b64_tr_b16 v[218:219], v250 offset:22528
  v_max3_f32 v253, v253, v117, v118
  v_max3_f32 v253, v253, v119, v124
  v_mfma_f32_16x16x32_bf16 a[144:147], v[204:207], v[128:131], a[144:147]
  ds_read_b64_tr_b16 v[200:201], v249 offset:20736
  v_max3_f32 v253, v253, v125, v126
  v_mfma_f32_16x16x32_bf16 a[152:155], v[204:207], v[132:135], a[152:155]
  ds_read_b64_tr_b16 v[202:203], v249 offset:22784
  v_max_f32 v253, v253, v127
  v_cmp_lt_f32 vcc, 0x41200000, v253
  v_mfma_f32_16x16x32_bf16 a[148:151], v[208:211], v[128:131], a[148:151]
  s_cbranch_vccnz L_r2_6t
L_r2_6:
  ds_read_b64_tr_b16 v[204:205], v250 offset:20736
  ds_read_b64_tr_b16 v[206:207], v250 offset:22784
  v_mfma_f32_16x16x32_bf16 a[156:159], v[208:211], v[132:135], a[156:159]
  s_waitcnt lgkmcnt(4)
  v_exp_f32 v96, v96
  v_mfma_f32_16x16x32_bf16 a[128:131], v[212:215], v[136:139], a[128:131]
  ds_read_b64_tr_b16 v[208:209], v249 offset:24576
  ds_read_b64_tr_b16 v[210:211], v249 offset:26624
  v_mfma_f32_16x16x32_bf16 a[136:139], v[212:215], v[140:143], a[136:139]
  v_exp_f32 v97, v97
  v_mfma_f32_16x16x32_bf16 a[132:135], v[216:219], v[136:139], a[132:135]
  ds_read_b64_tr_b16 v[212:213], v250 offset:24576
  v_cvt_pk_bf16_f32 v96, v96, v97
  v_mfma_f32_16x16x32_bf16 a[140:143], v[216:219], v[140:143], a[140:143]
  s_waitcnt lgkmcnt(3)
  ds_read_b64_tr_b16 v[214:215], v250 offset:26624
  v_exp_f32 v98, v98
  v_mfma_f32_16x16x32_bf16 a[144:147], v[200:203], v[136:139], a[144:147]
  ds_read_b64_tr_b16 v[216:217], v249 offset:24832
  ds_read_b64_tr_b16 v[218:219], v249 offset:26880
  v_mfma_f32_16x16x32_bf16 a[152:155], v[200:203], v[140:143], a[152:155]
  v_exp_f32 v99, v99
  v_mfma_f32_16x16x32_bf16 a[148:151], v[204:207], v[136:139], a[148:151]
  ds_read_b64_tr_b16 v[200:201], v250 offset:24832
  v_cvt_pk_bf16_f32 v97, v98, v99
  v_mfma_f32_16x16x32_bf16 a[156:159], v[204:207], v[140:143], a[156:159]
  s_waitcnt lgkmcnt(3)
  ds_read_b64_tr_b16 v[202:203], v250 offset:26880
  v_exp_f32 v100, v100
  v_mfma_f32_16x16x32_bf16 a[128:131], v[208:211], v[144:147], a[128:131]
  ds_read_b64_tr_b16 v[204:205], v249 offset:28672
  ds_read_b64_tr_b16 v[206:207], v249 offset:30720
  v_mfma_f32_16x16x32_bf16 a[136:139], v[208:211], v[148:151], a[136:139]
  v_exp_f32 v101, v101
  v_mfma_f32_16x16x32_bf16 a[132:135], v[212:215], v[144:147], a[132:135]
  ds_read_b64_tr_b16 v[208:209], v250 offset:28672
  v_cvt_pk_bf16_f32 v98, v100, v101
  v_mfma_f32_16x16x32_bf16 a[140:143], v[212:215], v[148:151], a[140:143]
  s_waitcnt lgkmcnt(3)
  ds_read_b64_tr_b16 v[210:211], v250 offset:30720
  v_exp_f32 v102, v102
  v_mfma_f32_16x16x32_bf16 a[144:147], v[216:219], v[144:147], a[144:147]
  ds_read_b64_tr_b16 v[212:213], v249 offset:28928
  ds_read_b64_tr_b16 v[214:215], v249 offset:30976
  v_mfma_f32_16x16x32_bf16 a[152:155], v[216:219], v[148:151], a[152:155]
  v_exp_f32 v103, v103
  v_mfma_f32_16x16x32_bf16 a[148:151], v[200:203], v[144:147], a[148:151]
  ds_read_b64_tr_b16 v[216:217], v250 offset:28928
  v_cvt_pk_bf16_f32 v99, v102, v103
  v_mfma_f32_16x16x32_bf16 a[156:159], v[200:203], v[148:151], a[156:159]
  s_waitcnt lgkmcnt(3)
  ds_read_b64_tr_b16 v[218:219], v250 offset:30976
  v_exp_f32 v104, v104
  v_mfma_f32_16x16x32_bf16 v[224:227], v[220:223], v[96:99], v[224:227]
  v_exp_f32 v105, v105
  v_mfma_f32_16x16x32_bf16 a[128:131], v[204:207], v[152:155], a[128:131]
  s_waitcnt vmcnt(14)
  s_barrier
  ds_read_b64_tr_b16 v[200:201], v245 offset:32768
  v_mfma_f32_16x16x32_bf16 a[136:139], v[204:207], v[156:159], a[136:139]
  ds_read_b64_tr_b16 v[202:203], v245 offset:33792
  v_cvt_pk_bf16_f32 v100, v104, v105
  v_mfma_f32_16x16x32_bf16 a[132:135], v[208:211], v[152:155], a[132:135]
  ds_read_b64_tr_b16 v[204:205], v246 offset:32768
  ds_read_b64_tr_b16 v[206:207], v246 offset:33792
  v_mfma_f32_16x16x32_bf16 a[140:143], v[208:211], v[156:159], a[140:143]
  s_waitcnt lgkmcnt(4)
  v_exp_f32 v106, v106
  v_mfma_f32_16x16x32_bf16 a[144:147], v[212:215], v[152:155], a[144:147]
  ds_read_b64_tr_b16 v[208:209], v245 offset:33024
  ds_read_b64_tr_b16 v[210:211], v245 offset:34048
  v_mfma_f32_16x16x32_bf16 a[152:155], v[212:215], v[156:159], a[152:155]
  v_exp_f32 v107, v107
  v_exp_f32 v108, v108
  v_cvt_pk_bf16_f32 v101, v106, v107
  v_exp_f32 v109, v109
  v_exp_f32 v110, v110
  v_cvt_pk_bf16_f32 v102, v108, v109
  v_exp_f32 v111, v111
  v_exp_f32 v112, v112
  v_cvt_pk_bf16_f32 v103, v110, v111
  v_mfma_f32_16x16x32_bf16 a[148:151], v[216:219], v[152:155], a[148:151]
  ds_read_b64_tr_b16 v[212:213], v246 offset:33024
  ds_read_b64_tr_b16 v[214:215], v246 offset:34048
  v_mfma_f32_16x16x32_bf16 a[156:159], v[216:219], v[156:159], a[156:159]
  s_waitcnt lgkmcnt(4)
  v_exp_f32 v113, v113
  v_mfma_f32_16x16x32_bf16 v[228:231], v[220:223], v[100:103], v[228:231]
  v_cvt_pk_bf16_f32 v104, v112, v113
  v_mfma_f32_16x16x32_bf16 v[32:35], v[200:203], v[96:99], v[32:35]
  ds_read_b64_tr_b16 v[216:217], v245 offset:33280
  ds_read_b64_tr_b16 v[218:219], v245 offset:34304
  v_mfma_f32_16x16x32_bf16 v[40:43], v[200:203], v[100:103], v[40:43]
  v_exp_f32 v114, v114
  v_mfma_f32_16x16x32_bf16 v[36:39], v[204:207], v[96:99], v[36:39]
  ds_read_b64_tr_b16 v[200:201], v246 offset:33280
  ds_read_b64_tr_b16 v[202:203], v246 offset:34304
  v_mfma_f32_16x16x32_bf16 v[44:47], v[204:207], v[100:103], v[44:47]
  s_waitcnt lgkmcnt(4)
  buffer_load_dwordx4 v237, s[12:15], s95 offen offset:2048 nt lds
  v_mfma_f32_16x16x32_bf16 v[48:51], v[208:211], v[96:99], v[48:51]
  ds_read_b64_tr_b16 v[204:205], v245 offset:33536
  ds_read_b64_tr_b16 v[206:207], v245 offset:34560
  v_mfma_f32_16x16x32_bf16 v[56:59], v[208:211], v[100:103], v[56:59]
  v_exp_f32 v115, v115
  v_mfma_f32_16x16x32_bf16 v[52:55], v[212:215], v[96:99], v[52:55]
  ds_read_b64_tr_b16 v[208:209], v246 offset:33536
  ds_read_b64_tr_b16 v[210:211], v246 offset:34560
  v_mfma_f32_16x16x32_bf16 v[60:63], v[212:215], v[100:103], v[60:63]
  s_waitcnt lgkmcnt(4)
  buffer_load_dwordx4 v237, s[12:15], s95 offen offset:3072 nt lds
  v_add_u32 v237, 262144, v237
  v_mfma_f32_16x16x32_bf16 v[64:67], v[216:219], v[96:99], v[64:67]
  ds_read_b64_tr_b16 v[212:213], v245 offset:34816
  v_cvt_pk_bf16_f32 v105, v114, v115
  v_mfma_f32_16x16x32_bf16 v[72:75], v[216:219], v[100:103], v[72:75]
  ds_read_b64_tr_b16 v[214:215], v245 offset:35840
  v_exp_f32 v116, v116
  v_mfma_f32_16x16x32_bf16 v[68:71], v[200:203], v[96:99], v[68:71]
  s_add_u32 m0, s68, 32768
  ds_read_b64_tr_b16 v[216:217], v246 offset:34816
  ds_read_b64_tr_b16 v[218:219], v246 offset:35840
  v_mfma_f32_16x16x32_bf16 v[76:79], v[200:203], v[100:103], v[76:79]
  s_waitcnt lgkmcnt(4)
  buffer_load_dwordx4 v236, s[8:11], s88 offen nt lds
  v_mfma_f32_16x16x32_bf16 v[80:83], v[204:207], v[96:99], v[80:83]
  ds_read_b64_tr_b16 v[200:201], v245 offset:35072
  ds_read_b64_tr_b16 v[202:203], v245 offset:36096
  v_mfma_f32_16x16x32_bf16 v[88:91], v[204:207], v[100:103], v[88:91]
  v_exp_f32 v117, v117
  v_exp_f32 v118, v118
  v_cvt_pk_bf16_f32 v106, v116, v117
  v_exp_f32 v119, v119
  v_exp_f32 v120, v120
  v_cvt_pk_bf16_f32 v107, v118, v119
  v_exp_f32 v121, v121
  v_exp_f32 v122, v122
  v_cvt_pk_bf16_f32 v108, v120, v121
  v_exp_f32 v123, v123
  v_exp_f32 v124, v124
  v_cvt_pk_bf16_f32 v109, v122, v123
  v_exp_f32 v125, v125
  v_exp_f32 v126, v126
  v_cvt_pk_bf16_f32 v110, v124, v125
  v_exp_f32 v127, v127
  s_nop 0
  v_cvt_pk_bf16_f32 v111, v126, v127
  v_mfma_f32_16x16x32_bf16 v[84:87], v[208:211], v[96:99], v[84:87]
  ds_read_b64_tr_b16 v[204:205], v246 offset:35072
  ds_read_b64_tr_b16 v[206:207], v246 offset:36096
  v_mfma_f32_16x16x32_bf16 v[92:95], v[208:211], v[100:103], v[92:95]
  s_waitcnt lgkmcnt(4)
  buffer_load_dwordx4 v236, s[8:11], s88 offen offset:1024 nt lds
  v_mfma_f32_16x16x32_bf16 v[32:35], v[212:215], v[104:107], v[32:35]
  ds_read_b64_tr_b16 v[208:209], v245 offset:35328
  v_mfma_f32_16x16x32_bf16 v[40:43], v[212:215], v[108:111], v[40:43]
  ds_read_b64_tr_b16 v[210:211], v245 offset:36352
  v_mfma_f32_16x16x32_bf16 v[36:39], v[216:219], v[104:107], v[36:39]
  ds_read_b64_tr_b16 v[212:213], v246 offset:35328
  ds_read_b64_tr_b16 v[214:215], v246 offset:36352
  v_mfma_f32_16x16x32_bf16 v[44:47], v[216:219], v[108:111], v[44:47]
  s_waitcnt lgkmcnt(4)
  buffer_load_dwordx4 v236, s[8:11], s88 offen offset:2048 nt lds
  v_mfma_f32_16x16x32_bf16 v[48:51], v[200:203], v[104:107], v[48:51]
  ds_read_b64_tr_b16 v[216:217], v245 offset:35584
  v_mfma_f32_16x16x32_bf16 v[56:59], v[200:203], v[108:111], v[56:59]
  ds_read_b64_tr_b16 v[218:219], v245 offset:36608
  v_mfma_f32_16x16x32_bf16 v[52:55], v[204:207], v[104:107], v[52:55]
  ds_read_b64_tr_b16 v[200:201], v246 offset:35584
  ds_read_b64_tr_b16 v[202:203], v246 offset:36608
  v_mfma_f32_16x16x32_bf16 v[60:63], v[204:207], v[108:111], v[60:63]
  s_waitcnt lgkmcnt(4)
  buffer_load_dwordx4 v236, s[8:11], s88 offen offset:3072 nt lds
  v_mfma_f32_16x16x32_bf16 v[64:67], v[208:211], v[104:107], v[64:67]
  s_waitcnt vmcnt(12)
  s_barrier
  ds_read_b128 v[204:207], v241 offset:16384
  v_mfma_f32_16x16x32_bf16 v[72:75], v[208:211], v[108:111], v[72:75]
  v_mfma_f32_16x16x32_bf16 v[224:227], v[220:223], v[104:107], v[224:227]
  v_mfma_f32_16x16x32_bf16 v[68:71], v[212:215], v[104:107], v[68:71]
  s_add_u32 m0, s68, 114688
  ds_read_b128 v[208:211], v242 offset:16384
  v_mfma_f32_16x16x32_bf16 v[76:79], v[212:215], v[108:111], v[76:79]
  s_waitcnt lgkmcnt(2)
  buffer_load_dwordx4 v240, s[48:51], s72 offen lds
  v_mfma_f32_16x16x32_bf16 v[228:231], v[220:223], v[108:111], v[228:231]
  v_mfma_f32_16x16x32_bf16 v[80:83], v[216:219], v[104:107], v[80:83]
  ds_read_b128 v[212:215], v241 offset:24576
  v_mfma_f32_16x16x32_bf16 v[88:91], v[216:219], v[108:111], v[88:91]
  v_mfma_f32_16x16x32_bf16 v[84:87], v[200:203], v[104:107], v[84:87]
  ds_read_b128 v[216:219], v242 offset:24576
  v_mfma_f32_16x16x32_bf16 v[92:95], v[200:203], v[108:111], v[92:95]
  s_waitcnt lgkmcnt(2)
  buffer_load_dwordx4 v240, s[52:55], s72 offen offset:1024 lds
  v_mfma_f32_16x16x32_bf16 v[96:99], v[204:207], v[160:163], v[192:195]
  ds_read_b128 v[200:203], v241 offset:17408
  v_mfma_f32_16x16x32_bf16 v[104:107], v[204:207], v[164:167], v[196:199]
  v_mfma_f32_16x16x32_bf16 v[96:99], v[208:211], v[168:171], v[96:99]
  ds_read_b128 v[204:207], v242 offset:17408
  v_mfma_f32_16x16x32_bf16 v[104:107], v[208:211], v[172:175], v[104:107]
  s_waitcnt lgkmcnt(2)
  v_mfma_f32_16x16x32_bf16 v[96:99], v[212:215], v[176:179], v[96:99]
  ds_read_b128 v[208:211], v241 offset:25600
  v_mfma_f32_16x16x32_bf16 v[104:107], v[212:215], v[180:183], v[104:107]
  v_mfma_f32_16x16x32_bf16 v[96:99], v[216:219], v[184:187], v[96:99]
  ds_read_b128 v[212:215], v242 offset:25600
  v_mfma_f32_16x16x32_bf16 v[104:107], v[216:219], v[188:191], v[104:107]
  s_waitcnt lgkmcnt(2)
  v_mfma_f32_16x16x32_bf16 v[100:103], v[200:203], v[160:163], v[192:195]
  ds_read_b128 v[216:219], v241 offset:18432
  v_mfma_f32_16x16x32_bf16 v[108:111], v[200:203], v[164:167], v[196:199]
  v_mfma_f32_16x16x32_bf16 v[100:103], v[204:207], v[168:171], v[100:103]
  ds_read_b128 v[200:203], v242 offset:18432
  v_max3_f32 v253, v96, v97, v98
  v_mfma_f32_16x16x32_bf16 v[108:111], v[204:207], v[172:175], v[108:111]
  s_waitcnt lgkmcnt(2)
  v_max3_f32 v253, v253, v99, v104
  v_max3_f32 v253, v253, v105, v106
  v_mfma_f32_16x16x32_bf16 v[100:103], v[208:211], v[176:179], v[100:103]
  ds_read_b128 v[204:207], v241 offset:26624
  v_mfma_f32_16x16x32_bf16 v[108:111], v[208:211], v[180:183], v[108:111]
  v_mfma_f32_16x16x32_bf16 v[100:103], v[212:215], v[184:187], v[100:103]
  ds_read_b128 v[208:211], v242 offset:26624
  v_mfma_f32_16x16x32_bf16 v[108:111], v[212:215], v[188:191], v[108:111]
  s_waitcnt lgkmcnt(2)
  v_mfma_f32_16x16x32_bf16 v[112:115], v[216:219], v[160:163], v[192:195]
  ds_read_b128 v[212:215], v241 offset:19456
  v_mfma_f32_16x16x32_bf16 v[120:123], v[216:219], v[164:167], v[196:199]
  v_mfma_f32_16x16x32_bf16 v[112:115], v[200:203], v[168:171], v[112:115]
  ds_read_b128 v[216:219], v242 offset:19456
  v_max3_f32 v253, v253, v107, v100
  v_mfma_f32_16x16x32_bf16 v[120:123], v[200:203], v[172:175], v[120:123]
  s_waitcnt lgkmcnt(2)
  v_max3_f32 v253, v253, v101, v102
  v_max3_f32 v253, v253, v103, v108
  v_mfma_f32_16x16x32_bf16 v[112:115], v[204:207], v[176:179], v[112:115]
  ds_read_b128 v[200:203], v241 offset:27648
  v_max3_f32 v253, v253, v109, v110
  v_mfma_f32_16x16x32_bf16 v[120:123], v[204:207], v[180:183], v[120:123]
  v_mfma_f32_16x16x32_bf16 v[112:115], v[208:211], v[184:187], v[112:115]
  ds_read_b128 v[204:207], v242 offset:27648
  v_mfma_f32_16x16x32_bf16 v[120:123], v[208:211], v[188:191], v[120:123]
  s_waitcnt lgkmcnt(2)
  v_mfma_f32_16x16x32_bf16 v[116:119], v[212:215], v[160:163], v[192:195]
  s_waitcnt vmcnt(18)
  s_barrier
  ds_read_b64_tr_b16 v[208:209], v249 offset:32768
  v_mfma_f32_16x16x32_bf16 v[124:127], v[212:215], v[164:167], v[196:199]
  ds_read_b64_tr_b16 v[210:211], v249 offset:34816
  v_mfma_f32_16x16x32_bf16 v[116:119], v[216:219], v[168:171], v[116:119]
  ds_read_b64_tr_b16 v[212:213], v250 offset:32768
  v_max3_f32 v253, v253, v111, v112
  v_mfma_f32_16x16x32_bf16 v[124:127], v[216:219], v[172:175], v[124:127]
  s_waitcnt lgkmcnt(3)
  ds_read_b64_tr_b16 v[214:215], v250 offset:34816
  v_max3_f32 v253, v253, v113, v114
  v_mfma_f32_16x16x32_bf16 v[116:119], v[200:203], v[176:179], v[116:119]
  ds_read_b64_tr_b16 v[216:217], v249 offset:33024
  v_max3_f32 v253, v253, v115, v120
  v_mfma_f32_16x16x32_bf16 v[124:127], v[200:203], v[180:183], v[124:127]
  ds_read_b64_tr_b16 v[218:219], v249 offset:35072
  v_max3_f32 v253, v253, v121, v122
  v_mfma_f32_16x16x32_bf16 v[116:119], v[204:207], v[184:187], v[116:119]
  ds_read_b64_tr_b16 v[200:201], v250 offset:33024
  v_mfma_f32_16x16x32_bf16 v[124:127], v[204:207], v[188:191], v[124:127]
  s_waitcnt lgkmcnt(3)
  ds_read_b64_tr_b16 v[202:203], v250 offset:35072
  v_mfma_f32_16x16x32_bf16 a[160:163], v[208:211], v[128:131], a[160:163]
  ds_read_b64_tr_b16 v[204:205], v249 offset:36864
  v_mfma_f32_16x16x32_bf16 a[168:171], v[208:211], v[132:135], a[168:171]
  ds_read_b64_tr_b16 v[206:207], v249 offset:38912
  v_mfma_f32_16x16x32_bf16 a[164:167], v[212:215], v[128:131], a[164:167]
  ds_read_b64_tr_b16 v[208:209], v250 offset:36864
  v_max3_f32 v253, v253, v123, v116
  v_mfma_f32_16x16x32_bf16 a[172:175], v[212:215], v[132:135], a[172:175]
  s_waitcnt lgkmcnt(3)
  ds_read_b64_tr_b16 v[210:211], v250 offset:38912
  v_max3_f32 v253, v253, v117, v118
  v_max3_f32 v253, v253, v119, v124
  v_mfma_f32_16x16x32_bf16 a[176:179], v[216:219], v[128:131], a[176:179]
  ds_read_b64_tr_b16 v[212:213], v249 offset:37120
  v_max3_f32 v253, v253, v125, v126
  v_mfma_f32_16x16x32_bf16 a[184:187], v[216:219], v[132:135], a[184:187]
  ds_read_b64_tr_b16 v[214:215], v249 offset:39168
  v_max_f32 v253, v253, v127
  v_cmp_lt_f32 vcc, 0x41200000, v253
  v_mfma_f32_16x16x32_bf16 a[180:183], v[200:203], v[128:131], a[180:183]
  s_cbranch_vccnz L_r2_7t
L_r2_7:
  ds_read_b64_tr_b16 v[216:217], v250 offset:37120
  ds_read_b64_tr_b16 v[218:219], v250 offset:39168
  v_mfma_f32_16x16x32_bf16 a[188:191], v[200:203], v[132:135], a[188:191]
  s_waitcnt lgkmcnt(4)
  v_exp_f32 v96, v96
  v_mfma_f32_16x16x32_bf16 a[160:163], v[204:207], v[136:139], a[160:163]
  ds_read_b64_tr_b16 v[200:201], v249 offset:40960
  ds_read_b64_tr_b16 v[202:203], v249 offset:43008
  v_mfma_f32_16x16x32_bf16 a[168:171], v[204:207], v[140:143], a[168:171]
  buffer_load_dwordx4 v240, s[56:59], s72 offen offset:2048 lds
  v_mfma_f32_16x16x32_bf16 a[164:167], v[208:211], v[136:139], a[164:167]
  ds_read_b64_tr_b16 v[204:205], v250 offset:40960
  ds_read_b64_tr_b16 v[206:207], v250 offset:43008
  v_mfma_f32_16x16x32_bf16 a[172:175], v[208:211], v[140:143], a[172:175]
  s_waitcnt lgkmcnt(4)
  v_exp_f32 v97, v97
  v_mfma_f32_16x16x32_bf16 a[176:179], v[212:215], v[136:139], a[176:179]
  ds_read_b64_tr_b16 v[208:209], v249 offset:41216
  ds_read_b64_tr_b16 v[210:211], v249 offset:43264
  v_mfma_f32_16x16x32_bf16 a[184:187], v[212:215], v[140:143], a[184:187]
  buffer_load_dwordx4 v240, s[60:63], s72 offen offset:3072 lds
  v_cvt_pk_bf16_f32 v96, v96, v97
  v_mfma_f32_16x16x32_bf16 a[180:183], v[216:219], v[136:139], a[180:183]
  ds_read_b64_tr_b16 v[212:213], v250 offset:41216
  ds_read_b64_tr_b16 v[214:215], v250 offset:43264
  v_mfma_f32_16x16x32_bf16 a[188:191], v[216:219], v[140:143], a[188:191]
  s_waitcnt lgkmcnt(4)
  v_exp_f32 v98, v98
  v_mfma_f32_16x16x32_bf16 a[160:163], v[200:203], v[144:147], a[160:163]
  s_add_u32 m0, s68, 65536
  ds_read_b64_tr_b16 v[216:217], v249 offset:45056
  ds_read_b64_tr_b16 v[218:219], v249 offset:47104
  v_mfma_f32_16x16x32_bf16 a[168:171], v[200:203], v[148:151], a[168:171]
  buffer_load_dwordx4 v237, s[12:15], s88 offen nt lds
  v_mfma_f32_16x16x32_bf16 a[164:167], v[204:207], v[144:147], a[164:167]
  ds_read_b64_tr_b16 v[200:201], v250 offset:45056
  ds_read_b64_tr_b16 v[202:203], v250 offset:47104
  v_mfma_f32_16x16x32_bf16 a[172:175], v[204:207], v[148:151], a[172:175]
  s_waitcnt lgkmcnt(4)
  v_exp_f32 v99, v99
  v_mfma_f32_16x16x32_bf16 a[176:179], v[208:211], v[144:147], a[176:179]
  ds_read_b64_tr_b16 v[204:205], v249 offset:45312
  ds_read_b64_tr_b16 v[206:207], v249 offset:47360
  v_mfma_f32_16x16x32_bf16 a[184:187], v[208:211], v[148:151], a[184:187]
  buffer_load_dwordx4 v237, s[12:15], s88 offen offset:1024 nt lds
  v_cvt_pk_bf16_f32 v97, v98, v99
  v_mfma_f32_16x16x32_bf16 a[180:183], v[212:215], v[144:147], a[180:183]
  ds_read_b64_tr_b16 v[208:209], v250 offset:45312
  ds_read_b64_tr_b16 v[210:211], v250 offset:47360
  v_mfma_f32_16x16x32_bf16 a[188:191], v[212:215], v[148:151], a[188:191]
  s_waitcnt lgkmcnt(4)
  v_exp_f32 v100, v100
  v_mfma_f32_16x16x32_bf16 a[160:163], v[216:219], v[152:155], a[160:163]
  s_waitcnt vmcnt(10)
  s_barrier
  ds_read_b64_tr_b16 v[212:213], v245 offset:16384
  ds_read_b64_tr_b16 v[214:215], v245 offset:17408
  v_mfma_f32_16x16x32_bf16 a[168:171], v[216:219], v[156:159], a[168:171]
  buffer_load_dwordx4 v237, s[12:15], s88 offen offset:2048 nt lds
  v_mfma_f32_16x16x32_bf16 a[164:167], v[200:203], v[152:155], a[164:167]
  ds_read_b64_tr_b16 v[216:217], v246 offset:16384
  ds_read_b64_tr_b16 v[218:219], v246 offset:17408
  v_mfma_f32_16x16x32_bf16 a[172:175], v[200:203], v[156:159], a[172:175]
  s_waitcnt lgkmcnt(4)
  v_exp_f32 v101, v101
  v_mfma_f32_16x16x32_bf16 a[176:179], v[204:207], v[152:155], a[176:179]
  ds_read_b64_tr_b16 v[200:201], v245 offset:16640
  ds_read_b64_tr_b16 v[202:203], v245 offset:17664
  v_mfma_f32_16x16x32_bf16 a[184:187], v[204:207], v[156:159], a[184:187]
  buffer_load_dwordx4 v237, s[12:15], s88 offen offset:3072 nt lds
  v_cvt_pk_bf16_f32 v98, v100, v101
  v_exp_f32 v102, v102
  v_exp_f32 v103, v103
  v_exp_f32 v104, v104
  v_cvt_pk_bf16_f32 v99, v102, v103
  v_exp_f32 v105, v105
  v_exp_f32 v106, v106
  v_cvt_pk_bf16_f32 v100, v104, v105
  v_exp_f32 v107, v107
  v_exp_f32 v108, v108
  v_cvt_pk_bf16_f32 v101, v106, v107
  v_exp_f32 v109, v109
  v_exp_f32 v110, v110
  v_cvt_pk_bf16_f32 v102, v108, v109
  v_exp_f32 v111, v111
  v_exp_f32 v112, v112
  v_cvt_pk_bf16_f32 v103, v110, v111
  v_mfma_f32_16x16x32_bf16 a[180:183], v[208:211], v[152:155], a[180:183]
  ds_read_b64_tr_b16 v[204:205], v246 offset:16640
  ds_read_b64_tr_b16 v[206:207], v246 offset:17664
  v_mfma_f32_16x16x32_bf16 a[188:191], v[208:211], v[156:159], a[188:191]
  s_waitcnt lgkmcnt(4)
  v_exp_f32 v113, v113
  v_mfma_f32_16x16x32_bf16 v[224:227], v[220:223], v[96:99], v[224:227]
  v_cvt_pk_bf16_f32 v104, v112, v113
  v_mfma_f32_16x16x32_bf16 v[32:35], v[212:215], v[96:99], v[32:35]
  s_add_u32 m0, s68, 49152
  ds_read_b64_tr_b16 v[208:209], v245 offset:16896
  ds_read_b64_tr_b16 v[210:211], v245 offset:17920
  v_mfma_f32_16x16x32_bf16 v[40:43], v[212:215], v[100:103], v[40:43]
  buffer_load_dwordx4 v236, s[8:11], s89 offen nt lds
  v_mfma_f32_16x16x32_bf16 v[228:231], v[220:223], v[100:103], v[228:231]
  v_exp_f32 v114, v114
  v_mfma_f32_16x16x32_bf16 v[36:39], v[216:219], v[96:99], v[36:39]
  ds_read_b64_tr_b16 v[212:213], v246 offset:16896
  ds_read_b64_tr_b16 v[214:215], v246 offset:17920
  v_mfma_f32_16x16x32_bf16 v[44:47], v[216:219], v[100:103], v[44:47]
  s_waitcnt lgkmcnt(4)
  v_exp_f32 v115, v115
  v_mfma_f32_16x16x32_bf16 v[48:51], v[200:203], v[96:99], v[48:51]
  ds_read_b64_tr_b16 v[216:217], v245 offset:17152
  v_cvt_pk_bf16_f32 v105, v114, v115
  v_mfma_f32_16x16x32_bf16 v[56:59], v[200:203], v[100:103], v[56:59]
  ds_read_b64_tr_b16 v[218:219], v245 offset:18176
  v_exp_f32 v116, v116
  v_mfma_f32_16x16x32_bf16 v[52:55], v[204:207], v[96:99], v[52:55]
  ds_read_b64_tr_b16 v[200:201], v246 offset:17152
  ds_read_b64_tr_b16 v[202:203], v246 offset:18176
  v_mfma_f32_16x16x32_bf16 v[60:63], v[204:207], v[100:103], v[60:63]
  s_waitcnt lgkmcnt(4)
  v_exp_f32 v117, v117
  v_mfma_f32_16x16x32_bf16 v[64:67], v[208:211], v[96:99], v[64:67]
  ds_read_b64_tr_b16 v[204:205], v245 offset:18432
  v_cvt_pk_bf16_f32 v106, v116, v117
  v_mfma_f32_16x16x32_bf16 v[72:75], v[208:211], v[100:103], v[72:75]
  ds_read_b64_tr_b16 v[206:207], v245 offset:19456
  v_exp_f32 v118, v118
  v_mfma_f32_16x16x32_bf16 v[68:71], v[212:215], v[96:99], v[68:71]
  ds_read_b64_tr_b16 v[208:209], v246 offset:18432
  ds_read_b64_tr_b16 v[210:211], v246 offset:19456
  v_mfma_f32_16x16x32_bf16 v[76:79], v[212:215], v[100:103], v[76:79]
  s_waitcnt lgkmcnt(4)
  v_exp_f32 v119, v119
  v_mfma_f32_16x16x32_bf16 v[80:83], v[216:219], v[96:99], v[80:83]
  ds_read_b64_tr_b16 v[212:213], v245 offset:18688
  v_cvt_pk_bf16_f32 v107, v118, v119
  v_mfma_f32_16x16x32_bf16 v[88:91], v[216:219], v[100:103], v[88:91]
  ds_read_b64_tr_b16 v[214:215], v245 offset:19712
  v_exp_f32 v120, v120
  v_exp_f32 v121, v121
  v_exp_f32 v122, v122
  v_cvt_pk_bf16_f32 v108, v120, v121
  v_exp_f32 v123, v123
  v_exp_f32 v124, v124
  v_cvt_pk_bf16_f32 v109, v122, v123
  v_exp_f32 v125, v125
  v_exp_f32 v126, v126
  v_cvt_pk_bf16_f32 v110, v124, v125
  v_exp_f32 v127, v127
  s_nop 0
  v_cvt_pk_bf16_f32 v111, v126, v127
  v_mfma_f32_16x16x32_bf16 v[84:87], v[200:203], v[96:99], v[84:87]
  ds_read_b64_tr_b16 v[216:217], v246 offset:18688
  v_mfma_f32_16x16x32_bf16 v[92:95], v[200:203], v[100:103], v[92:95]
  s_waitcnt lgkmcnt(3)
  ds_read_b64_tr_b16 v[218:219], v246 offset:19712
  v_mfma_f32_16x16x32_bf16 v[32:35], v[204:207], v[104:107], v[32:35]
  ds_read_b64_tr_b16 v[200:201], v245 offset:18944
  v_mfma_f32_16x16x32_bf16 v[40:43], v[204:207], v[108:111], v[40:43]
  ds_read_b64_tr_b16 v[202:203], v245 offset:19968
  v_mfma_f32_16x16x32_bf16 v[36:39], v[208:211], v[104:107], v[36:39]
  ds_read_b64_tr_b16 v[204:205], v246 offset:18944
  v_mfma_f32_16x16x32_bf16 v[44:47], v[208:211], v[108:111], v[44:47]
  s_waitcnt lgkmcnt(3)
  ds_read_b64_tr_b16 v[206:207], v246 offset:19968
  v_mfma_f32_16x16x32_bf16 v[48:51], v[212:215], v[104:107], v[48:51]
  ds_read_b64_tr_b16 v[208:209], v245 offset:19200
  v_mfma_f32_16x16x32_bf16 v[56:59], v[212:215], v[108:111], v[56:59]
  ds_read_b64_tr_b16 v[210:211], v245 offset:20224
  v_mfma_f32_16x16x32_bf16 v[52:55], v[216:219], v[104:107], v[52:55]
  ds_read_b64_tr_b16 v[212:213], v246 offset:19200
  v_mfma_f32_16x16x32_bf16 v[60:63], v[216:219], v[108:111], v[60:63]
  s_waitcnt lgkmcnt(3)
  ds_read_b64_tr_b16 v[214:215], v246 offset:20224
  v_mfma_f32_16x16x32_bf16 v[64:67], v[200:203], v[104:107], v[64:67]
  s_waitcnt vmcnt(9)
  s_barrier
  ds_read_b128 v[216:219], v241 offset:32768
  v_mfma_f32_16x16x32_bf16 v[72:75], v[200:203], v[108:111], v[72:75]
  buffer_load_dwordx4 v236, s[8:11], s89 offen offset:1024 nt lds
  v_mfma_f32_16x16x32_bf16 v[224:227], v[220:223], v[104:107], v[224:227]
  v_mfma_f32_16x16x32_bf16 v[68:71], v[204:207], v[104:107], v[68:71]
  ds_read_b128 v[200:203], v242 offset:32768
  v_mfma_f32_16x16x32_bf16 v[76:79], v[204:207], v[108:111], v[76:79]
  s_waitcnt lgkmcnt(2)
  v_mfma_f32_16x16x32_bf16 v[228:231], v[220:223], v[108:111], v[228:231]
  v_mfma_f32_16x16x32_bf16 v[80:83], v[208:211], v[104:107], v[80:83]
  ds_read_b128 v[204:207], v241 offset:40960
  v_mfma_f32_16x16x32_bf16 v[88:91], v[208:211], v[108:111], v[88:91]
  buffer_load_dwordx4 v236, s[8:11], s89 offen offset:2048 nt lds
  v_mfma_f32_16x16x32_bf16 v[84:87], v[212:215], v[104:107], v[84:87]
  ds_read_b128 v[208:211], v242 offset:40960
  v_mfma_f32_16x16x32_bf16 v[92:95], v[212:215], v[108:111], v[92:95]
  s_waitcnt lgkmcnt(2)
  v_rcp_f32 v238, v224
  v_mfma_f32_16x16x32_bf16 v[96:99], v[216:219], v[0:3], 0
  ds_read_b128 v[212:215], v241 offset:33792
  v_mfma_f32_16x16x32_bf16 v[104:107], v[216:219], v[4:7], 0
  buffer_load_dwordx4 v236, s[8:11], s89 offen offset:3072 nt lds
  v_mfma_f32_16x16x32_bf16 v[96:99], v[200:203], v[8:11], v[96:99]
  ds_read_b128 v[216:219], v242 offset:33792
  v_mfma_f32_16x16x32_bf16 v[104:107], v[200:203], v[12:15], v[104:107]
  s_waitcnt lgkmcnt(2)
  v_rcp_f32 v244, v228
  v_mul_f32 v32, v238, v32
  v_mfma_f32_16x16x32_bf16 v[96:99], v[204:207], v[16:19], v[96:99]
  s_add_u32 m0, s68, 131072
  ds_read_b128 v[200:203], v241 offset:41984
  v_mul_f32 v33, v238, v33
  v_mfma_f32_16x16x32_bf16 v[104:107], v[204:207], v[20:23], v[104:107]
  buffer_load_dwordx4 v240, s[48:51], s73 offen lds
  v_cvt_pk_bf16_f32 v160, v32, v33
  v_mfma_f32_16x16x32_bf16 v[96:99], v[208:211], v[24:27], v[96:99]
  ds_read_b128 v[204:207], v242 offset:41984
  v_mul_f32 v34, v238, v34
  v_mfma_f32_16x16x32_bf16 v[104:107], v[208:211], v[28:31], v[104:107]
  s_waitcnt lgkmcnt(2)
  v_mul_f32 v35, v238, v35
  v_cvt_pk_bf16_f32 v161, v34, v35
  v_mul_f32 v36, v238, v36
  v_mfma_f32_16x16x32_bf16 v[100:103], v[212:215], v[0:3], 0
  ds_read_b128 v[208:211], v241 offset:34816
  v_mul_f32 v37, v238, v37
  v_mfma_f32_16x16x32_bf16 v[108:111], v[212:215], v[4:7], 0
  buffer_load_dwordx4 v240, s[52:55], s73 offen offset:1024 lds
  v_cvt_pk_bf16_f32 v162, v36, v37
  v_mfma_f32_16x16x32_bf16 v[100:103], v[216:219], v[8:11], v[100:103]
  ds_read_b128 v[212:215], v242 offset:34816
  v_max3_f32 v193, v96, v97, v98
  v_mfma_f32_16x16x32_bf16 v[108:111], v[216:219], v[12:15], v[108:111]
  s_waitcnt lgkmcnt(2)
  v_max3_f32 v197, v104, v105, v106
  v_mul_f32 v38, v238, v38
  v_mul_f32 v39, v238, v39
  v_mfma_f32_16x16x32_bf16 v[100:103], v[200:203], v[16:19], v[100:103]
  ds_read_b128 v[216:219], v241 offset:43008
  v_cvt_pk_bf16_f32 v163, v38, v39
  v_mfma_f32_16x16x32_bf16 v[108:111], v[200:203], v[20:23], v[108:111]
  buffer_load_dwordx4 v240, s[56:59], s73 offen offset:2048 lds
  v_mul_f32 v40, v244, v40
  v_mfma_f32_16x16x32_bf16 v[100:103], v[204:207], v[24:27], v[100:103]
  ds_read_b128 v[200:203], v242 offset:43008
  v_mul_f32 v41, v244, v41
  v_mfma_f32_16x16x32_bf16 v[108:111], v[204:207], v[28:31], v[108:111]
  s_waitcnt lgkmcnt(2)
  v_cvt_pk_bf16_f32 v164, v40, v41
  v_mul_f32 v42, v244, v42
  v_mul_f32 v43, v244, v43
  v_mfma_f32_16x16x32_bf16 v[112:115], v[208:211], v[0:3], 0
  ds_read_b128 v[204:207], v241 offset:35840
  v_cvt_pk_bf16_f32 v165, v42, v43
  v_mfma_f32_16x16x32_bf16 v[120:123], v[208:211], v[4:7], 0
  buffer_load_dwordx4 v240, s[60:63], s73 offen offset:3072 lds
  v_mul_f32 v44, v244, v44
  v_mfma_f32_16x16x32_bf16 v[112:115], v[212:215], v[8:11], v[112:115]
  ds_read_b128 v[208:211], v242 offset:35840
  v_max3_f32 v193, v193, v99, v100
  v_mfma_f32_16x16x32_bf16 v[120:123], v[212:215], v[12:15], v[120:123]
  s_waitcnt lgkmcnt(2)
  v_max3_f32 v193, v193, v101, v102
  v_max3_f32 v197, v197, v107, v108
  v_max3_f32 v197, v197, v109, v110
  v_mfma_f32_16x16x32_bf16 v[112:115], v[216:219], v[16:19], v[112:115]
  ds_read_b128 v[212:215], v241 offset:44032
  v_mul_f32 v45, v244, v45
  v_mfma_f32_16x16x32_bf16 v[120:123], v[216:219], v[20:23], v[120:123]
  v_cvt_pk_bf16_f32 v166, v44, v45
  v_mul_f32 v46, v244, v46
  v_mul_f32 v47, v244, v47
  v_mfma_f32_16x16x32_bf16 v[112:115], v[200:203], v[24:27], v[112:115]
  ds_read_b128 v[216:219], v242 offset:44032
  v_cvt_pk_bf16_f32 v167, v46, v47
  v_mfma_f32_16x16x32_bf16 v[120:123], v[200:203], v[28:31], v[120:123]
  s_waitcnt lgkmcnt(2)
  v_mul_f32 v48, v238, v48
  v_mul_f32 v49, v238, v49
  v_cvt_pk_bf16_f32 v168, v48, v49
  v_mfma_f32_16x16x32_bf16 v[116:119], v[204:207], v[0:3], 0
  s_waitcnt vmcnt(24)
  s_barrier
  ds_read_b64_tr_b16 v[200:201], v249 offset:49152
  v_mfma_f32_16x16x32_bf16 v[124:127], v[204:207], v[4:7], 0
  ds_read_b64_tr_b16 v[202:203], v249 offset:51200
  v_mul_f32 v50, v238, v50
  v_mfma_f32_16x16x32_bf16 v[116:119], v[208:211], v[8:11], v[116:119]
  ds_read_b64_tr_b16 v[204:205], v250 offset:49152
  v_max3_f32 v193, v193, v103, v112
  v_mfma_f32_16x16x32_bf16 v[124:127], v[208:211], v[12:15], v[124:127]
  s_waitcnt lgkmcnt(3)
  ds_read_b64_tr_b16 v[206:207], v250 offset:51200
  v_max3_f32 v193, v193, v113, v114
  v_max3_f32 v197, v197, v111, v120
  v_mfma_f32_16x16x32_bf16 v[116:119], v[212:215], v[16:19], v[116:119]
  ds_read_b64_tr_b16 v[208:209], v249 offset:49408
  v_max3_f32 v197, v197, v121, v122
  v_mfma_f32_16x16x32_bf16 v[124:127], v[212:215], v[20:23], v[124:127]
  ds_read_b64_tr_b16 v[210:211], v249 offset:51456
  v_mul_f32 v51, v238, v51
  v_cvt_pk_bf16_f32 v169, v50, v51
  v_mfma_f32_16x16x32_bf16 v[116:119], v[216:219], v[24:27], v[116:119]
  ds_read_b64_tr_b16 v[212:213], v250 offset:49408
  v_mul_f32 v52, v238, v52
  v_mfma_f32_16x16x32_bf16 v[124:127], v[216:219], v[28:31], v[124:127]
  s_waitcnt lgkmcnt(3)
  ds_read_b64_tr_b16 v[214:215], v250 offset:51456
  v_mul_f32 v53, v238, v53
  v_cvt_pk_bf16_f32 v170, v52, v53
  v_mfma_f32_16x16x32_bf16 a[192:195], v[200:203], v[128:131], a[192:195]
  ds_read_b64_tr_b16 v[216:217], v249 offset:53248
  v_mul_f32 v54, v238, v54
  v_mfma_f32_16x16x32_bf16 a[200:203], v[200:203], v[132:135], a[200:203]
  ds_read_b64_tr_b16 v[218:219], v249 offset:55296
  v_mul_f32 v55, v238, v55
  v_cvt_pk_bf16_f32 v171, v54, v55
  v_mfma_f32_16x16x32_bf16 a[196:199], v[204:207], v[128:131], a[196:199]
  ds_read_b64_tr_b16 v[200:201], v250 offset:53248
  v_max3_f32 v193, v193, v115, v116
  v_mfma_f32_16x16x32_bf16 a[204:207], v[204:207], v[132:135], a[204:207]
  s_waitcnt lgkmcnt(3)
  ds_read_b64_tr_b16 v[202:203], v250 offset:55296
  v_max3_f32 v193, v193, v117, v118
  v_max_f32 v193, v193, v119
  v_mfma_f32_16x16x32_bf16 a[208:211], v[208:211], v[128:131], a[208:211]
  ds_read_b64_tr_b16 v[204:205], v249 offset:53504
  v_mov_b32 v194, v193
  v_mfma_f32_16x16x32_bf16 a[216:219], v[208:211], v[132:135], a[216:219]
  ds_read_b64_tr_b16 v[206:207], v249 offset:55552
  v_max3_f32 v197, v197, v123, v124
  v_max3_f32 v197, v197, v125, v126
  v_mfma_f32_16x16x32_bf16 a[212:215], v[212:215], v[128:131], a[212:215]
  ds_read_b64_tr_b16 v[208:209], v250 offset:53504
  v_max_f32 v197, v197, v127
  v_mfma_f32_16x16x32_bf16 a[220:223], v[212:215], v[132:135], a[220:223]
  s_waitcnt lgkmcnt(3)
  ds_read_b64_tr_b16 v[210:211], v250 offset:55552
  v_mov_b32 v198, v197
  v_permlane32_swap_b32 v194, v193
  v_mfma_f32_16x16x32_bf16 a[192:195], v[216:219], v[136:139], a[192:195]
  ds_read_b64_tr_b16 v[212:213], v249 offset:57344
  v_max_f32 v193, v193, v194
  v_mfma_f32_16x16x32_bf16 a[200:203], v[216:219], v[140:143], a[200:203]
  ds_read_b64_tr_b16 v[214:215], v249 offset:59392
  v_mov_b32 v194, v193
  v_permlane32_swap_b32 v198, v197
  v_mfma_f32_16x16x32_bf16 a[196:199], v[200:203], v[136:139], a[196:199]
  ds_read_b64_tr_b16 v[216:217], v250 offset:57344
  v_max_f32 v197, v197, v198
  v_mfma_f32_16x16x32_bf16 a[204:207], v[200:203], v[140:143], a[204:207]
  s_waitcnt lgkmcnt(3)
  ds_read_b64_tr_b16 v[218:219], v250 offset:59392
  v_mov_b32 v198, v197
  v_permlane16_swap_b32 v194, v193
  v_mfma_f32_16x16x32_bf16 a[208:211], v[204:207], v[136:139], a[208:211]
  ds_read_b64_tr_b16 v[200:201], v249 offset:57600
  v_max_f32 v193, v193, v194
  v_mfma_f32_16x16x32_bf16 a[216:219], v[204:207], v[140:143], a[216:219]
  ds_read_b64_tr_b16 v[202:203], v249 offset:59648
  v_sub_f32 v192, 0, v193
  v_permlane16_swap_b32 v198, v197
  v_mfma_f32_16x16x32_bf16 a[212:215], v[208:211], v[136:139], a[212:215]
  ds_read_b64_tr_b16 v[204:205], v250 offset:57600
  v_max_f32 v197, v197, v198
  v_mfma_f32_16x16x32_bf16 a[220:223], v[208:211], v[140:143], a[220:223]
  s_waitcnt lgkmcnt(3)
  ds_read_b64_tr_b16 v[206:207], v250 offset:59648
  v_sub_f32 v196, 0, v197
  v_add_f32 v96, v96, v192
  v_mfma_f32_16x16x32_bf16 a[192:195], v[212:215], v[144:147], a[192:195]
  ds_read_b64_tr_b16 v[208:209], v249 offset:61440
  v_exp_f32 v96, v96
  v_mfma_f32_16x16x32_bf16 a[200:203], v[212:215], v[148:151], a[200:203]
  ds_read_b64_tr_b16 v[210:211], v249 offset:63488
  v_add_f32 v97, v97, v192
  v_mul_f32 v56, v244, v56
  v_mfma_f32_16x16x32_bf16 a[196:199], v[216:219], v[144:147], a[196:199]
  ds_read_b64_tr_b16 v[212:213], v250 offset:61440
  v_exp_f32 v97, v97
  v_mfma_f32_16x16x32_bf16 a[204:207], v[216:219], v[148:151], a[204:207]
  s_waitcnt lgkmcnt(3)
  ds_read_b64_tr_b16 v[214:215], v250 offset:63488
  v_cvt_pk_bf16_f32 v96, v96, v97
  v_add_f32 v98, v98, v192
  v_mfma_f32_16x16x32_bf16 a[208:211], v[200:203], v[144:147], a[208:211]
  ds_read_b64_tr_b16 v[216:217], v249 offset:61696
  v_exp_f32 v98, v98
  v_mfma_f32_16x16x32_bf16 a[216:219], v[200:203], v[148:151], a[216:219]
  ds_read_b64_tr_b16 v[218:219], v249 offset:63744
  v_add_f32 v99, v99, v192
  v_mul_f32 v57, v244, v57
  v_mfma_f32_16x16x32_bf16 a[212:215], v[204:207], v[144:147], a[212:215]
  ds_read_b64_tr_b16 v[200:201], v250 offset:61696
  v_exp_f32 v99, v99
  v_mfma_f32_16x16x32_bf16 a[220:223], v[204:207], v[148:151], a[220:223]
  s_waitcnt lgkmcnt(3)
  ds_read_b64_tr_b16 v[202:203], v250 offset:63744
  v_cvt_pk_bf16_f32 v97, v98, v99
  v_add_f32 v100, v100, v192
  v_mfma_f32_16x16x32_bf16 a[192:195], v[208:211], v[152:155], a[192:195]
  s_waitcnt vmcnt(8)
  s_barrier
  s_add_u32 m0, s68, 98304
  ds_read_b64_tr_b16 v[204:205], v245 offset:0
  ds_read_b64_tr_b16 v[206:207], v245 offset:1024
  v_mfma_f32_16x16x32_bf16 a[200:203], v[208:211], v[156:159], a[200:203]
  buffer_load_dwordx4 v237, s[12:15], s89 offen nt lds
  v_cvt_pk_bf16_f32 v172, v56, v57
  v_mfma_f32_16x16x32_bf16 a[196:199], v[212:215], v[152:155], a[196:199]
  ds_read_b64_tr_b16 v[208:209], v246 offset:0
  v_exp_f32 v100, v100
  v_mfma_f32_16x16x32_bf16 a[204:207], v[212:215], v[156:159], a[204:207]
  s_waitcnt lgkmcnt(3)
  ds_read_b64_tr_b16 v[210:211], v246 offset:1024
  v_add_f32 v101, v101, v192
  v_mul_f32 v58, v244, v58
  v_mfma_f32_16x16x32_bf16 a[208:211], v[216:219], v[152:155], a[208:211]
  ds_read_b64_tr_b16 v[212:213], v245 offset:256
  ds_read_b64_tr_b16 v[214:215], v245 offset:1280
  v_mfma_f32_16x16x32_bf16 a[216:219], v[216:219], v[156:159], a[216:219]
  buffer_load_dwordx4 v237, s[12:15], s89 offen offset:1024 nt lds
  v_exp_f32 v101, v101
  v_add_f32 v102, v102, v192
  v_cvt_pk_bf16_f32 v98, v100, v101
  v_exp_f32 v102, v102
  v_add_f32 v103, v103, v192
  v_exp_f32 v103, v103
  v_add_f32 v104, v104, v196
  v_cvt_pk_bf16_f32 v99, v102, v103
  v_exp_f32 v104, v104
  v_add_f32 v105, v105, v196
  v_exp_f32 v105, v105
  v_add_f32 v106, v106, v196
  v_cvt_pk_bf16_f32 v100, v104, v105
  v_exp_f32 v106, v106
  v_add_f32 v107, v107, v196
  v_exp_f32 v107, v107
  v_add_f32 v108, v108, v196
  v_cvt_pk_bf16_f32 v101, v106, v107
  v_exp_f32 v108, v108
  v_add_f32 v109, v109, v196
  v_exp_f32 v109, v109
  v_add_f32 v110, v110, v196
  v_cvt_pk_bf16_f32 v102, v108, v109
  v_exp_f32 v110, v110
  v_add_f32 v111, v111, v196
  v_exp_f32 v111, v111
  v_mul_f32 v59, v244, v59
  v_cvt_pk_bf16_f32 v103, v110, v111
  v_mfma_f32_16x16x32_bf16 a[212:215], v[200:203], v[152:155], a[212:215]
  ds_read_b64_tr_b16 v[216:217], v246 offset:256
  v_cvt_pk_bf16_f32 v173, v58, v59
  v_mfma_f32_16x16x32_bf16 a[220:223], v[200:203], v[156:159], a[220:223]
  s_waitcnt lgkmcnt(3)
  ds_read_b64_tr_b16 v[218:219], v246 offset:1280
  v_mul_f32 v60, v244, v60
  v_mul_f32 v61, v244, v61
  v_mfma_f32_16x16x32_bf16 v[224:227], v[220:223], v[96:99], 0
  v_cvt_pk_bf16_f32 v174, v60, v61
  v_mul_f32 v62, v244, v62
  v_mfma_f32_16x16x32_bf16 v[32:35], v[204:207], v[96:99], 0
  ds_read_b64_tr_b16 v[200:201], v245 offset:512
  ds_read_b64_tr_b16 v[202:203], v245 offset:1536
  v_mfma_f32_16x16x32_bf16 v[40:43], v[204:207], v[100:103], 0
  buffer_load_dwordx4 v237, s[12:15], s89 offen offset:2048 nt lds
  v_mul_f32 v63, v244, v63
  v_cvt_pk_bf16_f32 v175, v62, v63
  v_mfma_f32_16x16x32_bf16 v[228:231], v[220:223], v[100:103], 0
  v_mul_f32 v64, v238, v64
  v_mul_f32 v65, v238, v65
  v_mfma_f32_16x16x32_bf16 v[36:39], v[208:211], v[96:99], 0
  ds_read_b64_tr_b16 v[204:205], v246 offset:512
  v_cvt_pk_bf16_f32 v176, v64, v65
  v_mfma_f32_16x16x32_bf16 v[44:47], v[208:211], v[100:103], 0
  s_waitcnt lgkmcnt(3)
  ds_read_b64_tr_b16 v[206:207], v246 offset:1536
  v_mul_f32 v66, v238, v66
  v_mul_f32 v67, v238, v67
  v_mfma_f32_16x16x32_bf16 v[48:51], v[212:215], v[96:99], 0
  ds_read_b64_tr_b16 v[208:209], v245 offset:768
  ds_read_b64_tr_b16 v[210:211], v245 offset:1792
  v_mfma_f32_16x16x32_bf16 v[56:59], v[212:215], v[100:103], 0
  buffer_load_dwordx4 v237, s[12:15], s89 offen offset:3072 nt lds
  v_cvt_pk_bf16_f32 v177, v66, v67
  v_mul_f32 v68, v238, v68
  v_mul_f32 v69, v238, v69
  v_cvt_pk_bf16_f32 v178, v68, v69
  v_mul_f32 v70, v238, v70
  v_mul_f32 v71, v238, v71
  v_cvt_pk_bf16_f32 v179, v70, v71
  v_mul_f32 v72, v244, v72
  v_mul_f32 v73, v244, v73
  v_cvt_pk_bf16_f32 v180, v72, v73
  v_mul_f32 v74, v244, v74
  v_mul_f32 v75, v244, v75
  v_cvt_pk_bf16_f32 v181, v74, v75
  v_mul_f32 v76, v244, v76
  v_mul_f32 v77, v244, v77
  v_cvt_pk_bf16_f32 v182, v76, v77
  v_mul_f32 v78, v244, v78
  v_mul_f32 v79, v244, v79
  v_cvt_pk_bf16_f32 v183, v78, v79
  v_mfma_f32_16x16x32_bf16 v[52:55], v[216:219], v[96:99], 0
  ds_read_b64_tr_b16 v[212:213], v246 offset:768
  v_mul_f32 v80, v238, v80
  v_mfma_f32_16x16x32_bf16 v[60:63], v[216:219], v[100:103], 0
  s_waitcnt lgkmcnt(3)
  ds_read_b64_tr_b16 v[214:215], v246 offset:1792
  v_mul_f32 v81, v238, v81
  v_cvt_pk_bf16_f32 v184, v80, v81
  v_mfma_f32_16x16x32_bf16 v[64:67], v[200:203], v[96:99], 0
  s_add_u32 m0, s68, 0
  ds_read_b64_tr_b16 v[216:217], v245 offset:2048
  ds_read_b64_tr_b16 v[218:219], v245 offset:3072
  v_mfma_f32_16x16x32_bf16 v[72:75], v[200:203], v[100:103], 0
  buffer_load_dwordx4 v236, s[8:11], s90 offen nt lds
  v_mul_f32 v82, v238, v82
  v_mul_f32 v83, v238, v83
  v_cvt_pk_bf16_f32 v185, v82, v83
  v_mul_f32 v84, v238, v84
  v_mul_f32 v85, v238, v85
  v_cvt_pk_bf16_f32 v186, v84, v85
  v_mul_f32 v86, v238, v86
  v_mul_f32 v87, v238, v87
  v_cvt_pk_bf16_f32 v187, v86, v87
  v_mul_f32 v88, v244, v88
  v_mul_f32 v89, v244, v89
  v_cvt_pk_bf16_f32 v188, v88, v89
  v_mul_f32 v90, v244, v90
  v_mul_f32 v91, v244, v91
  v_cvt_pk_bf16_f32 v189, v90, v91
  v_mul_f32 v92, v244, v92
  v_mul_f32 v93, v244, v93
  v_cvt_pk_bf16_f32 v190, v92, v93
  v_mul_f32 v94, v244, v94
  v_mul_f32 v95, v244, v95
  v_cvt_pk_bf16_f32 v191, v94, v95
  v_mfma_f32_16x16x32_bf16 v[68:71], v[204:207], v[96:99], 0
  ds_read_b64_tr_b16 v[200:201], v246 offset:2048
  v_add_f32 v112, v112, v192
  v_mfma_f32_16x16x32_bf16 v[76:79], v[204:207], v[100:103], 0
  s_waitcnt lgkmcnt(3)
  ds_read_b64_tr_b16 v[202:203], v246 offset:3072
  v_exp_f32 v112, v112
  v_mfma_f32_16x16x32_bf16 v[80:83], v[208:211], v[96:99], 0
  ds_read_b64_tr_b16 v[204:205], v245 offset:2304
  ds_read_b64_tr_b16 v[206:207], v245 offset:3328
  v_mfma_f32_16x16x32_bf16 v[88:91], v[208:211], v[100:103], 0
  buffer_load_dwordx4 v236, s[8:11], s90 offen offset:1024 nt lds
  v_add_f32 v113, v113, v192
  v_exp_f32 v113, v113
  v_add_f32 v114, v114, v192
  v_cvt_pk_bf16_f32 v104, v112, v113
  v_exp_f32 v114, v114
  v_add_f32 v115, v115, v192
  v_exp_f32 v115, v115
  v_add_f32 v116, v116, v192
  v_cvt_pk_bf16_f32 v105, v114, v115
  v_exp_f32 v116, v116
  v_add_f32 v117, v117, v192
  v_exp_f32 v117, v117
  v_add_f32 v118, v118, v192
  v_cvt_pk_bf16_f32 v106, v116, v117
  v_exp_f32 v118, v118
  v_add_f32 v119, v119, v192
  v_exp_f32 v119, v119
  v_add_f32 v120, v120, v196
  v_cvt_pk_bf16_f32 v107, v118, v119
  v_exp_f32 v120, v120
  v_add_f32 v121, v121, v196
  v_exp_f32 v121, v121
  v_add_f32 v122, v122, v196
  v_cvt_pk_bf16_f32 v108, v120, v121
  v_exp_f32 v122, v122
  v_add_f32 v123, v123, v196
  v_exp_f32 v123, v123
  v_add_f32 v124, v124, v196
  v_cvt_pk_bf16_f32 v109, v122, v123
  v_exp_f32 v124, v124
  v_add_f32 v125, v125, v196
  v_exp_f32 v125, v125
  v_add_f32 v126, v126, v196
  v_cvt_pk_bf16_f32 v110, v124, v125
  v_exp_f32 v126, v126
  v_add_f32 v127, v127, v196
  v_exp_f32 v127, v127
  v_mov_b32 v193, v192
  v_cvt_pk_bf16_f32 v111, v126, v127
  v_mfma_f32_16x16x32_bf16 v[84:87], v[212:215], v[96:99], 0
  ds_read_b64_tr_b16 v[208:209], v246 offset:2304
  v_mov_b32 v194, v192
  v_mfma_f32_16x16x32_bf16 v[92:95], v[212:215], v[100:103], 0
  s_waitcnt lgkmcnt(3)
  ds_read_b64_tr_b16 v[210:211], v246 offset:3328
  v_mov_b32 v195, v192
  v_mfma_f32_16x16x32_bf16 v[224:227], v[220:223], v[104:107], v[224:227]
  v_mov_b32 v197, v196
  v_mov_b32 v198, v196
  v_mfma_f32_16x16x32_bf16 v[32:35], v[216:219], v[104:107], v[32:35]
  ds_read_b64_tr_b16 v[212:213], v245 offset:2560
  ds_read_b64_tr_b16 v[214:215], v245 offset:3584
  v_mfma_f32_16x16x32_bf16 v[40:43], v[216:219], v[108:111], v[40:43]
  buffer_load_dwordx4 v236, s[8:11], s90 offen offset:2048 nt lds
  v_mfma_f32_16x16x32_bf16 v[228:231], v[220:223], v[108:111], v[228:231]
  v_mov_b32 v199, v196
  v_mfma_f32_16x16x32_bf16 v[36:39], v[200:203], v[104:107], v[36:39]
  ds_read_b64_tr_b16 v[216:217], v246 offset:2560
  v_mfma_f32_16x16x32_bf16 v[44:47], v[200:203], v[108:111], v[44:47]
  s_waitcnt lgkmcnt(3)
  ds_read_b64_tr_b16 v[218:219], v246 offset:3584
  v_mfma_f32_16x16x32_bf16 v[48:51], v[204:207], v[104:107], v[48:51]
  ds_read_b64_tr_b16 v[200:201], v245 offset:2816
  ds_read_b64_tr_b16 v[202:203], v245 offset:3840
  v_mfma_f32_16x16x32_bf16 v[56:59], v[204:207], v[108:111], v[56:59]
  buffer_load_dwordx4 v236, s[8:11], s90 offen offset:3072 nt lds
  v_mfma_f32_16x16x32_bf16 v[52:55], v[208:211], v[104:107], v[52:55]
  ds_read_b64_tr_b16 v[204:205], v246 offset:2816
  v_mfma_f32_16x16x32_bf16 v[60:63], v[208:211], v[108:111], v[60:63]
  s_waitcnt lgkmcnt(3)
  ds_read_b64_tr_b16 v[206:207], v246 offset:3840
  v_mfma_f32_16x16x32_bf16 v[64:67], v[212:215], v[104:107], v[64:67]
  s_waitcnt vmcnt(12)
  s_barrier
  s_add_u32 m0, s68, 147456
  ds_read_b128 v[208:211], v241 offset:49152
  v_mfma_f32_16x16x32_bf16 v[72:75], v[212:215], v[108:111], v[72:75]
  buffer_load_dwordx4 v240, s[48:51], s74 offen lds
  v_mfma_f32_16x16x32_bf16 v[68:71], v[216:219], v[104:107], v[68:71]
  ds_read_b128 v[212:215], v242 offset:49152
  v_mfma_f32_16x16x32_bf16 v[76:79], v[216:219], v[108:111], v[76:79]
  s_waitcnt lgkmcnt(2)
  v_mfma_f32_16x16x32_bf16 v[80:83], v[200:203], v[104:107], v[80:83]
  ds_read_b128 v[216:219], v241 offset:57344
  v_mfma_f32_16x16x32_bf16 v[88:91], v[200:203], v[108:111], v[88:91]
  buffer_load_dwordx4 v240, s[52:55], s74 offen offset:1024 lds
  v_mfma_f32_16x16x32_bf16 v[84:87], v[204:207], v[104:107], v[84:87]
  ds_read_b128 v[200:203], v242 offset:57344
  v_mfma_f32_16x16x32_bf16 v[92:95], v[204:207], v[108:111], v[92:95]
  s_waitcnt lgkmcnt(2)
  v_mfma_f32_16x16x32_bf16 v[96:99], v[208:211], v[0:3], v[192:195]
  ds_read_b128 v[204:207], v241 offset:50176
  v_mfma_f32_16x16x32_bf16 v[104:107], v[208:211], v[4:7], v[196:199]
  v_mfma_f32_16x16x32_bf16 v[96:99], v[212:215], v[8:11], v[96:99]
  ds_read_b128 v[208:211], v242 offset:50176
  v_mfma_f32_16x16x32_bf16 v[104:107], v[212:215], v[12:15], v[104:107]
  s_waitcnt lgkmcnt(2)
  v_mfma_f32_16x16x32_bf16 v[96:99], v[216:219], v[16:19], v[96:99]
  ds_read_b128 v[212:215], v241 offset:58368
  v_mfma_f32_16x16x32_bf16 v[104:107], v[216:219], v[20:23], v[104:107]
  v_mfma_f32_16x16x32_bf16 v[96:99], v[200:203], v[24:27], v[96:99]
  ds_read_b128 v[216:219], v242 offset:58368
  v_mfma_f32_16x16x32_bf16 v[104:107], v[200:203], v[28:31], v[104:107]
  s_waitcnt lgkmcnt(2)
  v_mfma_f32_16x16x32_bf16 v[100:103], v[204:207], v[0:3], v[192:195]
  ds_read_b128 v[200:203], v241 offset:51200
  v_mfma_f32_16x16x32_bf16 v[108:111], v[204:207], v[4:7], v[196:199]
  buffer_load_dwordx4 v240, s[56:59], s74 offen offset:2048 lds
  v_mfma_f32_16x16x32_bf16 v[100:103], v[208:211], v[8:11], v[100:103]
  ds_read_b128 v[204:207], v242 offset:51200
  v_max3_f32 v253, v96, v97, v98
  v_mfma_f32_16x16x32_bf16 v[108:111], v[208:211], v[12:15], v[108:111]
  s_waitcnt lgkmcnt(2)
  v_max3_f32 v253, v253, v99, v104
  v_max3_f32 v253, v253, v105, v106
  v_mfma_f32_16x16x32_bf16 v[100:103], v[212:215], v[16:19], v[100:103]
  ds_read_b128 v[208:211], v241 offset:59392
  v_mfma_f32_16x16x32_bf16 v[108:111], v[212:215], v[20:23], v[108:111]
  buffer_load_dwordx4 v240, s[60:63], s74 offen offset:3072 lds
  v_mfma_f32_16x16x32_bf16 v[100:103], v[216:219], v[24:27], v[100:103]
  ds_read_b128 v[212:215], v242 offset:59392
  v_mfma_f32_16x16x32_bf16 v[108:111], v[216:219], v[28:31], v[108:111]
  s_waitcnt lgkmcnt(2)
  v_mfma_f32_16x16x32_bf16 v[112:115], v[200:203], v[0:3], v[192:195]
  ds_read_b128 v[216:219], v241 offset:52224
  v_mfma_f32_16x16x32_bf16 v[120:123], v[200:203], v[4:7], v[196:199]
  v_mfma_f32_16x16x32_bf16 v[112:115], v[204:207], v[8:11], v[112:115]
  ds_read_b128 v[200:203], v242 offset:52224
  v_max3_f32 v253, v253, v107, v100
  v_mfma_f32_16x16x32_bf16 v[120:123], v[204:207], v[12:15], v[120:123]
  s_waitcnt lgkmcnt(2)
  v_max3_f32 v253, v253, v101, v102
  v_max3_f32 v253, v253, v103, v108
  v_mfma_f32_16x16x32_bf16 v[112:115], v[208:211], v[16:19], v[112:115]
  s_add_u32 m0, s68, 81920
  ds_read_b128 v[204:207], v241 offset:60416
  v_max3_f32 v253, v253, v109, v110
  v_mfma_f32_16x16x32_bf16 v[120:123], v[208:211], v[20:23], v[120:123]
  buffer_load_dwordx4 v237, s[12:15], s90 offen nt lds
  v_mfma_f32_16x16x32_bf16 v[112:115], v[212:215], v[24:27], v[112:115]
  ds_read_b128 v[208:211], v242 offset:60416
  v_mfma_f32_16x16x32_bf16 v[120:123], v[212:215], v[28:31], v[120:123]
  s_waitcnt lgkmcnt(2)
  v_mfma_f32_16x16x32_bf16 v[116:119], v[216:219], v[0:3], v[192:195]
  s_waitcnt vmcnt(25)
  s_barrier
  ds_read_b64_tr_b16 v[212:213], v249 offset:16384
  v_mfma_f32_16x16x32_bf16 v[124:127], v[216:219], v[4:7], v[196:199]
  ds_read_b64_tr_b16 v[214:215], v249 offset:18432
  v_mfma_f32_16x16x32_bf16 v[116:119], v[200:203], v[8:11], v[116:119]
  ds_read_b64_tr_b16 v[216:217], v250 offset:16384
  ds_read_b64_tr_b16 v[218:219], v250 offset:18432
  v_mfma_f32_16x16x32_bf16 v[124:127], v[200:203], v[12:15], v[124:127]
  s_waitcnt lgkmcnt(4)
  buffer_load_dwordx4 v237, s[12:15], s90 offen offset:1024 nt lds
  v_mfma_f32_16x16x32_bf16 v[116:119], v[204:207], v[16:19], v[116:119]
  ds_read_b64_tr_b16 v[200:201], v249 offset:16640
  v_max3_f32 v253, v253, v111, v112
  v_mfma_f32_16x16x32_bf16 v[124:127], v[204:207], v[20:23], v[124:127]
  ds_read_b64_tr_b16 v[202:203], v249 offset:18688
  v_max3_f32 v253, v253, v113, v114
  v_mfma_f32_16x16x32_bf16 v[116:119], v[208:211], v[24:27], v[116:119]
  ds_read_b64_tr_b16 v[204:205], v250 offset:16640
  v_max3_f32 v253, v253, v115, v120
  v_mfma_f32_16x16x32_bf16 v[124:127], v[208:211], v[28:31], v[124:127]
  s_waitcnt lgkmcnt(3)
  ds_read_b64_tr_b16 v[206:207], v250 offset:18688
  v_max3_f32 v253, v253, v121, v122
  v_mfma_f32_16x16x32_bf16 a[0:3], v[212:215], v[160:163], a[0:3]
  ds_read_b64_tr_b16 v[208:209], v249 offset:20480
  ds_read_b64_tr_b16 v[210:211], v249 offset:22528
  v_mfma_f32_16x16x32_bf16 a[8:11], v[212:215], v[164:167], a[8:11]
  buffer_load_dwordx4 v237, s[12:15], s90 offen offset:2048 nt lds
  v_mfma_f32_16x16x32_bf16 a[4:7], v[216:219], v[160:163], a[4:7]
  ds_read_b64_tr_b16 v[212:213], v250 offset:20480
  v_max3_f32 v253, v253, v123, v116
  v_mfma_f32_16x16x32_bf16 a[12:15], v[216:219], v[164:167], a[12:15]
  s_waitcnt lgkmcnt(3)
  ds_read_b64_tr_b16 v[214:215], v250 offset:22528
  v_max3_f32 v253, v253, v117, v118
  v_max3_f32 v253, v253, v119, v124
  v_mfma_f32_16x16x32_bf16 a[16:19], v[200:203], v[160:163], a[16:19]
  ds_read_b64_tr_b16 v[216:217], v249 offset:20736
  v_max3_f32 v253, v253, v125, v126
  v_mfma_f32_16x16x32_bf16 a[24:27], v[200:203], v[164:167], a[24:27]
  ds_read_b64_tr_b16 v[218:219], v249 offset:22784
  v_max_f32 v253, v253, v127
  v_cmp_lt_f32 vcc, 0x41200000, v253
  v_mfma_f32_16x16x32_bf16 a[20:23], v[204:207], v[160:163], a[20:23]
  s_cbranch_vccnz L_r3_1t
L_r3_1:
  ds_read_b64_tr_b16 v[200:201], v250 offset:20736
  ds_read_b64_tr_b16 v[202:203], v250 offset:22784
  v_mfma_f32_16x16x32_bf16 a[28:31], v[204:207], v[164:167], a[28:31]
  s_waitcnt lgkmcnt(4)
  v_exp_f32 v96, v96
  v_mfma_f32_16x16x32_bf16 a[0:3], v[208:211], v[168:171], a[0:3]
  ds_read_b64_tr_b16 v[204:205], v249 offset:24576
  ds_read_b64_tr_b16 v[206:207], v249 offset:26624
  v_mfma_f32_16x16x32_bf16 a[8:11], v[208:211], v[172:175], a[8:11]
  v_exp_f32 v97, v97
  v_mfma_f32_16x16x32_bf16 a[4:7], v[212:215], v[168:171], a[4:7]
  ds_read_b64_tr_b16 v[208:209], v250 offset:24576
  ds_read_b64_tr_b16 v[210:211], v250 offset:26624
  v_mfma_f32_16x16x32_bf16 a[12:15], v[212:215], v[172:175], a[12:15]
  s_waitcnt lgkmcnt(4)
  buffer_load_dwordx4 v237, s[12:15], s90 offen offset:3072 nt lds
  v_cvt_pk_bf16_f32 v96, v96, v97
  v_mfma_f32_16x16x32_bf16 a[16:19], v[216:219], v[168:171], a[16:19]
  ds_read_b64_tr_b16 v[212:213], v249 offset:24832
  ds_read_b64_tr_b16 v[214:215], v249 offset:26880
  v_mfma_f32_16x16x32_bf16 a[24:27], v[216:219], v[172:175], a[24:27]
  v_exp_f32 v98, v98
  v_mfma_f32_16x16x32_bf16 a[20:23], v[200:203], v[168:171], a[20:23]
  ds_read_b64_tr_b16 v[216:217], v250 offset:24832
  ds_read_b64_tr_b16 v[218:219], v250 offset:26880
  v_mfma_f32_16x16x32_bf16 a[28:31], v[200:203], v[172:175], a[28:31]
  s_waitcnt lgkmcnt(4)
  v_exp_f32 v99, v99
  v_mfma_f32_16x16x32_bf16 a[0:3], v[204:207], v[176:179], a[0:3]
  ds_read_b64_tr_b16 v[200:201], v249 offset:28672
  v_cvt_pk_bf16_f32 v97, v98, v99
  v_mfma_f32_16x16x32_bf16 a[8:11], v[204:207], v[180:183], a[8:11]
  ds_read_b64_tr_b16 v[202:203], v249 offset:30720
  v_exp_f32 v100, v100
  v_mfma_f32_16x16x32_bf16 a[4:7], v[208:211], v[176:179], a[4:7]
  ds_read_b64_tr_b16 v[204:205], v250 offset:28672
  ds_read_b64_tr_b16 v[206:207], v250 offset:30720
  v_mfma_f32_16x16x32_bf16 a[12:15], v[208:211], v[180:183], a[12:15]
  s_waitcnt lgkmcnt(4)
  v_exp_f32 v101, v101
  v_mfma_f32_16x16x32_bf16 a[16:19], v[212:215], v[176:179], a[16:19]
  ds_read_b64_tr_b16 v[208:209], v249 offset:28928
  v_cvt_pk_bf16_f32 v98, v100, v101
  v_mfma_f32_16x16x32_bf16 a[24:27], v[212:215], v[180:183], a[24:27]
  ds_read_b64_tr_b16 v[210:211], v249 offset:30976
  v_exp_f32 v102, v102
  v_mfma_f32_16x16x32_bf16 a[20:23], v[216:219], v[176:179], a[20:23]
  ds_read_b64_tr_b16 v[212:213], v250 offset:28928
  ds_read_b64_tr_b16 v[214:215], v250 offset:30976
  v_mfma_f32_16x16x32_bf16 a[28:31], v[216:219], v[180:183], a[28:31]
  s_waitcnt lgkmcnt(4)
  v_exp_f32 v103, v103
  v_mfma_f32_16x16x32_bf16 a[0:3], v[200:203], v[184:187], a[0:3]
  s_waitcnt vmcnt(12)
  s_barrier
  ds_read_b64_tr_b16 v[216:217], v245 offset:32768
  v_mfma_f32_16x16x32_bf16 a[8:11], v[200:203], v[188:191], a[8:11]
  ds_read_b64_tr_b16 v[218:219], v245 offset:33792
  v_cvt_pk_bf16_f32 v99, v102, v103
  v_mfma_f32_16x16x32_bf16 a[4:7], v[204:207], v[184:187], a[4:7]
  s_add_u32 m0, s68, 16384
  ds_read_b64_tr_b16 v[200:201], v246 offset:32768
  ds_read_b64_tr_b16 v[202:203], v246 offset:33792
  v_mfma_f32_16x16x32_bf16 a[12:15], v[204:207], v[188:191], a[12:15]
  s_waitcnt lgkmcnt(4)
  buffer_load_dwordx4 v236, s[8:11], s91 offen nt lds
  v_mfma_f32_16x16x32_bf16 v[224:227], v[220:223], v[96:99], v[224:227]
  v_exp_f32 v104, v104
  v_mfma_f32_16x16x32_bf16 a[16:19], v[208:211], v[184:187], a[16:19]
  ds_read_b64_tr_b16 v[204:205], v245 offset:33024
  ds_read_b64_tr_b16 v[206:207], v245 offset:34048
  v_mfma_f32_16x16x32_bf16 a[24:27], v[208:211], v[188:191], a[24:27]
  v_exp_f32 v105, v105
  v_exp_f32 v106, v106
  v_cvt_pk_bf16_f32 v100, v104, v105
  v_exp_f32 v107, v107
  v_exp_f32 v108, v108
  v_cvt_pk_bf16_f32 v101, v106, v107
  v_exp_f32 v109, v109
  v_exp_f32 v110, v110
  v_cvt_pk_bf16_f32 v102, v108, v109
  v_exp_f32 v111, v111
  v_exp_f32 v112, v112
  v_cvt_pk_bf16_f32 v103, v110, v111
  v_mfma_f32_16x16x32_bf16 a[20:23], v[212:215], v[184:187], a[20:23]
  ds_read_b64_tr_b16 v[208:209], v246 offset:33024
  ds_read_b64_tr_b16 v[210:211], v246 offset:34048
  v_mfma_f32_16x16x32_bf16 a[28:31], v[212:215], v[188:191], a[28:31]
  s_waitcnt lgkmcnt(4)
  v_exp_f32 v113, v113
  v_mfma_f32_16x16x32_bf16 v[228:231], v[220:223], v[100:103], v[228:231]
  v_cvt_pk_bf16_f32 v104, v112, v113
  v_mfma_f32_16x16x32_bf16 v[32:35], v[216:219], v[96:99], v[32:35]
  ds_read_b64_tr_b16 v[212:213], v245 offset:33280
  ds_read_b64_tr_b16 v[214:215], v245 offset:34304
  v_mfma_f32_16x16x32_bf16 v[40:43], v[216:219], v[100:103], v[40:43]
  v_exp_f32 v114, v114
  v_mfma_f32_16x16x32_bf16 v[36:39], v[200:203], v[96:99], v[36:39]
  ds_read_b64_tr_b16 v[216:217], v246 offset:33280
  ds_read_b64_tr_b16 v[218:219], v246 offset:34304
  v_mfma_f32_16x16x32_bf16 v[44:47], v[200:203], v[100:103], v[44:47]
  s_waitcnt lgkmcnt(4)
  v_exp_f32 v115, v115
  v_mfma_f32_16x16x32_bf16 v[48:51], v[204:207], v[96:99], v[48:51]
  ds_read_b64_tr_b16 v[200:201], v245 offset:33536
  v_cvt_pk_bf16_f32 v105, v114, v115
  v_mfma_f32_16x16x32_bf16 v[56:59], v[204:207], v[100:103], v[56:59]
  ds_read_b64_tr_b16 v[202:203], v245 offset:34560
  v_exp_f32 v116, v116
  v_mfma_f32_16x16x32_bf16 v[52:55], v[208:211], v[96:99], v[52:55]
  ds_read_b64_tr_b16 v[204:205], v246 offset:33536
  ds_read_b64_tr_b16 v[206:207], v246 offset:34560
  v_mfma_f32_16x16x32_bf16 v[60:63], v[208:211], v[100:103], v[60:63]
  s_waitcnt lgkmcnt(4)
  v_exp_f32 v117, v117
  v_mfma_f32_16x16x32_bf16 v[64:67], v[212:215], v[96:99], v[64:67]
  ds_read_b64_tr_b16 v[208:209], v245 offset:34816
  v_cvt_pk_bf16_f32 v106, v116, v117
  v_mfma_f32_16x16x32_bf16 v[72:75], v[212:215], v[100:103], v[72:75]
  ds_read_b64_tr_b16 v[210:211], v245 offset:35840
  v_exp_f32 v118, v118
  v_mfma_f32_16x16x32_bf16 v[68:71], v[216:219], v[96:99], v[68:71]
  ds_read_b64_tr_b16 v[212:213], v246 offset:34816
  ds_read_b64_tr_b16 v[214:215], v246 offset:35840
  v_mfma_f32_16x16x32_bf16 v[76:79], v[216:219], v[100:103], v[76:79]
  s_waitcnt lgkmcnt(4)
  buffer_load_dwordx4 v236, s[8:11], s91 offen offset:1024 nt lds
  v_mfma_f32_16x16x32_bf16 v[80:83], v[200:203], v[96:99], v[80:83]
  ds_read_b64_tr_b16 v[216:217], v245 offset:35072
  ds_read_b64_tr_b16 v[218:219], v245 offset:36096
  v_mfma_f32_16x16x32_bf16 v[88:91], v[200:203], v[100:103], v[88:91]
  v_exp_f32 v119, v119
  v_exp_f32 v120, v120
  v_cvt_pk_bf16_f32 v107, v118, v119
  v_exp_f32 v121, v121
  v_exp_f32 v122, v122
  v_cvt_pk_bf16_f32 v108, v120, v121
  v_exp_f32 v123, v123
  v_exp_f32 v124, v124
  v_cvt_pk_bf16_f32 v109, v122, v123
  v_exp_f32 v125, v125
  v_exp_f32 v126, v126
  v_cvt_pk_bf16_f32 v110, v124, v125
  v_exp_f32 v127, v127
  s_nop 0
  v_cvt_pk_bf16_f32 v111, v126, v127
  v_mfma_f32_16x16x32_bf16 v[84:87], v[204:207], v[96:99], v[84:87]
  ds_read_b64_tr_b16 v[200:201], v246 offset:35072
  ds_read_b64_tr_b16 v[202:203], v246 offset:36096
  v_mfma_f32_16x16x32_bf16 v[92:95], v[204:207], v[100:103], v[92:95]
  s_waitcnt lgkmcnt(4)
  buffer_load_dwordx4 v236, s[8:11], s91 offen offset:2048 nt lds
  v_mfma_f32_16x16x32_bf16 v[32:35], v[208:211], v[104:107], v[32:35]
  ds_read_b64_tr_b16 v[204:205], v245 offset:35328
  v_mfma_f32_16x16x32_bf16 v[40:43], v[208:211], v[108:111], v[40:43]
  ds_read_b64_tr_b16 v[206:207], v245 offset:36352
  v_mfma_f32_16x16x32_bf16 v[36:39], v[212:215], v[104:107], v[36:39]
  ds_read_b64_tr_b16 v[208:209], v246 offset:35328
  ds_read_b64_tr_b16 v[210:211], v246 offset:36352
  v_mfma_f32_16x16x32_bf16 v[44:47], v[212:215], v[108:111], v[44:47]
  s_waitcnt lgkmcnt(4)
  buffer_load_dwordx4 v236, s[8:11], s91 offen offset:3072 nt lds
  v_mfma_f32_16x16x32_bf16 v[48:51], v[216:219], v[104:107], v[48:51]
  ds_read_b64_tr_b16 v[212:213], v245 offset:35584
  v_mfma_f32_16x16x32_bf16 v[56:59], v[216:219], v[108:111], v[56:59]
  ds_read_b64_tr_b16 v[214:215], v245 offset:36608
  v_mfma_f32_16x16x32_bf16 v[52:55], v[200:203], v[104:107], v[52:55]
  s_add_u32 m0, s68, 65536
  ds_read_b64_tr_b16 v[216:217], v246 offset:35584
  ds_read_b64_tr_b16 v[218:219], v246 offset:36608
  v_mfma_f32_16x16x32_bf16 v[60:63], v[200:203], v[108:111], v[60:63]
  s_waitcnt lgkmcnt(4)
  buffer_load_dwordx4 v237, s[12:15], s91 offen nt lds
  v_mfma_f32_16x16x32_bf16 v[64:67], v[204:207], v[104:107], v[64:67]
  s_waitcnt vmcnt(13)
  s_barrier
  ds_read_b128 v[200:203], v241 offset:0
  v_mfma_f32_16x16x32_bf16 v[72:75], v[204:207], v[108:111], v[72:75]
  v_mfma_f32_16x16x32_bf16 v[224:227], v[220:223], v[104:107], v[224:227]
  v_mfma_f32_16x16x32_bf16 v[68:71], v[208:211], v[104:107], v[68:71]
  ds_read_b128 v[204:207], v242 offset:0
  v_mfma_f32_16x16x32_bf16 v[76:79], v[208:211], v[108:111], v[76:79]
  s_waitcnt lgkmcnt(2)
  buffer_load_dwordx4 v237, s[12:15], s91 offen offset:1024 nt lds
  v_mfma_f32_16x16x32_bf16 v[228:231], v[220:223], v[108:111], v[228:231]
  v_mfma_f32_16x16x32_bf16 v[80:83], v[212:215], v[104:107], v[80:83]
  ds_read_b128 v[208:211], v241 offset:8192
  v_mfma_f32_16x16x32_bf16 v[88:91], v[212:215], v[108:111], v[88:91]
  v_mfma_f32_16x16x32_bf16 v[84:87], v[216:219], v[104:107], v[84:87]
  ds_read_b128 v[212:215], v242 offset:8192
  v_mfma_f32_16x16x32_bf16 v[92:95], v[216:219], v[108:111], v[92:95]
  s_waitcnt lgkmcnt(2)
  v_mfma_f32_16x16x32_bf16 v[96:99], v[200:203], v[0:3], v[192:195]
  ds_read_b128 v[216:219], v241 offset:1024
  v_subrev_u32 v247, 98304, v249
  v_mfma_f32_16x16x32_bf16 v[104:107], v[200:203], v[4:7], v[196:199]
  v_subrev_u32 v248, 98304, v250
  v_mov_b32 v239, 0
  v_mfma_f32_16x16x32_bf16 v[96:99], v[204:207], v[8:11], v[96:99]
  ds_read_b128 v[200:203], v242 offset:1024
  v_mbcnt_lo_u32_b32 v251, -1, 0
  v_mfma_f32_16x16x32_bf16 v[104:107], v[204:207], v[12:15], v[104:107]
  s_waitcnt lgkmcnt(2)
  global_load_dword v239, v239, s[0:1] sc1
  v_mfma_f32_16x16x32_bf16 v[96:99], v[208:211], v[16:19], v[96:99]
  ds_read_b128 v[204:207], v241 offset:9216
  v_mbcnt_hi_u32_b32 v251, -1, v251
  v_mfma_f32_16x16x32_bf16 v[104:107], v[208:211], v[20:23], v[104:107]
  v_and_b32 v233, 7, v251
  s_and_b32 s17, s5, 0xffffffe0
  v_mfma_f32_16x16x32_bf16 v[96:99], v[212:215], v[24:27], v[96:99]
  ds_read_b128 v[208:211], v242 offset:9216
  v_lshl_add_u32 v233, v233, 2, s17
  v_mfma_f32_16x16x32_bf16 v[104:107], v[212:215], v[28:31], v[104:107]
  s_waitcnt lgkmcnt(2)
  v_and_b32 v235, 15, v251
  s_lshr_b32 s17, s68, 1
  v_mfma_f32_16x16x32_bf16 v[100:103], v[216:219], v[0:3], v[192:195]
  ds_read_b128 v[212:215], v241 offset:2048
  v_lshl_add_u32 v235, v235, 7, s17
  v_mfma_f32_16x16x32_bf16 v[108:111], v[216:219], v[4:7], v[196:199]
  s_getpc_b64 s[22:23]
L_pc2:
  s_add_u32 s22, s22, L_tailcode-L_pc2
  s_addc_u32 s23, s23, 0
  v_mfma_f32_16x16x32_bf16 v[100:103], v[200:203], v[8:11], v[100:103]
  ds_read_b128 v[216:219], v242 offset:2048
  v_max3_f32 v253, v96, v97, v98
  v_mfma_f32_16x16x32_bf16 v[108:111], v[200:203], v[12:15], v[108:111]
  s_waitcnt lgkmcnt(2)
  global_load_dword v234, v235, s[22:23]
  v_mfma_f32_16x16x32_bf16 v[100:103], v[204:207], v[16:19], v[100:103]
  ds_read_b128 v[200:203], v241 offset:10240
  v_max3_f32 v253, v253, v99, v104
  v_mfma_f32_16x16x32_bf16 v[108:111], v[204:207], v[20:23], v[108:111]
  v_max3_f32 v253, v253, v105, v106
  v_and_b32 v235, 15, v251
  v_mfma_f32_16x16x32_bf16 v[100:103], v[208:211], v[24:27], v[100:103]
  ds_read_b128 v[204:207], v242 offset:10240
  v_lshlrev_b32 v235, 11, v235
  v_mfma_f32_16x16x32_bf16 v[108:111], v[208:211], v[28:31], v[108:111]
  s_waitcnt lgkmcnt(2)
  v_bfe_u32 v232, v251, 4, 1
  v_lshl_add_u32 v235, v232, 5, v235
  v_mfma_f32_16x16x32_bf16 v[112:115], v[212:215], v[0:3], v[192:195]
  ds_read_b128 v[208:211], v241 offset:3072
  v_lshrrev_b32 v232, 5, v251
  v_mfma_f32_16x16x32_bf16 v[120:123], v[212:215], v[4:7], v[196:199]
  v_lshl_add_u32 v235, v232, 4, v235
  v_add_u32 v235, s79, v235
  v_mfma_f32_16x16x32_bf16 v[112:115], v[216:219], v[8:11], v[112:115]
  ds_read_b128 v[212:215], v242 offset:3072
  v_max3_f32 v253, v253, v107, v100
  v_mfma_f32_16x16x32_bf16 v[120:123], v[216:219], v[12:15], v[120:123]
  s_waitcnt lgkmcnt(2)
  v_max3_f32 v253, v253, v101, v102
  v_max3_f32 v253, v253, v103, v108
  v_mfma_f32_16x16x32_bf16 v[112:115], v[200:203], v[16:19], v[112:115]
  ds_read_b128 v[216:219], v241 offset:11264
  v_max3_f32 v253, v253, v109, v110
  v_mfma_f32_16x16x32_bf16 v[120:123], v[200:203], v[20:23], v[120:123]
  s_and_b32 s17, s4, 0xfffe3fff
  v_lshl_add_u32 v232, v251, 4, s17
  v_mfma_f32_16x16x32_bf16 v[112:115], v[204:207], v[24:27], v[112:115]
  ds_read_b128 v[200:203], v242 offset:11264
  s_lshl_b32 s18, s79, 10
  v_mfma_f32_16x16x32_bf16 v[120:123], v[204:207], v[28:31], v[120:123]
  s_waitcnt lgkmcnt(2)
  s_sub_u32 s41, s2, 1
  s_and_b32 s41, s41, 7
  v_mfma_f32_16x16x32_bf16 v[116:119], v[208:211], v[0:3], v[192:195]
  s_waitcnt vmcnt(24)
  s_barrier
  ds_read_b64_tr_b16 v[204:205], v249 offset:32768
  v_mfma_f32_16x16x32_bf16 v[124:127], v[208:211], v[4:7], v[196:199]
  ds_read_b64_tr_b16 v[206:207], v249 offset:34816
  s_lshl_b32 s33, s41, 14
  v_mfma_f32_16x16x32_bf16 v[116:119], v[212:215], v[8:11], v[116:119]
  ds_read_b64_tr_b16 v[208:209], v250 offset:32768
  v_max3_f32 v253, v253, v111, v112
  v_mfma_f32_16x16x32_bf16 v[124:127], v[212:215], v[12:15], v[124:127]
  s_waitcnt lgkmcnt(3)
  ds_read_b64_tr_b16 v[210:211], v250 offset:34816
  v_max3_f32 v253, v253, v113, v114
  v_mfma_f32_16x16x32_bf16 v[116:119], v[216:219], v[16:19], v[116:119]
  ds_read_b64_tr_b16 v[212:213], v249 offset:33024
  v_max3_f32 v253, v253, v115, v120
  v_mfma_f32_16x16x32_bf16 v[124:127], v[216:219], v[20:23], v[124:127]
  ds_read_b64_tr_b16 v[214:215], v249 offset:35072
  v_max3_f32 v253, v253, v121, v122
  v_mfma_f32_16x16x32_bf16 v[116:119], v[200:203], v[24:27], v[116:119]
  ds_read_b64_tr_b16 v[216:217], v250 offset:33024
  s_add_u32 s33, s33, s18
  v_mfma_f32_16x16x32_bf16 v[124:127], v[200:203], v[28:31], v[124:127]
  s_waitcnt lgkmcnt(3)
  ds_read_b64_tr_b16 v[218:219], v250 offset:35072
  s_sub_u32 s42, s2, 2
  v_mfma_f32_16x16x32_bf16 a[32:35], v[204:207], v[160:163], a[32:35]
  ds_read_b64_tr_b16 v[200:201], v249 offset:36864
  s_and_b32 s42, s42, 7
  v_mfma_f32_16x16x32_bf16 a[40:43], v[204:207], v[164:167], a[40:43]
  ds_read_b64_tr_b16 v[202:203], v249 offset:38912
  s_lshl_b32 s34, s42, 14
  v_mfma_f32_16x16x32_bf16 a[36:39], v[208:211], v[160:163], a[36:39]
  ds_read_b64_tr_b16 v[204:205], v250 offset:36864
  v_max3_f32 v253, v253, v123, v116
  v_mfma_f32_16x16x32_bf16 a[44:47], v[208:211], v[164:167], a[44:47]
  s_waitcnt lgkmcnt(3)
  ds_read_b64_tr_b16 v[206:207], v250 offset:38912
  v_max3_f32 v253, v253, v117, v118
  v_max3_f32 v253, v253, v119, v124
  v_mfma_f32_16x16x32_bf16 a[48:51], v[212:215], v[160:163], a[48:51]
  ds_read_b64_tr_b16 v[208:209], v249 offset:37120
  v_max3_f32 v253, v253, v125, v126
  v_mfma_f32_16x16x32_bf16 a[56:59], v[212:215], v[164:167], a[56:59]
  ds_read_b64_tr_b16 v[210:211], v249 offset:39168
  v_max_f32 v253, v253, v127
  v_cmp_lt_f32 vcc, 0x41200000, v253
  v_mfma_f32_16x16x32_bf16 a[52:55], v[216:219], v[160:163], a[52:55]
  s_cbranch_vccnz L_r3_2t
L_r3_2:
  ds_read_b64_tr_b16 v[212:213], v250 offset:37120
  v_exp_f32 v96, v96
  v_mfma_f32_16x16x32_bf16 a[60:63], v[216:219], v[164:167], a[60:63]
  s_waitcnt lgkmcnt(3)
  ds_read_b64_tr_b16 v[214:215], v250 offset:39168
  v_exp_f32 v97, v97
  v_mfma_f32_16x16x32_bf16 a[32:35], v[200:203], v[168:171], a[32:35]
  ds_read_b64_tr_b16 v[216:217], v249 offset:40960
  v_cvt_pk_bf16_f32 v96, v96, v97
  v_mfma_f32_16x16x32_bf16 a[40:43], v[200:203], v[172:175], a[40:43]
  ds_read_b64_tr_b16 v[218:219], v249 offset:43008
  v_exp_f32 v98, v98
  v_mfma_f32_16x16x32_bf16 a[36:39], v[204:207], v[168:171], a[36:39]
  ds_read_b64_tr_b16 v[200:201], v250 offset:40960
  v_exp_f32 v99, v99
  v_mfma_f32_16x16x32_bf16 a[44:47], v[204:207], v[172:175], a[44:47]
  s_waitcnt lgkmcnt(3)
  ds_read_b64_tr_b16 v[202:203], v250 offset:43008
  v_cvt_pk_bf16_f32 v97, v98, v99
  s_add_u32 s34, s34, s18
  v_mfma_f32_16x16x32_bf16 a[48:51], v[208:211], v[168:171], a[48:51]
  ds_read_b64_tr_b16 v[204:205], v249 offset:41216
  v_exp_f32 v100, v100
  v_mfma_f32_16x16x32_bf16 a[56:59], v[208:211], v[172:175], a[56:59]
  ds_read_b64_tr_b16 v[206:207], v249 offset:43264
  v_exp_f32 v101, v101
  v_mfma_f32_16x16x32_bf16 a[52:55], v[212:215], v[168:171], a[52:55]
  ds_read_b64_tr_b16 v[208:209], v250 offset:41216
  ds_read_b64_tr_b16 v[210:211], v250 offset:43264
  v_mfma_f32_16x16x32_bf16 a[60:63], v[212:215], v[172:175], a[60:63]
  s_waitcnt lgkmcnt(4)
  buffer_load_dwordx4 v237, s[12:15], s91 offen offset:2048 nt lds
  v_cvt_pk_bf16_f32 v98, v100, v101
  v_mfma_f32_16x16x32_bf16 a[32:35], v[216:219], v[176:179], a[32:35]
  ds_read_b64_tr_b16 v[212:213], v249 offset:45056
  v_exp_f32 v102, v102
  v_mfma_f32_16x16x32_bf16 a[40:43], v[216:219], v[180:183], a[40:43]
  ds_read_b64_tr_b16 v[214:215], v249 offset:47104
  v_exp_f32 v103, v103
  v_mfma_f32_16x16x32_bf16 a[36:39], v[200:203], v[176:179], a[36:39]
  ds_read_b64_tr_b16 v[216:217], v250 offset:45056
  ds_read_b64_tr_b16 v[218:219], v250 offset:47104
  v_mfma_f32_16x16x32_bf16 a[44:47], v[200:203], v[180:183], a[44:47]
  s_waitcnt lgkmcnt(4)
  buffer_load_dwordx4 v237, s[12:15], s91 offen offset:3072 nt lds
  v_cvt_pk_bf16_f32 v99, v102, v103
  v_mfma_f32_16x16x32_bf16 a[48:51], v[204:207], v[176:179], a[48:51]
  ds_read_b64_tr_b16 v[200:201], v249 offset:45312
  v_exp_f32 v104, v104
  v_mfma_f32_16x16x32_bf16 a[56:59], v[204:207], v[180:183], a[56:59]
  ds_read_b64_tr_b16 v[202:203], v249 offset:47360
  v_exp_f32 v105, v105
  v_mfma_f32_16x16x32_bf16 v[224:227], v[220:223], v[96:99], v[224:227]
  v_cvt_pk_bf16_f32 v100, v104, v105
  s_sub_u32 s43, s2, 3
  v_mfma_f32_16x16x32_bf16 a[52:55], v[208:211], v[176:179], a[52:55]
  s_add_u32 m0, s68, 114688
  ds_read_b64_tr_b16 v[204:205], v250 offset:45312
  ds_read_b64_tr_b16 v[206:207], v250 offset:47360
  v_mfma_f32_16x16x32_bf16 a[60:63], v[208:211], v[180:183], a[60:63]
  s_waitcnt lgkmcnt(4)
  buffer_load_dwordx4 v240, s[48:51], s75 offen lds
  s_and_b32 s43, s43, 7
  v_mfma_f32_16x16x32_bf16 a[32:35], v[212:215], v[184:187], a[32:35]
  s_waitcnt vmcnt(11)
  s_barrier
  ds_read_b64_tr_b16 v[208:209], v245 offset:16384
  v_mfma_f32_16x16x32_bf16 a[40:43], v[212:215], v[188:191], a[40:43]
  ds_read_b64_tr_b16 v[210:211], v245 offset:17408
  v_exp_f32 v106, v106
  v_mfma_f32_16x16x32_bf16 a[36:39], v[216:219], v[184:187], a[36:39]
  ds_read_b64_tr_b16 v[212:213], v246 offset:16384
  ds_read_b64_tr_b16 v[214:215], v246 offset:17408
  v_mfma_f32_16x16x32_bf16 a[44:47], v[216:219], v[188:191], a[44:47]
  s_waitcnt lgkmcnt(4)
  buffer_load_dwordx4 v240, s[52:55], s75 offen offset:1024 lds
  s_lshl_b32 s35, s43, 14
  v_mfma_f32_16x16x32_bf16 a[48:51], v[200:203], v[184:187], a[48:51]
  ds_read_b64_tr_b16 v[216:217], v245 offset:16640
  v_exp_f32 v107, v107
  v_mfma_f32_16x16x32_bf16 a[56:59], v[200:203], v[188:191], a[56:59]
  ds_read_b64_tr_b16 v[218:219], v245 offset:17664
  v_cvt_pk_bf16_f32 v101, v106, v107
  v_exp_f32 v108, v108
  v_exp_f32 v109, v109
  v_exp_f32 v110, v110
  v_cvt_pk_bf16_f32 v102, v108, v109
  v_exp_f32 v111, v111
  v_exp_f32 v112, v112
  v_cvt_pk_bf16_f32 v103, v110, v111
  v_mfma_f32_16x16x32_bf16 a[52:55], v[204:207], v[184:187], a[52:55]
  ds_read_b64_tr_b16 v[200:201], v246 offset:16640
  ds_read_b64_tr_b16 v[202:203], v246 offset:17664
  v_mfma_f32_16x16x32_bf16 a[60:63], v[204:207], v[188:191], a[60:63]
  s_waitcnt lgkmcnt(4)
  buffer_load_dwordx4 v240, s[56:59], s75 offen offset:2048 lds
  s_add_u32 s35, s35, s18
  v_mfma_f32_16x16x32_bf16 v[228:231], v[220:223], v[100:103], v[228:231]
  v_exp_f32 v113, v113
  v_mfma_f32_16x16x32_bf16 v[32:35], v[208:211], v[96:99], v[32:35]
  ds_read_b64_tr_b16 v[204:205], v245 offset:16896
  v_cvt_pk_bf16_f32 v104, v112, v113
  v_mfma_f32_16x16x32_bf16 v[40:43], v[208:211], v[100:103], v[40:43]
  ds_read_b64_tr_b16 v[206:207], v245 offset:17920
  v_exp_f32 v114, v114
  v_mfma_f32_16x16x32_bf16 v[36:39], v[212:215], v[96:99], v[36:39]
  ds_read_b64_tr_b16 v[208:209], v246 offset:16896
  v_exp_f32 v115, v115
  v_mfma_f32_16x16x32_bf16 v[44:47], v[212:215], v[100:103], v[44:47]
  s_waitcnt lgkmcnt(3)
  ds_read_b64_tr_b16 v[210:211], v246 offset:17920
  v_cvt_pk_bf16_f32 v105, v114, v115
  s_sub_u32 s44, s2, 4
  v_mfma_f32_16x16x32_bf16 v[48:51], v[216:219], v[96:99], v[48:51]
  ds_read_b64_tr_b16 v[212:213], v245 offset:17152
  v_exp_f32 v116, v116
  v_mfma_f32_16x16x32_bf16 v[56:59], v[216:219], v[100:103], v[56:59]
  ds_read_b64_tr_b16 v[214:215], v245 offset:18176
  v_exp_f32 v117, v117
  v_mfma_f32_16x16x32_bf16 v[52:55], v[200:203], v[96:99], v[52:55]
  ds_read_b64_tr_b16 v[216:217], v246 offset:17152
  v_cvt_pk_bf16_f32 v106, v116, v117
  v_mfma_f32_16x16x32_bf16 v[60:63], v[200:203], v[100:103], v[60:63]
  s_waitcnt lgkmcnt(3)
  ds_read_b64_tr_b16 v[218:219], v246 offset:18176
  v_exp_f32 v118, v118
  v_mfma_f32_16x16x32_bf16 v[64:67], v[204:207], v[96:99], v[64:67]
  ds_read_b64_tr_b16 v[200:201], v245 offset:18432
  ds_read_b64_tr_b16 v[202:203], v245 offset:19456
  v_mfma_f32_16x16x32_bf16 v[72:75], v[204:207], v[100:103], v[72:75]
  buffer_load_dwordx4 v240, s[60:63], s75 offen offset:3072 lds
  s_and_b32 s44, s44, 7
  v_mfma_f32_16x16x32_bf16 v[68:71], v[208:211], v[96:99], v[68:71]
  ds_read_b64_tr_b16 v[204:205], v246 offset:18432
  v_exp_f32 v119, v119
  v_mfma_f32_16x16x32_bf16 v[76:79], v[208:211], v[100:103], v[76:79]
  s_waitcnt lgkmcnt(3)
  ds_read_b64_tr_b16 v[206:207], v246 offset:19456
  v_cvt_pk_bf16_f32 v107, v118, v119
  s_lshl_b32 s36, s44, 14
  v_mfma_f32_16x16x32_bf16 v[80:83], v[212:215], v[96:99], v[80:83]
  ds_read_b64_tr_b16 v[208:209], v245 offset:18688
  v_exp_f32 v120, v120
  v_mfma_f32_16x16x32_bf16 v[88:91], v[212:215], v[100:103], v[88:91]
  ds_read_b64_tr_b16 v[210:211], v245 offset:19712
  v_exp_f32 v121, v121
  v_exp_f32 v122, v122
  v_cvt_pk_bf16_f32 v108, v120, v121
  v_exp_f32 v123, v123
  v_exp_f32 v124, v124
  v_cvt_pk_bf16_f32 v109, v122, v123
  v_exp_f32 v125, v125
  v_exp_f32 v126, v126
  v_cvt_pk_bf16_f32 v110, v124, v125
  v_exp_f32 v127, v127
  s_add_u32 s36, s36, s18
  v_cvt_pk_bf16_f32 v111, v126, v127
  v_mfma_f32_16x16x32_bf16 v[224:227], v[220:223], v[104:107], v[224:227]
  s_sub_u32 s45, s2, 5
  s_and_b32 s45, s45, 7
  v_mfma_f32_16x16x32_bf16 v[84:87], v[216:219], v[96:99], v[84:87]
  ds_read_b64_tr_b16 v[212:213], v246 offset:18688
  s_lshl_b32 s37, s45, 14
  v_mfma_f32_16x16x32_bf16 v[92:95], v[216:219], v[100:103], v[92:95]
  s_waitcnt lgkmcnt(3)
  ds_read_b64_tr_b16 v[214:215], v246 offset:19712
  s_add_u32 s37, s37, s18
  v_mfma_f32_16x16x32_bf16 v[228:231], v[220:223], v[108:111], v[228:231]
  s_sub_u32 s46, s2, 6
  s_and_b32 s46, s46, 7
  v_mfma_f32_16x16x32_bf16 v[32:35], v[200:203], v[104:107], v[32:35]
  ds_read_b64_tr_b16 v[216:217], v245 offset:18944
  s_lshl_b32 s38, s46, 14
  v_mfma_f32_16x16x32_bf16 v[40:43], v[200:203], v[108:111], v[40:43]
  ds_read_b64_tr_b16 v[218:219], v245 offset:19968
  s_add_u32 s38, s38, s18
  v_mfma_f32_16x16x32_bf16 v[36:39], v[204:207], v[104:107], v[36:39]
  s_add_u32 m0, s68, 32768
  ds_read_b64_tr_b16 v[200:201], v246 offset:18944
  ds_read_b64_tr_b16 v[202:203], v246 offset:19968
  v_mfma_f32_16x16x32_bf16 v[44:47], v[204:207], v[108:111], v[44:47]
  s_waitcnt lgkmcnt(4)
  buffer_load_dwordx4 v236, s[8:11], s92 offen nt lds
  v_mfma_f32_16x16x32_bf16 v[48:51], v[208:211], v[104:107], v[48:51]
  ds_read_b64_tr_b16 v[204:205], v245 offset:19200
  s_sub_u32 s47, s2, 7
  v_mfma_f32_16x16x32_bf16 v[56:59], v[208:211], v[108:111], v[56:59]
  ds_read_b64_tr_b16 v[206:207], v245 offset:20224
  s_and_b32 s47, s47, 7
  v_mfma_f32_16x16x32_bf16 v[52:55], v[212:215], v[104:107], v[52:55]
  ds_read_b64_tr_b16 v[208:209], v246 offset:19200
  s_lshl_b32 s39, s47, 14
  v_mfma_f32_16x16x32_bf16 v[60:63], v[212:215], v[108:111], v[60:63]
  s_waitcnt lgkmcnt(3)
  ds_read_b64_tr_b16 v[210:211], v246 offset:20224
  s_add_u32 s39, s39, s18
  v_mfma_f32_16x16x32_bf16 v[64:67], v[216:219], v[104:107], v[64:67]
  s_waitcnt vmcnt(11)
  s_barrier
  ds_read_b128 v[212:215], v241 offset:16384
  v_mfma_f32_16x16x32_bf16 v[72:75], v[216:219], v[108:111], v[72:75]
  v_mfma_f32_16x16x32_bf16 v[68:71], v[200:203], v[104:107], v[68:71]
  ds_read_b128 v[216:219], v242 offset:16384
  v_mfma_f32_16x16x32_bf16 v[76:79], v[200:203], v[108:111], v[76:79]
  s_waitcnt lgkmcnt(2)
  v_mfma_f32_16x16x32_bf16 v[80:83], v[204:207], v[104:107], v[80:83]
  ds_read_b128 v[200:203], v241 offset:24576
  v_mfma_f32_16x16x32_bf16 v[88:91], v[204:207], v[108:111], v[88:91]
  v_mfma_f32_16x16x32_bf16 v[84:87], v[208:211], v[104:107], v[84:87]
  ds_read_b128 v[204:207], v242 offset:24576
  v_mfma_f32_16x16x32_bf16 v[92:95], v[208:211], v[108:111], v[92:95]
  s_waitcnt lgkmcnt(2)
  v_mfma_f32_16x16x32_bf16 v[96:99], v[212:215], v[0:3], v[192:195]
  ds_read_b128 v[208:211], v241 offset:17408
  v_mfma_f32_16x16x32_bf16 v[104:107], v[212:215], v[4:7], v[196:199]
  v_mfma_f32_16x16x32_bf16 v[96:99], v[216:219], v[8:11], v[96:99]
  ds_read_b128 v[212:215], v242 offset:17408
  v_mfma_f32_16x16x32_bf16 v[104:107], v[216:219], v[12:15], v[104:107]
  s_waitcnt lgkmcnt(2)
  v_mfma_f32_16x16x32_bf16 v[96:99], v[200:203], v[16:19], v[96:99]
  ds_read_b128 v[216:219], v241 offset:25600
  v_mfma_f32_16x16x32_bf16 v[104:107], v[200:203], v[20:23], v[104:107]
  v_mfma_f32_16x16x32_bf16 v[96:99], v[204:207], v[24:27], v[96:99]
  ds_read_b128 v[200:203], v242 offset:25600
  v_mfma_f32_16x16x32_bf16 v[104:107], v[204:207], v[28:31], v[104:107]
  s_waitcnt lgkmcnt(2)
  v_mfma_f32_16x16x32_bf16 v[100:103], v[208:211], v[0:3], v[192:195]
  ds_read_b128 v[204:207], v241 offset:18432
  v_mfma_f32_16x16x32_bf16 v[108:111], v[208:211], v[4:7], v[196:199]
  v_mfma_f32_16x16x32_bf16 v[100:103], v[212:215], v[8:11], v[100:103]
  ds_read_b128 v[208:211], v242 offset:18432
  v_max3_f32 v253, v96, v97, v98
  v_mfma_f32_16x16x32_bf16 v[108:111], v[212:215], v[12:15], v[108:111]
  s_waitcnt lgkmcnt(2)
  buffer_load_dwordx4 v236, s[8:11], s92 offen offset:1024 nt lds
  v_mfma_f32_16x16x32_bf16 v[100:103], v[216:219], v[16:19], v[100:103]
  ds_read_b128 v[212:215], v241 offset:26624
  v_max3_f32 v253, v253, v99, v104
  v_mfma_f32_16x16x32_bf16 v[108:111], v[216:219], v[20:23], v[108:111]
  v_max3_f32 v253, v253, v105, v106
  v_mfma_f32_16x16x32_bf16 v[100:103], v[200:203], v[24:27], v[100:103]
  ds_read_b128 v[216:219], v242 offset:26624
  v_mfma_f32_16x16x32_bf16 v[108:111], v[200:203], v[28:31], v[108:111]
  s_waitcnt lgkmcnt(2)
  buffer_load_dwordx4 v236, s[8:11], s92 offen offset:2048 nt lds
  v_mfma_f32_16x16x32_bf16 v[112:115], v[204:207], v[0:3], v[192:195]
  ds_read_b128 v[200:203], v241 offset:19456
  v_mfma_f32_16x16x32_bf16 v[120:123], v[204:207], v[4:7], v[196:199]
  v_mfma_f32_16x16x32_bf16 v[112:115], v[208:211], v[8:11], v[112:115]
  ds_read_b128 v[204:207], v242 offset:19456
  v_max3_f32 v253, v253, v107, v100
  v_mfma_f32_16x16x32_bf16 v[120:123], v[208:211], v[12:15], v[120:123]
  s_waitcnt lgkmcnt(2)
  buffer_load_dwordx4 v236, s[8:11], s92 offen offset:3072 nt lds
  v_mfma_f32_16x16x32_bf16 v[112:115], v[212:215], v[16:19], v[112:115]
  ds_read_b128 v[208:211], v241 offset:27648
  v_max3_f32 v253, v253, v101, v102
  v_mfma_f32_16x16x32_bf16 v[120:123], v[212:215], v[20:23], v[120:123]
  v_max3_f32 v253, v253, v103, v108
  v_max3_f32 v253, v253, v109, v110
  v_mfma_f32_16x16x32_bf16 v[112:115], v[216:219], v[24:27], v[112:115]
  s_add_u32 m0, s68, 131072
  ds_read_b128 v[212:215], v242 offset:27648
  v_mfma_f32_16x16x32_bf16 v[120:123], v[216:219], v[28:31], v[120:123]
  s_waitcnt lgkmcnt(2)
  buffer_load_dwordx4 v240, s[48:51], s76 offen lds
  v_mfma_f32_16x16x32_bf16 v[116:119], v[200:203], v[0:3], v[192:195]
  s_waitcnt vmcnt(23)
  s_barrier
  ds_read_b64_tr_b16 v[216:217], v249 offset:49152
  v_mfma_f32_16x16x32_bf16 v[124:127], v[200:203], v[4:7], v[196:199]
  ds_read_b64_tr_b16 v[218:219], v249 offset:51200
  v_mfma_f32_16x16x32_bf16 v[116:119], v[204:207], v[8:11], v[116:119]
  ds_read_b64_tr_b16 v[200:201], v250 offset:49152
  ds_read_b64_tr_b16 v[202:203], v250 offset:51200
  v_mfma_f32_16x16x32_bf16 v[124:127], v[204:207], v[12:15], v[124:127]
  s_waitcnt lgkmcnt(4)
  buffer_load_dwordx4 v240, s[52:55], s76 offen offset:1024 lds
  v_mfma_f32_16x16x32_bf16 v[116:119], v[208:211], v[16:19], v[116:119]
  ds_read_b64_tr_b16 v[204:205], v249 offset:49408
  v_max3_f32 v253, v253, v111, v112
  v_mfma_f32_16x16x32_bf16 v[124:127], v[208:211], v[20:23], v[124:127]
  ds_read_b64_tr_b16 v[206:207], v249 offset:51456
  v_max3_f32 v253, v253, v113, v114
  v_mfma_f32_16x16x32_bf16 v[116:119], v[212:215], v[24:27], v[116:119]
  ds_read_b64_tr_b16 v[208:209], v250 offset:49408
  ds_read_b64_tr_b16 v[210:211], v250 offset:51456
  v_mfma_f32_16x16x32_bf16 v[124:127], v[212:215], v[28:31], v[124:127]
  s_waitcnt lgkmcnt(4)
  buffer_load_dwordx4 v240, s[56:59], s76 offen offset:2048 lds
  v_mfma_f32_16x16x32_bf16 a[64:67], v[216:219], v[160:163], a[64:67]
  ds_read_b64_tr_b16 v[212:213], v249 offset:53248
  v_max3_f32 v253, v253, v115, v120
  v_mfma_f32_16x16x32_bf16 a[72:75], v[216:219], v[164:167], a[72:75]
  ds_read_b64_tr_b16 v[214:215], v249 offset:55296
  v_max3_f32 v253, v253, v121, v122
  v_mfma_f32_16x16x32_bf16 a[68:71], v[200:203], v[160:163], a[68:71]
  ds_read_b64_tr_b16 v[216:217], v250 offset:53248
  ds_read_b64_tr_b16 v[218:219], v250 offset:55296
  v_mfma_f32_16x16x32_bf16 a[76:79], v[200:203], v[164:167], a[76:79]
  s_waitcnt lgkmcnt(4)
  buffer_load_dwordx4 v240, s[60:63], s76 offen offset:3072 lds
  v_max3_f32 v253, v253, v123, v116
  v_mfma_f32_16x16x32_bf16 a[80:83], v[204:207], v[160:163], a[80:83]
  ds_read_b64_tr_b16 v[200:201], v249 offset:53504
  v_max3_f32 v253, v253, v117, v118
  v_mfma_f32_16x16x32_bf16 a[88:91], v[204:207], v[164:167], a[88:91]
  ds_read_b64_tr_b16 v[202:203], v249 offset:55552
  v_max3_f32 v253, v253, v119, v124
  v_max3_f32 v253, v253, v125, v126
  v_mfma_f32_16x16x32_bf16 a[84:87], v[208:211], v[160:163], a[84:87]
  s_add_u32 m0, s68, 98304
  ds_read_b64_tr_b16 v[204:205], v250 offset:53504
  ds_read_b64_tr_b16 v[206:207], v250 offset:55552
  v_mfma_f32_16x16x32_bf16 a[92:95], v[208:211], v[164:167], a[92:95]
  s_waitcnt lgkmcnt(4)
  buffer_load_dwordx4 v237, s[12:15], s92 offen nt lds
  v_max_f32 v253, v253, v127
  v_mfma_f32_16x16x32_bf16 a[64:67], v[212:215], v[168:171], a[64:67]
  ds_read_b64_tr_b16 v[208:209], v249 offset:57344
  v_cmp_lt_f32 vcc, 0x41200000, v253
  v_mfma_f32_16x16x32_bf16 a[72:75], v[212:215], v[172:175], a[72:75]
  s_cbranch_vccnz L_r3_3t
L_r3_3:
  ds_read_b64_tr_b16 v[210:211], v249 offset:59392
  v_exp_f32 v96, v96
  v_mfma_f32_16x16x32_bf16 a[68:71], v[216:219], v[168:171], a[68:71]
  ds_read_b64_tr_b16 v[212:213], v250 offset:57344
  ds_read_b64_tr_b16 v[214:215], v250 offset:59392
  v_mfma_f32_16x16x32_bf16 a[76:79], v[216:219], v[172:175], a[76:79]
  s_waitcnt lgkmcnt(4)
  buffer_load_dwordx4 v237, s[12:15], s92 offen offset:1024 nt lds
  v_mfma_f32_16x16x32_bf16 a[80:83], v[200:203], v[168:171], a[80:83]
  ds_read_b64_tr_b16 v[216:217], v249 offset:57600
  ds_read_b64_tr_b16 v[218:219], v249 offset:59648
  v_mfma_f32_16x16x32_bf16 a[88:91], v[200:203], v[172:175], a[88:91]
  v_exp_f32 v97, v97
  v_mfma_f32_16x16x32_bf16 a[84:87], v[204:207], v[168:171], a[84:87]
  ds_read_b64_tr_b16 v[200:201], v250 offset:57600
  v_cvt_pk_bf16_f32 v96, v96, v97
  v_mfma_f32_16x16x32_bf16 a[92:95], v[204:207], v[172:175], a[92:95]
  s_waitcnt lgkmcnt(3)
  ds_read_b64_tr_b16 v[202:203], v250 offset:59648
  v_exp_f32 v98, v98
  v_mfma_f32_16x16x32_bf16 a[64:67], v[208:211], v[176:179], a[64:67]
  ds_read_b64_tr_b16 v[204:205], v249 offset:61440
  ds_read_b64_tr_b16 v[206:207], v249 offset:63488
  v_mfma_f32_16x16x32_bf16 a[72:75], v[208:211], v[180:183], a[72:75]
  v_exp_f32 v99, v99
  v_mfma_f32_16x16x32_bf16 a[68:71], v[212:215], v[176:179], a[68:71]
  ds_read_b64_tr_b16 v[208:209], v250 offset:61440
  v_cvt_pk_bf16_f32 v97, v98, v99
  v_mfma_f32_16x16x32_bf16 a[76:79], v[212:215], v[180:183], a[76:79]
  s_waitcnt lgkmcnt(3)
  ds_read_b64_tr_b16 v[210:211], v250 offset:63488
  v_exp_f32 v100, v100
  v_mfma_f32_16x16x32_bf16 a[80:83], v[216:219], v[176:179], a[80:83]
  ds_read_b64_tr_b16 v[212:213], v249 offset:61696
  ds_read_b64_tr_b16 v[214:215], v249 offset:63744
  v_mfma_f32_16x16x32_bf16 a[88:91], v[216:219], v[180:183], a[88:91]
  v_exp_f32 v101, v101
  v_mfma_f32_16x16x32_bf16 a[84:87], v[200:203], v[176:179], a[84:87]
  ds_read_b64_tr_b16 v[216:217], v250 offset:61696
  v_cvt_pk_bf16_f32 v98, v100, v101
  v_mfma_f32_16x16x32_bf16 a[92:95], v[200:203], v[180:183], a[92:95]
  s_waitcnt lgkmcnt(3)
  ds_read_b64_tr_b16 v[218:219], v250 offset:63744
  v_exp_f32 v102, v102
  v_mfma_f32_16x16x32_bf16 a[64:67], v[204:207], v[184:187], a[64:67]
  s_waitcnt vmcnt(14)
  s_barrier
  ds_read_b64_tr_b16 v[200:201], v245 offset:0
  ds_read_b64_tr_b16 v[202:203], v245 offset:1024
  v_mfma_f32_16x16x32_bf16 a[72:75], v[204:207], v[188:191], a[72:75]
  v_exp_f32 v103, v103
  v_mfma_f32_16x16x32_bf16 a[68:71], v[208:211], v[184:187], a[68:71]
  ds_read_b64_tr_b16 v[204:205], v246 offset:0
  v_cvt_pk_bf16_f32 v99, v102, v103
  v_mfma_f32_16x16x32_bf16 a[76:79], v[208:211], v[188:191], a[76:79]
  s_waitcnt lgkmcnt(3)
  ds_read_b64_tr_b16 v[206:207], v246 offset:1024
  v_exp_f32 v104, v104
  v_mfma_f32_16x16x32_bf16 v[224:227], v[220:223], v[96:99], v[224:227]
  v_exp_f32 v105, v105
  v_mfma_f32_16x16x32_bf16 a[80:83], v[212:215], v[184:187], a[80:83]
  ds_read_b64_tr_b16 v[208:209], v245 offset:256
  v_cvt_pk_bf16_f32 v100, v104, v105
  v_mfma_f32_16x16x32_bf16 a[88:91], v[212:215], v[188:191], a[88:91]
  ds_read_b64_tr_b16 v[210:211], v245 offset:1280
  v_exp_f32 v106, v106
  v_exp_f32 v107, v107
  v_exp_f32 v108, v108
  v_cvt_pk_bf16_f32 v101, v106, v107
  v_exp_f32 v109, v109
  v_exp_f32 v110, v110
  v_cvt_pk_bf16_f32 v102, v108, v109
  v_exp_f32 v111, v111
  v_exp_f32 v112, v112
  v_cvt_pk_bf16_f32 v103, v110, v111
  v_mfma_f32_16x16x32_bf16 a[84:87], v[216:219], v[184:187], a[84:87]
  ds_read_b64_tr_b16 v[212:213], v246 offset:256
  ds_read_b64_tr_b16 v[214:215], v246 offset:1280
  v_mfma_f32_16x16x32_bf16 a[92:95], v[216:219], v[188:191], a[92:95]
  s_waitcnt lgkmcnt(4)
  v_exp_f32 v113, v113
  v_mfma_f32_16x16x32_bf16 v[228:231], v[220:223], v[100:103], v[228:231]
  v_cvt_pk_bf16_f32 v104, v112, v113
  v_mfma_f32_16x16x32_bf16 v[32:35], v[200:203], v[96:99], v[32:35]
  ds_read_b64_tr_b16 v[216:217], v245 offset:512
  ds_read_b64_tr_b16 v[218:219], v245 offset:1536
  v_mfma_f32_16x16x32_bf16 v[40:43], v[200:203], v[100:103], v[40:43]
  v_exp_f32 v114, v114
  v_mfma_f32_16x16x32_bf16 v[36:39], v[204:207], v[96:99], v[36:39]
  ds_read_b64_tr_b16 v[200:201], v246 offset:512
  ds_read_b64_tr_b16 v[202:203], v246 offset:1536
  v_mfma_f32_16x16x32_bf16 v[44:47], v[204:207], v[100:103], v[44:47]
  s_waitcnt lgkmcnt(4)
  v_exp_f32 v115, v115
  v_mfma_f32_16x16x32_bf16 v[48:51], v[208:211], v[96:99], v[48:51]
  ds_read_b64_tr_b16 v[204:205], v245 offset:768
  v_cvt_pk_bf16_f32 v105, v114, v115
  v_mfma_f32_16x16x32_bf16 v[56:59], v[208:211], v[100:103], v[56:59]
  ds_read_b64_tr_b16 v[206:207], v245 offset:1792
  v_exp_f32 v116, v116
  v_mfma_f32_16x16x32_bf16 v[52:55], v[212:215], v[96:99], v[52:55]
  ds_read_b64_tr_b16 v[208:209], v246 offset:768
  ds_read_b64_tr_b16 v[210:211], v246 offset:1792
  v_mfma_f32_16x16x32_bf16 v[60:63], v[212:215], v[100:103], v[60:63]
  s_waitcnt lgkmcnt(4)
  v_exp_f32 v117, v117
  v_mfma_f32_16x16x32_bf16 v[64:67], v[216:219], v[96:99], v[64:67]
  ds_read_b64_tr_b16 v[212:213], v245 offset:2048
  v_cvt_pk_bf16_f32 v106, v116, v117
  v_mfma_f32_16x16x32_bf16 v[72:75], v[216:219], v[100:103], v[72:75]
  ds_read_b64_tr_b16 v[214:215], v245 offset:3072
  v_exp_f32 v118, v118
  v_mfma_f32_16x16x32_bf16 v[68:71], v[200:203], v[96:99], v[68:71]
  ds_read_b64_tr_b16 v[216:217], v246 offset:2048
  ds_read_b64_tr_b16 v[218:219], v246 offset:3072
  v_mfma_f32_16x16x32_bf16 v[76:79], v[200:203], v[100:103], v[76:79]
  s_waitcnt lgkmcnt(4)
  v_exp_f32 v119, v119
  v_mfma_f32_16x16x32_bf16 v[80:83], v[204:207], v[96:99], v[80:83]
  ds_read_b64_tr_b16 v[200:201], v245 offset:2304
  v_cvt_pk_bf16_f32 v107, v118, v119
  v_mfma_f32_16x16x32_bf16 v[88:91], v[204:207], v[100:103], v[88:91]
  ds_read_b64_tr_b16 v[202:203], v245 offset:3328
  v_exp_f32 v120, v120
  v_exp_f32 v121, v121
  v_exp_f32 v122, v122
  v_cvt_pk_bf16_f32 v108, v120, v121
  v_exp_f32 v123, v123
  v_exp_f32 v124, v124
  v_cvt_pk_bf16_f32 v109, v122, v123
  v_exp_f32 v125, v125
  v_exp_f32 v126, v126
  v_cvt_pk_bf16_f32 v110, v124, v125
  v_exp_f32 v127, v127
  s_nop 0
  v_cvt_pk_bf16_f32 v111, v126, v127
  v_mfma_f32_16x16x32_bf16 v[84:87], v[208:211], v[96:99], v[84:87]
  ds_read_b64_tr_b16 v[204:205], v246 offset:2304
  v_mfma_f32_16x16x32_bf16 v[92:95], v[208:211], v[100:103], v[92:95]
  s_waitcnt lgkmcnt(3)
  ds_read_b64_tr_b16 v[206:207], v246 offset:3328
  v_mfma_f32_16x16x32_bf16 v[32:35], v[212:215], v[104:107], v[32:35]
  ds_read_b64_tr_b16 v[208:209], v245 offset:2560
  ds_read_b64_tr_b16 v[210:211], v245 offset:3584
  v_mfma_f32_16x16x32_bf16 v[40:43], v[212:215], v[108:111], v[40:43]
  buffer_load_dwordx4 v237, s[12:15], s92 offen offset:2048 nt lds
  v_mfma_f32_16x16x32_bf16 v[36:39], v[216:219], v[104:107], v[36:39]
  ds_read_b64_tr_b16 v[212:213], v246 offset:2560
  v_mfma_f32_16x16x32_bf16 v[44:47], v[216:219], v[108:111], v[44:47]
  s_waitcnt lgkmcnt(3)
  ds_read_b64_tr_b16 v[214:215], v246 offset:3584
  v_mfma_f32_16x16x32_bf16 v[48:51], v[200:203], v[104:107], v[48:51]
  ds_read_b64_tr_b16 v[216:217], v245 offset:2816
  ds_read_b64_tr_b16 v[218:219], v245 offset:3840
  v_mfma_f32_16x16x32_bf16 v[56:59], v[200:203], v[108:111], v[56:59]
  buffer_load_dwordx4 v237, s[12:15], s92 offen offset:3072 nt lds
  v_mfma_f32_16x16x32_bf16 v[52:55], v[204:207], v[104:107], v[52:55]
  ds_read_b64_tr_b16 v[200:201], v246 offset:2816
  v_mfma_f32_16x16x32_bf16 v[60:63], v[204:207], v[108:111], v[60:63]
  s_waitcnt lgkmcnt(3)
  ds_read_b64_tr_b16 v[202:203], v246 offset:3840
  v_mfma_f32_16x16x32_bf16 v[64:67], v[208:211], v[104:107], v[64:67]
  s_waitcnt vmcnt(8)
  s_barrier
  s_add_u32 m0, s68, 49152
  ds_read_b128 v[204:207], v241 offset:32768
  v_mfma_f32_16x16x32_bf16 v[72:75], v[208:211], v[108:111], v[72:75]
  buffer_load_dwordx4 v236, s[8:11], s93 offen nt lds
  v_mfma_f32_16x16x32_bf16 v[224:227], v[220:223], v[104:107], v[224:227]
  v_mfma_f32_16x16x32_bf16 v[68:71], v[212:215], v[104:107], v[68:71]
  ds_read_b128 v[208:211], v242 offset:32768
  v_mfma_f32_16x16x32_bf16 v[76:79], v[212:215], v[108:111], v[76:79]
  s_waitcnt lgkmcnt(2)
  v_mfma_f32_16x16x32_bf16 v[228:231], v[220:223], v[108:111], v[228:231]
  v_mfma_f32_16x16x32_bf16 v[80:83], v[216:219], v[104:107], v[80:83]
  ds_read_b128 v[212:215], v241 offset:40960
  v_mfma_f32_16x16x32_bf16 v[88:91], v[216:219], v[108:111], v[88:91]
  buffer_load_dwordx4 v236, s[8:11], s93 offen offset:1024 nt lds
  v_mfma_f32_16x16x32_bf16 v[84:87], v[200:203], v[104:107], v[84:87]
  ds_read_b128 v[216:219], v242 offset:40960
  v_mfma_f32_16x16x32_bf16 v[92:95], v[200:203], v[108:111], v[92:95]
  s_waitcnt lgkmcnt(2)
  v_mfma_f32_16x16x32_bf16 v[96:99], v[204:207], v[0:3], v[192:195]
  ds_read_b128 v[200:203], v241 offset:33792
  v_mfma_f32_16x16x32_bf16 v[104:107], v[204:207], v[4:7], v[196:199]
  buffer_load_dwordx4 v236, s[8:11], s93 offen offset:2048 nt lds
  v_mfma_f32_16x16x32_bf16 v[96:99], v[208:211], v[8:11], v[96:99]
  ds_read_b128 v[204:207], v242 offset:33792
  v_mfma_f32_16x16x32_bf16 v[104:107], v[208:211], v[12:15], v[104:107]
  s_waitcnt lgkmcnt(2)
  v_mfma_f32_16x16x32_bf16 v[96:99], v[212:215], v[16:19], v[96:99]
  ds_read_b128 v[208:211], v241 offset:41984
  v_mfma_f32_16x16x32_bf16 v[104:107], v[212:215], v[20:23], v[104:107]
  buffer_load_dwordx4 v236, s[8:11], s93 offen offset:3072 nt lds
  v_mfma_f32_16x16x32_bf16 v[96:99], v[216:219], v[24:27], v[96:99]
  ds_read_b128 v[212:215], v242 offset:41984
  v_mfma_f32_16x16x32_bf16 v[104:107], v[216:219], v[28:31], v[104:107]
  s_waitcnt lgkmcnt(2)
  v_mfma_f32_16x16x32_bf16 v[100:103], v[200:203], v[0:3], v[192:195]
  s_add_u32 m0, s68, 147456
  ds_read_b128 v[216:219], v241 offset:34816
  v_mfma_f32_16x16x32_bf16 v[108:111], v[200:203], v[4:7], v[196:199]
  buffer_load_dwordx4 v240, s[48:51], s77 offen lds
  v_mfma_f32_16x16x32_bf16 v[100:103], v[204:207], v[8:11], v[100:103]
  ds_read_b128 v[200:203], v242 offset:34816
  v_max3_f32 v253, v96, v97, v98
  v_mfma_f32_16x16x32_bf16 v[108:111], v[204:207], v[12:15], v[108:111]
  s_waitcnt lgkmcnt(2)
  v_max3_f32 v253, v253, v99, v104
  v_max3_f32 v253, v253, v105, v106
  v_mfma_f32_16x16x32_bf16 v[100:103], v[208:211], v[16:19], v[100:103]
  ds_read_b128 v[204:207], v241 offset:43008
  v_mfma_f32_16x16x32_bf16 v[108:111], v[208:211], v[20:23], v[108:111]
  buffer_load_dwordx4 v240, s[52:55], s77 offen offset:1024 lds
  v_mfma_f32_16x16x32_bf16 v[100:103], v[212:215], v[24:27], v[100:103]
  ds_read_b128 v[208:211], v242 offset:43008
  v_mfma_f32_16x16x32_bf16 v[108:111], v[212:215], v[28:31], v[108:111]
  s_waitcnt lgkmcnt(2)
  v_mfma_f32_16x16x32_bf16 v[112:115], v[216:219], v[0:3], v[192:195]
  ds_read_b128 v[212:215], v241 offset:35840
  v_mfma_f32_16x16x32_bf16 v[120:123], v[216:219], v[4:7], v[196:199]
  v_mfma_f32_16x16x32_bf16 v[112:115], v[200:203], v[8:11], v[112:115]
  ds_read_b128 v[216:219], v242 offset:35840
  v_max3_f32 v253, v253, v107, v100
  v_mfma_f32_16x16x32_bf16 v[120:123], v[200:203], v[12:15], v[120:123]
  s_waitcnt lgkmcnt(2)
  v_max3_f32 v253, v253, v101, v102
  v_max3_f32 v253, v253, v103, v108
  v_mfma_f32_16x16x32_bf16 v[112:115], v[204:207], v[16:19], v[112:115]
  ds_read_b128 v[200:203], v241 offset:44032
  v_max3_f32 v253, v253, v109, v110
  v_mfma_f32_16x16x32_bf16 v[120:123], v[204:207], v[20:23], v[120:123]
  v_mfma_f32_16x16x32_bf16 v[112:115], v[208:211], v[24:27], v[112:115]
  ds_read_b128 v[204:207], v242 offset:44032
  v_mfma_f32_16x16x32_bf16 v[120:123], v[208:211], v[28:31], v[120:123]
  s_waitcnt lgkmcnt(2)
  v_mfma_f32_16x16x32_bf16 v[116:119], v[212:215], v[0:3], v[192:195]
  s_waitcnt vmcnt(18)
  s_barrier
  ds_read_b64_tr_b16 v[208:209], v249 offset:16384
  v_mfma_f32_16x16x32_bf16 v[124:127], v[212:215], v[4:7], v[196:199]
  ds_read_b64_tr_b16 v[210:211], v249 offset:18432
  v_mfma_f32_16x16x32_bf16 v[116:119], v[216:219], v[8:11], v[116:119]
  ds_read_b64_tr_b16 v[212:213], v250 offset:16384
  v_max3_f32 v253, v253, v111, v112
  v_mfma_f32_16x16x32_bf16 v[124:127], v[216:219], v[12:15], v[124:127]
  s_waitcnt lgkmcnt(3)
  ds_read_b64_tr_b16 v[214:215], v250 offset:18432
  v_max3_f32 v253, v253, v113, v114
  v_mfma_f32_16x16x32_bf16 v[116:119], v[200:203], v[16:19], v[116:119]
  ds_read_b64_tr_b16 v[216:217], v249 offset:16640
  v_max3_f32 v253, v253, v115, v120
  v_mfma_f32_16x16x32_bf16 v[124:127], v[200:203], v[20:23], v[124:127]
  ds_read_b64_tr_b16 v[218:219], v249 offset:18688
  v_max3_f32 v253, v253, v121, v122
  v_mfma_f32_16x16x32_bf16 v[116:119], v[204:207], v[24:27], v[116:119]
  ds_read_b64_tr_b16 v[200:201], v250 offset:16640
  v_mfma_f32_16x16x32_bf16 v[124:127], v[204:207], v[28:31], v[124:127]
  s_waitcnt lgkmcnt(3)
  ds_read_b64_tr_b16 v[202:203], v250 offset:18688
  v_mfma_f32_16x16x32_bf16 a[96:99], v[208:211], v[160:163], a[96:99]
  ds_read_b64_tr_b16 v[204:205], v249 offset:20480
  v_mfma_f32_16x16x32_bf16 a[104:107], v[208:211], v[164:167], a[104:107]
  ds_read_b64_tr_b16 v[206:207], v249 offset:22528
  v_mfma_f32_16x16x32_bf16 a[100:103], v[212:215], v[160:163], a[100:103]
  ds_read_b64_tr_b16 v[208:209], v250 offset:20480
  v_max3_f32 v253, v253, v123, v116
  v_mfma_f32_16x16x32_bf16 a[108:111], v[212:215], v[164:167], a[108:111]
  s_waitcnt lgkmcnt(3)
  ds_read_b64_tr_b16 v[210:211], v250 offset:22528
  v_max3_f32 v253, v253, v117, v118
  v_max3_f32 v253, v253, v119, v124
  v_mfma_f32_16x16x32_bf16 a[112:115], v[216:219], v[160:163], a[112:115]
  ds_read_b64_tr_b16 v[212:213], v249 offset:20736
  v_max3_f32 v253, v253, v125, v126
  v_mfma_f32_16x16x32_bf16 a[120:123], v[216:219], v[164:167], a[120:123]
  ds_read_b64_tr_b16 v[214:215], v249 offset:22784
  v_max_f32 v253, v253, v127
  v_cmp_lt_f32 vcc, 0x41200000, v253
  v_mfma_f32_16x16x32_bf16 a[116:119], v[200:203], v[160:163], a[116:119]
  s_cbranch_vccnz L_r3_4t
L_r3_4:
  ds_read_b64_tr_b16 v[216:217], v250 offset:20736
  ds_read_b64_tr_b16 v[218:219], v250 offset:22784
  v_mfma_f32_16x16x32_bf16 a[124:127], v[200:203], v[164:167], a[124:127]
  s_waitcnt lgkmcnt(4)
  v_exp_f32 v96, v96
  v_mfma_f32_16x16x32_bf16 a[96:99], v[204:207], v[168:171], a[96:99]
  ds_read_b64_tr_b16 v[200:201], v249 offset:24576
  ds_read_b64_tr_b16 v[202:203], v249 offset:26624
  v_mfma_f32_16x16x32_bf16 a[104:107], v[204:207], v[172:175], a[104:107]
  v_exp_f32 v97, v97
  v_mfma_f32_16x16x32_bf16 a[100:103], v[208:211], v[168:171], a[100:103]
  ds_read_b64_tr_b16 v[204:205], v250 offset:24576
  v_cvt_pk_bf16_f32 v96, v96, v97
  v_mfma_f32_16x16x32_bf16 a[108:111], v[208:211], v[172:175], a[108:111]
  s_waitcnt lgkmcnt(3)
  ds_read_b64_tr_b16 v[206:207], v250 offset:26624
  v_exp_f32 v98, v98
  v_mfma_f32_16x16x32_bf16 a[112:115], v[212:215], v[168:171], a[112:115]
  ds_read_b64_tr_b16 v[208:209], v249 offset:24832
  ds_read_b64_tr_b16 v[210:211], v249 offset:26880
  v_mfma_f32_16x16x32_bf16 a[120:123], v[212:215], v[172:175], a[120:123]
  v_exp_f32 v99, v99
  v_mfma_f32_16x16x32_bf16 a[116:119], v[216:219], v[168:171], a[116:119]
  ds_read_b64_tr_b16 v[212:213], v250 offset:24832
  v_cvt_pk_bf16_f32 v97, v98, v99
  v_mfma_f32_16x16x32_bf16 a[124:127], v[216:219], v[172:175], a[124:127]
  s_waitcnt lgkmcnt(3)
  ds_read_b64_tr_b16 v[214:215], v250 offset:26880
  v_exp_f32 v100, v100
  v_mfma_f32_16x16x32_bf16 a[96:99], v[200:203], v[176:179], a[96:99]
  ds_read_b64_tr_b16 v[216:217], v249 offset:28672
  ds_read_b64_tr_b16 v[218:219], v249 offset:30720
  v_mfma_f32_16x16x32_bf16 a[104:107], v[200:203], v[180:183], a[104:107]
  v_exp_f32 v101, v101
  v_mfma_f32_16x16x32_bf16 a[100:103], v[204:207], v[176:179], a[100:103]
  ds_read_b64_tr_b16 v[200:201], v250 offset:28672
  v_cvt_pk_bf16_f32 v98, v100, v101
  v_mfma_f32_16x16x32_bf16 a[108:111], v[204:207], v[180:183], a[108:111]
  s_waitcnt lgkmcnt(3)
  ds_read_b64_tr_b16 v[202:203], v250 offset:30720
  v_exp_f32 v102, v102
  v_mfma_f32_16x16x32_bf16 a[112:115], v[208:211], v[176:179], a[112:115]
  ds_read_b64_tr_b16 v[204:205], v249 offset:28928
  ds_read_b64_tr_b16 v[206:207], v249 offset:30976
  v_mfma_f32_16x16x32_bf16 a[120:123], v[208:211], v[180:183], a[120:123]
  v_exp_f32 v103, v103
  v_mfma_f32_16x16x32_bf16 a[116:119], v[212:215], v[176:179], a[116:119]
  ds_read_b64_tr_b16 v[208:209], v250 offset:28928
  v_cvt_pk_bf16_f32 v99, v102, v103
  v_mfma_f32_16x16x32_bf16 a[124:127], v[212:215], v[180:183], a[124:127]
  s_waitcnt lgkmcnt(3)
  ds_read_b64_tr_b16 v[210:211], v250 offset:30976
  v_exp_f32 v104, v104
  v_mfma_f32_16x16x32_bf16 v[224:227], v[220:223], v[96:99], v[224:227]
  v_exp_f32 v105, v105
  v_mfma_f32_16x16x32_bf16 a[96:99], v[216:219], v[184:187], a[96:99]
  s_waitcnt vmcnt(6)
  s_barrier
  ds_read_b64_tr_b16 v[212:213], v245 offset:32768
  ds_read_b64_tr_b16 v[214:215], v245 offset:33792
  v_mfma_f32_16x16x32_bf16 a[104:107], v[216:219], v[188:191], a[104:107]
  buffer_load_dwordx4 v240, s[56:59], s77 offen offset:2048 lds
  v_cvt_pk_bf16_f32 v100, v104, v105
  v_mfma_f32_16x16x32_bf16 a[100:103], v[200:203], v[184:187], a[100:103]
  ds_read_b64_tr_b16 v[216:217], v246 offset:32768
  ds_read_b64_tr_b16 v[218:219], v246 offset:33792
  v_mfma_f32_16x16x32_bf16 a[108:111], v[200:203], v[188:191], a[108:111]
  s_waitcnt lgkmcnt(4)
  v_exp_f32 v106, v106
  v_mfma_f32_16x16x32_bf16 a[112:115], v[204:207], v[184:187], a[112:115]
  ds_read_b64_tr_b16 v[200:201], v245 offset:33024
  ds_read_b64_tr_b16 v[202:203], v245 offset:34048
  v_mfma_f32_16x16x32_bf16 a[120:123], v[204:207], v[188:191], a[120:123]
  buffer_load_dwordx4 v240, s[60:63], s77 offen offset:3072 lds
  v_exp_f32 v107, v107
  v_exp_f32 v108, v108
  v_cvt_pk_bf16_f32 v101, v106, v107
  v_exp_f32 v109, v109
  v_exp_f32 v110, v110
  v_cvt_pk_bf16_f32 v102, v108, v109
  v_exp_f32 v111, v111
  v_exp_f32 v112, v112
  v_cvt_pk_bf16_f32 v103, v110, v111
  v_mfma_f32_16x16x32_bf16 a[116:119], v[208:211], v[184:187], a[116:119]
  ds_read_b64_tr_b16 v[204:205], v246 offset:33024
  ds_read_b64_tr_b16 v[206:207], v246 offset:34048
  v_mfma_f32_16x16x32_bf16 a[124:127], v[208:211], v[188:191], a[124:127]
  s_waitcnt lgkmcnt(4)
  v_exp_f32 v113, v113
  v_mfma_f32_16x16x32_bf16 v[228:231], v[220:223], v[100:103], v[228:231]
  v_cvt_pk_bf16_f32 v104, v112, v113
  v_mfma_f32_16x16x32_bf16 v[32:35], v[212:215], v[96:99], v[32:35]
  s_add_u32 m0, s68, 81920
  ds_read_b64_tr_b16 v[208:209], v245 offset:33280
  ds_read_b64_tr_b16 v[210:211], v245 offset:34304
  v_mfma_f32_16x16x32_bf16 v[40:43], v[212:215], v[100:103], v[40:43]
  buffer_load_dwordx4 v237, s[12:15], s93 offen nt lds
  v_mfma_f32_16x16x32_bf16 v[36:39], v[216:219], v[96:99], v[36:39]
  ds_read_b64_tr_b16 v[212:213], v246 offset:33280
  ds_read_b64_tr_b16 v[214:215], v246 offset:34304
  v_mfma_f32_16x16x32_bf16 v[44:47], v[216:219], v[100:103], v[44:47]
  s_waitcnt lgkmcnt(4)
  v_exp_f32 v114, v114
  v_mfma_f32_16x16x32_bf16 v[48:51], v[200:203], v[96:99], v[48:51]
  ds_read_b64_tr_b16 v[216:217], v245 offset:33536
  ds_read_b64_tr_b16 v[218:219], v245 offset:34560
  v_mfma_f32_16x16x32_bf16 v[56:59], v[200:203], v[100:103], v[56:59]
  buffer_load_dwordx4 v237, s[12:15], s93 offen offset:1024 nt lds
  v_mfma_f32_16x16x32_bf16 v[52:55], v[204:207], v[96:99], v[52:55]
  ds_read_b64_tr_b16 v[200:201], v246 offset:33536
  ds_read_b64_tr_b16 v[202:203], v246 offset:34560
  v_mfma_f32_16x16x32_bf16 v[60:63], v[204:207], v[100:103], v[60:63]
  s_waitcnt lgkmcnt(4)
  v_exp_f32 v115, v115
  v_mfma_f32_16x16x32_bf16 v[64:67], v[208:211], v[96:99], v[64:67]
  ds_read_b64_tr_b16 v[204:205], v245 offset:34816
  ds_read_b64_tr_b16 v[206:207], v245 offset:35840
  v_mfma_f32_16x16x32_bf16 v[72:75], v[208:211], v[100:103], v[72:75]
  buffer_load_dwordx4 v237, s[12:15], s93 offen offset:2048 nt lds
  v_cvt_pk_bf16_f32 v105, v114, v115
  v_mfma_f32_16x16x32_bf16 v[68:71], v[212:215], v[96:99], v[68:71]
  ds_read_b64_tr_b16 v[208:209], v246 offset:34816
  ds_read_b64_tr_b16 v[210:211], v246 offset:35840
  v_mfma_f32_16x16x32_bf16 v[76:79], v[212:215], v[100:103], v[76:79]
  s_waitcnt lgkmcnt(4)
  v_exp_f32 v116, v116
  v_mfma_f32_16x16x32_bf16 v[80:83], v[216:219], v[96:99], v[80:83]
  ds_read_b64_tr_b16 v[212:213], v245 offset:35072
  ds_read_b64_tr_b16 v[214:215], v245 offset:36096
  v_mfma_f32_16x16x32_bf16 v[88:91], v[216:219], v[100:103], v[88:91]
  buffer_load_dwordx4 v237, s[12:15], s93 offen offset:3072 nt lds
  v_exp_f32 v117, v117
  v_exp_f32 v118, v118
  v_cvt_pk_bf16_f32 v106, v116, v117
  v_exp_f32 v119, v119
  v_exp_f32 v120, v120
  v_cvt_pk_bf16_f32 v107, v118, v119
  v_exp_f32 v121, v121
  v_exp_f32 v122, v122
  v_cvt_pk_bf16_f32 v108, v120, v121
  v_exp_f32 v123, v123
  v_exp_f32 v124, v124
  v_cvt_pk_bf16_f32 v109, v122, v123
  v_exp_f32 v125, v125
  v_exp_f32 v126, v126
  v_cvt_pk_bf16_f32 v110, v124, v125
  v_exp_f32 v127, v127
  s_nop 0
  v_cvt_pk_bf16_f32 v111, v126, v127
  v_mfma_f32_16x16x32_bf16 v[84:87], v[200:203], v[96:99], v[84:87]
  ds_read_b64_tr_b16 v[216:217], v246 offset:35072
  v_mfma_f32_16x16x32_bf16 v[92:95], v[200:203], v[100:103], v[92:95]
  s_waitcnt lgkmcnt(3)
  ds_read_b64_tr_b16 v[218:219], v246 offset:36096
  v_mfma_f32_16x16x32_bf16 v[32:35], v[204:207], v[104:107], v[32:35]
  s_add_u32 m0, s68, 0
  ds_read_b64_tr_b16 v[200:201], v245 offset:35328
  ds_read_b64_tr_b16 v[202:203], v245 offset:36352
  v_mfma_f32_16x16x32_bf16 v[40:43], v[204:207], v[108:111], v[40:43]
  buffer_load_dwordx4 v236, s[8:11], s94 offen nt lds
  v_mfma_f32_16x16x32_bf16 v[36:39], v[208:211], v[104:107], v[36:39]
  ds_read_b64_tr_b16 v[204:205], v246 offset:35328
  v_mfma_f32_16x16x32_bf16 v[44:47], v[208:211], v[108:111], v[44:47]
  s_waitcnt lgkmcnt(3)
  ds_read_b64_tr_b16 v[206:207], v246 offset:36352
  v_mfma_f32_16x16x32_bf16 v[48:51], v[212:215], v[104:107], v[48:51]
  ds_read_b64_tr_b16 v[208:209], v245 offset:35584
  v_mfma_f32_16x16x32_bf16 v[56:59], v[212:215], v[108:111], v[56:59]
  ds_read_b64_tr_b16 v[210:211], v245 offset:36608
  v_mfma_f32_16x16x32_bf16 v[52:55], v[216:219], v[104:107], v[52:55]
  ds_read_b64_tr_b16 v[212:213], v246 offset:35584
  v_mfma_f32_16x16x32_bf16 v[60:63], v[216:219], v[108:111], v[60:63]
  s_waitcnt lgkmcnt(3)
  ds_read_b64_tr_b16 v[214:215], v246 offset:36608
  v_mfma_f32_16x16x32_bf16 v[64:67], v[200:203], v[104:107], v[64:67]
  s_waitcnt vmcnt(9)
  s_barrier
  ds_read_b128 v[216:219], v241 offset:49152
  v_mfma_f32_16x16x32_bf16 v[72:75], v[200:203], v[108:111], v[72:75]
  buffer_load_dwordx4 v236, s[8:11], s94 offen offset:1024 nt lds
  v_mfma_f32_16x16x32_bf16 v[224:227], v[220:223], v[104:107], v[224:227]
  v_mfma_f32_16x16x32_bf16 v[68:71], v[204:207], v[104:107], v[68:71]
  ds_read_b128 v[200:203], v242 offset:49152
  v_mfma_f32_16x16x32_bf16 v[76:79], v[204:207], v[108:111], v[76:79]
  s_waitcnt lgkmcnt(2)
  v_mfma_f32_16x16x32_bf16 v[228:231], v[220:223], v[108:111], v[228:231]
  v_mfma_f32_16x16x32_bf16 v[80:83], v[208:211], v[104:107], v[80:83]
  ds_read_b128 v[204:207], v241 offset:57344
  v_mfma_f32_16x16x32_bf16 v[88:91], v[208:211], v[108:111], v[88:91]
  buffer_load_dwordx4 v236, s[8:11], s94 offen offset:2048 nt lds
  v_mfma_f32_16x16x32_bf16 v[84:87], v[212:215], v[104:107], v[84:87]
  ds_read_b128 v[208:211], v242 offset:57344
  v_mfma_f32_16x16x32_bf16 v[92:95], v[212:215], v[108:111], v[92:95]
  s_waitcnt lgkmcnt(2)
  v_mfma_f32_16x16x32_bf16 v[96:99], v[216:219], v[0:3], v[192:195]
  ds_read_b128 v[212:215], v241 offset:50176
  v_mfma_f32_16x16x32_bf16 v[104:107], v[216:219], v[4:7], v[196:199]
  buffer_load_dwordx4 v236, s[8:11], s94 offen offset:3072 nt lds
  v_mfma_f32_16x16x32_bf16 v[96:99], v[200:203], v[8:11], v[96:99]
  ds_read_b128 v[216:219], v242 offset:50176
  v_mfma_f32_16x16x32_bf16 v[104:107], v[200:203], v[12:15], v[104:107]
  s_waitcnt lgkmcnt(2)
  v_mfma_f32_16x16x32_bf16 v[96:99], v[204:207], v[16:19], v[96:99]
  s_add_u32 m0, s68, 114688
  ds_read_b128 v[200:203], v241 offset:58368
  v_mfma_f32_16x16x32_bf16 v[104:107], v[204:207], v[20:23], v[104:107]
  buffer_load_dwordx4 v240, s[48:51], s78 offen lds
  v_mfma_f32_16x16x32_bf16 v[96:99], v[208:211], v[24:27], v[96:99]
  ds_read_b128 v[204:207], v242 offset:58368
  v_mfma_f32_16x16x32_bf16 v[104:107], v[208:211], v[28:31], v[104:107]
  s_waitcnt lgkmcnt(2)
  v_mfma_f32_16x16x32_bf16 v[100:103], v[212:215], v[0:3], v[192:195]
  ds_read_b128 v[208:211], v241 offset:51200
  v_mfma_f32_16x16x32_bf16 v[108:111], v[212:215], v[4:7], v[196:199]
  buffer_load_dwordx4 v240, s[52:55], s78 offen offset:1024 lds
  v_mfma_f32_16x16x32_bf16 v[100:103], v[216:219], v[8:11], v[100:103]
  ds_read_b128 v[212:215], v242 offset:51200
  v_max3_f32 v253, v96, v97, v98
  v_mfma_f32_16x16x32_bf16 v[108:111], v[216:219], v[12:15], v[108:111]
  s_waitcnt lgkmcnt(2)
  v_max3_f32 v253, v253, v99, v104
  v_max3_f32 v253, v253, v105, v106
  v_mfma_f32_16x16x32_bf16 v[100:103], v[200:203], v[16:19], v[100:103]
  ds_read_b128 v[216:219], v241 offset:59392
  v_mfma_f32_16x16x32_bf16 v[108:111], v[200:203], v[20:23], v[108:111]
  v_mfma_f32_16x16x32_bf16 v[100:103], v[204:207], v[24:27], v[100:103]
  ds_read_b128 v[200:203], v242 offset:59392
  v_mfma_f32_16x16x32_bf16 v[108:111], v[204:207], v[28:31], v[108:111]
  s_waitcnt lgkmcnt(2)
  v_mfma_f32_16x16x32_bf16 v[112:115], v[208:211], v[0:3], v[192:195]
  ds_read_b128 v[204:207], v241 offset:52224
  v_mfma_f32_16x16x32_bf16 v[120:123], v[208:211], v[4:7], v[196:199]
  buffer_load_dwordx4 v240, s[56:59], s78 offen offset:2048 lds
  v_mfma_f32_16x16x32_bf16 v[112:115], v[212:215], v[8:11], v[112:115]
  ds_read_b128 v[208:211], v242 offset:52224
  v_max3_f32 v253, v253, v107, v100
  v_mfma_f32_16x16x32_bf16 v[120:123], v[212:215], v[12:15], v[120:123]
  s_waitcnt lgkmcnt(2)
  v_max3_f32 v253, v253, v101, v102
  v_max3_f32 v253, v253, v103, v108
  v_mfma_f32_16x16x32_bf16 v[112:115], v[216:219], v[16:19], v[112:115]
  ds_read_b128 v[212:215], v241 offset:60416
  v_max3_f32 v253, v253, v109, v110
  v_mfma_f32_16x16x32_bf16 v[120:123], v[216:219], v[20:23], v[120:123]
  v_mfma_f32_16x16x32_bf16 v[112:115], v[200:203], v[24:27], v[112:115]
  ds_read_b128 v[216:219], v242 offset:60416
  v_mfma_f32_16x16x32_bf16 v[120:123], v[200:203], v[28:31], v[120:123]
  s_waitcnt lgkmcnt(2)
  buffer_load_dwordx4 v240, s[60:63], s78 offen offset:3072 lds
  v_add_u32 v240, 262144, v240
  v_mfma_f32_16x16x32_bf16 v[116:119], v[204:207], v[0:3], v[192:195]
  s_waitcnt vmcnt(24)
  s_barrier
  ds_read_b64_tr_b16 v[200:201], v249 offset:32768
  v_mfma_f32_16x16x32_bf16 v[124:127], v[204:207], v[4:7], v[196:199]
  ds_read_b64_tr_b16 v[202:203], v249 offset:34816
  v_mfma_f32_16x16x32_bf16 v[116:119], v[208:211], v[8:11], v[116:119]
  ds_read_b64_tr_b16 v[204:205], v250 offset:32768
  v_max3_f32 v253, v253, v111, v112
  v_mfma_f32_16x16x32_bf16 v[124:127], v[208:211], v[12:15], v[124:127]
  s_waitcnt lgkmcnt(3)
  ds_read_b64_tr_b16 v[206:207], v250 offset:34816
  v_max3_f32 v253, v253, v113, v114
  v_mfma_f32_16x16x32_bf16 v[116:119], v[212:215], v[16:19], v[116:119]
  ds_read_b64_tr_b16 v[208:209], v249 offset:33024
  v_max3_f32 v253, v253, v115, v120
  v_mfma_f32_16x16x32_bf16 v[124:127], v[212:215], v[20:23], v[124:127]
  ds_read_b64_tr_b16 v[210:211], v249 offset:35072
  v_max3_f32 v253, v253, v121, v122
  v_mfma_f32_16x16x32_bf16 v[116:119], v[216:219], v[24:27], v[116:119]
  ds_read_b64_tr_b16 v[212:213], v250 offset:33024
  v_mfma_f32_16x16x32_bf16 v[124:127], v[216:219], v[28:31], v[124:127]
  s_waitcnt lgkmcnt(3)
  ds_read_b64_tr_b16 v[214:215], v250 offset:35072
  v_mfma_f32_16x16x32_bf16 a[128:131], v[200:203], v[160:163], a[128:131]
  ds_read_b64_tr_b16 v[216:217], v249 offset:36864
  v_mfma_f32_16x16x32_bf16 a[136:139], v[200:203], v[164:167], a[136:139]
  ds_read_b64_tr_b16 v[218:219], v249 offset:38912
  v_mfma_f32_16x16x32_bf16 a[132:135], v[204:207], v[160:163], a[132:135]
  ds_read_b64_tr_b16 v[200:201], v250 offset:36864
  v_max3_f32 v253, v253, v123, v116
  v_mfma_f32_16x16x32_bf16 a[140:143], v[204:207], v[164:167], a[140:143]
  s_waitcnt lgkmcnt(3)
  ds_read_b64_tr_b16 v[202:203], v250 offset:38912
  v_max3_f32 v253, v253, v117, v118
  v_max3_f32 v253, v253, v119, v124
  v_mfma_f32_16x16x32_bf16 a[144:147], v[208:211], v[160:163], a[144:147]
  ds_read_b64_tr_b16 v[204:205], v249 offset:37120
  v_max3_f32 v253, v253, v125, v126
  v_mfma_f32_16x16x32_bf16 a[152:155], v[208:211], v[164:167], a[152:155]
  ds_read_b64_tr_b16 v[206:207], v249 offset:39168
  v_max_f32 v253, v253, v127
  v_cmp_lt_f32 vcc, 0x41200000, v253
  v_mfma_f32_16x16x32_bf16 a[148:151], v[212:215], v[160:163], a[148:151]
  s_cbranch_vccnz L_r3_5t
L_r3_5:
  ds_read_b64_tr_b16 v[208:209], v250 offset:37120
  ds_read_b64_tr_b16 v[210:211], v250 offset:39168
  v_mfma_f32_16x16x32_bf16 a[156:159], v[212:215], v[164:167], a[156:159]
  s_waitcnt lgkmcnt(4)
  v_exp_f32 v96, v96
  v_mfma_f32_16x16x32_bf16 a[128:131], v[216:219], v[168:171], a[128:131]
  ds_read_b64_tr_b16 v[212:213], v249 offset:40960
  ds_read_b64_tr_b16 v[214:215], v249 offset:43008
  v_mfma_f32_16x16x32_bf16 a[136:139], v[216:219], v[172:175], a[136:139]
  v_exp_f32 v97, v97
  v_mfma_f32_16x16x32_bf16 a[132:135], v[200:203], v[168:171], a[132:135]
  ds_read_b64_tr_b16 v[216:217], v250 offset:40960
  v_cvt_pk_bf16_f32 v96, v96, v97
  v_mfma_f32_16x16x32_bf16 a[140:143], v[200:203], v[172:175], a[140:143]
  s_waitcnt lgkmcnt(3)
  ds_read_b64_tr_b16 v[218:219], v250 offset:43008
  v_exp_f32 v98, v98
  v_mfma_f32_16x16x32_bf16 a[144:147], v[204:207], v[168:171], a[144:147]
  ds_read_b64_tr_b16 v[200:201], v249 offset:41216
  ds_read_b64_tr_b16 v[202:203], v249 offset:43264
  v_mfma_f32_16x16x32_bf16 a[152:155], v[204:207], v[172:175], a[152:155]
  v_exp_f32 v99, v99
  v_mfma_f32_16x16x32_bf16 a[148:151], v[208:211], v[168:171], a[148:151]
  ds_read_b64_tr_b16 v[204:205], v250 offset:41216
  v_cvt_pk_bf16_f32 v97, v98, v99
  v_mfma_f32_16x16x32_bf16 a[156:159], v[208:211], v[172:175], a[156:159]
  s_waitcnt lgkmcnt(3)
  ds_read_b64_tr_b16 v[206:207], v250 offset:43264
  v_exp_f32 v100, v100
  v_mfma_f32_16x16x32_bf16 a[128:131], v[212:215], v[176:179], a[128:131]
  ds_read_b64_tr_b16 v[208:209], v249 offset:45056
  ds_read_b64_tr_b16 v[210:211], v249 offset:47104
  v_mfma_f32_16x16x32_bf16 a[136:139], v[212:215], v[180:183], a[136:139]
  v_exp_f32 v101, v101
  v_mfma_f32_16x16x32_bf16 a[132:135], v[216:219], v[176:179], a[132:135]
  ds_read_b64_tr_b16 v[212:213], v250 offset:45056
  v_cvt_pk_bf16_f32 v98, v100, v101
  v_mfma_f32_16x16x32_bf16 a[140:143], v[216:219], v[180:183], a[140:143]
  s_waitcnt lgkmcnt(3)
  ds_read_b64_tr_b16 v[214:215], v250 offset:47104
  v_exp_f32 v102, v102
  v_mfma_f32_16x16x32_bf16 a[144:147], v[200:203], v[176:179], a[144:147]
  ds_read_b64_tr_b16 v[216:217], v249 offset:45312
  ds_read_b64_tr_b16 v[218:219], v249 offset:47360
  v_mfma_f32_16x16x32_bf16 a[152:155], v[200:203], v[180:183], a[152:155]
  v_exp_f32 v103, v103
  v_mfma_f32_16x16x32_bf16 a[148:151], v[204:207], v[176:179], a[148:151]
  ds_read_b64_tr_b16 v[200:201], v250 offset:45312
  v_cvt_pk_bf16_f32 v99, v102, v103
  v_mfma_f32_16x16x32_bf16 a[156:159], v[204:207], v[180:183], a[156:159]
  s_waitcnt lgkmcnt(3)
  ds_read_b64_tr_b16 v[202:203], v250 offset:47360
  v_exp_f32 v104, v104
  v_mfma_f32_16x16x32_bf16 v[224:227], v[220:223], v[96:99], v[224:227]
  v_exp_f32 v105, v105
  v_mfma_f32_16x16x32_bf16 a[128:131], v[208:211], v[184:187], a[128:131]
  s_waitcnt vmcnt(8)
  s_barrier
  s_add_u32 m0, s68, 65536
  ds_read_b64_tr_b16 v[204:205], v245 offset:16384
  ds_read_b64_tr_b16 v[206:207], v245 offset:17408
  v_mfma_f32_16x16x32_bf16 a[136:139], v[208:211], v[188:191], a[136:139]
  buffer_load_dwordx4 v237, s[12:15], s94 offen nt lds
  v_cvt_pk_bf16_f32 v100, v104, v105
  v_mfma_f32_16x16x32_bf16 a[132:135], v[212:215], v[184:187], a[132:135]
  ds_read_b64_tr_b16 v[208:209], v246 offset:16384
  ds_read_b64_tr_b16 v[210:211], v246 offset:17408
  v_mfma_f32_16x16x32_bf16 a[140:143], v[212:215], v[188:191], a[140:143]
  s_waitcnt lgkmcnt(4)
  v_exp_f32 v106, v106
  v_mfma_f32_16x16x32_bf16 a[144:147], v[216:219], v[184:187], a[144:147]
  ds_read_b64_tr_b16 v[212:213], v245 offset:16640
  ds_read_b64_tr_b16 v[214:215], v245 offset:17664
  v_mfma_f32_16x16x32_bf16 a[152:155], v[216:219], v[188:191], a[152:155]
  buffer_load_dwordx4 v237, s[12:15], s94 offen offset:1024 nt lds
  v_exp_f32 v107, v107
  v_exp_f32 v108, v108
  v_cvt_pk_bf16_f32 v101, v106, v107
  v_exp_f32 v109, v109
  v_exp_f32 v110, v110
  v_cvt_pk_bf16_f32 v102, v108, v109
  v_exp_f32 v111, v111
  v_exp_f32 v112, v112
  v_cvt_pk_bf16_f32 v103, v110, v111
  v_mfma_f32_16x16x32_bf16 a[148:151], v[200:203], v[184:187], a[148:151]
  ds_read_b64_tr_b16 v[216:217], v246 offset:16640
  ds_read_b64_tr_b16 v[218:219], v246 offset:17664
  v_mfma_f32_16x16x32_bf16 a[156:159], v[200:203], v[188:191], a[156:159]
  s_waitcnt lgkmcnt(4)
  v_exp_f32 v113, v113
  v_mfma_f32_16x16x32_bf16 v[228:231], v[220:223], v[100:103], v[228:231]
  v_cvt_pk_bf16_f32 v104, v112, v113
  v_mfma_f32_16x16x32_bf16 v[32:35], v[204:207], v[96:99], v[32:35]
  ds_read_b64_tr_b16 v[200:201], v245 offset:16896
  ds_read_b64_tr_b16 v[202:203], v245 offset:17920
  v_mfma_f32_16x16x32_bf16 v[40:43], v[204:207], v[100:103], v[40:43]
  buffer_load_dwordx4 v237, s[12:15], s94 offen offset:2048 nt lds
  v_mfma_f32_16x16x32_bf16 v[36:39], v[208:211], v[96:99], v[36:39]
  ds_read_b64_tr_b16 v[204:205], v246 offset:16896
  ds_read_b64_tr_b16 v[206:207], v246 offset:17920
  v_mfma_f32_16x16x32_bf16 v[44:47], v[208:211], v[100:103], v[44:47]
  s_waitcnt lgkmcnt(4)
  v_exp_f32 v114, v114
  v_mfma_f32_16x16x32_bf16 v[48:51], v[212:215], v[96:99], v[48:51]
  ds_read_b64_tr_b16 v[208:209], v245 offset:17152
  ds_read_b64_tr_b16 v[210:211], v245 offset:18176
  v_mfma_f32_16x16x32_bf16 v[56:59], v[212:215], v[100:103], v[56:59]
  buffer_load_dwordx4 v237, s[12:15], s94 offen offset:3072 nt lds
  v_mfma_f32_16x16x32_bf16 v[52:55], v[216:219], v[96:99], v[52:55]
  ds_read_b64_tr_b16 v[212:213], v246 offset:17152
  ds_read_b64_tr_b16 v[214:215], v246 offset:18176
  v_mfma_f32_16x16x32_bf16 v[60:63], v[216:219], v[100:103], v[60:63]
  s_waitcnt lgkmcnt(4)
  v_exp_f32 v115, v115
  v_mfma_f32_16x16x32_bf16 v[64:67], v[200:203], v[96:99], v[64:67]
  s_add_u32 m0, s68, 16384
  ds_read_b64_tr_b16 v[216:217], v245 offset:18432
  ds_read_b64_tr_b16 v[218:219], v245 offset:19456
  v_mfma_f32_16x16x32_bf16 v[72:75], v[200:203], v[100:103], v[72:75]
  buffer_load_dwordx4 v236, s[8:11], s95 offen nt lds
  v_cvt_pk_bf16_f32 v105, v114, v115
  v_mfma_f32_16x16x32_bf16 v[68:71], v[204:207], v[96:99], v[68:71]
  ds_read_b64_tr_b16 v[200:201], v246 offset:18432
  ds_read_b64_tr_b16 v[202:203], v246 offset:19456
  v_mfma_f32_16x16x32_bf16 v[76:79], v[204:207], v[100:103], v[76:79]
  s_waitcnt lgkmcnt(4)
  v_exp_f32 v116, v116
  v_mfma_f32_16x16x32_bf16 v[80:83], v[208:211], v[96:99], v[80:83]
  ds_read_b64_tr_b16 v[204:205], v245 offset:18688
  ds_read_b64_tr_b16 v[206:207], v245 offset:19712
  v_mfma_f32_16x16x32_bf16 v[88:91], v[208:211], v[100:103], v[88:91]
  buffer_load_dwordx4 v236, s[8:11], s95 offen offset:1024 nt lds
  v_exp_f32 v117, v117
  v_exp_f32 v118, v118
  v_cvt_pk_bf16_f32 v106, v116, v117
  v_exp_f32 v119, v119
  v_exp_f32 v120, v120
  v_cvt_pk_bf16_f32 v107, v118, v119
  v_exp_f32 v121, v121
  v_exp_f32 v122, v122
  v_cvt_pk_bf16_f32 v108, v120, v121
  v_exp_f32 v123, v123
  v_exp_f32 v124, v124
  v_cvt_pk_bf16_f32 v109, v122, v123
  v_exp_f32 v125, v125
  v_exp_f32 v126, v126
  v_cvt_pk_bf16_f32 v110, v124, v125
  v_exp_f32 v127, v127
  s_nop 0
  v_cvt_pk_bf16_f32 v111, v126, v127
  v_mfma_f32_16x16x32_bf16 v[84:87], v[212:215], v[96:99], v[84:87]
  ds_read_b64_tr_b16 v[208:209], v246 offset:18688
  v_mfma_f32_16x16x32_bf16 v[92:95], v[212:215], v[100:103], v[92:95]
  s_waitcnt lgkmcnt(3)
  ds_read_b64_tr_b16 v[210:211], v246 offset:19712
  v_mfma_f32_16x16x32_bf16 v[32:35], v[216:219], v[104:107], v[32:35]
  ds_read_b64_tr_b16 v[212:213], v245 offset:18944
  ds_read_b64_tr_b16 v[214:215], v245 offset:19968
  v_mfma_f32_16x16x32_bf16 v[40:43], v[216:219], v[108:111], v[40:43]
  buffer_load_dwordx4 v236, s[8:11], s95 offen offset:2048 nt lds
  v_mfma_f32_16x16x32_bf16 v[36:39], v[200:203], v[104:107], v[36:39]
  ds_read_b64_tr_b16 v[216:217], v246 offset:18944
  v_mfma_f32_16x16x32_bf16 v[44:47], v[200:203], v[108:111], v[44:47]
  s_waitcnt lgkmcnt(3)
  ds_read_b64_tr_b16 v[218:219], v246 offset:19968
  v_mfma_f32_16x16x32_bf16 v[48:51], v[204:207], v[104:107], v[48:51]
  ds_read_b64_tr_b16 v[200:201], v245 offset:19200
  ds_read_b64_tr_b16 v[202:203], v245 offset:20224
  v_mfma_f32_16x16x32_bf16 v[56:59], v[204:207], v[108:111], v[56:59]
  buffer_load_dwordx4 v236, s[8:11], s95 offen offset:3072 nt lds
  v_mfma_f32_16x16x32_bf16 v[52:55], v[208:211], v[104:107], v[52:55]
  ds_read_b64_tr_b16 v[204:205], v246 offset:19200
  v_mfma_f32_16x16x32_bf16 v[60:63], v[208:211], v[108:111], v[60:63]
  s_waitcnt lgkmcnt(3)
  ds_read_b64_tr_b16 v[206:207], v246 offset:20224
  v_mfma_f32_16x16x32_bf16 v[64:67], v[212:215], v[104:107], v[64:67]
  s_waitcnt vmcnt(12)
  s_barrier
  s_add_u32 m0, s68, 32768
  ds_read_b128 v[208:211], v241 offset:0
  v_mfma_f32_16x16x32_bf16 v[72:75], v[212:215], v[108:111], v[72:75]
  buffer_load_dwordx4 v240, s[48:51], s72 offen lds
  v_readfirstlane_b32 s69, v239
  s_nop 0
  s_cmp_lt_u32 s69, 32
  s_cbranch_scc1 L_hs_slow
L_hs_ok:
  v_mfma_f32_16x16x32_bf16 v[224:227], v[220:223], v[104:107], v[224:227]
  v_mfma_f32_16x16x32_bf16 v[68:71], v[216:219], v[104:107], v[68:71]
  ds_read_b128 v[212:215], v242 offset:0
  v_mfma_f32_16x16x32_bf16 v[76:79], v[216:219], v[108:111], v[76:79]
  s_waitcnt lgkmcnt(2)
  v_mfma_f32_16x16x32_bf16 v[228:231], v[220:223], v[108:111], v[228:231]
  v_mfma_f32_16x16x32_bf16 v[80:83], v[200:203], v[104:107], v[80:83]
  ds_read_b128 v[216:219], v241 offset:8192
  v_mfma_f32_16x16x32_bf16 v[88:91], v[200:203], v[108:111], v[88:91]
  buffer_load_dwordx4 v240, s[52:55], s72 offen offset:1024 lds
  v_mfma_f32_16x16x32_bf16 v[84:87], v[204:207], v[104:107], v[84:87]
  ds_read_b128 v[200:203], v242 offset:8192
  v_mfma_f32_16x16x32_bf16 v[92:95], v[204:207], v[108:111], v[92:95]
  s_waitcnt lgkmcnt(2)
  v_mfma_f32_16x16x32_bf16 v[96:99], v[208:211], v[0:3], v[192:195]
  ds_read_b128 v[204:207], v241 offset:1024
  v_mfma_f32_16x16x32_bf16 v[104:107], v[208:211], v[4:7], v[196:199]
  v_mfma_f32_16x16x32_bf16 v[96:99], v[212:215], v[8:11], v[96:99]
  ds_read_b128 v[208:211], v242 offset:1024
  v_mfma_f32_16x16x32_bf16 v[104:107], v[212:215], v[12:15], v[104:107]
  s_waitcnt lgkmcnt(2)
  v_mfma_f32_16x16x32_bf16 v[96:99], v[216:219], v[16:19], v[96:99]
  ds_read_b128 v[212:215], v241 offset:9216
  v_mfma_f32_16x16x32_bf16 v[104:107], v[216:219], v[20:23], v[104:107]
  v_mfma_f32_16x16x32_bf16 v[96:99], v[200:203], v[24:27], v[96:99]
  ds_read_b128 v[216:219], v242 offset:9216
  v_mfma_f32_16x16x32_bf16 v[104:107], v[200:203], v[28:31], v[104:107]
  s_waitcnt lgkmcnt(2)
  v_mfma_f32_16x16x32_bf16 v[100:103], v[204:207], v[0:3], v[192:195]
  ds_read_b128 v[200:203], v241 offset:2048
  v_mfma_f32_16x16x32_bf16 v[108:111], v[204:207], v[4:7], v[196:199]
  v_mfma_f32_16x16x32_bf16 v[100:103], v[208:211], v[8:11], v[100:103]
  ds_read_b128 v[204:207], v242 offset:2048
  v_max3_f32 v253, v96, v97, v98
  v_mfma_f32_16x16x32_bf16 v[108:111], v[208:211], v[12:15], v[108:111]
  s_waitcnt lgkmcnt(2)
  v_max3_f32 v253, v253, v99, v104
  v_max3_f32 v253, v253, v105, v106
  v_mfma_f32_16x16x32_bf16 v[100:103], v[212:215], v[16:19], v[100:103]
  ds_read_b128 v[208:211], v241 offset:10240
  v_mfma_f32_16x16x32_bf16 v[108:111], v[212:215], v[20:23], v[108:111]
  v_mfma_f32_16x16x32_bf16 v[100:103], v[216:219], v[24:27], v[100:103]
  ds_read_b128 v[212:215], v242 offset:10240
  v_mfma_f32_16x16x32_bf16 v[108:111], v[216:219], v[28:31], v[108:111]
  s_waitcnt lgkmcnt(2)
  v_mfma_f32_16x16x32_bf16 v[112:115], v[200:203], v[0:3], v[192:195]
  ds_read_b128 v[216:219], v241 offset:3072
  v_mfma_f32_16x16x32_bf16 v[120:123], v[200:203], v[4:7], v[196:199]
  v_mfma_f32_16x16x32_bf16 v[112:115], v[204:207], v[8:11], v[112:115]
  ds_read_b128 v[200:203], v242 offset:3072
  v_max3_f32 v253, v253, v107, v100
  v_mfma_f32_16x16x32_bf16 v[120:123], v[204:207], v[12:15], v[120:123]
  s_waitcnt lgkmcnt(2)
  v_max3_f32 v253, v253, v101, v102
  v_max3_f32 v253, v253, v103, v108
  v_mfma_f32_16x16x32_bf16 v[112:115], v[208:211], v[16:19], v[112:115]
  ds_read_b128 v[204:207], v241 offset:11264
  v_max3_f32 v253, v253, v109, v110
  v_mfma_f32_16x16x32_bf16 v[120:123], v[208:211], v[20:23], v[120:123]
  v_mfma_f32_16x16x32_bf16 v[112:115], v[212:215], v[24:27], v[112:115]
  ds_read_b128 v[208:211], v242 offset:11264
  v_mfma_f32_16x16x32_bf16 v[120:123], v[212:215], v[28:31], v[120:123]
  s_waitcnt lgkmcnt(2)
  v_mfma_f32_16x16x32_bf16 v[116:119], v[216:219], v[0:3], v[192:195]
  s_waitcnt vmcnt(22)
  s_barrier
  ds_read_b64_tr_b16 v[212:213], v249 offset:49152
  v_mfma_f32_16x16x32_bf16 v[124:127], v[216:219], v[4:7], v[196:199]
  ds_read_b64_tr_b16 v[214:215], v249 offset:51200
  v_mfma_f32_16x16x32_bf16 v[116:119], v[200:203], v[8:11], v[116:119]
  ds_read_b64_tr_b16 v[216:217], v250 offset:49152
  v_max3_f32 v253, v253, v111, v112
  v_mfma_f32_16x16x32_bf16 v[124:127], v[200:203], v[12:15], v[124:127]
  s_waitcnt lgkmcnt(3)
  ds_read_b64_tr_b16 v[218:219], v250 offset:51200
  v_max3_f32 v253, v253, v113, v114
  v_mfma_f32_16x16x32_bf16 v[116:119], v[204:207], v[16:19], v[116:119]
  ds_read_b64_tr_b16 v[200:201], v249 offset:49408
  ds_read_b64_tr_b16 v[202:203], v249 offset:51456
  v_mfma_f32_16x16x32_bf16 v[124:127], v[204:207], v[20:23], v[124:127]
  buffer_load_dwordx4 v240, s[56:59], s72 offen offset:2048 lds
  v_mfma_f32_16x16x32_bf16 v[116:119], v[208:211], v[24:27], v[116:119]
  ds_read_b64_tr_b16 v[204:205], v250 offset:49408
  v_max3_f32 v253, v253, v115, v120
  v_mfma_f32_16x16x32_bf16 v[124:127], v[208:211], v[28:31], v[124:127]
  s_waitcnt lgkmcnt(3)
  ds_read_b64_tr_b16 v[206:207], v250 offset:51456
  v_max3_f32 v253, v253, v121, v122
  v_mfma_f32_16x16x32_bf16 a[160:163], v[212:215], v[160:163], a[160:163]
  ds_read_b64_tr_b16 v[208:209], v249 offset:53248
  ds_read_b64_tr_b16 v[210:211], v249 offset:55296
  v_mfma_f32_16x16x32_bf16 a[168:171], v[212:215], v[164:167], a[168:171]
  buffer_load_dwordx4 v240, s[60:63], s72 offen offset:3072 lds
  v_mfma_f32_16x16x32_bf16 a[164:167], v[216:219], v[160:163], a[164:167]
  ds_read_b64_tr_b16 v[212:213], v250 offset:53248
  v_max3_f32 v253, v253, v123, v116
  v_mfma_f32_16x16x32_bf16 a[172:175], v[216:219], v[164:167], a[172:175]
  s_waitcnt lgkmcnt(3)
  ds_read_b64_tr_b16 v[214:215], v250 offset:55296
  v_max3_f32 v253, v253, v117, v118
  v_max3_f32 v253, v253, v119, v124
  v_mfma_f32_16x16x32_bf16 a[176:179], v[200:203], v[160:163], a[176:179]
  ds_read_b64_tr_b16 v[216:217], v249 offset:53504
  v_max3_f32 v253, v253, v125, v126
  v_mfma_f32_16x16x32_bf16 a[184:187], v[200:203], v[164:167], a[184:187]
  ds_read_b64_tr_b16 v[218:219], v249 offset:55552
  v_max_f32 v253, v253, v127
  v_cmp_lt_f32 vcc, 0x41200000, v253
  v_mfma_f32_16x16x32_bf16 a[180:183], v[204:207], v[160:163], a[180:183]
  s_cbranch_vccnz L_r3_6t
L_r3_6:
  ds_read_b64_tr_b16 v[200:201], v250 offset:53504
  ds_read_b64_tr_b16 v[202:203], v250 offset:55552
  v_mfma_f32_16x16x32_bf16 a[188:191], v[204:207], v[164:167], a[188:191]
  s_waitcnt lgkmcnt(4)
  v_exp_f32 v96, v96
  v_mfma_f32_16x16x32_bf16 a[160:163], v[208:211], v[168:171], a[160:163]
  ds_read_b64_tr_b16 v[204:205], v249 offset:57344
  ds_read_b64_tr_b16 v[206:207], v249 offset:59392
  v_mfma_f32_16x16x32_bf16 a[168:171], v[208:211], v[172:175], a[168:171]
  v_exp_f32 v97, v97
  v_mfma_f32_16x16x32_bf16 a[164:167], v[212:215], v[168:171], a[164:167]
  s_add_u32 m0, s68, 81920
  ds_read_b64_tr_b16 v[208:209], v250 offset:57344
  ds_read_b64_tr_b16 v[210:211], v250 offset:59392
  v_mfma_f32_16x16x32_bf16 a[172:175], v[212:215], v[172:175], a[172:175]
  s_waitcnt lgkmcnt(4)
  buffer_load_dwordx4 v237, s[12:15], s95 offen nt lds
  v_cvt_pk_bf16_f32 v96, v96, v97
  v_mfma_f32_16x16x32_bf16 a[176:179], v[216:219], v[168:171], a[176:179]
  ds_read_b64_tr_b16 v[212:213], v249 offset:57600
  ds_read_b64_tr_b16 v[214:215], v249 offset:59648
  v_mfma_f32_16x16x32_bf16 a[184:187], v[216:219], v[172:175], a[184:187]
  v_exp_f32 v98, v98
  v_mfma_f32_16x16x32_bf16 a[180:183], v[200:203], v[168:171], a[180:183]
  ds_read_b64_tr_b16 v[216:217], v250 offset:57600
  ds_read_b64_tr_b16 v[218:219], v250 offset:59648
  v_mfma_f32_16x16x32_bf16 a[188:191], v[200:203], v[172:175], a[188:191]
  s_waitcnt lgkmcnt(4)
  buffer_load_dwordx4 v237, s[12:15], s95 offen offset:1024 nt lds
  v_mfma_f32_16x16x32_bf16 a[160:163], v[204:207], v[176:179], a[160:163]
  ds_read_b64_tr_b16 v[200:201], v249 offset:61440
  ds_read_b64_tr_b16 v[202:203], v249 offset:63488
  v_mfma_f32_16x16x32_bf16 a[168:171], v[204:207], v[180:183], a[168:171]
  v_exp_f32 v99, v99
  v_mfma_f32_16x16x32_bf16 a[164:167], v[208:211], v[176:179], a[164:167]
  ds_read_b64_tr_b16 v[204:205], v250 offset:61440
  ds_read_b64_tr_b16 v[206:207], v250 offset:63488
  v_mfma_f32_16x16x32_bf16 a[172:175], v[208:211], v[180:183], a[172:175]
  s_waitcnt lgkmcnt(4)
  buffer_load_dwordx4 v237, s[12:15], s95 offen offset:2048 nt lds
  v_cvt_pk_bf16_f32 v97, v98, v99
  v_mfma_f32_16x16x32_bf16 a[176:179], v[212:215], v[176:179], a[176:179]
  ds_read_b64_tr_b16 v[208:209], v249 offset:61696
  ds_read_b64_tr_b16 v[210:211], v249 offset:63744
  v_mfma_f32_16x16x32_bf16 a[184:187], v[212:215], v[180:183], a[184:187]
  v_exp_f32 v100, v100
  v_mfma_f32_16x16x32_bf16 a[180:183], v[216:219], v[176:179], a[180:183]
  ds_read_b64_tr_b16 v[212:213], v250 offset:61696
  ds_read_b64_tr_b16 v[214:215], v250 offset:63744
  v_mfma_f32_16x16x32_bf16 a[188:191], v[216:219], v[180:183], a[188:191]
  s_waitcnt lgkmcnt(4)
  buffer_load_dwordx4 v237, s[12:15], s95 offen offset:3072 nt lds
  v_mfma_f32_16x16x32_bf16 a[160:163], v[200:203], v[184:187], a[160:163]
  s_waitcnt vmcnt(12)
  s_barrier
  ds_read_b64_tr_b16 v[216:217], v245 offset:0
  ds_read_b64_tr_b16 v[218:219], v245 offset:1024
  v_mfma_f32_16x16x32_bf16 a[168:171], v[200:203], v[188:191], a[168:171]
  v_exp_f32 v101, v101
  v_mfma_f32_16x16x32_bf16 a[164:167], v[204:207], v[184:187], a[164:167]
  s_add_u32 m0, s68, 98304
  ds_read_b64_tr_b16 v[200:201], v246 offset:0
  ds_read_b64_tr_b16 v[202:203], v246 offset:1024
  v_mfma_f32_16x16x32_bf16 a[172:175], v[204:207], v[188:191], a[172:175]
  s_waitcnt lgkmcnt(4)
  buffer_load_dwordx4 v240, s[48:51], s73 offen lds
  v_cvt_pk_bf16_f32 v98, v100, v101
  v_mfma_f32_16x16x32_bf16 a[176:179], v[208:211], v[184:187], a[176:179]
  ds_read_b64_tr_b16 v[204:205], v245 offset:256
  ds_read_b64_tr_b16 v[206:207], v245 offset:1280
  v_mfma_f32_16x16x32_bf16 a[184:187], v[208:211], v[188:191], a[184:187]
  v_exp_f32 v102, v102
  v_exp_f32 v103, v103
  v_exp_f32 v104, v104
  v_cvt_pk_bf16_f32 v99, v102, v103
  v_exp_f32 v105, v105
  v_exp_f32 v106, v106
  v_cvt_pk_bf16_f32 v100, v104, v105
  v_exp_f32 v107, v107
  v_exp_f32 v108, v108
  v_cvt_pk_bf16_f32 v101, v106, v107
  v_exp_f32 v109, v109
  v_exp_f32 v110, v110
  v_cvt_pk_bf16_f32 v102, v108, v109
  v_exp_f32 v111, v111
  v_exp_f32 v112, v112
  v_cvt_pk_bf16_f32 v103, v110, v111
  v_mfma_f32_16x16x32_bf16 a[180:183], v[212:215], v[184:187], a[180:183]
  ds_read_b64_tr_b16 v[208:209], v246 offset:256
  ds_read_b64_tr_b16 v[210:211], v246 offset:1280
  v_mfma_f32_16x16x32_bf16 a[188:191], v[212:215], v[188:191], a[188:191]
  s_waitcnt lgkmcnt(4)
  v_exp_f32 v113, v113
  v_mfma_f32_16x16x32_bf16 v[224:227], v[220:223], v[96:99], v[224:227]
  v_cvt_pk_bf16_f32 v104, v112, v113
  v_mfma_f32_16x16x32_bf16 v[32:35], v[216:219], v[96:99], v[32:35]
  ds_read_b64_tr_b16 v[212:213], v245 offset:512
  ds_read_b64_tr_b16 v[214:215], v245 offset:1536
  v_mfma_f32_16x16x32_bf16 v[40:43], v[216:219], v[100:103], v[40:43]
  v_exp_f32 v114, v114
  v_mfma_f32_16x16x32_bf16 v[228:231], v[220:223], v[100:103], v[228:231]
  v_exp_f32 v115, v115
  v_mfma_f32_16x16x32_bf16 v[36:39], v[200:203], v[96:99], v[36:39]
  ds_read_b64_tr_b16 v[216:217], v246 offset:512
  v_cvt_pk_bf16_f32 v105, v114, v115
  v_mfma_f32_16x16x32_bf16 v[44:47], v[200:203], v[100:103], v[44:47]
  s_waitcnt lgkmcnt(3)
  ds_read_b64_tr_b16 v[218:219], v246 offset:1536
  v_exp_f32 v116, v116
  v_mfma_f32_16x16x32_bf16 v[48:51], v[204:207], v[96:99], v[48:51]
  ds_read_b64_tr_b16 v[200:201], v245 offset:768
  ds_read_b64_tr_b16 v[202:203], v245 offset:1792
  v_mfma_f32_16x16x32_bf16 v[56:59], v[204:207], v[100:103], v[56:59]
  v_exp_f32 v117, v117
  v_mfma_f32_16x16x32_bf16 v[52:55], v[208:211], v[96:99], v[52:55]
  ds_read_b64_tr_b16 v[204:205], v246 offset:768
  v_cvt_pk_bf16_f32 v106, v116, v117
  v_mfma_f32_16x16x32_bf16 v[60:63], v[208:211], v[100:103], v[60:63]
  s_waitcnt lgkmcnt(3)
  ds_read_b64_tr_b16 v[206:207], v246 offset:1792
  v_exp_f32 v118, v118
  v_mfma_f32_16x16x32_bf16 v[64:67], v[212:215], v[96:99], v[64:67]
  ds_read_b64_tr_b16 v[208:209], v245 offset:2048
  ds_read_b64_tr_b16 v[210:211], v245 offset:3072
  v_mfma_f32_16x16x32_bf16 v[72:75], v[212:215], v[100:103], v[72:75]
  v_exp_f32 v119, v119
  v_mfma_f32_16x16x32_bf16 v[68:71], v[216:219], v[96:99], v[68:71]
  ds_read_b64_tr_b16 v[212:213], v246 offset:2048
  v_cvt_pk_bf16_f32 v107, v118, v119
  v_mfma_f32_16x16x32_bf16 v[76:79], v[216:219], v[100:103], v[76:79]
  s_waitcnt lgkmcnt(3)
  ds_read_b64_tr_b16 v[214:215], v246 offset:3072
  v_exp_f32 v120, v120
  v_mfma_f32_16x16x32_bf16 v[224:227], v[220:223], v[104:107], v[224:227]
  v_exp_f32 v121, v121
  v_mfma_f32_16x16x32_bf16 v[80:83], v[200:203], v[96:99], v[80:83]
  ds_read_b64_tr_b16 v[216:217], v245 offset:2304
  v_cvt_pk_bf16_f32 v108, v120, v121
  v_mfma_f32_16x16x32_bf16 v[88:91], v[200:203], v[100:103], v[88:91]
  ds_read_b64_tr_b16 v[218:219], v245 offset:3328
  v_exp_f32 v122, v122
  v_exp_f32 v123, v123
  v_exp_f32 v124, v124
  v_cvt_pk_bf16_f32 v109, v122, v123
  v_exp_f32 v125, v125
  v_exp_f32 v126, v126
  v_cvt_pk_bf16_f32 v110, v124, v125
  v_exp_f32 v127, v127
  s_nop 0
  v_cvt_pk_bf16_f32 v111, v126, v127
  v_mfma_f32_16x16x32_bf16 v[84:87], v[204:207], v[96:99], v[84:87]
  ds_read_b64_tr_b16 v[200:201], v246 offset:2304
  v_mfma_f32_16x16x32_bf16 v[92:95], v[204:207], v[100:103], v[92:95]
  s_waitcnt lgkmcnt(3)
  ds_read_b64_tr_b16 v[202:203], v246 offset:3328
  v_mfma_f32_16x16x32_bf16 v[32:35], v[208:211], v[104:107], v[32:35]
  ds_read_b64_tr_b16 v[204:205], v245 offset:2560
  v_mfma_f32_16x16x32_bf16 v[40:43], v[208:211], v[108:111], v[40:43]
  ds_read_b64_tr_b16 v[206:207], v245 offset:3584
  v_mfma_f32_16x16x32_bf16 v[36:39], v[212:215], v[104:107], v[36:39]
  ds_read_b64_tr_b16 v[208:209], v246 offset:2560
  v_mfma_f32_16x16x32_bf16 v[44:47], v[212:215], v[108:111], v[44:47]
  s_waitcnt lgkmcnt(3)
  ds_read_b64_tr_b16 v[210:211], v246 offset:3584
  v_mfma_f32_16x16x32_bf16 v[48:51], v[216:219], v[104:107], v[48:51]
  ds_read_b64_tr_b16 v[212:213], v245 offset:2816
  v_mfma_f32_16x16x32_bf16 v[56:59], v[216:219], v[108:111], v[56:59]
  ds_read_b64_tr_b16 v[214:215], v245 offset:3840
  v_mfma_f32_16x16x32_bf16 v[52:55], v[200:203], v[104:107], v[52:55]
  ds_read_b64_tr_b16 v[216:217], v246 offset:2816
  v_mfma_f32_16x16x32_bf16 v[60:63], v[200:203], v[108:111], v[60:63]
  s_waitcnt lgkmcnt(3)
  ds_read_b64_tr_b16 v[218:219], v246 offset:3840
  v_mfma_f32_16x16x32_bf16 v[64:67], v[204:207], v[104:107], v[64:67]
  s_waitcnt vmcnt(9)
  s_barrier
  ds_read_b128 v[200:203], v241 offset:16384
  v_mfma_f32_16x16x32_bf16 v[72:75], v[204:207], v[108:111], v[72:75]
  buffer_load_dwordx4 v240, s[52:55], s73 offen offset:1024 lds
  v_mfma_f32_16x16x32_bf16 v[68:71], v[208:211], v[104:107], v[68:71]
  ds_read_b128 v[204:207], v242 offset:16384
  v_mfma_f32_16x16x32_bf16 v[76:79], v[208:211], v[108:111], v[76:79]
  s_waitcnt lgkmcnt(2)
  v_mfma_f32_16x16x32_bf16 v[228:231], v[220:223], v[108:111], v[228:231]
  v_mfma_f32_16x16x32_bf16 v[80:83], v[212:215], v[104:107], v[80:83]
  ds_read_b128 v[208:211], v241 offset:24576
  v_mfma_f32_16x16x32_bf16 v[88:91], v[212:215], v[108:111], v[88:91]
  buffer_load_dwordx4 v240, s[56:59], s73 offen offset:2048 lds
  v_mfma_f32_16x16x32_bf16 v[84:87], v[216:219], v[104:107], v[84:87]
  ds_read_b128 v[212:215], v242 offset:24576
  v_mfma_f32_16x16x32_bf16 v[92:95], v[216:219], v[108:111], v[92:95]
  s_waitcnt lgkmcnt(2)
  v_mfma_f32_16x16x32_bf16 v[96:99], v[200:203], v[0:3], v[192:195]
  ds_read_b128 v[216:219], v241 offset:17408
  v_lshl_add_u32 v236, v251, 4, s4
  v_mfma_f32_16x16x32_bf16 v[104:107], v[200:203], v[4:7], v[196:199]
  v_mfma_f32_16x16x32_bf16 v[96:99], v[204:207], v[8:11], v[96:99]
  ds_read_b128 v[200:203], v242 offset:17408
  v_mfma_f32_16x16x32_bf16 v[104:107], v[204:207], v[12:15], v[104:107]
  s_waitcnt lgkmcnt(2)
  v_mfma_f32_16x16x32_bf16 v[96:99], v[208:211], v[16:19], v[96:99]
  ds_read_b128 v[204:207], v241 offset:25600
  v_mfma_f32_16x16x32_bf16 v[104:107], v[208:211], v[20:23], v[104:107]
  buffer_load_dwordx4 v240, s[60:63], s73 offen offset:3072 lds
  v_mfma_f32_16x16x32_bf16 v[96:99], v[212:215], v[24:27], v[96:99]
  ds_read_b128 v[208:211], v242 offset:25600
  v_mfma_f32_16x16x32_bf16 v[104:107], v[212:215], v[28:31], v[104:107]
  s_waitcnt lgkmcnt(2)
  v_mfma_f32_16x16x32_bf16 v[100:103], v[216:219], v[0:3], v[192:195]
  s_add_u32 m0, s68, 49152
  ds_read_b128 v[212:215], v241 offset:18432
  v_mfma_f32_16x16x32_bf16 v[108:111], v[216:219], v[4:7], v[196:199]
  buffer_load_dwordx4 v240, s[48:51], s74 offen lds
  v_mfma_f32_16x16x32_bf16 v[100:103], v[200:203], v[8:11], v[100:103]
  ds_read_b128 v[216:219], v242 offset:18432
  v_max3_f32 v253, v96, v97, v98
  v_mfma_f32_16x16x32_bf16 v[108:111], v[200:203], v[12:15], v[108:111]
  s_waitcnt lgkmcnt(2)
  v_max3_f32 v253, v253, v99, v104
  v_max3_f32 v253, v253, v105, v106
  v_mfma_f32_16x16x32_bf16 v[100:103], v[204:207], v[16:19], v[100:103]
  ds_read_b128 v[200:203], v241 offset:26624
  v_mfma_f32_16x16x32_bf16 v[108:111], v[204:207], v[20:23], v[108:111]
  buffer_load_dwordx4 v240, s[52:55], s74 offen offset:1024 lds
  v_mfma_f32_16x16x32_bf16 v[100:103], v[208:211], v[24:27], v[100:103]
  ds_read_b128 v[204:207], v242 offset:26624
  v_mfma_f32_16x16x32_bf16 v[108:111], v[208:211], v[28:31], v[108:111]
  s_waitcnt lgkmcnt(2)
  v_mfma_f32_16x16x32_bf16 v[112:115], v[212:215], v[0:3], v[192:195]
  ds_read_b128 v[208:211], v241 offset:19456
  v_mfma_f32_16x16x32_bf16 v[120:123], v[212:215], v[4:7], v[196:199]
  buffer_load_dwordx4 v240, s[56:59], s74 offen offset:2048 lds
  v_mfma_f32_16x16x32_bf16 v[112:115], v[216:219], v[8:11], v[112:115]
  ds_read_b128 v[212:215], v242 offset:19456
  v_max3_f32 v253, v253, v107, v100
  v_mfma_f32_16x16x32_bf16 v[120:123], v[216:219], v[12:15], v[120:123]
  s_waitcnt lgkmcnt(2)
  v_max3_f32 v253, v253, v101, v102
  v_max3_f32 v253, v253, v103, v108
  v_mfma_f32_16x16x32_bf16 v[112:115], v[200:203], v[16:19], v[112:115]
  ds_read_b128 v[216:219], v241 offset:27648
  v_max3_f32 v253, v253, v109, v110
  v_mfma_f32_16x16x32_bf16 v[120:123], v[200:203], v[20:23], v[120:123]
  buffer_load_dwordx4 v240, s[60:63], s74 offen offset:3072 lds
  v_mfma_f32_16x16x32_bf16 v[112:115], v[204:207], v[24:27], v[112:115]
  ds_read_b128 v[200:203], v242 offset:27648
  v_mfma_f32_16x16x32_bf16 v[120:123], v[204:207], v[28:31], v[120:123]
  s_waitcnt lgkmcnt(2)
  v_mfma_f32_16x16x32_bf16 v[116:119], v[208:211], v[0:3], v[192:195]
  s_waitcnt vmcnt(24)
  s_barrier
  ds_read_b64_tr_b16 v[204:205], v249 offset:16384
  v_mfma_f32_16x16x32_bf16 v[124:127], v[208:211], v[4:7], v[196:199]
  ds_read_b64_tr_b16 v[206:207], v249 offset:18432
  v_mfma_f32_16x16x32_bf16 v[116:119], v[212:215], v[8:11], v[116:119]
  ds_read_b64_tr_b16 v[208:209], v250 offset:16384
  v_max3_f32 v253, v253, v111, v112
  v_mfma_f32_16x16x32_bf16 v[124:127], v[212:215], v[12:15], v[124:127]
  s_waitcnt lgkmcnt(3)
  ds_read_b64_tr_b16 v[210:211], v250 offset:18432
  v_max3_f32 v253, v253, v113, v114
  v_mfma_f32_16x16x32_bf16 v[116:119], v[216:219], v[16:19], v[116:119]
  ds_read_b64_tr_b16 v[212:213], v249 offset:16640
  v_max3_f32 v253, v253, v115, v120
  v_mfma_f32_16x16x32_bf16 v[124:127], v[216:219], v[20:23], v[124:127]
  ds_read_b64_tr_b16 v[214:215], v249 offset:18688
  v_max3_f32 v253, v253, v121, v122
  v_mfma_f32_16x16x32_bf16 v[116:119], v[200:203], v[24:27], v[116:119]
  ds_read_b64_tr_b16 v[216:217], v250 offset:16640
  v_mfma_f32_16x16x32_bf16 v[124:127], v[200:203], v[28:31], v[124:127]
  s_waitcnt lgkmcnt(3)
  ds_read_b64_tr_b16 v[218:219], v250 offset:18688
  v_mfma_f32_16x16x32_bf16 a[192:195], v[204:207], v[160:163], a[192:195]
  ds_read_b64_tr_b16 v[200:201], v249 offset:20480
  v_mfma_f32_16x16x32_bf16 a[200:203], v[204:207], v[164:167], a[200:203]
  ds_read_b64_tr_b16 v[202:203], v249 offset:22528
  v_mfma_f32_16x16x32_bf16 a[196:199], v[208:211], v[160:163], a[196:199]
  ds_read_b64_tr_b16 v[204:205], v250 offset:20480
  v_max3_f32 v253, v253, v123, v116
  v_mfma_f32_16x16x32_bf16 a[204:207], v[208:211], v[164:167], a[204:207]
  s_waitcnt lgkmcnt(3)
  ds_read_b64_tr_b16 v[206:207], v250 offset:22528
  v_max3_f32 v253, v253, v117, v118
  v_max3_f32 v253, v253, v119, v124
  v_mfma_f32_16x16x32_bf16 a[208:211], v[212:215], v[160:163], a[208:211]
  ds_read_b64_tr_b16 v[208:209], v249 offset:20736
  v_max3_f32 v253, v253, v125, v126
  v_mfma_f32_16x16x32_bf16 a[216:219], v[212:215], v[164:167], a[216:219]
  ds_read_b64_tr_b16 v[210:211], v249 offset:22784
  v_max_f32 v253, v253, v127
  v_cmp_lt_f32 vcc, 0x41200000, v253
  v_mfma_f32_16x16x32_bf16 a[212:215], v[216:219], v[160:163], a[212:215]
  s_cbranch_vccnz L_r3_7t
L_r3_7:
  ds_read_b64_tr_b16 v[212:213], v250 offset:20736
  ds_read_b64_tr_b16 v[214:215], v250 offset:22784
  v_mfma_f32_16x16x32_bf16 a[220:223], v[216:219], v[164:167], a[220:223]
  s_waitcnt lgkmcnt(4)
  v_exp_f32 v96, v96
  v_mfma_f32_16x16x32_bf16 a[192:195], v[200:203], v[168:171], a[192:195]
  ds_read_b64_tr_b16 v[216:217], v249 offset:24576
  ds_read_b64_tr_b16 v[218:219], v249 offset:26624
  v_mfma_f32_16x16x32_bf16 a[200:203], v[200:203], v[172:175], a[200:203]
  v_exp_f32 v97, v97
  v_mfma_f32_16x16x32_bf16 a[196:199], v[204:207], v[168:171], a[196:199]
  ds_read_b64_tr_b16 v[200:201], v250 offset:24576
  v_cvt_pk_bf16_f32 v96, v96, v97
  v_mfma_f32_16x16x32_bf16 a[204:207], v[204:207], v[172:175], a[204:207]
  s_waitcnt lgkmcnt(3)
  ds_read_b64_tr_b16 v[202:203], v250 offset:26624
  v_exp_f32 v98, v98
  v_mfma_f32_16x16x32_bf16 a[208:211], v[208:211], v[168:171], a[208:211]
  ds_read_b64_tr_b16 v[204:205], v249 offset:24832
  ds_read_b64_tr_b16 v[206:207], v249 offset:26880
  v_mfma_f32_16x16x32_bf16 a[216:219], v[208:211], v[172:175], a[216:219]
  v_exp_f32 v99, v99
  v_mfma_f32_16x16x32_bf16 a[212:215], v[212:215], v[168:171], a[212:215]
  ds_read_b64_tr_b16 v[208:209], v250 offset:24832
  v_cvt_pk_bf16_f32 v97, v98, v99
  v_mfma_f32_16x16x32_bf16 a[220:223], v[212:215], v[172:175], a[220:223]
  s_waitcnt lgkmcnt(3)
  ds_read_b64_tr_b16 v[210:211], v250 offset:26880
  v_exp_f32 v100, v100
  v_mfma_f32_16x16x32_bf16 a[192:195], v[216:219], v[176:179], a[192:195]
  ds_read_b64_tr_b16 v[212:213], v249 offset:28672
  ds_read_b64_tr_b16 v[214:215], v249 offset:30720
  v_mfma_f32_16x16x32_bf16 a[200:203], v[216:219], v[180:183], a[200:203]
  v_exp_f32 v101, v101
  v_mfma_f32_16x16x32_bf16 a[196:199], v[200:203], v[176:179], a[196:199]
  ds_read_b64_tr_b16 v[216:217], v250 offset:28672
  v_cvt_pk_bf16_f32 v98, v100, v101
  v_mfma_f32_16x16x32_bf16 a[204:207], v[200:203], v[180:183], a[204:207]
  s_waitcnt lgkmcnt(3)
  ds_read_b64_tr_b16 v[218:219], v250 offset:30720
  v_exp_f32 v102, v102
  v_mfma_f32_16x16x32_bf16 a[208:211], v[204:207], v[176:179], a[208:211]
  s_add_u32 m0, s68, 131072
  ds_read_b64_tr_b16 v[200:201], v249 offset:28928
  ds_read_b64_tr_b16 v[202:203], v249 offset:30976
  v_mfma_f32_16x16x32_bf16 a[216:219], v[204:207], v[180:183], a[216:219]
  buffer_load_dwordx4 v240, s[48:51], s75 offen lds
  v_mfma_f32_16x16x32_bf16 a[212:215], v[208:211], v[176:179], a[212:215]
  ds_read_b64_tr_b16 v[204:205], v250 offset:28928
  ds_read_b64_tr_b16 v[206:207], v250 offset:30976
  v_mfma_f32_16x16x32_bf16 a[220:223], v[208:211], v[180:183], a[220:223]
  s_waitcnt lgkmcnt(4)
  v_exp_f32 v103, v103
  v_mfma_f32_16x16x32_bf16 a[192:195], v[212:215], v[184:187], a[192:195]
  s_waitcnt vmcnt(9)
  s_barrier
  ds_read_b64_tr_b16 v[208:209], v245 offset:16384
  ds_read_b64_tr_b16 v[210:211], v245 offset:17408
  v_mfma_f32_16x16x32_bf16 a[200:203], v[212:215], v[188:191], a[200:203]
  buffer_load_dwordx4 v240, s[52:55], s75 offen offset:1024 lds
  v_cvt_pk_bf16_f32 v99, v102, v103
  v_mfma_f32_16x16x32_bf16 a[196:199], v[216:219], v[184:187], a[196:199]
  ds_read_b64_tr_b16 v[212:213], v246 offset:16384
  ds_read_b64_tr_b16 v[214:215], v246 offset:17408
  v_mfma_f32_16x16x32_bf16 a[204:207], v[216:219], v[188:191], a[204:207]
  s_waitcnt lgkmcnt(4)
  buffer_load_dwordx4 v240, s[56:59], s75 offen offset:2048 lds
  v_mfma_f32_16x16x32_bf16 v[224:227], v[220:223], v[96:99], v[224:227]
  v_exp_f32 v104, v104
  v_mfma_f32_16x16x32_bf16 a[208:211], v[200:203], v[184:187], a[208:211]
  ds_read_b64_tr_b16 v[216:217], v245 offset:16640
  ds_read_b64_tr_b16 v[218:219], v245 offset:17664
  v_mfma_f32_16x16x32_bf16 a[216:219], v[200:203], v[188:191], a[216:219]
  v_exp_f32 v105, v105
  v_exp_f32 v106, v106
  v_cvt_pk_bf16_f32 v100, v104, v105
  v_exp_f32 v107, v107
  v_exp_f32 v108, v108
  v_cvt_pk_bf16_f32 v101, v106, v107
  v_exp_f32 v109, v109
  v_exp_f32 v110, v110
  v_cvt_pk_bf16_f32 v102, v108, v109
  v_exp_f32 v111, v111
  v_exp_f32 v112, v112
  v_cvt_pk_bf16_f32 v103, v110, v111
  v_mfma_f32_16x16x32_bf16 a[212:215], v[204:207], v[184:187], a[212:215]
  ds_read_b64_tr_b16 v[200:201], v246 offset:16640
  ds_read_b64_tr_b16 v[202:203], v246 offset:17664
  v_mfma_f32_16x16x32_bf16 a[220:223], v[204:207], v[188:191], a[220:223]
  s_waitcnt lgkmcnt(4)
  buffer_load_dwordx4 v240, s[60:63], s75 offen offset:3072 lds
  v_mfma_f32_16x16x32_bf16 v[228:231], v[220:223], v[100:103], v[228:231]
  v_exp_f32 v113, v113
  v_mfma_f32_16x16x32_bf16 v[32:35], v[208:211], v[96:99], v[32:35]
  s_add_u32 m0, s68, 0
  ds_read_b64_tr_b16 v[204:205], v245 offset:16896
  ds_read_b64_tr_b16 v[206:207], v245 offset:17920
  v_mfma_f32_16x16x32_bf16 v[40:43], v[208:211], v[100:103], v[40:43]
  buffer_load_dwordx4 v240, s[48:51], s76 offen lds
  v_cvt_pk_bf16_f32 v104, v112, v113
  v_mfma_f32_16x16x32_bf16 v[36:39], v[212:215], v[96:99], v[36:39]
  ds_read_b64_tr_b16 v[208:209], v246 offset:16896
  v_exp_f32 v114, v114
  v_mfma_f32_16x16x32_bf16 v[44:47], v[212:215], v[100:103], v[44:47]
  s_waitcnt lgkmcnt(3)
  ds_read_b64_tr_b16 v[210:211], v246 offset:17920
  v_exp_f32 v115, v115
  v_mfma_f32_16x16x32_bf16 v[48:51], v[216:219], v[96:99], v[48:51]
  ds_read_b64_tr_b16 v[212:213], v245 offset:17152
  ds_read_b64_tr_b16 v[214:215], v245 offset:18176
  v_mfma_f32_16x16x32_bf16 v[56:59], v[216:219], v[100:103], v[56:59]
  buffer_load_dwordx4 v240, s[52:55], s76 offen offset:1024 lds
  v_cvt_pk_bf16_f32 v105, v114, v115
  v_mfma_f32_16x16x32_bf16 v[52:55], v[200:203], v[96:99], v[52:55]
  ds_read_b64_tr_b16 v[216:217], v246 offset:17152
  ds_read_b64_tr_b16 v[218:219], v246 offset:18176
  v_mfma_f32_16x16x32_bf16 v[60:63], v[200:203], v[100:103], v[60:63]
  s_waitcnt lgkmcnt(4)
  buffer_load_dwordx4 v240, s[56:59], s76 offen offset:2048 lds
  v_mov_b32 v252, 1
  v_mfma_f32_16x16x32_bf16 v[64:67], v[204:207], v[96:99], v[64:67]
  ds_read_b64_tr_b16 v[200:201], v245 offset:18432
  v_exp_f32 v116, v116
  v_mfma_f32_16x16x32_bf16 v[72:75], v[204:207], v[100:103], v[72:75]
  ds_read_b64_tr_b16 v[202:203], v245 offset:19456
  v_exp_f32 v117, v117
  v_mfma_f32_16x16x32_bf16 v[68:71], v[208:211], v[96:99], v[68:71]
  ds_read_b64_tr_b16 v[204:205], v246 offset:18432
  ds_read_b64_tr_b16 v[206:207], v246 offset:19456
  v_mfma_f32_16x16x32_bf16 v[76:79], v[208:211], v[100:103], v[76:79]
  s_waitcnt lgkmcnt(4)
  buffer_load_dwordx4 v240, s[60:63], s76 offen offset:3072 lds
  v_cvt_pk_bf16_f32 v106, v116, v117
  v_mfma_f32_16x16x32_bf16 v[80:83], v[212:215], v[96:99], v[80:83]
  s_add_u32 m0, s68, 147456
  ds_read_b64_tr_b16 v[208:209], v245 offset:18688
  ds_read_b64_tr_b16 v[210:211], v245 offset:19712
  v_mfma_f32_16x16x32_bf16 v[88:91], v[212:215], v[100:103], v[88:91]
  buffer_load_dwordx4 v240, s[48:51], s77 offen lds
  v_exp_f32 v118, v118
  v_exp_f32 v119, v119
  v_exp_f32 v120, v120
  v_cvt_pk_bf16_f32 v107, v118, v119
  v_exp_f32 v121, v121
  v_exp_f32 v122, v122
  v_cvt_pk_bf16_f32 v108, v120, v121
  v_exp_f32 v123, v123
  v_exp_f32 v124, v124
  v_cvt_pk_bf16_f32 v109, v122, v123
  v_exp_f32 v125, v125
  v_exp_f32 v126, v126
  v_cvt_pk_bf16_f32 v110, v124, v125
  v_exp_f32 v127, v127
  v_mov_b32 v237, 0x7fffff00
  v_cvt_pk_bf16_f32 v111, v126, v127
  v_mfma_f32_16x16x32_bf16 v[84:87], v[216:219], v[96:99], v[84:87]
  ds_read_b64_tr_b16 v[212:213], v246 offset:18688
  v_writelane_b32 v237, s5, 0
  v_mfma_f32_16x16x32_bf16 v[92:95], v[216:219], v[100:103], v[92:95]
  s_waitcnt lgkmcnt(3)
  ds_read_b64_tr_b16 v[214:215], v246 offset:19712
  v_mfma_f32_16x16x32_bf16 v[32:35], v[200:203], v[104:107], v[32:35]
  ds_read_b64_tr_b16 v[216:217], v245 offset:18944
  ds_read_b64_tr_b16 v[218:219], v245 offset:19968
  v_mfma_f32_16x16x32_bf16 v[40:43], v[200:203], v[108:111], v[40:43]
  buffer_load_dwordx4 v240, s[52:55], s77 offen offset:1024 lds
  v_mfma_f32_16x16x32_bf16 v[36:39], v[204:207], v[104:107], v[36:39]
  ds_read_b64_tr_b16 v[200:201], v246 offset:18944
  ds_read_b64_tr_b16 v[202:203], v246 offset:19968
  v_mfma_f32_16x16x32_bf16 v[44:47], v[204:207], v[108:111], v[44:47]
  s_waitcnt lgkmcnt(4)
  buffer_load_dwordx4 v240, s[56:59], s77 offen offset:2048 lds
  v_mfma_f32_16x16x32_bf16 v[48:51], v[208:211], v[104:107], v[48:51]
  ds_read_b64_tr_b16 v[204:205], v245 offset:19200
  v_mfma_f32_16x16x32_bf16 v[56:59], v[208:211], v[108:111], v[56:59]
  ds_read_b64_tr_b16 v[206:207], v245 offset:20224
  v_mfma_f32_16x16x32_bf16 v[224:227], v[220:223], v[104:107], v[224:227]
  v_mfma_f32_16x16x32_bf16 v[52:55], v[212:215], v[104:107], v[52:55]
  ds_read_b64_tr_b16 v[208:209], v246 offset:19200
  ds_read_b64_tr_b16 v[210:211], v246 offset:20224
  v_mfma_f32_16x16x32_bf16 v[60:63], v[212:215], v[108:111], v[60:63]
  s_waitcnt lgkmcnt(4)
  buffer_load_dwordx4 v240, s[60:63], s77 offen offset:3072 lds
  v_mfma_f32_16x16x32_bf16 v[228:231], v[220:223], v[108:111], v[228:231]
  v_mfma_f32_16x16x32_bf16 v[64:67], v[216:219], v[104:107], v[64:67]
  s_waitcnt vmcnt(24)
  s_barrier
  s_add_u32 m0, s68, 16384
  ds_read_b64_tr_b16 v[212:213], v247 offset:32768
  ds_read_b64_tr_b16 v[214:215], v247 offset:34816
  v_mfma_f32_16x16x32_bf16 v[72:75], v[216:219], v[108:111], v[72:75]
  buffer_load_dwordx4 v240, s[48:51], s78 offen lds
  v_mfma_f32_16x16x32_bf16 v[68:71], v[200:203], v[104:107], v[68:71]
  ds_read_b64_tr_b16 v[216:217], v248 offset:32768
  ds_read_b64_tr_b16 v[218:219], v248 offset:34816
  v_mfma_f32_16x16x32_bf16 v[76:79], v[200:203], v[108:111], v[76:79]
  s_waitcnt lgkmcnt(4)
  v_rcp_f32 v238, v224
  v_mfma_f32_16x16x32_bf16 v[80:83], v[204:207], v[104:107], v[80:83]
  ds_read_b64_tr_b16 v[200:201], v247 offset:33024
  ds_read_b64_tr_b16 v[202:203], v247 offset:35072
  v_mfma_f32_16x16x32_bf16 v[88:91], v[204:207], v[108:111], v[88:91]
  buffer_load_dwordx4 v240, s[52:55], s78 offen offset:1024 lds
  v_rcp_f32 v244, v228
  v_mul_f32 v32, v238, v32
  v_mul_f32 v33, v238, v33
  v_cvt_pk_bf16_f32 v0, v32, v33
  v_mul_f32 v34, v238, v34
  v_mul_f32 v35, v238, v35
  v_cvt_pk_bf16_f32 v1, v34, v35
  v_mul_f32 v36, v238, v36
  v_mul_f32 v37, v238, v37
  v_cvt_pk_bf16_f32 v2, v36, v37
  v_mul_f32 v38, v238, v38
  v_mul_f32 v39, v238, v39
  v_cvt_pk_bf16_f32 v3, v38, v39
  v_mul_f32 v40, v244, v40
  v_mul_f32 v41, v244, v41
  v_cvt_pk_bf16_f32 v4, v40, v41
  v_mul_f32 v42, v244, v42
  v_mul_f32 v43, v244, v43
  v_cvt_pk_bf16_f32 v5, v42, v43
  v_mul_f32 v44, v244, v44
  v_mul_f32 v45, v244, v45
  v_cvt_pk_bf16_f32 v6, v44, v45
  v_mul_f32 v46, v244, v46
  v_mul_f32 v47, v244, v47
  v_cvt_pk_bf16_f32 v7, v46, v47
  v_mfma_f32_16x16x32_bf16 v[84:87], v[208:211], v[104:107], v[84:87]
  ds_read_b64_tr_b16 v[204:205], v248 offset:33024
  ds_read_b64_tr_b16 v[206:207], v248 offset:35072
  v_mfma_f32_16x16x32_bf16 v[92:95], v[208:211], v[108:111], v[92:95]
  s_waitcnt lgkmcnt(4)
  buffer_load_dwordx4 v240, s[56:59], s78 offen offset:2048 lds
  v_mul_f32 v48, v238, v48
  v_mfma_f32_16x16x32_bf16 a[0:3], v[212:215], v[0:3], a[0:3]
  ds_read_b64_tr_b16 v[208:209], v247 offset:36864
  v_mul_f32 v49, v238, v49
  v_mfma_f32_16x16x32_bf16 a[8:11], v[212:215], v[4:7], a[8:11]
  ds_read_b64_tr_b16 v[210:211], v247 offset:38912
  v_cvt_pk_bf16_f32 v8, v48, v49
  v_mul_f32 v50, v238, v50
  v_mfma_f32_16x16x32_bf16 a[4:7], v[216:219], v[0:3], a[4:7]
  ds_read_b64_tr_b16 v[212:213], v248 offset:36864
  ds_read_b64_tr_b16 v[214:215], v248 offset:38912
  v_mfma_f32_16x16x32_bf16 a[12:15], v[216:219], v[4:7], a[12:15]
  s_waitcnt lgkmcnt(4)
  buffer_load_dwordx4 v240, s[60:63], s78 offen offset:3072 lds
  v_subrev_u32 v240, 524288, v240
  v_mfma_f32_16x16x32_bf16 a[16:19], v[200:203], v[0:3], a[16:19]
  s_add_u32 m0, s68, 114688
  ds_read_b64_tr_b16 v[216:217], v247 offset:37120
  ds_read_b64_tr_b16 v[218:219], v247 offset:39168
  v_mfma_f32_16x16x32_bf16 a[24:27], v[200:203], v[4:7], a[24:27]
  buffer_load_dwordx4 v240, s[48:51], s79 offen lds
  v_mul_f32 v51, v238, v51
  v_cvt_pk_bf16_f32 v9, v50, v51
  v_mul_f32 v52, v238, v52
  v_mul_f32 v53, v238, v53
  v_cvt_pk_bf16_f32 v10, v52, v53
  v_mul_f32 v54, v238, v54
  v_mul_f32 v55, v238, v55
  v_cvt_pk_bf16_f32 v11, v54, v55
  v_mul_f32 v56, v244, v56
  v_mul_f32 v57, v244, v57
  v_cvt_pk_bf16_f32 v12, v56, v57
  v_mul_f32 v58, v244, v58
  v_mul_f32 v59, v244, v59
  v_cvt_pk_bf16_f32 v13, v58, v59
  v_mul_f32 v60, v244, v60
  v_mul_f32 v61, v244, v61
  v_cvt_pk_bf16_f32 v14, v60, v61
  v_mul_f32 v62, v244, v62
  v_mul_f32 v63, v244, v63
  v_cvt_pk_bf16_f32 v15, v62, v63
  v_mfma_f32_16x16x32_bf16 a[20:23], v[204:207], v[0:3], a[20:23]
  ds_read_b64_tr_b16 v[200:201], v248 offset:37120
  v_mul_f32 v64, v238, v64
  v_mfma_f32_16x16x32_bf16 a[28:31], v[204:207], v[4:7], a[28:31]
  s_waitcnt lgkmcnt(3)
  ds_read_b64_tr_b16 v[202:203], v248 offset:39168
  v_mul_f32 v65, v238, v65
  v_cvt_pk_bf16_f32 v16, v64, v65
  v_mfma_f32_16x16x32_bf16 a[0:3], v[208:211], v[8:11], a[0:3]
  ds_read_b64_tr_b16 v[204:205], v247 offset:40960
  ds_read_b64_tr_b16 v[206:207], v247 offset:43008
  v_mfma_f32_16x16x32_bf16 a[8:11], v[208:211], v[12:15], a[8:11]
  buffer_load_dwordx4 v240, s[52:55], s79 offen offset:1024 lds
  v_mul_f32 v66, v238, v66
  v_mfma_f32_16x16x32_bf16 a[4:7], v[212:215], v[8:11], a[4:7]
  ds_read_b64_tr_b16 v[208:209], v248 offset:40960
  ds_read_b64_tr_b16 v[210:211], v248 offset:43008
  v_mfma_f32_16x16x32_bf16 a[12:15], v[212:215], v[12:15], a[12:15]
  s_waitcnt lgkmcnt(4)
  buffer_load_dwordx4 v240, s[56:59], s79 offen offset:2048 lds
  v_mul_f32 v67, v238, v67
  v_mfma_f32_16x16x32_bf16 a[16:19], v[216:219], v[8:11], a[16:19]
  ds_read_b64_tr_b16 v[212:213], v247 offset:41216
  v_cvt_pk_bf16_f32 v17, v66, v67
  v_mfma_f32_16x16x32_bf16 a[24:27], v[216:219], v[12:15], a[24:27]
  ds_read_b64_tr_b16 v[214:215], v247 offset:43264
  v_mul_f32 v68, v238, v68
  v_mul_f32 v69, v238, v69
  v_cvt_pk_bf16_f32 v18, v68, v69
  v_mul_f32 v70, v238, v70
  v_mul_f32 v71, v238, v71
  v_cvt_pk_bf16_f32 v19, v70, v71
  v_mul_f32 v72, v244, v72
  v_mul_f32 v73, v244, v73
  v_cvt_pk_bf16_f32 v20, v72, v73
  v_mul_f32 v74, v244, v74
  v_mul_f32 v75, v244, v75
  v_cvt_pk_bf16_f32 v21, v74, v75
  v_mul_f32 v76, v244, v76
  v_mul_f32 v77, v244, v77
  v_cvt_pk_bf16_f32 v22, v76, v77
  v_mul_f32 v78, v244, v78
  v_mul_f32 v79, v244, v79
  v_cvt_pk_bf16_f32 v23, v78, v79
  v_mfma_f32_16x16x32_bf16 a[20:23], v[200:203], v[8:11], a[20:23]
  ds_read_b64_tr_b16 v[216:217], v248 offset:41216
  ds_read_b64_tr_b16 v[218:219], v248 offset:43264
  v_mfma_f32_16x16x32_bf16 a[28:31], v[200:203], v[12:15], a[28:31]
  s_waitcnt lgkmcnt(4)
  buffer_load_dwordx4 v240, s[60:63], s79 offen offset:3072 lds
  v_add_u32 v240, 262144, v240
  v_mfma_f32_16x16x32_bf16 a[0:3], v[204:207], v[16:19], a[0:3]
  s_add_u32 m0, s68, 65536
  ds_read_b64_tr_b16 v[200:201], v247 offset:45056
  ds_read_b64_tr_b16 v[202:203], v247 offset:47104
  v_mfma_f32_16x16x32_bf16 a[8:11], v[204:207], v[20:23], a[8:11]
  buffer_load_dwordx4 v240, s[48:51], s79 offen lds
  v_mul_f32 v80, v238, v80
  v_mfma_f32_16x16x32_bf16 a[4:7], v[208:211], v[16:19], a[4:7]
  ds_read_b64_tr_b16 v[204:205], v248 offset:45056
  v_mul_f32 v81, v238, v81
  v_mfma_f32_16x16x32_bf16 a[12:15], v[208:211], v[20:23], a[12:15]
  s_waitcnt lgkmcnt(3)
  ds_read_b64_tr_b16 v[206:207], v248 offset:47104
  v_cvt_pk_bf16_f32 v24, v80, v81
  v_mul_f32 v82, v238, v82
  v_mfma_f32_16x16x32_bf16 a[16:19], v[212:215], v[16:19], a[16:19]
  ds_read_b64_tr_b16 v[208:209], v247 offset:45312
  ds_read_b64_tr_b16 v[210:211], v247 offset:47360
  v_mfma_f32_16x16x32_bf16 a[24:27], v[212:215], v[20:23], a[24:27]
  buffer_load_dwordx4 v240, s[52:55], s79 offen offset:1024 lds
  v_mul_f32 v83, v238, v83
  v_cvt_pk_bf16_f32 v25, v82, v83
  v_mul_f32 v84, v238, v84
  v_mul_f32 v85, v238, v85
  v_cvt_pk_bf16_f32 v26, v84, v85
  v_mul_f32 v86, v238, v86
  v_mul_f32 v87, v238, v87
  v_cvt_pk_bf16_f32 v27, v86, v87
  v_mul_f32 v88, v244, v88
  v_mul_f32 v89, v244, v89
  v_cvt_pk_bf16_f32 v28, v88, v89
  v_mul_f32 v90, v244, v90
  v_mul_f32 v91, v244, v91
  v_cvt_pk_bf16_f32 v29, v90, v91
  v_mul_f32 v92, v244, v92
  v_mul_f32 v93, v244, v93
  v_cvt_pk_bf16_f32 v30, v92, v93
  v_mul_f32 v94, v244, v94
  v_mul_f32 v95, v244, v95
  v_cvt_pk_bf16_f32 v31, v94, v95
  v_mfma_f32_16x16x32_bf16 a[20:23], v[216:219], v[16:19], a[20:23]
  ds_read_b64_tr_b16 v[212:213], v248 offset:45312
  ds_read_b64_tr_b16 v[214:215], v248 offset:47360
  v_mfma_f32_16x16x32_bf16 a[28:31], v[216:219], v[20:23], a[28:31]
  s_waitcnt lgkmcnt(4)
  buffer_load_dwordx4 v240, s[56:59], s79 offen offset:2048 lds
  v_mfma_f32_16x16x32_bf16 a[0:3], v[200:203], v[24:27], a[0:3]
  s_waitcnt vmcnt(27)
  s_barrier
  ds_read_b64_tr_b16 v[216:217], v249 offset:0
  v_mfma_f32_16x16x32_bf16 a[8:11], v[200:203], v[28:31], a[8:11]
  ds_read_b64_tr_b16 v[218:219], v249 offset:2048
  s_lshl_b32 s69, s72, 10
  v_mfma_f32_16x16x32_bf16 a[4:7], v[204:207], v[24:27], a[4:7]
  ds_read_b64_tr_b16 v[200:201], v250 offset:0
  ds_read_b64_tr_b16 v[202:203], v250 offset:2048
  v_mfma_f32_16x16x32_bf16 a[12:15], v[204:207], v[28:31], a[12:15]
  s_waitcnt lgkmcnt(4)
  buffer_load_dwordx4 v240, s[60:63], s79 offen offset:3072 lds
  v_add_u32 v240, 262144, v240
  v_mfma_f32_16x16x32_bf16 a[16:19], v[208:211], v[24:27], a[16:19]
  s_add_u32 m0, s68, 81920
  ds_read_b64_tr_b16 v[204:205], v249 offset:4096
  ds_read_b64_tr_b16 v[206:207], v249 offset:6144
  v_mfma_f32_16x16x32_bf16 a[24:27], v[208:211], v[28:31], a[24:27]
  buffer_load_dwordx4 v240, s[48:51], s79 offen lds
  v_mfma_f32_16x16x32_bf16 a[20:23], v[212:215], v[24:27], a[20:23]
  ds_read_b64_tr_b16 v[208:209], v250 offset:4096
  v_mfma_f32_16x16x32_bf16 a[28:31], v[212:215], v[28:31], a[28:31]
  s_waitcnt lgkmcnt(3)
  ds_read_b64_tr_b16 v[210:211], v250 offset:6144
  v_mfma_f32_16x16x32_bf16 a[32:35], v[216:219], v[0:3], a[32:35]
  ds_read_b64_tr_b16 v[212:213], v249 offset:8192
  ds_read_b64_tr_b16 v[214:215], v249 offset:10240
  v_mfma_f32_16x16x32_bf16 a[40:43], v[216:219], v[4:7], a[40:43]
  buffer_load_dwordx4 v240, s[52:55], s79 offen offset:1024 lds
  v_mfma_f32_16x16x32_bf16 a[36:39], v[200:203], v[0:3], a[36:39]
  ds_read_b64_tr_b16 v[216:217], v250 offset:8192
  ds_read_b64_tr_b16 v[218:219], v250 offset:10240
  v_mfma_f32_16x16x32_bf16 a[44:47], v[200:203], v[4:7], a[44:47]
  s_waitcnt lgkmcnt(4)
  buffer_load_dwordx4 v240, s[56:59], s79 offen offset:2048 lds
  v_accvgpr_read_b32 v32, a0
  v_mfma_f32_16x16x32_bf16 a[32:35], v[204:207], v[8:11], a[32:35]
  ds_read_b64_tr_b16 v[200:201], v249 offset:12288
  v_accvgpr_read_b32 v33, a1
  v_mfma_f32_16x16x32_bf16 a[40:43], v[204:207], v[12:15], a[40:43]
  ds_read_b64_tr_b16 v[202:203], v249 offset:14336
  v_cvt_pk_bf16_f32 v96, v32, v33
  v_accvgpr_read_b32 v34, a2
  v_mfma_f32_16x16x32_bf16 a[36:39], v[208:211], v[8:11], a[36:39]
  ds_read_b64_tr_b16 v[204:205], v250 offset:12288
  ds_read_b64_tr_b16 v[206:207], v250 offset:14336
  v_mfma_f32_16x16x32_bf16 a[44:47], v[208:211], v[12:15], a[44:47]
  s_waitcnt lgkmcnt(4)
  buffer_load_dwordx4 v240, s[60:63], s79 offen offset:3072 lds
  v_accvgpr_read_b32 v35, a3
  v_mfma_f32_16x16x32_bf16 a[32:35], v[212:215], v[16:19], a[32:35]
  ds_read_b64_tr_b16 v[208:209], v249 offset:256
  v_cvt_pk_bf16_f32 v97, v34, v35
  v_mfma_f32_16x16x32_bf16 a[40:43], v[212:215], v[20:23], a[40:43]
  ds_read_b64_tr_b16 v[210:211], v249 offset:2304
  v_accvgpr_read_b32 v36, a4
  v_accvgpr_read_b32 v37, a5
  v_mfma_f32_16x16x32_bf16 a[36:39], v[216:219], v[16:19], a[36:39]
  ds_read_b64_tr_b16 v[212:213], v250 offset:256
  v_cvt_pk_bf16_f32 v98, v36, v37
  v_mfma_f32_16x16x32_bf16 a[44:47], v[216:219], v[20:23], a[44:47]
  s_waitcnt lgkmcnt(3)
  ds_read_b64_tr_b16 v[214:215], v250 offset:2304
  v_accvgpr_read_b32 v38, a6
  v_accvgpr_read_b32 v39, a7
  v_cvt_pk_bf16_f32 v99, v38, v39
  v_mfma_f32_16x16x32_bf16 a[32:35], v[200:203], v[24:27], a[32:35]
  ds_read_b64_tr_b16 v[216:217], v249 offset:4352
  ds_read_b64_tr_b16 v[218:219], v249 offset:6400
  v_mfma_f32_16x16x32_bf16 a[40:43], v[200:203], v[28:31], a[40:43]
  buffer_store_dwordx4 v[96:99], v236, s[64:67], s69 offen offset:0 sc1
  v_accvgpr_read_b32 v40, a8
  v_accvgpr_read_b32 v41, a9
  v_cvt_pk_bf16_f32 v100, v40, v41
  v_accvgpr_read_b32 v42, a10
  v_accvgpr_read_b32 v43, a11
  v_cvt_pk_bf16_f32 v101, v42, v43
  v_accvgpr_read_b32 v44, a12
  v_accvgpr_read_b32 v45, a13
  v_cvt_pk_bf16_f32 v102, v44, v45
  v_accvgpr_read_b32 v46, a14
  v_accvgpr_read_b32 v47, a15
  v_cvt_pk_bf16_f32 v103, v46, v47
  v_mfma_f32_16x16x32_bf16 a[36:39], v[204:207], v[24:27], a[36:39]
  ds_read_b64_tr_b16 v[200:201], v250 offset:4352
  ds_read_b64_tr_b16 v[202:203], v250 offset:6400
  v_mfma_f32_16x16x32_bf16 a[44:47], v[204:207], v[28:31], a[44:47]
  s_waitcnt lgkmcnt(4)
  buffer_store_dwordx4 v[100:103], v236, s[64:67], s69 offen offset:1024 sc1
  v_accvgpr_read_b32 v48, a16
  v_accvgpr_read_b32 v49, a17
  v_cvt_pk_bf16_f32 v104, v48, v49
  v_accvgpr_read_b32 v50, a18
  v_accvgpr_read_b32 v51, a19
  v_cvt_pk_bf16_f32 v105, v50, v51
  v_accvgpr_read_b32 v52, a20
  v_accvgpr_read_b32 v53, a21
  v_cvt_pk_bf16_f32 v106, v52, v53
  v_accvgpr_read_b32 v54, a22
  v_accvgpr_read_b32 v55, a23
  v_cvt_pk_bf16_f32 v107, v54, v55
  v_mfma_f32_16x16x32_bf16 a[48:51], v[208:211], v[0:3], a[48:51]
  ds_read_b64_tr_b16 v[204:205], v249 offset:8448
  ds_read_b64_tr_b16 v[206:207], v249 offset:10496
  v_mfma_f32_16x16x32_bf16 a[56:59], v[208:211], v[4:7], a[56:59]
  buffer_store_dwordx4 v[104:107], v236, s[64:67], s69 offen offset:2048 sc1
  v_accvgpr_read_b32 v56, a24
  v_accvgpr_read_b32 v57, a25
  v_cvt_pk_bf16_f32 v108, v56, v57
  v_accvgpr_read_b32 v58, a26
  v_accvgpr_read_b32 v59, a27
  v_cvt_pk_bf16_f32 v109, v58, v59
  v_accvgpr_read_b32 v60, a28
  v_accvgpr_read_b32 v61, a29
  v_cvt_pk_bf16_f32 v110, v60, v61
  v_accvgpr_read_b32 v62, a30
  v_accvgpr_read_b32 v63, a31
  v_cvt_pk_bf16_f32 v111, v62, v63
  v_mfma_f32_16x16x32_bf16 a[52:55], v[212:215], v[0:3], a[52:55]
  ds_read_b64_tr_b16 v[208:209], v250 offset:8448
  ds_read_b64_tr_b16 v[210:211], v250 offset:10496
  v_mfma_f32_16x16x32_bf16 a[60:63], v[212:215], v[4:7], a[60:63]
  s_waitcnt lgkmcnt(4)
  buffer_store_dwordx4 v[108:111], v236, s[64:67], s69 offen offset:3072 sc1
  v_mfma_f32_16x16x32_bf16 a[48:51], v[216:219], v[8:11], a[48:51]
  ds_read_b64_tr_b16 v[212:213], v249 offset:12544
  s_lshl_b32 s69, s73, 10
  v_mfma_f32_16x16x32_bf16 a[56:59], v[216:219], v[12:15], a[56:59]
  ds_read_b64_tr_b16 v[214:215], v249 offset:14592
  v_accvgpr_read_b32 v32, a32
  v_mfma_f32_16x16x32_bf16 a[52:55], v[200:203], v[8:11], a[52:55]
  ds_read_b64_tr_b16 v[216:217], v250 offset:12544
  v_accvgpr_read_b32 v33, a33
  v_mfma_f32_16x16x32_bf16 a[60:63], v[200:203], v[12:15], a[60:63]
  s_waitcnt lgkmcnt(3)
  ds_read_b64_tr_b16 v[218:219], v250 offset:14592
  v_cvt_pk_bf16_f32 v112, v32, v33
  v_mfma_f32_16x16x32_bf16 a[48:51], v[204:207], v[16:19], a[48:51]
  s_waitcnt vmcnt(4)
  s_barrier
  ds_read_b64_tr_b16 v[200:201], v247 offset:49152
  v_mfma_f32_16x16x32_bf16 a[56:59], v[204:207], v[20:23], a[56:59]
  ds_read_b64_tr_b16 v[202:203], v247 offset:51200
  v_accvgpr_read_b32 v34, a34
  v_mfma_f32_16x16x32_bf16 a[52:55], v[208:211], v[16:19], a[52:55]
  ds_read_b64_tr_b16 v[204:205], v248 offset:49152
  v_accvgpr_read_b32 v35, a35
  v_mfma_f32_16x16x32_bf16 a[60:63], v[208:211], v[20:23], a[60:63]
  s_waitcnt lgkmcnt(3)
  ds_read_b64_tr_b16 v[206:207], v248 offset:51200
  v_cvt_pk_bf16_f32 v113, v34, v35
  v_mfma_f32_16x16x32_bf16 a[48:51], v[212:215], v[24:27], a[48:51]
  ds_read_b64_tr_b16 v[208:209], v247 offset:53248
  v_accvgpr_read_b32 v36, a36
  v_mfma_f32_16x16x32_bf16 a[56:59], v[212:215], v[28:31], a[56:59]
  ds_read_b64_tr_b16 v[210:211], v247 offset:55296
  v_accvgpr_read_b32 v37, a37
  v_mfma_f32_16x16x32_bf16 a[52:55], v[216:219], v[24:27], a[52:55]
  ds_read_b64_tr_b16 v[212:213], v248 offset:53248
  v_cvt_pk_bf16_f32 v114, v36, v37
  v_mfma_f32_16x16x32_bf16 a[60:63], v[216:219], v[28:31], a[60:63]
  s_waitcnt lgkmcnt(3)
  ds_read_b64_tr_b16 v[214:215], v248 offset:55296
  v_accvgpr_read_b32 v38, a38
L_tailcode:
  v_mfma_f32_16x16x32_bf16 a[64:67], v[200:203], v[0:3], a[64:67]
  ds_read_b64_tr_b16 v[216:217], v247 offset:57344
  v_accvgpr_read_b32 v39, a39
  v_mfma_f32_16x16x32_bf16 a[72:75], v[200:203], v[4:7], a[72:75]
  ds_read_b64_tr_b16 v[218:219], v247 offset:59392
  v_cvt_pk_bf16_f32 v115, v38, v39
  v_mfma_f32_16x16x32_bf16 a[68:71], v[204:207], v[0:3], a[68:71]
  ds_read_b64_tr_b16 v[200:201], v248 offset:57344
  ds_read_b64_tr_b16 v[202:203], v248 offset:59392
  v_mfma_f32_16x16x32_bf16 a[76:79], v[204:207], v[4:7], a[76:79]
  s_waitcnt lgkmcnt(4)
  buffer_store_dwordx4 v[112:115], v236, s[64:67], s69 offen offset:0 sc1
  v_accvgpr_read_b32 v40, a40
  v_mfma_f32_16x16x32_bf16 a[64:67], v[208:211], v[8:11], a[64:67]
  ds_read_b64_tr_b16 v[204:205], v247 offset:61440
  v_accvgpr_read_b32 v41, a41
  v_mfma_f32_16x16x32_bf16 a[72:75], v[208:211], v[12:15], a[72:75]
  ds_read_b64_tr_b16 v[206:207], v247 offset:63488
  v_cvt_pk_bf16_f32 v116, v40, v41
  v_accvgpr_read_b32 v42, a42
  v_mfma_f32_16x16x32_bf16 a[68:71], v[212:215], v[8:11], a[68:71]
  ds_read_b64_tr_b16 v[208:209], v248 offset:61440
  v_accvgpr_read_b32 v43, a43
  v_mfma_f32_16x16x32_bf16 a[76:79], v[212:215], v[12:15], a[76:79]
  s_waitcnt lgkmcnt(3)
  ds_read_b64_tr_b16 v[210:211], v248 offset:63488
  v_cvt_pk_bf16_f32 v117, v42, v43
  v_accvgpr_read_b32 v44, a44
  v_mfma_f32_16x16x32_bf16 a[64:67], v[216:219], v[16:19], a[64:67]
  ds_read_b64_tr_b16 v[212:213], v247 offset:49408
  v_accvgpr_read_b32 v45, a45
  v_mfma_f32_16x16x32_bf16 a[72:75], v[216:219], v[20:23], a[72:75]
  ds_read_b64_tr_b16 v[214:215], v247 offset:51456
  v_cvt_pk_bf16_f32 v118, v44, v45
  v_accvgpr_read_b32 v46, a46
  v_mfma_f32_16x16x32_bf16 a[68:71], v[200:203], v[16:19], a[68:71]
  ds_read_b64_tr_b16 v[216:217], v248 offset:49408
  v_accvgpr_read_b32 v47, a47
  v_mfma_f32_16x16x32_bf16 a[76:79], v[200:203], v[20:23], a[76:79]
  s_waitcnt lgkmcnt(3)
  ds_read_b64_tr_b16 v[218:219], v248 offset:51456
  v_cvt_pk_bf16_f32 v119, v46, v47
  v_accvgpr_read_b32 v48, a48
  v_mfma_f32_16x16x32_bf16 a[64:67], v[204:207], v[24:27], a[64:67]
  ds_read_b64_tr_b16 v[200:201], v247 offset:53504
  ds_read_b64_tr_b16 v[202:203], v247 offset:55552
  v_mfma_f32_16x16x32_bf16 a[72:75], v[204:207], v[28:31], a[72:75]
  buffer_store_dwordx4 v[116:119], v236, s[64:67], s69 offen offset:1024 sc1
  v_accvgpr_read_b32 v49, a49
  v_mfma_f32_16x16x32_bf16 a[68:71], v[208:211], v[24:27], a[68:71]
  ds_read_b64_tr_b16 v[204:205], v248 offset:53504
  v_cvt_pk_bf16_f32 v120, v48, v49
  v_mfma_f32_16x16x32_bf16 a[76:79], v[208:211], v[28:31], a[76:79]
  s_waitcnt lgkmcnt(3)
  ds_read_b64_tr_b16 v[206:207], v248 offset:55552
  v_accvgpr_read_b32 v50, a50
  v_accvgpr_read_b32 v51, a51
  v_cvt_pk_bf16_f32 v121, v50, v51
  v_accvgpr_read_b32 v52, a52
  v_accvgpr_read_b32 v53, a53
  v_cvt_pk_bf16_f32 v122, v52, v53
  v_accvgpr_read_b32 v54, a54
  v_accvgpr_read_b32 v55, a55
  v_cvt_pk_bf16_f32 v123, v54, v55
  v_mfma_f32_16x16x32_bf16 a[80:83], v[212:215], v[0:3], a[80:83]
  ds_read_b64_tr_b16 v[208:209], v247 offset:57600
  ds_read_b64_tr_b16 v[210:211], v247 offset:59648
  v_mfma_f32_16x16x32_bf16 a[88:91], v[212:215], v[4:7], a[88:91]
  buffer_store_dwordx4 v[120:123], v236, s[64:67], s69 offen offset:2048 sc1
  v_accvgpr_read_b32 v56, a56
  v_accvgpr_read_b32 v57, a57
  v_cvt_pk_bf16_f32 v124, v56, v57
  v_accvgpr_read_b32 v58, a58
  v_accvgpr_read_b32 v59, a59
  v_cvt_pk_bf16_f32 v125, v58, v59
  v_accvgpr_read_b32 v60, a60
  v_accvgpr_read_b32 v61, a61
  v_cvt_pk_bf16_f32 v126, v60, v61
  v_accvgpr_read_b32 v62, a62
  v_accvgpr_read_b32 v63, a63
  v_cvt_pk_bf16_f32 v127, v62, v63
  v_mfma_f32_16x16x32_bf16 a[84:87], v[216:219], v[0:3], a[84:87]
  ds_read_b64_tr_b16 v[212:213], v248 offset:57600
  ds_read_b64_tr_b16 v[214:215], v248 offset:59648
  v_mfma_f32_16x16x32_bf16 a[92:95], v[216:219], v[4:7], a[92:95]
  s_waitcnt lgkmcnt(4)
  buffer_store_dwordx4 v[124:127], v236, s[64:67], s69 offen offset:3072 sc1
  v_mfma_f32_16x16x32_bf16 a[80:83], v[200:203], v[8:11], a[80:83]
  ds_read_b64_tr_b16 v[216:217], v247 offset:61696
  s_lshl_b32 s69, s74, 10
  v_mfma_f32_16x16x32_bf16 a[88:91], v[200:203], v[12:15], a[88:91]
  ds_read_b64_tr_b16 v[218:219], v247 offset:63744
  v_accvgpr_read_b32 v32, a64
  v_mfma_f32_16x16x32_bf16 a[84:87], v[204:207], v[8:11], a[84:87]
  ds_read_b64_tr_b16 v[200:201], v248 offset:61696
  v_accvgpr_read_b32 v33, a65
  v_mfma_f32_16x16x32_bf16 a[92:95], v[204:207], v[12:15], a[92:95]
  s_waitcnt lgkmcnt(3)
  ds_read_b64_tr_b16 v[202:203], v248 offset:63744
  v_cvt_pk_bf16_f32 v96, v32, v33
  v_mfma_f32_16x16x32_bf16 a[80:83], v[208:211], v[16:19], a[80:83]
  ds_read_b64_tr_b16 v[204:205], v249 offset:32768
  v_accvgpr_read_b32 v34, a66
  v_mfma_f32_16x16x32_bf16 a[88:91], v[208:211], v[20:23], a[88:91]
  ds_read_b64_tr_b16 v[206:207], v249 offset:34816
  v_accvgpr_read_b32 v35, a67
  v_mfma_f32_16x16x32_bf16 a[84:87], v[212:215], v[16:19], a[84:87]
  ds_read_b64_tr_b16 v[208:209], v250 offset:32768
  v_cvt_pk_bf16_f32 v97, v34, v35
  v_mfma_f32_16x16x32_bf16 a[92:95], v[212:215], v[20:23], a[92:95]
  s_waitcnt lgkmcnt(3)
  ds_read_b64_tr_b16 v[210:211], v250 offset:34816
  v_accvgpr_read_b32 v36, a68
  v_mfma_f32_16x16x32_bf16 a[80:83], v[216:219], v[24:27], a[80:83]
  ds_read_b64_tr_b16 v[212:213], v249 offset:36864
  v_accvgpr_read_b32 v37, a69
  v_mfma_f32_16x16x32_bf16 a[88:91], v[216:219], v[28:31], a[88:91]
  ds_read_b64_tr_b16 v[214:215], v249 offset:38912
  v_cvt_pk_bf16_f32 v98, v36, v37
  v_mfma_f32_16x16x32_bf16 a[84:87], v[200:203], v[24:27], a[84:87]
  ds_read_b64_tr_b16 v[216:217], v250 offset:36864
  v_accvgpr_read_b32 v38, a70
  v_mfma_f32_16x16x32_bf16 a[92:95], v[200:203], v[28:31], a[92:95]
  s_waitcnt lgkmcnt(3)
  ds_read_b64_tr_b16 v[218:219], v250 offset:38912
  v_accvgpr_read_b32 v39, a71
  v_mfma_f32_16x16x32_bf16 a[96:99], v[204:207], v[0:3], a[96:99]
  ds_read_b64_tr_b16 v[200:201], v249 offset:40960
  v_cvt_pk_bf16_f32 v99, v38, v39
  v_mfma_f32_16x16x32_bf16 a[104:107], v[204:207], v[4:7], a[104:107]
  ds_read_b64_tr_b16 v[202:203], v249 offset:43008
  buffer_store_dwordx4 v[96:99], v236, s[64:67], s69 offen offset:0 sc1
  v_mfma_f32_16x16x32_bf16 a[100:103], v[208:211], v[0:3], a[100:103]
  ds_read_b64_tr_b16 v[204:205], v250 offset:40960
  v_accvgpr_read_b32 v40, a72
  v_mfma_f32_16x16x32_bf16 a[108:111], v[208:211], v[4:7], a[108:111]
  s_waitcnt lgkmcnt(3)
  ds_read_b64_tr_b16 v[206:207], v250 offset:43008
  v_accvgpr_read_b32 v41, a73
  v_cvt_pk_bf16_f32 v100, v40, v41
  v_mfma_f32_16x16x32_bf16 a[96:99], v[212:215], v[8:11], a[96:99]
  ds_read_b64_tr_b16 v[208:209], v249 offset:45056
  v_accvgpr_read_b32 v42, a74
  v_mfma_f32_16x16x32_bf16 a[104:107], v[212:215], v[12:15], a[104:107]
  ds_read_b64_tr_b16 v[210:211], v249 offset:47104
  v_accvgpr_read_b32 v43, a75
  v_cvt_pk_bf16_f32 v101, v42, v43
  v_mfma_f32_16x16x32_bf16 a[100:103], v[216:219], v[8:11], a[100:103]
  ds_read_b64_tr_b16 v[212:213], v250 offset:45056
  v_accvgpr_read_b32 v44, a76
  v_mfma_f32_16x16x32_bf16 a[108:111], v[216:219], v[12:15], a[108:111]
  s_waitcnt lgkmcnt(3)
  ds_read_b64_tr_b16 v[214:215], v250 offset:47104
  v_accvgpr_read_b32 v45, a77
  v_cvt_pk_bf16_f32 v102, v44, v45
  v_mfma_f32_16x16x32_bf16 a[96:99], v[200:203], v[16:19], a[96:99]
  ds_read_b64_tr_b16 v[216:217], v249 offset:33024
  v_accvgpr_read_b32 v46, a78
  v_mfma_f32_16x16x32_bf16 a[104:107], v[200:203], v[20:23], a[104:107]
  s_waitcnt vmcnt(5)
  ds_read_b64_tr_b16 v[218:219], v249 offset:35072
  buffer_store_dword v252, v237, s[64:67], s72 offen sc1
  v_mfma_f32_16x16x32_bf16 a[100:103], v[204:207], v[16:19], a[100:103]
  ds_read_b64_tr_b16 v[200:201], v250 offset:33024
  v_accvgpr_read_b32 v47, a79
  v_mfma_f32_16x16x32_bf16 a[108:111], v[204:207], v[20:23], a[108:111]
  s_waitcnt lgkmcnt(3)
  ds_read_b64_tr_b16 v[202:203], v250 offset:35072
  v_cvt_pk_bf16_f32 v103, v46, v47
  v_accvgpr_read_b32 v48, a80
  v_mfma_f32_16x16x32_bf16 a[96:99], v[208:211], v[24:27], a[96:99]
  ds_read_b64_tr_b16 v[204:205], v249 offset:37120
  ds_read_b64_tr_b16 v[206:207], v249 offset:39168
  v_mfma_f32_16x16x32_bf16 a[104:107], v[208:211], v[28:31], a[104:107]
  buffer_store_dwordx4 v[100:103], v236, s[64:67], s69 offen offset:1024 sc1
  v_accvgpr_read_b32 v49, a81
  v_mfma_f32_16x16x32_bf16 a[100:103], v[212:215], v[24:27], a[100:103]
  ds_read_b64_tr_b16 v[208:209], v250 offset:37120
  v_cvt_pk_bf16_f32 v104, v48, v49
  v_mfma_f32_16x16x32_bf16 a[108:111], v[212:215], v[28:31], a[108:111]
  s_waitcnt lgkmcnt(3)
  ds_read_b64_tr_b16 v[210:211], v250 offset:39168
  v_accvgpr_read_b32 v50, a82
  v_accvgpr_read_b32 v51, a83
  v_cvt_pk_bf16_f32 v105, v50, v51
  v_accvgpr_read_b32 v52, a84
  v_accvgpr_read_b32 v53, a85
  v_cvt_pk_bf16_f32 v106, v52, v53
  v_accvgpr_read_b32 v54, a86
  v_accvgpr_read_b32 v55, a87
  v_cvt_pk_bf16_f32 v107, v54, v55
  v_mfma_f32_16x16x32_bf16 a[112:115], v[216:219], v[0:3], a[112:115]
  ds_read_b64_tr_b16 v[212:213], v249 offset:41216
  ds_read_b64_tr_b16 v[214:215], v249 offset:43264
  v_mfma_f32_16x16x32_bf16 a[120:123], v[216:219], v[4:7], a[120:123]
  buffer_store_dwordx4 v[104:107], v236, s[64:67], s69 offen offset:2048 sc1
  v_accvgpr_read_b32 v56, a88
  v_accvgpr_read_b32 v57, a89
  v_cvt_pk_bf16_f32 v108, v56, v57
  v_accvgpr_read_b32 v58, a90
  v_accvgpr_read_b32 v59, a91
  v_cvt_pk_bf16_f32 v109, v58, v59
  v_accvgpr_read_b32 v60, a92
  v_accvgpr_read_b32 v61, a93
  v_cvt_pk_bf16_f32 v110, v60, v61
  v_accvgpr_read_b32 v62, a94
  v_accvgpr_read_b32 v63, a95
  v_cvt_pk_bf16_f32 v111, v62, v63
  v_mfma_f32_16x16x32_bf16 a[116:119], v[200:203], v[0:3], a[116:119]
  ds_read_b64_tr_b16 v[216:217], v250 offset:41216
  ds_read_b64_tr_b16 v[218:219], v250 offset:43264
  v_mfma_f32_16x16x32_bf16 a[124:127], v[200:203], v[4:7], a[124:127]
  s_waitcnt lgkmcnt(4)
  buffer_store_dwordx4 v[108:111], v236, s[64:67], s69 offen offset:3072 sc1
  v_mfma_f32_16x16x32_bf16 a[112:115], v[204:207], v[8:11], a[112:115]
  ds_read_b64_tr_b16 v[200:201], v249 offset:45312
  s_lshl_b32 s69, s75, 10
  v_mfma_f32_16x16x32_bf16 a[120:123], v[204:207], v[12:15], a[120:123]
  ds_read_b64_tr_b16 v[202:203], v249 offset:47360
  v_accvgpr_read_b32 v32, a96
  v_mfma_f32_16x16x32_bf16 a[116:119], v[208:211], v[8:11], a[116:119]
  ds_read_b64_tr_b16 v[204:205], v250 offset:45312
  v_accvgpr_read_b32 v33, a97
  v_mfma_f32_16x16x32_bf16 a[124:127], v[208:211], v[12:15], a[124:127]
  s_waitcnt lgkmcnt(3)
  ds_read_b64_tr_b16 v[206:207], v250 offset:47360
  v_cvt_pk_bf16_f32 v112, v32, v33
  v_mfma_f32_16x16x32_bf16 a[112:115], v[212:215], v[16:19], a[112:115]
  ds_read_b64_tr_b16 v[208:209], v247 offset:0
  v_accvgpr_read_b32 v34, a98
  v_mfma_f32_16x16x32_bf16 a[120:123], v[212:215], v[20:23], a[120:123]
  ds_read_b64_tr_b16 v[210:211], v247 offset:2048
  v_accvgpr_read_b32 v35, a99
  v_mfma_f32_16x16x32_bf16 a[116:119], v[216:219], v[16:19], a[116:119]
  ds_read_b64_tr_b16 v[212:213], v248 offset:0
  v_cvt_pk_bf16_f32 v113, v34, v35
  v_mfma_f32_16x16x32_bf16 a[124:127], v[216:219], v[20:23], a[124:127]
  s_waitcnt lgkmcnt(3)
  ds_read_b64_tr_b16 v[214:215], v248 offset:2048
  v_accvgpr_read_b32 v36, a100
  v_mfma_f32_16x16x32_bf16 a[112:115], v[200:203], v[24:27], a[112:115]
  ds_read_b64_tr_b16 v[216:217], v247 offset:4096
  v_accvgpr_read_b32 v37, a101
  v_mfma_f32_16x16x32_bf16 a[120:123], v[200:203], v[28:31], a[120:123]
  ds_read_b64_tr_b16 v[218:219], v247 offset:6144
  v_cvt_pk_bf16_f32 v114, v36, v37
  v_mfma_f32_16x16x32_bf16 a[116:119], v[204:207], v[24:27], a[116:119]
  ds_read_b64_tr_b16 v[200:201], v248 offset:4096
  v_accvgpr_read_b32 v38, a102
  v_mfma_f32_16x16x32_bf16 a[124:127], v[204:207], v[28:31], a[124:127]
  s_waitcnt lgkmcnt(3)
  ds_read_b64_tr_b16 v[202:203], v248 offset:6144
  v_accvgpr_read_b32 v39, a103
  v_mfma_f32_16x16x32_bf16 a[128:131], v[208:211], v[0:3], a[128:131]
  ds_read_b64_tr_b16 v[204:205], v247 offset:8192
  v_cvt_pk_bf16_f32 v115, v38, v39
  v_mfma_f32_16x16x32_bf16 a[136:139], v[208:211], v[4:7], a[136:139]
  ds_read_b64_tr_b16 v[206:207], v247 offset:10240
  buffer_store_dwordx4 v[112:115], v236, s[64:67], s69 offen offset:0 sc1
  v_mfma_f32_16x16x32_bf16 a[132:135], v[212:215], v[0:3], a[132:135]
  ds_read_b64_tr_b16 v[208:209], v248 offset:8192
  v_accvgpr_read_b32 v40, a104
  v_mfma_f32_16x16x32_bf16 a[140:143], v[212:215], v[4:7], a[140:143]
  s_waitcnt lgkmcnt(3)
  ds_read_b64_tr_b16 v[210:211], v248 offset:10240
  v_accvgpr_read_b32 v41, a105
  v_cvt_pk_bf16_f32 v116, v40, v41
  v_mfma_f32_16x16x32_bf16 a[128:131], v[216:219], v[8:11], a[128:131]
  ds_read_b64_tr_b16 v[212:213], v247 offset:12288
  v_accvgpr_read_b32 v42, a106
  v_mfma_f32_16x16x32_bf16 a[136:139], v[216:219], v[12:15], a[136:139]
  ds_read_b64_tr_b16 v[214:215], v247 offset:14336
  v_accvgpr_read_b32 v43, a107
  v_cvt_pk_bf16_f32 v117, v42, v43
  v_mfma_f32_16x16x32_bf16 a[132:135], v[200:203], v[8:11], a[132:135]
  ds_read_b64_tr_b16 v[216:217], v248 offset:12288
  v_accvgpr_read_b32 v44, a108
  v_mfma_f32_16x16x32_bf16 a[140:143], v[200:203], v[12:15], a[140:143]
  s_waitcnt lgkmcnt(3)
  ds_read_b64_tr_b16 v[218:219], v248 offset:14336
  v_accvgpr_read_b32 v45, a109
  v_cvt_pk_bf16_f32 v118, v44, v45
  v_mfma_f32_16x16x32_bf16 a[128:131], v[204:207], v[16:19], a[128:131]
  ds_read_b64_tr_b16 v[200:201], v247 offset:256
  v_accvgpr_read_b32 v46, a110
  v_mfma_f32_16x16x32_bf16 a[136:139], v[204:207], v[20:23], a[136:139]
  s_waitcnt vmcnt(6)
  ds_read_b64_tr_b16 v[202:203], v247 offset:2304
  buffer_store_dword v252, v237, s[64:67], s73 offen sc1
  v_mfma_f32_16x16x32_bf16 a[132:135], v[208:211], v[16:19], a[132:135]
  ds_read_b64_tr_b16 v[204:205], v248 offset:256
  v_accvgpr_read_b32 v47, a111
  v_mfma_f32_16x16x32_bf16 a[140:143], v[208:211], v[20:23], a[140:143]
  s_waitcnt lgkmcnt(3)
  ds_read_b64_tr_b16 v[206:207], v248 offset:2304
  v_cvt_pk_bf16_f32 v119, v46, v47
  v_accvgpr_read_b32 v48, a112
  v_mfma_f32_16x16x32_bf16 a[128:131], v[212:215], v[24:27], a[128:131]
  ds_read_b64_tr_b16 v[208:209], v247 offset:4352
  ds_read_b64_tr_b16 v[210:211], v247 offset:6400
  v_mfma_f32_16x16x32_bf16 a[136:139], v[212:215], v[28:31], a[136:139]
  buffer_store_dwordx4 v[116:119], v236, s[64:67], s69 offen offset:1024 sc1
  v_accvgpr_read_b32 v49, a113
  v_mfma_f32_16x16x32_bf16 a[132:135], v[216:219], v[24:27], a[132:135]
  ds_read_b64_tr_b16 v[212:213], v248 offset:4352
  v_cvt_pk_bf16_f32 v120, v48, v49
  v_mfma_f32_16x16x32_bf16 a[140:143], v[216:219], v[28:31], a[140:143]
  s_waitcnt lgkmcnt(3)
  ds_read_b64_tr_b16 v[214:215], v248 offset:6400
  v_accvgpr_read_b32 v50, a114
  v_accvgpr_read_b32 v51, a115
  v_cvt_pk_bf16_f32 v121, v50, v51
  v_accvgpr_read_b32 v52, a116
  v_accvgpr_read_b32 v53, a117
  v_cvt_pk_bf16_f32 v122, v52, v53
  v_accvgpr_read_b32 v54, a118
  v_accvgpr_read_b32 v55, a119
  v_cvt_pk_bf16_f32 v123, v54, v55
  v_mfma_f32_16x16x32_bf16 a[144:147], v[200:203], v[0:3], a[144:147]
  ds_read_b64_tr_b16 v[216:217], v247 offset:8448
  ds_read_b64_tr_b16 v[218:219], v247 offset:10496
  v_mfma_f32_16x16x32_bf16 a[152:155], v[200:203], v[4:7], a[152:155]
  buffer_store_dwordx4 v[120:123], v236, s[64:67], s69 offen offset:2048 sc1
  v_accvgpr_read_b32 v56, a120
  v_accvgpr_read_b32 v57, a121
  v_cvt_pk_bf16_f32 v124, v56, v57
  v_accvgpr_read_b32 v58, a122
  v_accvgpr_read_b32 v59, a123
  v_cvt_pk_bf16_f32 v125, v58, v59
  v_accvgpr_read_b32 v60, a124
  v_accvgpr_read_b32 v61, a125
  v_cvt_pk_bf16_f32 v126, v60, v61
  v_accvgpr_read_b32 v62, a126
  v_accvgpr_read_b32 v63, a127
  v_cvt_pk_bf16_f32 v127, v62, v63
  v_mfma_f32_16x16x32_bf16 a[148:151], v[204:207], v[0:3], a[148:151]
  ds_read_b64_tr_b16 v[200:201], v248 offset:8448
  ds_read_b64_tr_b16 v[202:203], v248 offset:10496
  v_mfma_f32_16x16x32_bf16 a[156:159], v[204:207], v[4:7], a[156:159]
  s_waitcnt lgkmcnt(4)
  buffer_store_dwordx4 v[124:127], v236, s[64:67], s69 offen offset:3072 sc1
  v_mfma_f32_16x16x32_bf16 a[144:147], v[208:211], v[8:11], a[144:147]
  ds_read_b64_tr_b16 v[204:205], v247 offset:12544
  v_subrev_u32 v245, 32768, v249
  v_mfma_f32_16x16x32_bf16 a[152:155], v[208:211], v[12:15], a[152:155]
  ds_read_b64_tr_b16 v[206:207], v247 offset:14592
  v_subrev_u32 v246, 32768, v250
  v_mfma_f32_16x16x32_bf16 a[148:151], v[212:215], v[8:11], a[148:151]
  ds_read_b64_tr_b16 v[208:209], v248 offset:12544
  s_lshl_b32 s69, s76, 10
  v_mfma_f32_16x16x32_bf16 a[156:159], v[212:215], v[12:15], a[156:159]
  s_waitcnt lgkmcnt(3)
  ds_read_b64_tr_b16 v[210:211], v248 offset:14592
  v_accvgpr_read_b32 v32, a128
  v_mfma_f32_16x16x32_bf16 a[144:147], v[216:219], v[16:19], a[144:147]
  ds_read_b64_tr_b16 v[212:213], v249 offset:49152
  v_accvgpr_read_b32 v33, a129
  v_mfma_f32_16x16x32_bf16 a[152:155], v[216:219], v[20:23], a[152:155]
  ds_read_b64_tr_b16 v[214:215], v249 offset:51200
  v_cvt_pk_bf16_f32 v96, v32, v33
  v_mfma_f32_16x16x32_bf16 a[148:151], v[200:203], v[16:19], a[148:151]
  ds_read_b64_tr_b16 v[216:217], v250 offset:49152
  v_accvgpr_read_b32 v34, a130
  v_mfma_f32_16x16x32_bf16 a[156:159], v[200:203], v[20:23], a[156:159]
  s_waitcnt lgkmcnt(3)
  ds_read_b64_tr_b16 v[218:219], v250 offset:51200
  v_accvgpr_read_b32 v35, a131
  v_mfma_f32_16x16x32_bf16 a[144:147], v[204:207], v[24:27], a[144:147]
  ds_read_b64_tr_b16 v[200:201], v249 offset:53248
  v_cvt_pk_bf16_f32 v97, v34, v35
  v_mfma_f32_16x16x32_bf16 a[152:155], v[204:207], v[28:31], a[152:155]
  ds_read_b64_tr_b16 v[202:203], v249 offset:55296
  v_accvgpr_read_b32 v36, a132
  v_mfma_f32_16x16x32_bf16 a[148:151], v[208:211], v[24:27], a[148:151]
  ds_read_b64_tr_b16 v[204:205], v250 offset:53248
  v_accvgpr_read_b32 v37, a133
  v_mfma_f32_16x16x32_bf16 a[156:159], v[208:211], v[28:31], a[156:159]
  s_waitcnt lgkmcnt(3)
  ds_read_b64_tr_b16 v[206:207], v250 offset:55296
  v_cvt_pk_bf16_f32 v98, v36, v37
  v_mfma_f32_16x16x32_bf16 a[160:163], v[212:215], v[0:3], a[160:163]
  ds_read_b64_tr_b16 v[208:209], v249 offset:57344
  v_accvgpr_read_b32 v38, a134
  v_mfma_f32_16x16x32_bf16 a[168:171], v[212:215], v[4:7], a[168:171]
  ds_read_b64_tr_b16 v[210:211], v249 offset:59392
  v_accvgpr_read_b32 v39, a135
  v_mfma_f32_16x16x32_bf16 a[164:167], v[216:219], v[0:3], a[164:167]
  ds_read_b64_tr_b16 v[212:213], v250 offset:57344
  v_cvt_pk_bf16_f32 v99, v38, v39
  v_mfma_f32_16x16x32_bf16 a[172:175], v[216:219], v[4:7], a[172:175]
  s_waitcnt lgkmcnt(3)
  ds_read_b64_tr_b16 v[214:215], v250 offset:59392
  buffer_store_dwordx4 v[96:99], v236, s[64:67], s69 offen offset:0 sc1
  v_mfma_f32_16x16x32_bf16 a[160:163], v[200:203], v[8:11], a[160:163]
  ds_read_b64_tr_b16 v[216:217], v249 offset:61440
  v_accvgpr_read_b32 v40, a136
  v_mfma_f32_16x16x32_bf16 a[168:171], v[200:203], v[12:15], a[168:171]
  ds_read_b64_tr_b16 v[218:219], v249 offset:63488
  v_accvgpr_read_b32 v41, a137
  v_cvt_pk_bf16_f32 v100, v40, v41
  v_mfma_f32_16x16x32_bf16 a[164:167], v[204:207], v[8:11], a[164:167]
  ds_read_b64_tr_b16 v[200:201], v250 offset:61440
  v_accvgpr_read_b32 v42, a138
  v_mfma_f32_16x16x32_bf16 a[172:175], v[204:207], v[12:15], a[172:175]
  s_waitcnt lgkmcnt(3)
  ds_read_b64_tr_b16 v[202:203], v250 offset:63488
  v_accvgpr_read_b32 v43, a139
  v_cvt_pk_bf16_f32 v101, v42, v43
  v_mfma_f32_16x16x32_bf16 a[160:163], v[208:211], v[16:19], a[160:163]
  ds_read_b64_tr_b16 v[204:205], v249 offset:49408
  v_accvgpr_read_b32 v44, a140
  v_mfma_f32_16x16x32_bf16 a[168:171], v[208:211], v[20:23], a[168:171]
  s_waitcnt vmcnt(6)
  ds_read_b64_tr_b16 v[206:207], v249 offset:51456
  buffer_store_dword v252, v237, s[64:67], s74 offen sc1
  v_mfma_f32_16x16x32_bf16 a[164:167], v[212:215], v[16:19], a[164:167]
  ds_read_b64_tr_b16 v[208:209], v250 offset:49408
  v_accvgpr_read_b32 v45, a141
  v_mfma_f32_16x16x32_bf16 a[172:175], v[212:215], v[20:23], a[172:175]
  s_waitcnt lgkmcnt(3)
  ds_read_b64_tr_b16 v[210:211], v250 offset:51456
  v_cvt_pk_bf16_f32 v102, v44, v45
  v_accvgpr_read_b32 v46, a142
  v_mfma_f32_16x16x32_bf16 a[160:163], v[216:219], v[24:27], a[160:163]
  ds_read_b64_tr_b16 v[212:213], v249 offset:53504
  v_accvgpr_read_b32 v47, a143
  v_mfma_f32_16x16x32_bf16 a[168:171], v[216:219], v[28:31], a[168:171]
  ds_read_b64_tr_b16 v[214:215], v249 offset:55552
  v_cvt_pk_bf16_f32 v103, v46, v47
  v_accvgpr_read_b32 v48, a144
  v_mfma_f32_16x16x32_bf16 a[164:167], v[200:203], v[24:27], a[164:167]
  ds_read_b64_tr_b16 v[216:217], v250 offset:53504
  ds_read_b64_tr_b16 v[218:219], v250 offset:55552
  v_mfma_f32_16x16x32_bf16 a[172:175], v[200:203], v[28:31], a[172:175]
  s_waitcnt lgkmcnt(4)
  buffer_store_dwordx4 v[100:103], v236, s[64:67], s69 offen offset:1024 sc1
  v_accvgpr_read_b32 v49, a145
  v_cvt_pk_bf16_f32 v104, v48, v49
  v_accvgpr_read_b32 v50, a146
  v_accvgpr_read_b32 v51, a147
  v_cvt_pk_bf16_f32 v105, v50, v51
  v_accvgpr_read_b32 v52, a148
  v_accvgpr_read_b32 v53, a149
  v_cvt_pk_bf16_f32 v106, v52, v53
  v_accvgpr_read_b32 v54, a150
  v_accvgpr_read_b32 v55, a151
  v_cvt_pk_bf16_f32 v107, v54, v55
  v_mfma_f32_16x16x32_bf16 a[176:179], v[204:207], v[0:3], a[176:179]
  ds_read_b64_tr_b16 v[200:201], v249 offset:57600
  ds_read_b64_tr_b16 v[202:203], v249 offset:59648
  v_mfma_f32_16x16x32_bf16 a[184:187], v[204:207], v[4:7], a[184:187]
  buffer_store_dwordx4 v[104:107], v236, s[64:67], s69 offen offset:2048 sc1
  v_accvgpr_read_b32 v56, a152
  v_accvgpr_read_b32 v57, a153
  v_cvt_pk_bf16_f32 v108, v56, v57
  v_accvgpr_read_b32 v58, a154
  v_accvgpr_read_b32 v59, a155
  v_cvt_pk_bf16_f32 v109, v58, v59
  v_accvgpr_read_b32 v60, a156
  v_accvgpr_read_b32 v61, a157
  v_cvt_pk_bf16_f32 v110, v60, v61
  v_accvgpr_read_b32 v62, a158
  v_accvgpr_read_b32 v63, a159
  v_cvt_pk_bf16_f32 v111, v62, v63
  v_mfma_f32_16x16x32_bf16 a[180:183], v[208:211], v[0:3], a[180:183]
  ds_read_b64_tr_b16 v[204:205], v250 offset:57600
  ds_read_b64_tr_b16 v[206:207], v250 offset:59648
  v_mfma_f32_16x16x32_bf16 a[188:191], v[208:211], v[4:7], a[188:191]
  s_waitcnt lgkmcnt(4)
  buffer_store_dwordx4 v[108:111], v236, s[64:67], s69 offen offset:3072 sc1
  v_mfma_f32_16x16x32_bf16 a[176:179], v[212:215], v[8:11], a[176:179]
  ds_read_b64_tr_b16 v[208:209], v249 offset:61696
  s_lshl_b32 s69, s77, 10
  v_mfma_f32_16x16x32_bf16 a[184:187], v[212:215], v[12:15], a[184:187]
  ds_read_b64_tr_b16 v[210:211], v249 offset:63744
  v_accvgpr_read_b32 v32, a160
  v_mfma_f32_16x16x32_bf16 a[180:183], v[216:219], v[8:11], a[180:183]
  ds_read_b64_tr_b16 v[212:213], v250 offset:61696
  v_accvgpr_read_b32 v33, a161
  v_mfma_f32_16x16x32_bf16 a[188:191], v[216:219], v[12:15], a[188:191]
  s_waitcnt lgkmcnt(3)
  ds_read_b64_tr_b16 v[214:215], v250 offset:63744
  v_cvt_pk_bf16_f32 v112, v32, v33
  v_mfma_f32_16x16x32_bf16 a[176:179], v[200:203], v[16:19], a[176:179]
  ds_read_b64_tr_b16 v[216:217], v247 offset:16384
  v_accvgpr_read_b32 v34, a162
  v_mfma_f32_16x16x32_bf16 a[184:187], v[200:203], v[20:23], a[184:187]
  ds_read_b64_tr_b16 v[218:219], v247 offset:18432
  v_accvgpr_read_b32 v35, a163
  v_mfma_f32_16x16x32_bf16 a[180:183], v[204:207], v[16:19], a[180:183]
  ds_read_b64_tr_b16 v[200:201], v248 offset:16384
  v_cvt_pk_bf16_f32 v113, v34, v35
  v_mfma_f32_16x16x32_bf16 a[188:191], v[204:207], v[20:23], a[188:191]
  s_waitcnt lgkmcnt(3)
  ds_read_b64_tr_b16 v[202:203], v248 offset:18432
  v_accvgpr_read_b32 v36, a164
  v_mfma_f32_16x16x32_bf16 a[176:179], v[208:211], v[24:27], a[176:179]
  ds_read_b64_tr_b16 v[204:205], v247 offset:20480
  v_accvgpr_read_b32 v37, a165
  v_mfma_f32_16x16x32_bf16 a[184:187], v[208:211], v[28:31], a[184:187]
  ds_read_b64_tr_b16 v[206:207], v247 offset:22528
  v_cvt_pk_bf16_f32 v114, v36, v37
  v_mfma_f32_16x16x32_bf16 a[180:183], v[212:215], v[24:27], a[180:183]
  ds_read_b64_tr_b16 v[208:209], v248 offset:20480
  v_accvgpr_read_b32 v38, a166
  v_mfma_f32_16x16x32_bf16 a[188:191], v[212:215], v[28:31], a[188:191]
  s_waitcnt lgkmcnt(3)
  ds_read_b64_tr_b16 v[210:211], v248 offset:22528
  v_accvgpr_read_b32 v39, a167
  v_mfma_f32_16x16x32_bf16 a[192:195], v[216:219], v[0:3], a[192:195]
  ds_read_b64_tr_b16 v[212:213], v247 offset:24576
  v_cvt_pk_bf16_f32 v115, v38, v39
  v_mfma_f32_16x16x32_bf16 a[200:203], v[216:219], v[4:7], a[200:203]
  ds_read_b64_tr_b16 v[214:215], v247 offset:26624
  buffer_store_dwordx4 v[112:115], v236, s[64:67], s69 offen offset:0 sc1
  v_mfma_f32_16x16x32_bf16 a[196:199], v[200:203], v[0:3], a[196:199]
  ds_read_b64_tr_b16 v[216:217], v248 offset:24576
  v_accvgpr_read_b32 v40, a168
  v_mfma_f32_16x16x32_bf16 a[204:207], v[200:203], v[4:7], a[204:207]
  s_waitcnt lgkmcnt(3)
  ds_read_b64_tr_b16 v[218:219], v248 offset:26624
  v_accvgpr_read_b32 v41, a169
  v_cvt_pk_bf16_f32 v116, v40, v41
  v_mfma_f32_16x16x32_bf16 a[192:195], v[204:207], v[8:11], a[192:195]
  ds_read_b64_tr_b16 v[200:201], v247 offset:28672
  v_accvgpr_read_b32 v42, a170
  v_mfma_f32_16x16x32_bf16 a[200:203], v[204:207], v[12:15], a[200:203]
  ds_read_b64_tr_b16 v[202:203], v247 offset:30720
  v_accvgpr_read_b32 v43, a171
  v_cvt_pk_bf16_f32 v117, v42, v43
  v_mfma_f32_16x16x32_bf16 a[196:199], v[208:211], v[8:11], a[196:199]
  ds_read_b64_tr_b16 v[204:205], v248 offset:28672
  v_accvgpr_read_b32 v44, a172
  v_mfma_f32_16x16x32_bf16 a[204:207], v[208:211], v[12:15], a[204:207]
  s_waitcnt lgkmcnt(3)
  ds_read_b64_tr_b16 v[206:207], v248 offset:30720
  v_accvgpr_read_b32 v45, a173
  v_cvt_pk_bf16_f32 v118, v44, v45
  v_mfma_f32_16x16x32_bf16 a[192:195], v[212:215], v[16:19], a[192:195]
  ds_read_b64_tr_b16 v[208:209], v247 offset:16640
  v_accvgpr_read_b32 v46, a174
  v_mfma_f32_16x16x32_bf16 a[200:203], v[212:215], v[20:23], a[200:203]
  s_waitcnt vmcnt(6)
  ds_read_b64_tr_b16 v[210:211], v247 offset:18688
  buffer_store_dword v252, v237, s[64:67], s75 offen sc1
  v_mfma_f32_16x16x32_bf16 a[196:199], v[216:219], v[16:19], a[196:199]
  ds_read_b64_tr_b16 v[212:213], v248 offset:16640
  v_accvgpr_read_b32 v47, a175
  v_mfma_f32_16x16x32_bf16 a[204:207], v[216:219], v[20:23], a[204:207]
  s_waitcnt lgkmcnt(3)
  ds_read_b64_tr_b16 v[214:215], v248 offset:18688
  v_cvt_pk_bf16_f32 v119, v46, v47
  v_accvgpr_read_b32 v48, a176
  v_mfma_f32_16x16x32_bf16 a[192:195], v[200:203], v[24:27], a[192:195]
  ds_read_b64_tr_b16 v[216:217], v247 offset:20736
  ds_read_b64_tr_b16 v[218:219], v247 offset:22784
  v_mfma_f32_16x16x32_bf16 a[200:203], v[200:203], v[28:31], a[200:203]
  buffer_store_dwordx4 v[116:119], v236, s[64:67], s69 offen offset:1024 sc1
  v_accvgpr_read_b32 v49, a177
  v_mfma_f32_16x16x32_bf16 a[196:199], v[204:207], v[24:27], a[196:199]
  ds_read_b64_tr_b16 v[200:201], v248 offset:20736
  v_cvt_pk_bf16_f32 v120, v48, v49
  v_mfma_f32_16x16x32_bf16 a[204:207], v[204:207], v[28:31], a[204:207]
  s_waitcnt lgkmcnt(3)
  ds_read_b64_tr_b16 v[202:203], v248 offset:22784
  v_accvgpr_read_b32 v50, a178
  v_accvgpr_read_b32 v51, a179
  v_cvt_pk_bf16_f32 v121, v50, v51
  v_accvgpr_read_b32 v52, a180
  v_accvgpr_read_b32 v53, a181
  v_cvt_pk_bf16_f32 v122, v52, v53
  v_accvgpr_read_b32 v54, a182
  v_accvgpr_read_b32 v55, a183
  v_cvt_pk_bf16_f32 v123, v54, v55
  v_mfma_f32_16x16x32_bf16 a[208:211], v[208:211], v[0:3], a[208:211]
  ds_read_b64_tr_b16 v[204:205], v247 offset:24832
  ds_read_b64_tr_b16 v[206:207], v247 offset:26880
  v_mfma_f32_16x16x32_bf16 a[216:219], v[208:211], v[4:7], a[216:219]
  buffer_store_dwordx4 v[120:123], v236, s[64:67], s69 offen offset:2048 sc1
  v_accvgpr_read_b32 v56, a184
  v_accvgpr_read_b32 v57, a185
  v_cvt_pk_bf16_f32 v124, v56, v57
  v_accvgpr_read_b32 v58, a186
  v_accvgpr_read_b32 v59, a187
  v_cvt_pk_bf16_f32 v125, v58, v59
  v_accvgpr_read_b32 v60, a188
  v_accvgpr_read_b32 v61, a189
  v_cvt_pk_bf16_f32 v126, v60, v61
  v_accvgpr_read_b32 v62, a190
  v_accvgpr_read_b32 v63, a191
  v_cvt_pk_bf16_f32 v127, v62, v63
  v_mfma_f32_16x16x32_bf16 a[212:215], v[212:215], v[0:3], a[212:215]
  ds_read_b64_tr_b16 v[208:209], v248 offset:24832
  ds_read_b64_tr_b16 v[210:211], v248 offset:26880
  v_mfma_f32_16x16x32_bf16 a[220:223], v[212:215], v[4:7], a[220:223]
  s_waitcnt lgkmcnt(4)
  buffer_store_dwordx4 v[124:127], v236, s[64:67], s69 offen offset:3072 sc1
  v_mfma_f32_16x16x32_bf16 a[208:211], v[216:219], v[8:11], a[208:211]
  ds_read_b64_tr_b16 v[212:213], v247 offset:28928
  s_lshl_b32 s69, s78, 10
  v_mfma_f32_16x16x32_bf16 a[216:219], v[216:219], v[12:15], a[216:219]
  ds_read_b64_tr_b16 v[214:215], v247 offset:30976
  v_accvgpr_read_b32 v32, a192
  v_mfma_f32_16x16x32_bf16 a[212:215], v[200:203], v[8:11], a[212:215]
  ds_read_b64_tr_b16 v[216:217], v248 offset:28928
  v_accvgpr_read_b32 v33, a193
  v_mfma_f32_16x16x32_bf16 a[220:223], v[200:203], v[12:15], a[220:223]
  s_waitcnt lgkmcnt(3)
  ds_read_b64_tr_b16 v[218:219], v248 offset:30976
  v_cvt_pk_bf16_f32 v96, v32, v33
  v_mfma_f32_16x16x32_bf16 a[208:211], v[204:207], v[16:19], a[208:211]
  ds_read_b64_tr_b16 v[200:201], v249 offset:16384
  v_accvgpr_read_b32 v34, a194
  v_mfma_f32_16x16x32_bf16 a[216:219], v[204:207], v[20:23], a[216:219]
  ds_read_b64_tr_b16 v[202:203], v249 offset:18432
  v_accvgpr_read_b32 v35, a195
  v_mfma_f32_16x16x32_bf16 a[212:215], v[208:211], v[16:19], a[212:215]
  ds_read_b64_tr_b16 v[204:205], v250 offset:16384
  v_cvt_pk_bf16_f32 v97, v34, v35
  v_mfma_f32_16x16x32_bf16 a[220:223], v[208:211], v[20:23], a[220:223]
  s_waitcnt lgkmcnt(3)
  ds_read_b64_tr_b16 v[206:207], v250 offset:18432
  v_accvgpr_read_b32 v36, a196
  v_mfma_f32_16x16x32_bf16 a[208:211], v[212:215], v[24:27], a[208:211]
  ds_read_b64_tr_b16 v[208:209], v249 offset:16640
  v_accvgpr_read_b32 v37, a197
  v_mfma_f32_16x16x32_bf16 a[216:219], v[212:215], v[28:31], a[216:219]
  ds_read_b64_tr_b16 v[210:211], v249 offset:18688
  v_cvt_pk_bf16_f32 v98, v36, v37
  v_mfma_f32_16x16x32_bf16 a[212:215], v[216:219], v[24:27], a[212:215]
  ds_read_b64_tr_b16 v[212:213], v250 offset:16640
  v_accvgpr_read_b32 v38, a198
  v_mfma_f32_16x16x32_bf16 a[220:223], v[216:219], v[28:31], a[220:223]
  s_waitcnt lgkmcnt(3)
  ds_read_b64_tr_b16 v[214:215], v250 offset:18688
  v_accvgpr_read_b32 v39, a199
  v_mfma_f32_16x16x32_bf16 a[224:227], v[200:203], v[128:131], a[224:227]
  ds_read_b64_tr_b16 v[216:217], v249 offset:20480
  v_cvt_pk_bf16_f32 v99, v38, v39
  v_mfma_f32_16x16x32_bf16 a[232:235], v[200:203], v[132:135], a[232:235]
  ds_read_b64_tr_b16 v[218:219], v249 offset:22528
  buffer_store_dwordx4 v[96:99], v236, s[64:67], s69 offen offset:0 sc1
  v_mfma_f32_16x16x32_bf16 a[228:231], v[204:207], v[128:131], a[228:231]
  ds_read_b64_tr_b16 v[200:201], v250 offset:20480
  v_accvgpr_read_b32 v40, a200
  v_mfma_f32_16x16x32_bf16 a[236:239], v[204:207], v[132:135], a[236:239]
  s_waitcnt lgkmcnt(3)
  ds_read_b64_tr_b16 v[202:203], v250 offset:22528
  v_accvgpr_read_b32 v41, a201
  v_cvt_pk_bf16_f32 v100, v40, v41
  v_mfma_f32_16x16x32_bf16 a[240:243], v[208:211], v[128:131], a[240:243]
  ds_read_b64_tr_b16 v[204:205], v249 offset:20736
  v_accvgpr_read_b32 v42, a202
  v_mfma_f32_16x16x32_bf16 a[248:251], v[208:211], v[132:135], a[248:251]
  ds_read_b64_tr_b16 v[206:207], v249 offset:22784
  v_accvgpr_read_b32 v43, a203
  v_cvt_pk_bf16_f32 v101, v42, v43
  v_mfma_f32_16x16x32_bf16 a[244:247], v[212:215], v[128:131], a[244:247]
  ds_read_b64_tr_b16 v[208:209], v250 offset:20736
  v_accvgpr_read_b32 v44, a204
  v_mfma_f32_16x16x32_bf16 a[252:255], v[212:215], v[132:135], a[252:255]
  s_waitcnt lgkmcnt(3)
  ds_read_b64_tr_b16 v[210:211], v250 offset:22784
  v_accvgpr_read_b32 v45, a205
  v_cvt_pk_bf16_f32 v102, v44, v45
  v_mfma_f32_16x16x32_bf16 a[224:227], v[216:219], v[136:139], a[224:227]
  ds_read_b64_tr_b16 v[212:213], v249 offset:24576
  v_accvgpr_read_b32 v46, a206
  v_mfma_f32_16x16x32_bf16 a[232:235], v[216:219], v[140:143], a[232:235]
  s_waitcnt vmcnt(6)
  ds_read_b64_tr_b16 v[214:215], v249 offset:26624
  buffer_store_dword v252, v237, s[64:67], s76 offen sc1
  v_mfma_f32_16x16x32_bf16 a[228:231], v[200:203], v[136:139], a[228:231]
  ds_read_b64_tr_b16 v[216:217], v250 offset:24576
  v_accvgpr_read_b32 v47, a207
  v_mfma_f32_16x16x32_bf16 a[236:239], v[200:203], v[140:143], a[236:239]
  s_waitcnt lgkmcnt(3)
  ds_read_b64_tr_b16 v[218:219], v250 offset:26624
  v_cvt_pk_bf16_f32 v103, v46, v47
  v_accvgpr_read_b32 v48, a208
  v_mfma_f32_16x16x32_bf16 a[240:243], v[204:207], v[136:139], a[240:243]
  ds_read_b64_tr_b16 v[200:201], v249 offset:24832
  ds_read_b64_tr_b16 v[202:203], v249 offset:26880
  v_mfma_f32_16x16x32_bf16 a[248:251], v[204:207], v[140:143], a[248:251]
  buffer_store_dwordx4 v[100:103], v236, s[64:67], s69 offen offset:1024 sc1
  v_accvgpr_read_b32 v49, a209
  v_mfma_f32_16x16x32_bf16 a[244:247], v[208:211], v[136:139], a[244:247]
  ds_read_b64_tr_b16 v[204:205], v250 offset:24832
  v_cvt_pk_bf16_f32 v104, v48, v49
  v_mfma_f32_16x16x32_bf16 a[252:255], v[208:211], v[140:143], a[252:255]
  s_waitcnt lgkmcnt(3)
  ds_read_b64_tr_b16 v[206:207], v250 offset:26880
  v_accvgpr_read_b32 v50, a210
  v_accvgpr_read_b32 v51, a211
  v_cvt_pk_bf16_f32 v105, v50, v51
  v_accvgpr_read_b32 v52, a212
  v_accvgpr_read_b32 v53, a213
  v_cvt_pk_bf16_f32 v106, v52, v53
  v_accvgpr_read_b32 v54, a214
  v_accvgpr_read_b32 v55, a215
  v_cvt_pk_bf16_f32 v107, v54, v55
  v_mfma_f32_16x16x32_bf16 a[224:227], v[212:215], v[144:147], a[224:227]
  ds_read_b64_tr_b16 v[208:209], v249 offset:28672
  ds_read_b64_tr_b16 v[210:211], v249 offset:30720
  v_mfma_f32_16x16x32_bf16 a[232:235], v[212:215], v[148:151], a[232:235]
  buffer_store_dwordx4 v[104:107], v236, s[64:67], s69 offen offset:2048 sc1
  v_accvgpr_read_b32 v56, a216
  v_accvgpr_read_b32 v57, a217
  v_cvt_pk_bf16_f32 v108, v56, v57
  v_accvgpr_read_b32 v58, a218
  v_accvgpr_read_b32 v59, a219
  v_cvt_pk_bf16_f32 v109, v58, v59
  v_accvgpr_read_b32 v60, a220
  v_accvgpr_read_b32 v61, a221
  v_cvt_pk_bf16_f32 v110, v60, v61
  v_accvgpr_read_b32 v62, a222
  v_accvgpr_read_b32 v63, a223
  v_cvt_pk_bf16_f32 v111, v62, v63
  v_mfma_f32_16x16x32_bf16 a[228:231], v[216:219], v[144:147], a[228:231]
  ds_read_b64_tr_b16 v[212:213], v250 offset:28672
  ds_read_b64_tr_b16 v[214:215], v250 offset:30720
  v_mfma_f32_16x16x32_bf16 a[236:239], v[216:219], v[148:151], a[236:239]
  s_waitcnt lgkmcnt(4)
  buffer_store_dwordx4 v[108:111], v236, s[64:67], s69 offen offset:3072 sc1
  v_mfma_f32_16x16x32_bf16 a[240:243], v[200:203], v[144:147], a[240:243]
  ds_read_b64_tr_b16 v[216:217], v249 offset:28928
  v_mfma_f32_16x16x32_bf16 a[248:251], v[200:203], v[148:151], a[248:251]
  ds_read_b64_tr_b16 v[218:219], v249 offset:30976
  v_mfma_f32_16x16x32_bf16 a[244:247], v[204:207], v[144:147], a[244:247]
  ds_read_b64_tr_b16 v[200:201], v250 offset:28928
  v_mfma_f32_16x16x32_bf16 a[252:255], v[204:207], v[148:151], a[252:255]
  s_waitcnt lgkmcnt(3)
  ds_read_b64_tr_b16 v[202:203], v250 offset:30976
  v_mfma_f32_16x16x32_bf16 a[224:227], v[208:211], v[152:155], a[224:227]
  ds_read_b64_tr_b16 v[204:205], v245 offset:0
  v_mfma_f32_16x16x32_bf16 a[232:235], v[208:211], v[156:159], a[232:235]
  ds_read_b64_tr_b16 v[206:207], v245 offset:2048
  v_mfma_f32_16x16x32_bf16 a[228:231], v[212:215], v[152:155], a[228:231]
  ds_read_b64_tr_b16 v[208:209], v246 offset:0
  v_mfma_f32_16x16x32_bf16 a[236:239], v[212:215], v[156:159], a[236:239]
  s_waitcnt lgkmcnt(3)
  ds_read_b64_tr_b16 v[210:211], v246 offset:2048
  v_mfma_f32_16x16x32_bf16 a[240:243], v[216:219], v[152:155], a[240:243]
  ds_read_b64_tr_b16 v[212:213], v245 offset:256
  v_mfma_f32_16x16x32_bf16 a[248:251], v[216:219], v[156:159], a[248:251]
  ds_read_b64_tr_b16 v[214:215], v245 offset:2304
  v_mfma_f32_16x16x32_bf16 a[244:247], v[200:203], v[152:155], a[244:247]
  ds_read_b64_tr_b16 v[216:217], v246 offset:256
  v_mfma_f32_16x16x32_bf16 a[252:255], v[200:203], v[156:159], a[252:255]
  s_waitcnt lgkmcnt(3)
  ds_read_b64_tr_b16 v[218:219], v246 offset:2304
  v_mfma_f32_16x16x32_bf16 a[224:227], v[204:207], v[160:163], a[224:227]
  ds_read_b64_tr_b16 v[200:201], v245 offset:4096
  v_mfma_f32_16x16x32_bf16 a[232:235], v[204:207], v[164:167], a[232:235]
  ds_read_b64_tr_b16 v[202:203], v245 offset:6144
  v_mfma_f32_16x16x32_bf16 a[228:231], v[208:211], v[160:163], a[228:231]
  ds_read_b64_tr_b16 v[204:205], v246 offset:4096
  v_mfma_f32_16x16x32_bf16 a[236:239], v[208:211], v[164:167], a[236:239]
  s_waitcnt lgkmcnt(3)
  ds_read_b64_tr_b16 v[206:207], v246 offset:6144
  v_mfma_f32_16x16x32_bf16 a[240:243], v[212:215], v[160:163], a[240:243]
  ds_read_b64_tr_b16 v[208:209], v245 offset:4352
  v_lshrrev_b32 v72, 2, v251
  v_mfma_f32_16x16x32_bf16 a[248:251], v[212:215], v[164:167], a[248:251]
  ds_read_b64_tr_b16 v[210:211], v245 offset:6400
  v_xor_b32 v72, v72, v251
  v_mfma_f32_16x16x32_bf16 a[244:247], v[216:219], v[160:163], a[244:247]
  ds_read_b64_tr_b16 v[212:213], v246 offset:4352
  v_and_b32 v72, 12, v72
  v_mfma_f32_16x16x32_bf16 a[252:255], v[216:219], v[164:167], a[252:255]
  s_waitcnt lgkmcnt(3)
  ds_read_b64_tr_b16 v[214:215], v246 offset:6400
  v_bfe_u32 v73, v251, 1, 1
  v_mfma_f32_16x16x32_bf16 a[224:227], v[200:203], v[168:171], a[224:227]
  ds_read_b64_tr_b16 v[216:217], v245 offset:8192
  v_or_b32 v72, v72, v73
  v_mfma_f32_16x16x32_bf16 a[232:235], v[200:203], v[172:175], a[232:235]
  s_waitcnt vmcnt(5)
  ds_read_b64_tr_b16 v[218:219], v245 offset:10240
  buffer_store_dword v252, v237, s[64:67], s77 offen sc1
  v_mfma_f32_16x16x32_bf16 a[228:231], v[204:207], v[168:171], a[228:231]
  ds_read_b64_tr_b16 v[200:201], v246 offset:8192
  v_and_b32 v73, 1, v251
  v_mfma_f32_16x16x32_bf16 a[236:239], v[204:207], v[172:175], a[236:239]
  s_waitcnt lgkmcnt(3)
  ds_read_b64_tr_b16 v[202:203], v246 offset:10240
  v_lshlrev_b32 v73, 4, v73
  v_mfma_f32_16x16x32_bf16 a[240:243], v[208:211], v[168:171], a[240:243]
  ds_read_b64_tr_b16 v[204:205], v245 offset:8448
  v_mov_b32 v66, 0x3f80
  v_mfma_f32_16x16x32_bf16 a[248:251], v[208:211], v[172:175], a[248:251]
  ds_read_b64_tr_b16 v[206:207], v245 offset:10496
  v_lshlrev_b32 v73, v73, v66
  v_mfma_f32_16x16x32_bf16 a[244:247], v[212:215], v[168:171], a[244:247]
  ds_read_b64_tr_b16 v[208:209], v246 offset:8448
  v_cmp_eq_u32 s[24:25], 0, v72
  v_mfma_f32_16x16x32_bf16 a[252:255], v[212:215], v[172:175], a[252:255]
  s_waitcnt lgkmcnt(3)
  ds_read_b64_tr_b16 v[210:211], v246 offset:10496
  v_cndmask_b32 v64, 0, v73, s[24:25]
  v_mfma_f32_16x16x32_bf16 a[224:227], v[216:219], v[176:179], a[224:227]
  ds_read_b64_tr_b16 v[212:213], v245 offset:12288
  v_cmp_eq_u32 s[24:25], 1, v72
  v_mfma_f32_16x16x32_bf16 a[232:235], v[216:219], v[180:183], a[232:235]
  ds_read_b64_tr_b16 v[214:215], v245 offset:14336
  v_cndmask_b32 v65, 0, v73, s[24:25]
  v_mfma_f32_16x16x32_bf16 a[228:231], v[200:203], v[176:179], a[228:231]
  ds_read_b64_tr_b16 v[216:217], v246 offset:12288
  v_mov_b32 v66, 0
  v_mfma_f32_16x16x32_bf16 a[236:239], v[200:203], v[180:183], a[236:239]
  s_waitcnt lgkmcnt(3)
  ds_read_b64_tr_b16 v[218:219], v246 offset:14336
  v_mov_b32 v67, 0
  v_mfma_f32_16x16x32_bf16 a[240:243], v[204:207], v[176:179], a[240:243]
  ds_read_b64_tr_b16 v[200:201], v245 offset:12544
  v_mov_b32 v68, 0
  v_mfma_f32_16x16x32_bf16 a[248:251], v[204:207], v[180:183], a[248:251]
  ds_read_b64_tr_b16 v[202:203], v245 offset:14592
  v_mov_b32 v69, 0
  v_mfma_f32_16x16x32_bf16 a[244:247], v[208:211], v[176:179], a[244:247]
  ds_read_b64_tr_b16 v[204:205], v246 offset:12544
  v_mov_b32 v70, v64
  v_mfma_f32_16x16x32_bf16 a[252:255], v[208:211], v[180:183], a[252:255]
  s_waitcnt lgkmcnt(3)
  ds_read_b64_tr_b16 v[206:207], v246 offset:14592
  v_mov_b32 v71, v65
  v_mfma_f32_16x16x32_bf16 a[224:227], v[212:215], v[184:187], a[224:227]
  ds_read_b64_tr_b16 v[208:209], v245 offset:16384
  v_mfma_f32_16x16x32_bf16 a[232:235], v[212:215], v[188:191], a[232:235]
  ds_read_b64_tr_b16 v[210:211], v245 offset:18432
  v_mfma_f32_16x16x32_bf16 a[228:231], v[216:219], v[184:187], a[228:231]
  ds_read_b64_tr_b16 v[212:213], v246 offset:16384
  v_mfma_f32_16x16x32_bf16 a[236:239], v[216:219], v[188:191], a[236:239]
  s_waitcnt lgkmcnt(3)
  ds_read_b64_tr_b16 v[214:215], v246 offset:18432
  v_mfma_f32_16x16x32_bf16 a[240:243], v[200:203], v[184:187], a[240:243]
  ds_read_b64_tr_b16 v[216:217], v245 offset:20480
  v_mfma_f32_16x16x32_bf16 a[248:251], v[200:203], v[188:191], a[248:251]
  ds_read_b64_tr_b16 v[218:219], v245 offset:22528
  v_mfma_f32_16x16x32_bf16 a[244:247], v[204:207], v[184:187], a[244:247]
  ds_read_b64_tr_b16 v[200:201], v246 offset:20480
  v_mfma_f32_16x16x32_bf16 a[252:255], v[204:207], v[188:191], a[252:255]
  s_waitcnt lgkmcnt(3)
  ds_read_b64_tr_b16 v[202:203], v246 offset:22528
  v_mfma_f32_16x16x32_bf16 a[224:227], v[208:211], v[0:3], a[224:227]
  ds_read_b64_tr_b16 v[204:205], v245 offset:24576
  v_mfma_f32_16x16x32_bf16 a[232:235], v[208:211], v[4:7], a[232:235]
  ds_read_b64_tr_b16 v[206:207], v245 offset:26624
  v_mfma_f32_16x16x32_bf16 a[228:231], v[212:215], v[0:3], a[228:231]
  ds_read_b64_tr_b16 v[208:209], v246 offset:24576
  v_mfma_f32_16x16x32_bf16 a[236:239], v[212:215], v[4:7], a[236:239]
  s_waitcnt lgkmcnt(3)
  ds_read_b64_tr_b16 v[210:211], v246 offset:26624
  v_mfma_f32_16x16x32_bf16 a[224:227], v[216:219], v[8:11], a[224:227]
  ds_read_b64_tr_b16 v[212:213], v245 offset:28672
  ds_read_b64_tr_b16 v[214:215], v245 offset:30720
  v_mfma_f32_16x16x32_bf16 a[232:235], v[216:219], v[12:15], a[232:235]
  buffer_load_dword v234, v233, s[64:67], s79 offen sc1
  v_mfma_f32_16x16x32_bf16 a[228:231], v[200:203], v[8:11], a[228:231]
  ds_read_b64_tr_b16 v[216:217], v246 offset:28672
  v_mfma_f32_16x16x32_bf16 a[236:239], v[200:203], v[12:15], a[236:239]
  s_waitcnt lgkmcnt(3)
  ds_read_b64_tr_b16 v[218:219], v246 offset:30720
  v_mfma_f32_16x16x32_bf16 a[224:227], v[204:207], v[16:19], a[224:227]
  ds_read_b64_tr_b16 v[200:201], v245 offset:16640
  v_mfma_f32_16x16x32_bf16 a[232:235], v[204:207], v[20:23], a[232:235]
  s_waitcnt vmcnt(2)
  ds_read_b64_tr_b16 v[202:203], v245 offset:18688
  buffer_store_dword v252, v237, s[64:67], s78 offen sc1
  v_mfma_f32_16x16x32_bf16 a[228:231], v[208:211], v[16:19], a[228:231]
  ds_read_b64_tr_b16 v[204:205], v246 offset:16640
  v_mfma_f32_16x16x32_bf16 a[236:239], v[208:211], v[20:23], a[236:239]
  s_waitcnt lgkmcnt(3)
  ds_read_b64_tr_b16 v[206:207], v246 offset:18688
  v_mfma_f32_16x16x32_bf16 a[224:227], v[212:215], v[24:27], a[224:227]
  ds_read_b64_tr_b16 v[208:209], v245 offset:20736
  v_mfma_f32_16x16x32_bf16 a[232:235], v[212:215], v[28:31], a[232:235]
  ds_read_b64_tr_b16 v[210:211], v245 offset:22784
  v_mfma_f32_16x16x32_bf16 a[228:231], v[216:219], v[24:27], a[228:231]
  ds_read_b64_tr_b16 v[212:213], v246 offset:20736
  v_mfma_f32_16x16x32_bf16 a[236:239], v[216:219], v[28:31], a[236:239]
  s_waitcnt lgkmcnt(3)
  ds_read_b64_tr_b16 v[214:215], v246 offset:22784
  v_mfma_f32_16x16x32_bf16 a[240:243], v[200:203], v[0:3], a[240:243]
  ds_read_b64_tr_b16 v[216:217], v245 offset:24832
  v_mfma_f32_16x16x32_bf16 a[248:251], v[200:203], v[4:7], a[248:251]
  ds_read_b64_tr_b16 v[218:219], v245 offset:26880
  v_mfma_f32_16x16x32_bf16 a[244:247], v[204:207], v[0:3], a[244:247]
  ds_read_b64_tr_b16 v[200:201], v246 offset:24832
  v_mfma_f32_16x16x32_bf16 a[252:255], v[204:207], v[4:7], a[252:255]
  s_waitcnt lgkmcnt(3)
  ds_read_b64_tr_b16 v[202:203], v246 offset:26880
  v_mfma_f32_16x16x32_bf16 a[240:243], v[208:211], v[8:11], a[240:243]
  ds_read_b64_tr_b16 v[204:205], v245 offset:28928
  v_mfma_f32_16x16x32_bf16 a[248:251], v[208:211], v[12:15], a[248:251]
  ds_read_b64_tr_b16 v[206:207], v245 offset:30976
  v_mfma_f32_16x16x32_bf16 a[244:247], v[212:215], v[8:11], a[244:247]
  ds_read_b64_tr_b16 v[208:209], v246 offset:28928
  v_mfma_f32_16x16x32_bf16 a[252:255], v[212:215], v[12:15], a[252:255]
  s_waitcnt lgkmcnt(3)
  ds_read_b64_tr_b16 v[210:211], v246 offset:30976
  v_mfma_f32_16x16x32_bf16 a[240:243], v[216:219], v[16:19], a[240:243]
  v_mfma_f32_16x16x32_bf16 a[248:251], v[216:219], v[20:23], a[248:251]
  v_mfma_f32_16x16x32_bf16 a[244:247], v[200:203], v[16:19], a[244:247]
  v_mfma_f32_16x16x32_bf16 a[252:255], v[200:203], v[20:23], a[252:255]
  s_waitcnt lgkmcnt(0)
  v_mfma_f32_16x16x32_bf16 a[240:243], v[204:207], v[24:27], a[240:243]
  v_mfma_f32_16x16x32_bf16 a[248:251], v[204:207], v[28:31], a[248:251]
  v_mfma_f32_16x16x32_bf16 a[244:247], v[208:211], v[24:27], a[244:247]
  v_mfma_f32_16x16x32_bf16 a[252:255], v[208:211], v[28:31], a[252:255]
  s_mov_b32 s19, 0
  s_waitcnt vmcnt(1)
  v_cmp_eq_u32 vcc, 1, v234
  v_add_u32 v251, 0x8000, v235
  s_nop 0
  s_bitcmp1_b32 vcc_lo, s41
  s_cselect_b32 s16, s33, 0x7fff0000
  s_cselect_b32 s41, 8, s41
  buffer_load_dwordx4 a[0:3], v232, s[64:67], s16 offen offset:0 sc1
  buffer_load_dwordx4 a[4:7], v232, s[64:67], s16 offen offset:1024 sc1
  buffer_load_dwordx4 a[8:11], v232, s[64:67], s16 offen offset:2048 sc1
  buffer_load_dwordx4 a[12:15], v232, s[64:67], s16 offen offset:3072 sc1
  s_bitcmp1_b32 vcc_lo, s42
  s_cselect_b32 s16, s34, 0x7fff0000
  s_cselect_b32 s42, 8, s42
  buffer_load_dwordx4 a[16:19], v232, s[64:67], s16 offen offset:0 sc1
  buffer_load_dwordx4 a[20:23], v232, s[64:67], s16 offen offset:1024 sc1
  buffer_load_dwordx4 a[24:27], v232, s[64:67], s16 offen offset:2048 sc1
  buffer_load_dwordx4 a[28:31], v232, s[64:67], s16 offen offset:3072 sc1
  s_bitcmp1_b32 vcc_lo, s43
  s_cselect_b32 s16, s35, 0x7fff0000
  s_cselect_b32 s43, 8, s43
  buffer_load_dwordx4 a[32:35], v232, s[64:67], s16 offen offset:0 sc1
  buffer_load_dwordx4 a[36:39], v232, s[64:67], s16 offen offset:1024 sc1
  buffer_load_dwordx4 a[40:43], v232, s[64:67], s16 offen offset:2048 sc1
  buffer_load_dwordx4 a[44:47], v232, s[64:67], s16 offen offset:3072 sc1
  buffer_load_dword v234, v233, s[64:67], s79 offen sc1
  s_bitcmp1_b32 vcc_lo, s44
  s_cselect_b32 s16, s36, 0x7fff0000
  s_cselect_b32 s44, 8, s44
  buffer_load_dwordx4 a[48:51], v232, s[64:67], s16 offen offset:0 sc1
  buffer_load_dwordx4 a[52:55], v232, s[64:67], s16 offen offset:1024 sc1
  buffer_load_dwordx4 a[56:59], v232, s[64:67], s16 offen offset:2048 sc1
  buffer_load_dwordx4 a[60:63], v232, s[64:67], s16 offen offset:3072 sc1
  s_bitcmp1_b32 vcc_lo, s45
  s_cselect_b32 s16, s37, 0x7fff0000
  s_cselect_b32 s45, 8, s45
  buffer_load_dwordx4 a[64:67], v232, s[64:67], s16 offen offset:0 sc1
  buffer_load_dwordx4 a[68:71], v232, s[64:67], s16 offen offset:1024 sc1
  buffer_load_dwordx4 a[72:75], v232, s[64:67], s16 offen offset:2048 sc1
  buffer_load_dwordx4 a[76:79], v232, s[64:67], s16 offen offset:3072 sc1
  s_waitcnt vmcnt(8)
  v_cmp_eq_u32 vcc, 1, v234
  s_nop 1
  s_cmp_eq_u32 s41, 8
  s_cbranch_scc1 L_d1
L_p1:
  s_bitcmp1_b32 vcc_lo, s41
  s_cbranch_scc1 L_g1
  buffer_load_dword v234, v233, s[64:67], s79 offen sc1
  s_add_u32 s19, s19, 1
  s_waitcnt vmcnt(0)
  v_cmp_eq_u32 vcc, 1, v234
  s_cmp_lt_u32 s19, 400000
  s_cbranch_scc1 L_p1
L_g1:
  buffer_load_dwordx4 a[0:3], v232, s[64:67], s33 offen offset:0 sc1
  buffer_load_dwordx4 a[4:7], v232, s[64:67], s33 offen offset:1024 sc1
  buffer_load_dwordx4 a[8:11], v232, s[64:67], s33 offen offset:2048 sc1
  buffer_load_dwordx4 a[12:15], v232, s[64:67], s33 offen offset:3072 sc1
L_d1:
  s_cmp_eq_u32 s42, 8
  s_cbranch_scc1 L_d2
L_p2:
  s_bitcmp1_b32 vcc_lo, s42
  s_cbranch_scc1 L_g2
  buffer_load_dword v234, v233, s[64:67], s79 offen sc1
  s_add_u32 s19, s19, 1
  s_waitcnt vmcnt(0)
  v_cmp_eq_u32 vcc, 1, v234
  s_cmp_lt_u32 s19, 400000
  s_cbranch_scc1 L_p2
L_g2:
  buffer_load_dwordx4 a[16:19], v232, s[64:67], s34 offen offset:0 sc1
  buffer_load_dwordx4 a[20:23], v232, s[64:67], s34 offen offset:1024 sc1
  buffer_load_dwordx4 a[24:27], v232, s[64:67], s34 offen offset:2048 sc1
  buffer_load_dwordx4 a[28:31], v232, s[64:67], s34 offen offset:3072 sc1
L_d2:
  s_cmp_eq_u32 s43, 8
  s_cbranch_scc1 L_d3
L_p3:
  s_bitcmp1_b32 vcc_lo, s43
  s_cbranch_scc1 L_g3
  buffer_load_dword v234, v233, s[64:67], s79 offen sc1
  s_add_u32 s19, s19, 1
  s_waitcnt vmcnt(0)
  v_cmp_eq_u32 vcc, 1, v234
  s_cmp_lt_u32 s19, 400000
  s_cbranch_scc1 L_p3
L_g3:
  buffer_load_dwordx4 a[32:35], v232, s[64:67], s35 offen offset:0 sc1
  buffer_load_dwordx4 a[36:39], v232, s[64:67], s35 offen offset:1024 sc1
  buffer_load_dwordx4 a[40:43], v232, s[64:67], s35 offen offset:2048 sc1
  buffer_load_dwordx4 a[44:47], v232, s[64:67], s35 offen offset:3072 sc1
L_d3:
  s_cmp_eq_u32 s44, 8
  s_cbranch_scc1 L_d4
L_p4:
  s_bitcmp1_b32 vcc_lo, s44
  s_cbranch_scc1 L_g4
  buffer_load_dword v234, v233, s[64:67], s79 offen sc1
  s_add_u32 s19, s19, 1
  s_waitcnt vmcnt(0)
  v_cmp_eq_u32 vcc, 1, v234
  s_cmp_lt_u32 s19, 400000
  s_cbranch_scc1 L_p4
L_g4:
  buffer_load_dwordx4 a[48:51], v232, s[64:67], s36 offen offset:0 sc1
  buffer_load_dwordx4 a[52:55], v232, s[64:67], s36 offen offset:1024 sc1
  buffer_load_dwordx4 a[56:59], v232, s[64:67], s36 offen offset:2048 sc1
  buffer_load_dwordx4 a[60:63], v232, s[64:67], s36 offen offset:3072 sc1
L_d4:
  s_cmp_eq_u32 s45, 8
  s_cbranch_scc1 L_d5
L_p5:
  s_bitcmp1_b32 vcc_lo, s45
  s_cbranch_scc1 L_g5
  buffer_load_dword v234, v233, s[64:67], s79 offen sc1
  s_add_u32 s19, s19, 1
  s_waitcnt vmcnt(0)
  v_cmp_eq_u32 vcc, 1, v234
  s_cmp_lt_u32 s19, 400000
  s_cbranch_scc1 L_p5
L_g5:
  buffer_load_dwordx4 a[64:67], v232, s[64:67], s37 offen offset:0 sc1
  buffer_load_dwordx4 a[68:71], v232, s[64:67], s37 offen offset:1024 sc1
  buffer_load_dwordx4 a[72:75], v232, s[64:67], s37 offen offset:2048 sc1
  buffer_load_dwordx4 a[76:79], v232, s[64:67], s37 offen offset:3072 sc1
L_d5:
L_p6:
  s_bitcmp1_b32 vcc_lo, s46
  s_cbranch_scc1 L_g6
  buffer_load_dword v234, v233, s[64:67], s79 offen sc1
  s_add_u32 s19, s19, 1
  s_waitcnt vmcnt(0)
  v_cmp_eq_u32 vcc, 1, v234
  s_cmp_lt_u32 s19, 400000
  s_cbranch_scc1 L_p6
L_g6:
  buffer_load_dwordx4 a[80:83], v232, s[64:67], s38 offen offset:0 sc1
  buffer_load_dwordx4 a[84:87], v232, s[64:67], s38 offen offset:1024 sc1
  buffer_load_dwordx4 a[88:91], v232, s[64:67], s38 offen offset:2048 sc1
  buffer_load_dwordx4 a[92:95], v232, s[64:67], s38 offen offset:3072 sc1
L_d6:
L_p7:
  s_bitcmp1_b32 vcc_lo, s47
  s_cbranch_scc1 L_g7
  buffer_load_dword v234, v233, s[64:67], s79 offen sc1
  s_add_u32 s19, s19, 1
  s_waitcnt vmcnt(0)
  v_cmp_eq_u32 vcc, 1, v234
  s_cmp_lt_u32 s19, 400000
  s_cbranch_scc1 L_p7
L_g7:
  buffer_load_dwordx4 a[96:99], v232, s[64:67], s39 offen offset:0 sc1
  buffer_load_dwordx4 a[100:103], v232, s[64:67], s39 offen offset:1024 sc1
  buffer_load_dwordx4 a[104:107], v232, s[64:67], s39 offen offset:2048 sc1
  buffer_load_dwordx4 a[108:111], v232, s[64:67], s39 offen offset:3072 sc1
L_d7:
  s_waitcnt vmcnt(4)
  v_mfma_f32_16x16x32_bf16 a[224:227], v[64:67], a[0:3], a[224:227]
  v_mfma_f32_16x16x32_bf16 a[228:231], v[68:71], a[0:3], a[228:231]
  v_mfma_f32_16x16x32_bf16 a[232:235], v[64:67], a[4:7], a[232:235]
  v_mfma_f32_16x16x32_bf16 a[236:239], v[68:71], a[4:7], a[236:239]
  v_mfma_f32_16x16x32_bf16 a[240:243], v[64:67], a[8:11], a[240:243]
  v_mfma_f32_16x16x32_bf16 a[244:247], v[68:71], a[8:11], a[244:247]
  v_mfma_f32_16x16x32_bf16 a[248:251], v[64:67], a[12:15], a[248:251]
  v_mfma_f32_16x16x32_bf16 a[252:255], v[68:71], a[12:15], a[252:255]
  v_mfma_f32_16x16x32_bf16 a[224:227], v[64:67], a[16:19], a[224:227]
  v_mfma_f32_16x16x32_bf16 a[228:231], v[68:71], a[16:19], a[228:231]
  v_mfma_f32_16x16x32_bf16 a[232:235], v[64:67], a[20:23], a[232:235]
  v_mfma_f32_16x16x32_bf16 a[236:239], v[68:71], a[20:23], a[236:239]
  v_mfma_f32_16x16x32_bf16 a[240:243], v[64:67], a[24:27], a[240:243]
  v_mfma_f32_16x16x32_bf16 a[244:247], v[68:71], a[24:27], a[244:247]
  v_mfma_f32_16x16x32_bf16 a[248:251], v[64:67], a[28:31], a[248:251]
  v_mfma_f32_16x16x32_bf16 a[252:255], v[68:71], a[28:31], a[252:255]
  v_mfma_f32_16x16x32_bf16 a[224:227], v[64:67], a[32:35], a[224:227]
  v_mfma_f32_16x16x32_bf16 a[228:231], v[68:71], a[32:35], a[228:231]
  v_mfma_f32_16x16x32_bf16 a[232:235], v[64:67], a[36:39], a[232:235]
  v_mfma_f32_16x16x32_bf16 a[236:239], v[68:71], a[36:39], a[236:239]
  v_mfma_f32_16x16x32_bf16 a[240:243], v[64:67], a[40:43], a[240:243]
  v_mfma_f32_16x16x32_bf16 a[244:247], v[68:71], a[40:43], a[244:247]
  v_mfma_f32_16x16x32_bf16 a[248:251], v[64:67], a[44:47], a[248:251]
  v_mfma_f32_16x16x32_bf16 a[252:255], v[68:71], a[44:47], a[252:255]
  v_mfma_f32_16x16x32_bf16 a[224:227], v[64:67], a[48:51], a[224:227]
  v_mfma_f32_16x16x32_bf16 a[228:231], v[68:71], a[48:51], a[228:231]
  v_mfma_f32_16x16x32_bf16 a[232:235], v[64:67], a[52:55], a[232:235]
  v_mfma_f32_16x16x32_bf16 a[236:239], v[68:71], a[52:55], a[236:239]
  v_mfma_f32_16x16x32_bf16 a[240:243], v[64:67], a[56:59], a[240:243]
  v_mfma_f32_16x16x32_bf16 a[244:247], v[68:71], a[56:59], a[244:247]
  v_mfma_f32_16x16x32_bf16 a[248:251], v[64:67], a[60:63], a[248:251]
  v_mfma_f32_16x16x32_bf16 a[252:255], v[68:71], a[60:63], a[252:255]
  v_mfma_f32_16x16x32_bf16 a[224:227], v[64:67], a[64:67], a[224:227]
  v_mfma_f32_16x16x32_bf16 a[228:231], v[68:71], a[64:67], a[228:231]
  v_mfma_f32_16x16x32_bf16 a[232:235], v[64:67], a[68:71], a[232:235]
  v_mfma_f32_16x16x32_bf16 a[236:239], v[68:71], a[68:71], a[236:239]
  v_mfma_f32_16x16x32_bf16 a[240:243], v[64:67], a[72:75], a[240:243]
  v_mfma_f32_16x16x32_bf16 a[244:247], v[68:71], a[72:75], a[244:247]
  v_mfma_f32_16x16x32_bf16 a[248:251], v[64:67], a[76:79], a[248:251]
  v_mfma_f32_16x16x32_bf16 a[252:255], v[68:71], a[76:79], a[252:255]
  v_mfma_f32_16x16x32_bf16 a[224:227], v[64:67], a[80:83], a[224:227]
  v_mfma_f32_16x16x32_bf16 a[228:231], v[68:71], a[80:83], a[228:231]
  v_mfma_f32_16x16x32_bf16 a[232:235], v[64:67], a[84:87], a[232:235]
  v_mfma_f32_16x16x32_bf16 a[236:239], v[68:71], a[84:87], a[236:239]
  v_mfma_f32_16x16x32_bf16 a[240:243], v[64:67], a[88:91], a[240:243]
  v_mfma_f32_16x16x32_bf16 a[244:247], v[68:71], a[88:91], a[244:247]
  v_mfma_f32_16x16x32_bf16 a[248:251], v[64:67], a[92:95], a[248:251]
  v_mfma_f32_16x16x32_bf16 a[252:255], v[68:71], a[92:95], a[252:255]
  s_waitcnt vmcnt(0)
  v_mfma_f32_16x16x32_bf16 a[224:227], v[64:67], a[96:99], a[224:227]
  v_mfma_f32_16x16x32_bf16 a[228:231], v[68:71], a[96:99], a[228:231]
  v_mfma_f32_16x16x32_bf16 a[232:235], v[64:67], a[100:103], a[232:235]
  v_mfma_f32_16x16x32_bf16 a[236:239], v[68:71], a[100:103], a[236:239]
  v_mfma_f32_16x16x32_bf16 a[240:243], v[64:67], a[104:107], a[240:243]
  v_mfma_f32_16x16x32_bf16 a[244:247], v[68:71], a[104:107], a[244:247]
  v_mfma_f32_16x16x32_bf16 a[248:251], v[64:67], a[108:111], a[248:251]
  v_mfma_f32_16x16x32_bf16 a[252:255], v[68:71], a[108:111], a[252:255]
  s_nop 1
  v_accvgpr_read_b32 v32, a224
  v_accvgpr_read_b32 v33, a225
  v_accvgpr_read_b32 v34, a226
  v_accvgpr_read_b32 v35, a227
  v_accvgpr_read_b32 v36, a228
  v_accvgpr_read_b32 v37, a229
  v_accvgpr_read_b32 v38, a230
  v_accvgpr_read_b32 v39, a231
  v_cvt_pk_bf16_f32 v96, v32, v33
  v_cvt_pk_bf16_f32 v97, v34, v35
  v_cvt_pk_bf16_f32 v98, v36, v37
  v_cvt_pk_bf16_f32 v99, v38, v39
  s_nop 1
  v_permlane16_swap_b32 v96, v98
  v_permlane16_swap_b32 v97, v99
  global_store_dwordx4 v235, v[96:99], s[6:7] offset:0
  v_accvgpr_read_b32 v40, a232
  v_accvgpr_read_b32 v41, a233
  v_accvgpr_read_b32 v42, a234
  v_accvgpr_read_b32 v43, a235
  v_accvgpr_read_b32 v44, a236
  v_accvgpr_read_b32 v45, a237
  v_accvgpr_read_b32 v46, a238
  v_accvgpr_read_b32 v47, a239
  v_cvt_pk_bf16_f32 v100, v40, v41
  v_cvt_pk_bf16_f32 v101, v42, v43
  v_cvt_pk_bf16_f32 v102, v44, v45
  v_cvt_pk_bf16_f32 v103, v46, v47
  s_nop 1
  v_permlane16_swap_b32 v100, v102
  v_permlane16_swap_b32 v101, v103
  global_store_dwordx4 v251, v[100:103], s[6:7] offset:0
  v_accvgpr_read_b32 v48, a240
  v_accvgpr_read_b32 v49, a241
  v_accvgpr_read_b32 v50, a242
  v_accvgpr_read_b32 v51, a243
  v_accvgpr_read_b32 v52, a244
  v_accvgpr_read_b32 v53, a245
  v_accvgpr_read_b32 v54, a246
  v_accvgpr_read_b32 v55, a247
  v_cvt_pk_bf16_f32 v104, v48, v49
  v_cvt_pk_bf16_f32 v105, v50, v51
  v_cvt_pk_bf16_f32 v106, v52, v53
  v_cvt_pk_bf16_f32 v107, v54, v55
  s_nop 1
  v_permlane16_swap_b32 v104, v106
  v_permlane16_swap_b32 v105, v107
  global_store_dwordx4 v235, v[104:107], s[6:7] offset:64
  v_accvgpr_read_b32 v56, a248
  v_accvgpr_read_b32 v57, a249
  v_accvgpr_read_b32 v58, a250
  v_accvgpr_read_b32 v59, a251
  v_accvgpr_read_b32 v60, a252
  v_accvgpr_read_b32 v61, a253
  v_accvgpr_read_b32 v62, a254
  v_accvgpr_read_b32 v63, a255
  v_cvt_pk_bf16_f32 v108, v56, v57
  v_cvt_pk_bf16_f32 v109, v58, v59
  v_cvt_pk_bf16_f32 v110, v60, v61
  v_cvt_pk_bf16_f32 v111, v62, v63
  s_nop 1
  v_permlane16_swap_b32 v108, v110
  v_permlane16_swap_b32 v109, v111
  global_store_dwordx4 v251, v[108:111], s[6:7] offset:64
L_end1:
  s_endpgm
L_hs_slow:
  s_mov_b32 s96, 0
L_hs_spin:
  v_mov_b32 v239, 0
  global_load_dword v239, v239, s[0:1] sc1
  s_add_u32 s96, s96, 1
  s_waitcnt vmcnt(0)
  v_readfirstlane_b32 s69, v239
  s_cmp_gt_u32 s96, 400000
  s_cbranch_scc1 L_hs_ok
  s_cmp_lt_u32 s69, 32
  s_cbranch_scc1 L_hs_spin
  s_branch L_hs_ok
L_r0_1t:
  s_call_b64 s[96:97], L_rare_160
  s_branch L_r0_1
L_r0_2t:
  s_call_b64 s[96:97], L_rare_96
  s_branch L_r0_2
L_r0_3t:
  s_call_b64 s[96:97], L_rare_160
  s_branch L_r0_3
L_r0_4t:
  s_call_b64 s[96:97], L_rare_96
  s_branch L_r0_4
L_r0_5t:
  s_call_b64 s[96:97], L_rare_160
  s_branch L_r0_5
L_r0_6t:
  s_call_b64 s[96:97], L_rare_96
  s_branch L_r0_6
L_r0_7t:
  s_call_b64 s[96:97], L_rare_96
  s_branch L_r0_7
L_r1_1t:
  s_call_b64 s[96:97], L_rare_96
  s_branch L_r1_1
L_r1_2t:
  s_call_b64 s[96:97], L_rare_96
  s_branch L_r1_2
L_r1_3t:
  s_call_b64 s[96:97], L_rare_96
  s_branch L_r1_3
L_r1_4t:
  s_call_b64 s[96:97], L_rare_96
  s_branch L_r1_4
L_r1_5t:
  s_call_b64 s[96:97], L_rare_96
  s_branch L_r1_5
L_r1_6t:
  s_call_b64 s[96:97], L_rare_96
  s_branch L_r1_6
L_r1_7t:
  s_call_b64 s[96:97], L_rare_96
  s_branch L_r1_7
L_r2_1t:
  s_call_b64 s[96:97], L_rare_96
  s_branch L_r2_1
L_r2_2t:
  s_call_b64 s[96:97], L_rare_96
  s_branch L_r2_2
L_r2_3t:
  s_call_b64 s[96:97], L_rare_96
  s_branch L_r2_3
L_r2_4t:
  s_call_b64 s[96:97], L_rare_96
  s_branch L_r2_4
L_r2_5t:
  s_call_b64 s[96:97], L_rare_96
  s_branch L_r2_5
L_r2_6t:
  s_call_b64 s[96:97], L_rare_96
  s_branch L_r2_6
L_r2_7t:
  s_call_b64 s[96:97], L_rare_96
  s_branch L_r2_7
L_r3_1t:
  s_call_b64 s[96:97], L_rare_96
  s_branch L_r3_1
L_r3_2t:
  s_call_b64 s[96:97], L_rare_96
  s_branch L_r3_2
L_r3_3t:
  s_call_b64 s[96:97], L_rare_96
  s_branch L_r3_3
L_r3_4t:
  s_call_b64 s[96:97], L_rare_96
  s_branch L_r3_4
L_r3_5t:
  s_call_b64 s[96:97], L_rare_96
  s_branch L_r3_5
L_r3_6t:
  s_call_b64 s[96:97], L_rare_96
  s_branch L_r3_6
L_r3_7t:
  s_call_b64 s[96:97], L_rare_96
  s_branch L_r3_7
L_rare_96:
s_nop 15
v_max3_f32 v253, v96, v97, 0
v_max3_f32 v253, v253, v98, v99
v_max3_f32 v253, v253, v100, v101
v_max3_f32 v253, v253, v102, v103
v_max3_f32 v253, v253, v112, v113
v_max3_f32 v253, v253, v114, v115
v_max3_f32 v253, v253, v116, v117
v_max3_f32 v253, v253, v118, v119
v_mov_b32 v254, v253
s_nop 1
v_permlane32_swap_b32 v254, v253
s_nop 1
v_max_f32 v253, v253, v254
v_mov_b32 v254, v253
s_nop 1
v_permlane16_swap_b32 v254, v253
s_nop 1
v_max_f32 v253, v253, v254
v_exp_f32 v254, -v253
s_nop 0
v_sub_f32 v96, v96, v253
v_sub_f32 v97, v97, v253
v_sub_f32 v98, v98, v253
v_sub_f32 v99, v99, v253
v_sub_f32 v100, v100, v253
v_sub_f32 v101, v101, v253
v_sub_f32 v102, v102, v253
v_sub_f32 v103, v103, v253
v_sub_f32 v112, v112, v253
v_sub_f32 v113, v113, v253
v_sub_f32 v114, v114, v253
v_sub_f32 v115, v115, v253
v_sub_f32 v116, v116, v253
v_sub_f32 v117, v117, v253
v_sub_f32 v118, v118, v253
v_sub_f32 v119, v119, v253
v_sub_f32 v192, v192, v253
v_sub_f32 v193, v193, v253
v_sub_f32 v194, v194, v253
v_sub_f32 v195, v195, v253
v_mul_f32 v32, v254, v32
v_mul_f32 v33, v254, v33
v_mul_f32 v34, v254, v34
v_mul_f32 v35, v254, v35
v_mul_f32 v36, v254, v36
v_mul_f32 v37, v254, v37
v_mul_f32 v38, v254, v38
v_mul_f32 v39, v254, v39
v_mul_f32 v48, v254, v48
v_mul_f32 v49, v254, v49
v_mul_f32 v50, v254, v50
v_mul_f32 v51, v254, v51
v_mul_f32 v52, v254, v52
v_mul_f32 v53, v254, v53
v_mul_f32 v54, v254, v54
v_mul_f32 v55, v254, v55
v_mul_f32 v64, v254, v64
v_mul_f32 v65, v254, v65
v_mul_f32 v66, v254, v66
v_mul_f32 v67, v254, v67
v_mul_f32 v68, v254, v68
v_mul_f32 v69, v254, v69
v_mul_f32 v70, v254, v70
v_mul_f32 v71, v254, v71
v_mul_f32 v80, v254, v80
v_mul_f32 v81, v254, v81
v_mul_f32 v82, v254, v82
v_mul_f32 v83, v254, v83
v_mul_f32 v84, v254, v84
v_mul_f32 v85, v254, v85
v_mul_f32 v86, v254, v86
v_mul_f32 v87, v254, v87
v_mul_f32 v224, v254, v224
v_max3_f32 v253, v104, v105, 0
v_max3_f32 v253, v253, v106, v107
v_max3_f32 v253, v253, v108, v109
v_max3_f32 v253, v253, v110, v111
v_max3_f32 v253, v253, v120, v121
v_max3_f32 v253, v253, v122, v123
v_max3_f32 v253, v253, v124, v125
v_max3_f32 v253, v253, v126, v127
v_mov_b32 v254, v253
s_nop 1
v_permlane32_swap_b32 v254, v253
s_nop 1
v_max_f32 v253, v253, v254
v_mov_b32 v254, v253
s_nop 1
v_permlane16_swap_b32 v254, v253
s_nop 1
v_max_f32 v253, v253, v254
v_exp_f32 v254, -v253
s_nop 0
v_sub_f32 v104, v104, v253
v_sub_f32 v105, v105, v253
v_sub_f32 v106, v106, v253
v_sub_f32 v107, v107, v253
v_sub_f32 v108, v108, v253
v_sub_f32 v109, v109, v253
v_sub_f32 v110, v110, v253
v_sub_f32 v111, v111, v253
v_sub_f32 v120, v120, v253
v_sub_f32 v121, v121, v253
v_sub_f32 v122, v122, v253
v_sub_f32 v123, v123, v253
v_sub_f32 v124, v124, v253
v_sub_f32 v125, v125, v253
v_sub_f32 v126, v126, v253
v_sub_f32 v127, v127, v253
v_sub_f32 v196, v196, v253
v_sub_f32 v197, v197, v253
v_sub_f32 v198, v198, v253
v_sub_f32 v199, v199, v253
v_mul_f32 v40, v254, v40
v_mul_f32 v41, v254, v41
v_mul_f32 v42, v254, v42
v_mul_f32 v43, v254, v43
v_mul_f32 v44, v254, v44
v_mul_f32 v45, v254, v45
v_mul_f32 v46, v254, v46
v_mul_f32 v47, v254, v47
v_mul_f32 v56, v254, v56
v_mul_f32 v57, v254, v57
v_mul_f32 v58, v254, v58
v_mul_f32 v59, v254, v59
v_mul_f32 v60, v254, v60
v_mul_f32 v61, v254, v61
v_mul_f32 v62, v254, v62
v_mul_f32 v63, v254, v63
v_mul_f32 v72, v254, v72
v_mul_f32 v73, v254, v73
v_mul_f32 v74, v254, v74
v_mul_f32 v75, v254, v75
v_mul_f32 v76, v254, v76
v_mul_f32 v77, v254, v77
v_mul_f32 v78, v254, v78
v_mul_f32 v79, v254, v79
v_mul_f32 v88, v254, v88
v_mul_f32 v89, v254, v89
v_mul_f32 v90, v254, v90
v_mul_f32 v91, v254, v91
v_mul_f32 v92, v254, v92
v_mul_f32 v93, v254, v93
v_mul_f32 v94, v254, v94
v_mul_f32 v95, v254, v95
v_mul_f32 v228, v254, v228
s_nop 1
s_setpc_b64 s[96:97]
L_rare_160:
s_nop 15
v_max3_f32 v253, v160, v161, 0
v_max3_f32 v253, v253, v162, v163
v_max3_f32 v253, v253, v164, v165
v_max3_f32 v253, v253, v166, v167
v_max3_f32 v253, v253, v176, v177
v_max3_f32 v253, v253, v178, v179
v_max3_f32 v253, v253, v180, v181
v_max3_f32 v253, v253, v182, v183
v_mov_b32 v254, v253
s_nop 1
v_permlane32_swap_b32 v254, v253
s_nop 1
v_max_f32 v253, v253, v254
v_mov_b32 v254, v253
s_nop 1
v_permlane16_swap_b32 v254, v253
s_nop 1
v_max_f32 v253, v253, v254
v_exp_f32 v254, -v253
s_nop 0
v_sub_f32 v160, v160, v253
v_sub_f32 v161, v161, v253
v_sub_f32 v162, v162, v253
v_sub_f32 v163, v163, v253
v_sub_f32 v164, v164, v253
v_sub_f32 v165, v165, v253
v_sub_f32 v166, v166, v253
v_sub_f32 v167, v167, v253
v_sub_f32 v176, v176, v253
v_sub_f32 v177, v177, v253
v_sub_f32 v178, v178, v253
v_sub_f32 v179, v179, v253
v_sub_f32 v180, v180, v253
v_sub_f32 v181, v181, v253
v_sub_f32 v182, v182, v253
v_sub_f32 v183, v183, v253
v_sub_f32 v192, v192, v253
v_sub_f32 v193, v193, v253
v_sub_f32 v194, v194, v253
v_sub_f32 v195, v195, v253
v_mul_f32 v32, v254, v32
v_mul_f32 v33, v254, v33
v_mul_f32 v34, v254, v34
v_mul_f32 v35, v254, v35
v_mul_f32 v36, v254, v36
v_mul_f32 v37, v254, v37
v_mul_f32 v38, v254, v38
v_mul_f32 v39, v254, v39
v_mul_f32 v48, v254, v48
v_mul_f32 v49, v254, v49
v_mul_f32 v50, v254, v50
v_mul_f32 v51, v254, v51
v_mul_f32 v52, v254, v52
v_mul_f32 v53, v254, v53
v_mul_f32 v54, v254, v54
v_mul_f32 v55, v254, v55
v_mul_f32 v64, v254, v64
v_mul_f32 v65, v254, v65
v_mul_f32 v66, v254, v66
v_mul_f32 v67, v254, v67
v_mul_f32 v68, v254, v68
v_mul_f32 v69, v254, v69
v_mul_f32 v70, v254, v70
v_mul_f32 v71, v254, v71
v_mul_f32 v80, v254, v80
v_mul_f32 v81, v254, v81
v_mul_f32 v82, v254, v82
v_mul_f32 v83, v254, v83
v_mul_f32 v84, v254, v84
v_mul_f32 v85, v254, v85
v_mul_f32 v86, v254, v86
v_mul_f32 v87, v254, v87
v_mul_f32 v224, v254, v224
v_max3_f32 v253, v168, v169, 0
v_max3_f32 v253, v253, v170, v171
v_max3_f32 v253, v253, v172, v173
v_max3_f32 v253, v253, v174, v175
v_max3_f32 v253, v253, v184, v185
v_max3_f32 v253, v253, v186, v187
v_max3_f32 v253, v253, v188, v189
v_max3_f32 v253, v253, v190, v191
v_mov_b32 v254, v253
s_nop 1
v_permlane32_swap_b32 v254, v253
s_nop 1
v_max_f32 v253, v253, v254
v_mov_b32 v254, v253
s_nop 1
v_permlane16_swap_b32 v254, v253
s_nop 1
v_max_f32 v253, v253, v254
v_exp_f32 v254, -v253
s_nop 0
v_sub_f32 v168, v168, v253
v_sub_f32 v169, v169, v253
v_sub_f32 v170, v170, v253
v_sub_f32 v171, v171, v253
v_sub_f32 v172, v172, v253
v_sub_f32 v173, v173, v253
v_sub_f32 v174, v174, v253
v_sub_f32 v175, v175, v253
v_sub_f32 v184, v184, v253
v_sub_f32 v185, v185, v253
v_sub_f32 v186, v186, v253
v_sub_f32 v187, v187, v253
v_sub_f32 v188, v188, v253
v_sub_f32 v189, v189, v253
v_sub_f32 v190, v190, v253
v_sub_f32 v191, v191, v253
v_sub_f32 v196, v196, v253
v_sub_f32 v197, v197, v253
v_sub_f32 v198, v198, v253
v_sub_f32 v199, v199, v253
v_mul_f32 v40, v254, v40
v_mul_f32 v41, v254, v41
v_mul_f32 v42, v254, v42
v_mul_f32 v43, v254, v43
v_mul_f32 v44, v254, v44
v_mul_f32 v45, v254, v45
v_mul_f32 v46, v254, v46
v_mul_f32 v47, v254, v47
v_mul_f32 v56, v254, v56
v_mul_f32 v57, v254, v57
v_mul_f32 v58, v254, v58
v_mul_f32 v59, v254, v59
v_mul_f32 v60, v254, v60
v_mul_f32 v61, v254, v61
v_mul_f32 v62, v254, v62
v_mul_f32 v63, v254, v63
v_mul_f32 v72, v254, v72
v_mul_f32 v73, v254, v73
v_mul_f32 v74, v254, v74
v_mul_f32 v75, v254, v75
v_mul_f32 v76, v254, v76
v_mul_f32 v77, v254, v77
v_mul_f32 v78, v254, v78
v_mul_f32 v79, v254, v79
v_mul_f32 v88, v254, v88
v_mul_f32 v89, v254, v89
v_mul_f32 v90, v254, v90
v_mul_f32 v91, v254, v91
v_mul_f32 v92, v254, v92
v_mul_f32 v93, v254, v93
v_mul_f32 v94, v254, v94
v_mul_f32 v95, v254, v95
v_mul_f32 v228, v254, v228
s_nop 1
s_setpc_b64 s[96:97]
.section .rodata,"a"
.p2align 6
.amdhsa_kernel concat_heads__mha_block_cached__mha_block_cached__near_ridge_kernel
  .amdhsa_next_free_vgpr 512
  .amdhsa_next_free_sgpr 102
  .amdhsa_accum_offset 256
  .amdhsa_group_segment_fixed_size 0
  .amdhsa_kernarg_size 104
  .amdhsa_user_sgpr_count 2
  .amdhsa_user_sgpr_kernarg_segment_ptr 1
  .amdhsa_system_sgpr_workgroup_id_x 1
.end_amdhsa_kernel
```
